```python
import torch

def _softmax(x, axis=-1):
    return torch.softmax(x, dim=axis)
def _gelu(x):
    return torch.nn.functional.gelu(x, approximate="tanh")
def _silu(x):
    return torch.nn.functional.silu(x)
def _sigmoid(x):
    return torch.sigmoid(x)
def _layernorm(x, axis=-1, eps=1e-5):
    m = x.mean(dim=axis, keepdim=True)
    v = x.var(dim=axis, keepdim=True, unbiased=False)
    return (x - m) / torch.sqrt(v + eps)
def _scatter_add(tgt, idx, src, axis=0):
    return tgt.clone().index_add_(axis, idx, src)
def _segment_sum(src, seg, n):
    out = torch.zeros((n,) + src.shape[1:], dtype=src.dtype)
    return out.index_add_(0, seg, src)
def _pad(x, pw):
    flat = tuple(v for pair in reversed(pw) for v in pair)
    return torch.nn.functional.pad(x, flat)

kernel_name = 'gated_mix__spectral_fnet__swiglu_ffn__prompt'

def setup_inputs():

    _w = (lambda a: (lambda t: t.to(torch.bfloat16) if t.is_floating_point() else t)(torch.as_tensor(a)))
    def _A_setup():
        B, S, D = 1, 2048, 576
        ns = torch.arange(S)[:, None] * torch.arange(S)[None, :]
        nd = torch.arange(D)[:, None] * torch.arange(D)[None, :]
        Ws_re = torch.cos(-2.0 * torch.pi * ns / S).to(float)
        Ws_im = torch.sin(-2.0 * torch.pi * ns / S).to(float)
        Wd_re = torch.cos(-2.0 * torch.pi * nd / D).to(float)
        Wd_im = torch.sin(-2.0 * torch.pi * nd / D).to(float)
        return {
            "x": _w((lambda *s: torch.randn(*s, dtype=torch.bfloat16) * 0.05)(B, S, D)),
            "dft_seq_re": _w(Ws_re),
            "dft_seq_im": _w(Ws_im),
            "dft_hid_re": _w(Wd_re),
            "dft_hid_im": _w(Wd_im),
        }
    _A_in = _A_setup()

    def _B_setup():
        B, S, D, F = 1, 2048, 576, 4608
        return {
            "x": _w((lambda *s: torch.randn(*s, dtype=torch.bfloat16) * 0.05)(B, S, D)),
            "w_gate": _w((lambda *s: torch.randn(*s, dtype=torch.bfloat16) * 0.8)(D, F)),
            "w_up": _w((lambda *s: torch.randn(*s, dtype=torch.bfloat16) * 0.8)(D, F)),
            "w_down": _w((lambda *s: torch.randn(*s, dtype=torch.bfloat16) * 0.8)(F, D)),
        }
    _B_in = _B_setup()

    return {
        "A_x": _A_in["x"],
        "A_dft_seq_re": _A_in["dft_seq_re"],
        "A_dft_seq_im": _A_in["dft_seq_im"],
        "A_dft_hid_re": _A_in["dft_hid_re"],
        "A_dft_hid_im": _A_in["dft_hid_im"],
        "B_x": _B_in["x"],
        "B_w_gate": _B_in["w_gate"],
        "B_w_up": _B_in["w_up"],
        "B_w_down": _B_in["w_down"],
        "gate_w": _w((lambda *s: torch.randn(*s, dtype=torch.bfloat16) * 0.05)(576) * 16.0),
    }

def reference(A_x, A_dft_seq_re, A_dft_seq_im, A_dft_hid_re, A_dft_hid_im, B_x, B_w_gate, B_w_up, B_w_down, gate_w):
    def _A_ref(x, dft_seq_re, dft_seq_im, dft_hid_re, dft_hid_im):
        a = torch.einsum("bsd,ed->bse", x, dft_hid_re)
        b = torch.einsum("bsd,ed->bse", x, dft_hid_im)
        y = torch.einsum("ts,bse->bte", dft_seq_re, a) - torch.einsum("ts,bse->bte", dft_seq_im, b)
        return y

    def _B_ref(x, w_gate, w_up, w_down):
        g = _silu(x @ w_gate)
        u = x @ w_up
        return (g * u) @ w_down

    x = A_x
    g = _sigmoid((x * gate_w).sum(-1, keepdims=True))
    a = _A_ref(x, A_dft_seq_re, A_dft_seq_im, A_dft_hid_re, A_dft_hid_im)
    b = _B_ref(x, B_w_gate, B_w_up, B_w_down)
    return g * a + (1 - g) * b
```

```asm
; @launch grid=(256,1,1) block=(256,1,1) lds=163840
.amdgcn_target "amdgcn-amd-amdhsa--gfx950"
.text
.globl gated_mix__spectral_fnet__swiglu_ffn__prompt_kernel
.p2align 8
.type gated_mix__spectral_fnet__swiglu_ffn__prompt_kernel,@function
gated_mix__spectral_fnet__swiglu_ffn__prompt_kernel:
  s_cmp_ge_u32 s2, 256
  s_cbranch_scc1 gated_mix__spectral_fnet__swiglu_ffn__prompt_kernel_end
  s_load_dwordx2 s[4:5], s[0:1], 0
  s_load_dwordx4 s[8:11], s[0:1], 48
  s_load_dwordx4 s[36:39], s[0:1], 24
  s_load_dwordx2 s[16:17], s[0:1], 96
  s_load_dwordx2 s[28:29], s[0:1], 64
  s_load_dwordx2 s[30:31], s[0:1], 8
  s_load_dwordx2 s[70:71], s[0:1], 16
  s_load_dwordx2 s[100:101], s[0:1], 88
  v_lshlrev_b32 v39, 7, v0
  s_getpc_b64 s[66:67]
.Lpf1:
  v_min_u32 v35, gated_mix__spectral_fnet__swiglu_ffn__prompt_kernel_p2-.Lpf1-4, v39
  global_load_dword v34, v35, s[66:67]
  v_lshrrev_b32 v1, 6, v0
  v_and_b32 v0, 63, v0
  s_and_b32 s68, s2, 7
  s_lshr_b32 s64, s2, 3
  v_readfirstlane_b32 s40, v1
  s_and_b32 s65, s68, 1
  s_lshr_b32 s66, s68, 1
  s_lshr_b32 s35, s64, 3
  s_lshl_b32 s65, s65, 2
  s_add_u32 s41, s65, s35
  s_and_b32 s69, s64, 7
  s_lshl_b32 s66, s66, 3
  s_add_u32 s42, s66, s69
  s_lshr_b32 s43, s42, 2
  s_and_b32 s44, s42, 3
  s_lshl_b32 s63, s35, 1
  s_add_u32 s63, s63, s69
  s_sub_u32 s64, s63, 9
  s_cmp_ge_u32 s63, 9
  s_cselect_b32 s63, s64, s63
  s_mov_b32 s66, 0x76543210
  s_mov_b32 s67, 0x65432108
  s_lshl_b32 s64, s63, 2
  s_lshr_b64 s[66:67], s[66:67], s64
  s_mov_b32 s59, s66
  s_sub_u32 s64, s63, 1
  s_cmp_eq_u32 s63, 0
  s_cselect_b32 s3, 8, s64
  s_mul_i32 s63, s43, 1152
  s_lshl_b32 s64, s44, 8
  s_add_u32 s47, s63, s64
  s_and_b32 s63, s40, 1
  s_lshr_b32 s64, s40, 1
  s_lshl_b32 s65, s41, 7
  s_lshl_b32 s66, s63, 6
  s_add_u32 s65, s65, s66
  s_add_u32 s45, s65, s64
  s_lshl_b32 s48, s40, 11
  s_lshl_b32 s33, s40, 14
  s_add_u32 s33, s33, 98304
  v_lshrrev_b32 v31, 3, v0
  s_lshl_b32 s63, s40, 3
  v_add_u32 v32, s63, v31
  v_and_b32 v33, 12, v32
  v_lshlrev_b32 v33, 1, v33
  v_lshrrev_b32 v28, 4, v32
  v_lshl_add_u32 v33, v28, 2, v33
  v_and_b32 v28, 3, v32
  v_add_u32 v33, v33, v28
  v_mul_u32_u24 v33, 9216, v33
  v_bfe_u32 v28, v0, 1, 2
  v_bfe_u32 v29, v31, 1, 2
  v_xor_b32 v28, v28, v29
  v_lshlrev_b32 v28, 5, v28
  v_and_b32 v29, 1, v0
  v_lshl_add_u32 v28, v29, 4, v28
  v_add_u32 v11, v33, v28
  v_and_b32 v32, 7, v0
  v_lshrrev_b32 v33, 1, v31
  v_xor_b32 v33, v33, v32
  v_lshlrev_b32 v33, 4, v33
  v_lshlrev_b32 v28, 1, v31
  v_add_u32 v28, s45, v28
  v_mul_u32_u24 v29, 1152, v28
  v_add_u32 v32, v29, v33
  v_xor_b32 v30, 64, v33
  v_add_u32 v30, v29, v30
  v_mov_b32 v18, v32
  v_add_u32 v19, 17408, v30
  v_add_u32 v20, 34816, v32
  v_add_u32 v21, 52224, v30
  v_sub_u32 v29, 2359296, v29
  v_add_u32 v32, v29, v33
  v_xor_b32 v30, 64, v33
  v_add_u32 v30, v29, v30
  v_cmp_eq_u32 vcc, 0, v28
  v_subrev_u32 v29, 1179648, v32
  s_nop 0
  v_cndmask_b32 v22, v32, v29, vcc
  v_subrev_u32 v23, 19456, v30
  v_subrev_u32 v24, 38912, v32
  v_subrev_u32 v25, 58368, v30
  s_waitcnt lgkmcnt(0)
  s_mov_b32 s6, 2359296
  s_mov_b32 s7, 0x20000
  s_mov_b32 s12, s10
  s_mov_b32 s13, s11
  s_mov_b32 s10, 5308416
  s_mov_b32 s11, 0x20000
  s_bitcmp1_b32 s40, 0
  s_cselect_b32 s24, s38, s36
  s_cselect_b32 s25, s39, s37
  s_cselect_b32 s20, s12, s8
  s_cselect_b32 s21, s13, s9
  s_sub_u32 s12, s12, 1024
  s_subb_u32 s13, s13, 0
  s_mov_b32 s14, 5309440
  s_mov_b32 s15, 0x20000
  s_bfe_u32 s49, s59, 0x40000
  s_mul_i32 s49, s49, 589824
  s_add_u32 s49, s49, s47
  s_add_u32 m0, s48, 0
  s_add_u32 s49, s49, 0
  buffer_load_dwordx4 v11, s[8:11], s49 offen lds
  buffer_load_dwordx4 v11, s[12:15], s49 offen offset:1024 lds
  s_bfe_u32 s49, s59, 0x40000
  s_mul_i32 s49, s49, 589824
  s_add_u32 s49, s49, s47
  s_add_u32 m0, s48, 8192
  s_add_u32 s49, s49, 294912
  buffer_load_dwordx4 v11, s[8:11], s49 offen lds
  buffer_load_dwordx4 v11, s[12:15], s49 offen offset:1024 lds
  s_bfe_u32 s32, s59, 0x40000
  s_lshl_b32 s32, s32, 7
  s_add_u32 m0, s33, 0
  s_nop 0
  buffer_load_dwordx4 v18, s[4:7], s32 offen lds
  buffer_load_dwordx4 v19, s[4:7], s32 offen offset:1024 lds
  buffer_load_dwordx4 v20, s[4:7], s32 offen offset:2048 lds
  buffer_load_dwordx4 v21, s[4:7], s32 offen offset:3072 lds
  s_add_u32 m0, s33, 4096
  s_nop 0
  buffer_load_dwordx4 v22, s[4:7], s32 offen lds
  buffer_load_dwordx4 v23, s[4:7], s32 offen offset:1024 lds
  buffer_load_dwordx4 v24, s[4:7], s32 offen offset:2048 lds
  buffer_load_dwordx4 v25, s[4:7], s32 offen offset:3072 lds
  s_bfe_u32 s49, s59, 0x40004
  s_mul_i32 s49, s49, 589824
  s_add_u32 s49, s49, s47
  s_add_u32 m0, s48, 16384
  s_add_u32 s49, s49, 0
  buffer_load_dwordx4 v11, s[8:11], s49 offen lds
  buffer_load_dwordx4 v11, s[12:15], s49 offen offset:1024 lds
  s_bfe_u32 s49, s59, 0x40004
  s_mul_i32 s49, s49, 589824
  s_add_u32 s49, s49, s47
  s_add_u32 m0, s48, 24576
  s_add_u32 s49, s49, 294912
  buffer_load_dwordx4 v11, s[8:11], s49 offen lds
  buffer_load_dwordx4 v11, s[12:15], s49 offen offset:1024 lds
  s_bfe_u32 s32, s59, 0x40004
  s_lshl_b32 s32, s32, 7
  s_add_u32 m0, s33, 8192
  s_nop 0
  buffer_load_dwordx4 v18, s[4:7], s32 offen lds
  buffer_load_dwordx4 v19, s[4:7], s32 offen offset:1024 lds
  buffer_load_dwordx4 v20, s[4:7], s32 offen offset:2048 lds
  buffer_load_dwordx4 v21, s[4:7], s32 offen offset:3072 lds
  s_add_u32 m0, s33, 12288
  s_nop 0
  buffer_load_dwordx4 v22, s[4:7], s32 offen lds
  buffer_load_dwordx4 v23, s[4:7], s32 offen offset:1024 lds
  buffer_load_dwordx4 v24, s[4:7], s32 offen offset:2048 lds
  buffer_load_dwordx4 v25, s[4:7], s32 offen offset:3072 lds
  v_and_b32 v26, 15, v0
  v_lshrrev_b32 v27, 4, v0
  v_lshlrev_b32 v14, 4, v0
  v_lshrrev_b32 v28, 1, v26
  v_add_u32 v29, 0, v27
  v_xor_b32 v29, v29, v28
  v_lshlrev_b32 v29, 4, v29
  v_lshl_add_u32 v29, v26, 7, v29
  v_add_u32 v2, s33, v29
  v_add_u32 v4, 98304, v29
  v_add_u32 v29, 4, v27
  v_xor_b32 v29, v29, v28
  v_lshlrev_b32 v29, 4, v29
  v_lshl_add_u32 v29, v26, 7, v29
  v_add_u32 v3, s33, v29
  v_add_u32 v5, 98304, v29
  v_lshrrev_b32 v31, 2, v26
  v_and_b32 v32, 3, v0
  v_and_b32 v28, 1, v27
  v_lshl_add_u32 v33, v28, 2, v31
  v_lshrrev_b32 v28, 1, v27
  v_lshlrev_b32 v28, 11, v28
  v_lshl_add_u32 v28, v33, 7, v28
  v_lshl_add_u32 v28, v32, 3, v28
  v_bfe_u32 v29, v33, 1, 2
  v_xor_b32 v30, 0, v29
  v_lshl_add_u32 v6, v30, 5, v28
  v_xor_b32 v30, 1, v29
  v_lshl_add_u32 v7, v30, 5, v28
  v_xor_b32 v30, 2, v29
  v_lshl_add_u32 v8, v30, 5, v28
  v_xor_b32 v30, 3, v29
  v_lshl_add_u32 v9, v30, 5, v28
  v_lshl_add_u32 v28, v27, 2, v31
  v_lshlrev_b32 v28, 5, v28
  v_lshl_add_u32 v10, v32, 3, v28
  v_lshrrev_b32 v28, 1, v27
  v_lshl_add_u32 v28, v28, 4, v26
  v_lshlrev_b32 v28, 4, v28
  v_and_b32 v29, 1, v27
  v_lshl_add_u32 v15, v29, 3, v28
  v_lshrrev_b32 v32, 1, v0
  v_and_b32 v33, 12, v32
  v_lshlrev_b32 v33, 1, v33
  v_lshrrev_b32 v28, 4, v32
  v_lshl_add_u32 v33, v28, 2, v33
  v_and_b32 v28, 3, v32
  v_add_u32 v33, v33, v28
  v_and_b32 v29, 1, v0
  v_lshlrev_b32 v29, 4, v29
  v_mul_u32_u24 v12, 9216, v33
  v_add_u32 v12, v12, v29
  s_lshr_b32 s67, s40, 1
  s_lshl_b32 s66, s67, 3
  s_lshl_b32 s65, s42, 4
  s_add_u32 s66, s66, s65
  v_lshrrev_b32 v33, 3, v0
  v_add_u32 v32, s66, v33
  v_mul_u32_u24 v32, 1152, v32
  v_lshrrev_b32 v33, 1, v33
  s_lshl_b32 s66, s67, 2
  v_add_u32 v33, s66, v33
  v_and_b32 v28, 7, v0
  v_xor_b32 v33, v33, v28
  v_lshl_add_u32 v13, v33, 4, v32
  s_and_b32 s66, s40, 1
  s_mul_i32 s66, s66, 18432
  s_lshl_b32 s65, s67, 10
  s_add_u32 s66, s66, s65
  s_add_u32 s34, s66, 98304
  s_mov_b32 s46, 0xbfb8aa3b
  s_lshl_b32 s60, s40, 10
  s_mul_i32 s63, s43, 1152
  s_mul_i32 s66, s67, 294912
  s_lshl_b32 s64, s44, 5
  s_add_u32 s58, s63, s64
  s_add_u32 s58, s58, 1024
  s_add_u32 s58, s58, s66
  s_lshl_b32 s63, s41, 4
  s_lshl_b32 s64, s40, 2
  s_add_u32 s63, s63, s64
  s_mul_i32 s64, s63, 144
  s_mul_i32 s66, s43, 18
  s_add_u32 s64, s64, s66
  s_lshl_b32 s66, s44, 2
  s_add_u32 s66, s66, s64
  s_lshl_b32 s50, s66, 10
  s_lshr_b32 s66, s44, 1
  s_add_u32 s66, s66, 16
  s_add_u32 s66, s66, s64
  s_lshl_b32 s66, s66, 10
  s_and_b32 s67, s44, 1
  s_lshl_b32 s67, s67, 9
  s_add_u32 s54, s66, s67
  s_add_u32 s51, s50, 147456
  s_add_u32 s55, s54, 147456
  s_add_u32 s52, s51, 147456
  s_add_u32 s56, s55, 147456
  s_add_u32 s53, s52, 147456
  s_add_u32 s57, s56, 147456
  s_lshr_b32 s63, s40, 1
  s_lshl_b32 s63, s63, 4
  s_lshl_b32 s64, s41, 1
  s_add_u32 s63, s63, s64
  s_and_b32 s64, s40, 1
  s_add_u32 s63, s63, s64
  s_mul_i32 s63, s63, 36864
  s_add_u32 s61, s63, 18874368
  s_add_u32 s62, s61, 1179648
  s_mov_b32 s18, 33333248
  s_mov_b32 s19, 0x20000
  s_mov_b32 s22, 5308416
  s_mov_b32 s23, 0x20000
  s_mov_b32 s26, 663552
  s_mov_b32 s27, 0x20000
  s_lshl_b32 s63, s2, 7
  s_add_u32 s63, s63, 33300480
  v_and_b32 v28, 31, v0
  v_lshlrev_b32 v28, 2, v28
  v_mov_b32 v29, 0
  buffer_store_dword v29, v28, s[16:19], s63 offen sc1
  s_waitcnt vmcnt(21)
  s_barrier
  ds_read_b64_tr_b16 v[72:73], v6 offset:0
  ds_read_b64_tr_b16 v[74:75], v6 offset:4096
  ds_read_b64_tr_b16 v[76:77], v6 offset:1024
  ds_read_b64_tr_b16 v[78:79], v6 offset:5120
  ds_read_b64_tr_b16 v[80:81], v7 offset:0
  ds_read_b64_tr_b16 v[82:83], v7 offset:4096
  ds_read_b64_tr_b16 v[84:85], v7 offset:1024
  ds_read_b64_tr_b16 v[86:87], v7 offset:5120
  s_waitcnt vmcnt(13)
  ds_read_b128 a[0:3], v2 offset:0
  ds_read_b128 a[4:7], v2 offset:2048
  ds_read_b128 a[8:11], v2 offset:4096
  ds_read_b128 a[12:15], v2 offset:6144
  ds_read_b128 a[16:19], v3 offset:0
  ds_read_b128 a[20:23], v3 offset:2048
  ds_read_b128 a[24:27], v3 offset:4096
  s_waitcnt lgkmcnt(14)
  ds_read_b128 a[28:31], v3 offset:6144
  s_waitcnt lgkmcnt(12)
  s_waitcnt lgkmcnt(7)
  v_mfma_f32_16x16x32_bf16 v[96:99], v[72:75], a[0:3], 0
  s_waitcnt lgkmcnt(6)
  ds_read_b64_tr_b16 v[88:89], v8 offset:0
  s_bfe_u32 s49, s59, 0x40008
  v_mfma_f32_16x16x32_bf16 v[100:103], v[72:75], a[4:7], 0
  s_waitcnt lgkmcnt(6)
  ds_read_b64_tr_b16 v[90:91], v8 offset:4096
  s_mul_i32 s49, s49, 589824
  v_mfma_f32_16x16x32_bf16 v[104:107], v[72:75], a[8:11], 0
  s_waitcnt lgkmcnt(6)
  ds_read_b64_tr_b16 v[92:93], v8 offset:1024
  s_add_u32 s49, s49, s47
  v_mfma_f32_16x16x32_bf16 v[108:111], v[72:75], a[12:15], 0
  s_add_u32 m0, s48, 32768
  ds_read_b64_tr_b16 v[94:95], v8 offset:5120
  s_add_u32 s49, s49, 0
  v_mfma_f32_16x16x32_bf16 v[112:115], v[76:79], a[0:3], 0
  buffer_load_dwordx4 v11, s[8:11], s49 offen lds
  v_mfma_f32_16x16x32_bf16 v[116:119], v[76:79], a[4:7], 0
  buffer_load_dwordx4 v11, s[12:15], s49 offen offset:1024 lds
  v_mfma_f32_16x16x32_bf16 v[120:123], v[76:79], a[8:11], 0
  v_mfma_f32_16x16x32_bf16 v[124:127], v[76:79], a[12:15], 0
  s_bfe_u32 s49, s59, 0x40008
  s_mul_i32 s49, s49, 589824
  s_add_u32 s49, s49, s47
  v_mfma_f32_16x16x32_bf16 v[128:131], v[80:83], a[0:3], 0
  s_add_u32 m0, s48, 40960
  ds_read_b64_tr_b16 v[72:73], v9 offset:0
  s_add_u32 s49, s49, 294912
  v_mfma_f32_16x16x32_bf16 v[132:135], v[80:83], a[4:7], 0
  buffer_load_dwordx4 v11, s[8:11], s49 offen lds
  v_mfma_f32_16x16x32_bf16 v[136:139], v[80:83], a[8:11], 0
  buffer_load_dwordx4 v11, s[12:15], s49 offen offset:1024 lds
  v_mfma_f32_16x16x32_bf16 v[140:143], v[80:83], a[12:15], 0
  ds_read_b64_tr_b16 v[74:75], v9 offset:4096
  ds_read_b64_tr_b16 v[76:77], v9 offset:1024
  v_mfma_f32_16x16x32_bf16 v[144:147], v[84:87], a[0:3], 0
  ds_read_b64_tr_b16 v[78:79], v9 offset:5120
  v_mfma_f32_16x16x32_bf16 v[148:151], v[84:87], a[4:7], 0
  v_mfma_f32_16x16x32_bf16 v[152:155], v[84:87], a[8:11], 0
  v_mfma_f32_16x16x32_bf16 v[156:159], v[84:87], a[12:15], 0
  s_waitcnt lgkmcnt(4)
  v_mfma_f32_16x16x32_bf16 v[160:163], v[88:91], a[0:3], 0
  ds_read_b64_tr_b16 v[80:81], v6 offset:8192
  ds_read_b64_tr_b16 v[82:83], v6 offset:12288
  v_mfma_f32_16x16x32_bf16 v[164:167], v[88:91], a[4:7], 0
  ds_read_b64_tr_b16 v[84:85], v6 offset:9216
  ds_read_b64_tr_b16 v[86:87], v6 offset:13312
  v_mfma_f32_16x16x32_bf16 v[168:171], v[88:91], a[8:11], 0
  s_bfe_u32 s32, s59, 0x40008
  s_lshl_b32 s32, s32, 7
  s_add_u32 m0, s33, 0
  v_mfma_f32_16x16x32_bf16 v[172:175], v[88:91], a[12:15], 0
  s_nop 0
  buffer_load_dwordx4 v18, s[4:7], s32 offen lds
  v_mfma_f32_16x16x32_bf16 v[176:179], v[92:95], a[0:3], 0
  v_mfma_f32_16x16x32_bf16 v[180:183], v[92:95], a[4:7], 0
  buffer_load_dwordx4 v19, s[4:7], s32 offen offset:1024 lds
  v_mfma_f32_16x16x32_bf16 v[184:187], v[92:95], a[8:11], 0
  v_mfma_f32_16x16x32_bf16 v[188:191], v[92:95], a[12:15], 0
  s_waitcnt lgkmcnt(4)
  v_mfma_f32_16x16x32_bf16 v[192:195], v[72:75], a[0:3], 0
  ds_read_b64_tr_b16 v[88:89], v7 offset:8192
  ds_read_b64_tr_b16 v[90:91], v7 offset:12288
  v_mfma_f32_16x16x32_bf16 v[196:199], v[72:75], a[4:7], 0
  buffer_load_dwordx4 v20, s[4:7], s32 offen offset:2048 lds
  v_mfma_f32_16x16x32_bf16 v[200:203], v[72:75], a[8:11], 0
  ds_read_b64_tr_b16 v[92:93], v7 offset:9216
  ds_read_b64_tr_b16 v[94:95], v7 offset:13312
  v_mfma_f32_16x16x32_bf16 v[204:207], v[72:75], a[12:15], 0
  v_mfma_f32_16x16x32_bf16 v[208:211], v[76:79], a[0:3], 0
  buffer_load_dwordx4 v21, s[4:7], s32 offen offset:3072 lds
  v_mfma_f32_16x16x32_bf16 v[212:215], v[76:79], a[4:7], 0
  v_mfma_f32_16x16x32_bf16 v[216:219], v[76:79], a[8:11], 0
  v_mfma_f32_16x16x32_bf16 v[220:223], v[76:79], a[12:15], 0
  s_waitcnt lgkmcnt(4)
  v_mfma_f32_16x16x32_bf16 v[96:99], v[80:83], a[16:19], v[96:99]
  s_add_u32 m0, s33, 4096
  s_nop 0
  buffer_load_dwordx4 v22, s[4:7], s32 offen lds
  v_mfma_f32_16x16x32_bf16 v[100:103], v[80:83], a[20:23], v[100:103]
  ds_read_b64_tr_b16 v[72:73], v8 offset:8192
  ds_read_b64_tr_b16 v[74:75], v8 offset:12288
  v_mfma_f32_16x16x32_bf16 v[104:107], v[80:83], a[24:27], v[104:107]
  ds_read_b64_tr_b16 v[76:77], v8 offset:9216
  ds_read_b64_tr_b16 v[78:79], v8 offset:13312
  v_mfma_f32_16x16x32_bf16 v[108:111], v[80:83], a[28:31], v[108:111]
  buffer_load_dwordx4 v23, s[4:7], s32 offen offset:1024 lds
  v_mfma_f32_16x16x32_bf16 v[112:115], v[84:87], a[16:19], v[112:115]
  v_mfma_f32_16x16x32_bf16 v[116:119], v[84:87], a[20:23], v[116:119]
  v_mfma_f32_16x16x32_bf16 v[120:123], v[84:87], a[24:27], v[120:123]
  v_mfma_f32_16x16x32_bf16 v[124:127], v[84:87], a[28:31], v[124:127]
  s_waitcnt lgkmcnt(4)
  buffer_load_dwordx4 v24, s[4:7], s32 offen offset:2048 lds
  v_mfma_f32_16x16x32_bf16 v[128:131], v[88:91], a[16:19], v[128:131]
  ds_read_b64_tr_b16 v[80:81], v9 offset:8192
  ds_read_b64_tr_b16 v[82:83], v9 offset:12288
  v_mfma_f32_16x16x32_bf16 v[132:135], v[88:91], a[20:23], v[132:135]
  ds_read_b64_tr_b16 v[84:85], v9 offset:9216
  ds_read_b64_tr_b16 v[86:87], v9 offset:13312
  v_mfma_f32_16x16x32_bf16 v[136:139], v[88:91], a[24:27], v[136:139]
  buffer_load_dwordx4 v25, s[4:7], s32 offen offset:3072 lds
  v_mfma_f32_16x16x32_bf16 v[140:143], v[88:91], a[28:31], v[140:143]
  s_waitcnt vmcnt(13)
  ds_read_b128 a[32:35], v2 offset:8192
  ds_read_b128 a[36:39], v2 offset:10240
  v_mfma_f32_16x16x32_bf16 v[144:147], v[92:95], a[16:19], v[144:147]
  ds_read_b128 a[40:43], v2 offset:12288
  ds_read_b128 a[44:47], v2 offset:14336
  v_mfma_f32_16x16x32_bf16 v[148:151], v[92:95], a[20:23], v[148:151]
  ds_read_b128 a[48:51], v3 offset:8192
  ds_read_b128 a[52:55], v3 offset:10240
  v_mfma_f32_16x16x32_bf16 v[152:155], v[92:95], a[24:27], v[152:155]
  ds_read_b128 a[56:59], v3 offset:12288
  s_waitcnt lgkmcnt(14)
  ds_read_b128 a[60:63], v3 offset:14336
  v_mfma_f32_16x16x32_bf16 v[156:159], v[92:95], a[28:31], v[156:159]
  s_bfe_u32 s49, s59, 0x4000c
  s_mul_i32 s49, s49, 589824
  s_add_u32 s49, s49, s47
  s_barrier
  s_waitcnt lgkmcnt(12)
  v_mfma_f32_16x16x32_bf16 v[160:163], v[72:75], a[16:19], v[160:163]
  s_add_u32 m0, s48, 49152
  ds_read_b64_tr_b16 v[88:89], v6 offset:16384
  s_add_u32 s49, s49, 0
  v_mfma_f32_16x16x32_bf16 v[164:167], v[72:75], a[20:23], v[164:167]
  buffer_load_dwordx4 v11, s[8:11], s49 offen lds
  v_mfma_f32_16x16x32_bf16 v[168:171], v[72:75], a[24:27], v[168:171]
  buffer_load_dwordx4 v11, s[12:15], s49 offen offset:1024 lds
  v_mfma_f32_16x16x32_bf16 v[172:175], v[72:75], a[28:31], v[172:175]
  s_bfe_u32 s49, s59, 0x4000c
  ds_read_b64_tr_b16 v[90:91], v6 offset:20480
  s_mul_i32 s49, s49, 589824
  v_mfma_f32_16x16x32_bf16 v[176:179], v[76:79], a[16:19], v[176:179]
  s_add_u32 s49, s49, s47
  ds_read_b64_tr_b16 v[92:93], v6 offset:17408
  s_add_u32 m0, s48, 57344
  v_mfma_f32_16x16x32_bf16 v[180:183], v[76:79], a[20:23], v[180:183]
  s_add_u32 s49, s49, 294912
  buffer_load_dwordx4 v11, s[8:11], s49 offen lds
  v_mfma_f32_16x16x32_bf16 v[184:187], v[76:79], a[24:27], v[184:187]
  buffer_load_dwordx4 v11, s[12:15], s49 offen offset:1024 lds
  v_mfma_f32_16x16x32_bf16 v[188:191], v[76:79], a[28:31], v[188:191]
  s_waitcnt lgkmcnt(11)
  ds_read_b64_tr_b16 v[94:95], v6 offset:21504
  v_mfma_f32_16x16x32_bf16 v[192:195], v[80:83], a[16:19], v[192:195]
  ds_read_b64_tr_b16 v[72:73], v7 offset:16384
  ds_read_b64_tr_b16 v[74:75], v7 offset:20480
  v_mfma_f32_16x16x32_bf16 v[196:199], v[80:83], a[20:23], v[196:199]
  ds_read_b64_tr_b16 v[76:77], v7 offset:17408
  s_waitcnt lgkmcnt(14)
  ds_read_b64_tr_b16 v[78:79], v7 offset:21504
  v_mfma_f32_16x16x32_bf16 v[200:203], v[80:83], a[24:27], v[200:203]
  s_waitcnt lgkmcnt(8)
  s_bfe_u32 s32, s59, 0x4000c
  s_lshl_b32 s32, s32, 7
  v_mfma_f32_16x16x32_bf16 v[204:207], v[80:83], a[28:31], v[204:207]
  s_add_u32 m0, s33, 8192
  s_nop 0
  v_mfma_f32_16x16x32_bf16 v[208:211], v[84:87], a[16:19], v[208:211]
  buffer_load_dwordx4 v18, s[4:7], s32 offen lds
  v_mfma_f32_16x16x32_bf16 v[212:215], v[84:87], a[20:23], v[212:215]
  buffer_load_dwordx4 v19, s[4:7], s32 offen offset:1024 lds
  v_mfma_f32_16x16x32_bf16 v[216:219], v[84:87], a[24:27], v[216:219]
  v_mfma_f32_16x16x32_bf16 v[220:223], v[84:87], a[28:31], v[220:223]
  s_waitcnt lgkmcnt(4)
  v_mfma_f32_16x16x32_bf16 v[96:99], v[88:91], a[32:35], v[96:99]
  ds_read_b64_tr_b16 v[80:81], v8 offset:16384
  ds_read_b64_tr_b16 v[82:83], v8 offset:20480
  v_mfma_f32_16x16x32_bf16 v[100:103], v[88:91], a[36:39], v[100:103]
  buffer_load_dwordx4 v20, s[4:7], s32 offen offset:2048 lds
  v_mfma_f32_16x16x32_bf16 v[104:107], v[88:91], a[40:43], v[104:107]
  ds_read_b64_tr_b16 v[84:85], v8 offset:17408
  ds_read_b64_tr_b16 v[86:87], v8 offset:21504
  v_mfma_f32_16x16x32_bf16 v[108:111], v[88:91], a[44:47], v[108:111]
  v_mfma_f32_16x16x32_bf16 v[112:115], v[92:95], a[32:35], v[112:115]
  buffer_load_dwordx4 v21, s[4:7], s32 offen offset:3072 lds
  v_mfma_f32_16x16x32_bf16 v[116:119], v[92:95], a[36:39], v[116:119]
  v_mfma_f32_16x16x32_bf16 v[120:123], v[92:95], a[40:43], v[120:123]
  v_mfma_f32_16x16x32_bf16 v[124:127], v[92:95], a[44:47], v[124:127]
  s_waitcnt lgkmcnt(4)
  v_mfma_f32_16x16x32_bf16 v[128:131], v[72:75], a[32:35], v[128:131]
  s_add_u32 m0, s33, 12288
  s_nop 0
  buffer_load_dwordx4 v22, s[4:7], s32 offen lds
  v_mfma_f32_16x16x32_bf16 v[132:135], v[72:75], a[36:39], v[132:135]
  ds_read_b64_tr_b16 v[88:89], v9 offset:16384
  ds_read_b64_tr_b16 v[90:91], v9 offset:20480
  v_mfma_f32_16x16x32_bf16 v[136:139], v[72:75], a[40:43], v[136:139]
  ds_read_b64_tr_b16 v[92:93], v9 offset:17408
  ds_read_b64_tr_b16 v[94:95], v9 offset:21504
  v_mfma_f32_16x16x32_bf16 v[140:143], v[72:75], a[44:47], v[140:143]
  buffer_load_dwordx4 v23, s[4:7], s32 offen offset:1024 lds
  v_mfma_f32_16x16x32_bf16 v[144:147], v[76:79], a[32:35], v[144:147]
  v_mfma_f32_16x16x32_bf16 v[148:151], v[76:79], a[36:39], v[148:151]
  v_mfma_f32_16x16x32_bf16 v[152:155], v[76:79], a[40:43], v[152:155]
  v_mfma_f32_16x16x32_bf16 v[156:159], v[76:79], a[44:47], v[156:159]
  s_waitcnt lgkmcnt(4)
  buffer_load_dwordx4 v24, s[4:7], s32 offen offset:2048 lds
  v_mfma_f32_16x16x32_bf16 v[160:163], v[80:83], a[32:35], v[160:163]
  ds_read_b64_tr_b16 v[72:73], v6 offset:24576
  ds_read_b64_tr_b16 v[74:75], v6 offset:28672
  v_mfma_f32_16x16x32_bf16 v[164:167], v[80:83], a[36:39], v[164:167]
  ds_read_b64_tr_b16 v[76:77], v6 offset:25600
  ds_read_b64_tr_b16 v[78:79], v6 offset:29696
  v_mfma_f32_16x16x32_bf16 v[168:171], v[80:83], a[40:43], v[168:171]
  buffer_load_dwordx4 v25, s[4:7], s32 offen offset:3072 lds
  v_mfma_f32_16x16x32_bf16 v[172:175], v[80:83], a[44:47], v[172:175]
  v_mfma_f32_16x16x32_bf16 v[176:179], v[84:87], a[32:35], v[176:179]
  v_mfma_f32_16x16x32_bf16 v[180:183], v[84:87], a[36:39], v[180:183]
  v_mfma_f32_16x16x32_bf16 v[184:187], v[84:87], a[40:43], v[184:187]
  v_mfma_f32_16x16x32_bf16 v[188:191], v[84:87], a[44:47], v[188:191]
  s_waitcnt lgkmcnt(4)
  v_mfma_f32_16x16x32_bf16 v[192:195], v[88:91], a[32:35], v[192:195]
  ds_read_b64_tr_b16 v[80:81], v7 offset:24576
  ds_read_b64_tr_b16 v[82:83], v7 offset:28672
  v_mfma_f32_16x16x32_bf16 v[196:199], v[88:91], a[36:39], v[196:199]
  ds_read_b64_tr_b16 v[84:85], v7 offset:25600
  ds_read_b64_tr_b16 v[86:87], v7 offset:29696
  v_mfma_f32_16x16x32_bf16 v[200:203], v[88:91], a[40:43], v[200:203]
  v_mfma_f32_16x16x32_bf16 v[204:207], v[88:91], a[44:47], v[204:207]
  v_mfma_f32_16x16x32_bf16 v[208:211], v[92:95], a[32:35], v[208:211]
  v_mfma_f32_16x16x32_bf16 v[212:215], v[92:95], a[36:39], v[212:215]
  v_mfma_f32_16x16x32_bf16 v[216:219], v[92:95], a[40:43], v[216:219]
  v_mfma_f32_16x16x32_bf16 v[220:223], v[92:95], a[44:47], v[220:223]
  s_waitcnt lgkmcnt(4)
  v_mfma_f32_16x16x32_bf16 v[96:99], v[72:75], a[48:51], v[96:99]
  s_waitcnt vmcnt(12)
  ds_read_b64_tr_b16 v[88:89], v8 offset:24576
  ds_read_b128 a[64:67], v2 offset:0
  v_mfma_f32_16x16x32_bf16 v[100:103], v[72:75], a[52:55], v[100:103]
  ds_read_b64_tr_b16 v[90:91], v8 offset:28672
  ds_read_b128 a[68:71], v2 offset:2048
  v_mfma_f32_16x16x32_bf16 v[104:107], v[72:75], a[56:59], v[104:107]
  ds_read_b64_tr_b16 v[92:93], v8 offset:25600
  ds_read_b128 a[72:75], v2 offset:4096
  v_mfma_f32_16x16x32_bf16 v[108:111], v[72:75], a[60:63], v[108:111]
  ds_read_b64_tr_b16 v[94:95], v8 offset:29696
  ds_read_b128 a[76:79], v2 offset:6144
  v_mfma_f32_16x16x32_bf16 v[112:115], v[76:79], a[48:51], v[112:115]
  ds_read_b128 a[80:83], v3 offset:0
  ds_read_b128 a[84:87], v3 offset:2048
  v_mfma_f32_16x16x32_bf16 v[116:119], v[76:79], a[52:55], v[116:119]
  ds_read_b128 a[88:91], v3 offset:4096
  s_waitcnt lgkmcnt(14)
  ds_read_b128 a[92:95], v3 offset:6144
  v_mfma_f32_16x16x32_bf16 v[120:123], v[76:79], a[56:59], v[120:123]
  s_bfe_u32 s49, s59, 0x40010
  s_mul_i32 s49, s49, 589824
  s_add_u32 s49, s49, s47
  v_mfma_f32_16x16x32_bf16 v[124:127], v[76:79], a[60:63], v[124:127]
  s_waitcnt lgkmcnt(12)
  s_add_u32 m0, s48, 65536
  s_add_u32 s49, s49, 0
  v_mfma_f32_16x16x32_bf16 v[128:131], v[80:83], a[48:51], v[128:131]
  buffer_load_dwordx4 v11, s[8:11], s49 offen lds
  v_mfma_f32_16x16x32_bf16 v[132:135], v[80:83], a[52:55], v[132:135]
  buffer_load_dwordx4 v11, s[12:15], s49 offen offset:1024 lds
  v_mfma_f32_16x16x32_bf16 v[136:139], v[80:83], a[56:59], v[136:139]
  ds_read_b64_tr_b16 v[72:73], v9 offset:24576
  ds_read_b64_tr_b16 v[74:75], v9 offset:28672
  v_mfma_f32_16x16x32_bf16 v[140:143], v[80:83], a[60:63], v[140:143]
  s_bfe_u32 s49, s59, 0x40010
  ds_read_b64_tr_b16 v[76:77], v9 offset:25600
  s_mul_i32 s49, s49, 589824
  v_mfma_f32_16x16x32_bf16 v[144:147], v[84:87], a[48:51], v[144:147]
  s_add_u32 s49, s49, s47
  s_waitcnt lgkmcnt(14)
  ds_read_b64_tr_b16 v[78:79], v9 offset:29696
  v_mfma_f32_16x16x32_bf16 v[148:151], v[84:87], a[52:55], v[148:151]
  s_add_u32 m0, s48, 73728
  s_add_u32 s49, s49, 294912
  v_mfma_f32_16x16x32_bf16 v[152:155], v[84:87], a[56:59], v[152:155]
  buffer_load_dwordx4 v11, s[8:11], s49 offen lds
  v_mfma_f32_16x16x32_bf16 v[156:159], v[84:87], a[60:63], v[156:159]
  buffer_load_dwordx4 v11, s[12:15], s49 offen offset:1024 lds
  s_barrier
  s_waitcnt lgkmcnt(9)
  v_mfma_f32_16x16x32_bf16 v[160:163], v[88:91], a[48:51], v[160:163]
  ds_read_b64_tr_b16 v[80:81], v6 offset:32768
  ds_read_b64_tr_b16 v[82:83], v6 offset:36864
  v_mfma_f32_16x16x32_bf16 v[164:167], v[88:91], a[52:55], v[164:167]
  ds_read_b64_tr_b16 v[84:85], v6 offset:33792
  ds_read_b64_tr_b16 v[86:87], v6 offset:37888
  v_mfma_f32_16x16x32_bf16 v[168:171], v[88:91], a[56:59], v[168:171]
  s_waitcnt lgkmcnt(8)
  s_bfe_u32 s32, s59, 0x40010
  s_lshl_b32 s32, s32, 7
  v_mfma_f32_16x16x32_bf16 v[172:175], v[88:91], a[60:63], v[172:175]
  s_add_u32 m0, s33, 0
  s_nop 0
  v_mfma_f32_16x16x32_bf16 v[176:179], v[92:95], a[48:51], v[176:179]
  buffer_load_dwordx4 v18, s[4:7], s32 offen lds
  v_mfma_f32_16x16x32_bf16 v[180:183], v[92:95], a[52:55], v[180:183]
  buffer_load_dwordx4 v19, s[4:7], s32 offen offset:1024 lds
  v_mfma_f32_16x16x32_bf16 v[184:187], v[92:95], a[56:59], v[184:187]
  v_mfma_f32_16x16x32_bf16 v[188:191], v[92:95], a[60:63], v[188:191]
  s_waitcnt lgkmcnt(4)
  v_mfma_f32_16x16x32_bf16 v[192:195], v[72:75], a[48:51], v[192:195]
  ds_read_b64_tr_b16 v[88:89], v7 offset:32768
  ds_read_b64_tr_b16 v[90:91], v7 offset:36864
  v_mfma_f32_16x16x32_bf16 v[196:199], v[72:75], a[52:55], v[196:199]
  buffer_load_dwordx4 v20, s[4:7], s32 offen offset:2048 lds
  v_mfma_f32_16x16x32_bf16 v[200:203], v[72:75], a[56:59], v[200:203]
  ds_read_b64_tr_b16 v[92:93], v7 offset:33792
  ds_read_b64_tr_b16 v[94:95], v7 offset:37888
  v_mfma_f32_16x16x32_bf16 v[204:207], v[72:75], a[60:63], v[204:207]
  v_mfma_f32_16x16x32_bf16 v[208:211], v[76:79], a[48:51], v[208:211]
  buffer_load_dwordx4 v21, s[4:7], s32 offen offset:3072 lds
  v_mfma_f32_16x16x32_bf16 v[212:215], v[76:79], a[52:55], v[212:215]
  v_mfma_f32_16x16x32_bf16 v[216:219], v[76:79], a[56:59], v[216:219]
  v_mfma_f32_16x16x32_bf16 v[220:223], v[76:79], a[60:63], v[220:223]
  s_waitcnt lgkmcnt(4)
  v_mfma_f32_16x16x32_bf16 v[96:99], v[80:83], a[64:67], v[96:99]
  s_add_u32 m0, s33, 4096
  s_cmp_lg_u32 s40, 0
  s_cbranch_scc1 gated_mix__spectral_fnet__swiglu_ffn__prompt_kernel_noinit
  v_mov_b32 v28, 0
  v_mov_b32 v29, 1
  s_mov_b64 exec, 1
  global_atomic_add v28, v29, s[100:101]
  s_mov_b64 exec, -1
gated_mix__spectral_fnet__swiglu_ffn__prompt_kernel_noinit:
  v_mfma_f32_16x16x32_bf16 v[100:103], v[80:83], a[68:71], v[100:103]
  buffer_load_dwordx4 v22, s[4:7], s32 offen lds
  v_mfma_f32_16x16x32_bf16 v[104:107], v[80:83], a[72:75], v[104:107]
  ds_read_b64_tr_b16 v[72:73], v8 offset:32768
  ds_read_b64_tr_b16 v[74:75], v8 offset:36864
  v_mfma_f32_16x16x32_bf16 v[108:111], v[80:83], a[76:79], v[108:111]
  buffer_load_dwordx4 v23, s[4:7], s32 offen offset:1024 lds
  v_mfma_f32_16x16x32_bf16 v[112:115], v[84:87], a[64:67], v[112:115]
  ds_read_b64_tr_b16 v[76:77], v8 offset:33792
  ds_read_b64_tr_b16 v[78:79], v8 offset:37888
  v_mfma_f32_16x16x32_bf16 v[116:119], v[84:87], a[68:71], v[116:119]
  v_mfma_f32_16x16x32_bf16 v[120:123], v[84:87], a[72:75], v[120:123]
  v_mfma_f32_16x16x32_bf16 v[124:127], v[84:87], a[76:79], v[124:127]
  s_waitcnt lgkmcnt(4)
  buffer_load_dwordx4 v24, s[4:7], s32 offen offset:2048 lds
  v_mfma_f32_16x16x32_bf16 v[128:131], v[88:91], a[64:67], v[128:131]
  ds_read_b64_tr_b16 v[80:81], v9 offset:32768
  ds_read_b64_tr_b16 v[82:83], v9 offset:36864
  v_mfma_f32_16x16x32_bf16 v[132:135], v[88:91], a[68:71], v[132:135]
  ds_read_b64_tr_b16 v[84:85], v9 offset:33792
  ds_read_b64_tr_b16 v[86:87], v9 offset:37888
  v_mfma_f32_16x16x32_bf16 v[136:139], v[88:91], a[72:75], v[136:139]
  buffer_load_dwordx4 v25, s[4:7], s32 offen offset:3072 lds
  v_mfma_f32_16x16x32_bf16 v[140:143], v[88:91], a[76:79], v[140:143]
  v_mfma_f32_16x16x32_bf16 v[144:147], v[92:95], a[64:67], v[144:147]
  v_mfma_f32_16x16x32_bf16 v[148:151], v[92:95], a[68:71], v[148:151]
  v_mfma_f32_16x16x32_bf16 v[152:155], v[92:95], a[72:75], v[152:155]
  v_mfma_f32_16x16x32_bf16 v[156:159], v[92:95], a[76:79], v[156:159]
  s_waitcnt lgkmcnt(4)
  v_mfma_f32_16x16x32_bf16 v[160:163], v[72:75], a[64:67], v[160:163]
  ds_read_b64_tr_b16 v[88:89], v6 offset:40960
  ds_read_b64_tr_b16 v[90:91], v6 offset:45056
  v_mfma_f32_16x16x32_bf16 v[164:167], v[72:75], a[68:71], v[164:167]
  ds_read_b64_tr_b16 v[92:93], v6 offset:41984
  ds_read_b64_tr_b16 v[94:95], v6 offset:46080
  v_mfma_f32_16x16x32_bf16 v[168:171], v[72:75], a[72:75], v[168:171]
  v_mfma_f32_16x16x32_bf16 v[172:175], v[72:75], a[76:79], v[172:175]
  v_mfma_f32_16x16x32_bf16 v[176:179], v[76:79], a[64:67], v[176:179]
  v_mfma_f32_16x16x32_bf16 v[180:183], v[76:79], a[68:71], v[180:183]
  v_mfma_f32_16x16x32_bf16 v[184:187], v[76:79], a[72:75], v[184:187]
  v_mfma_f32_16x16x32_bf16 v[188:191], v[76:79], a[76:79], v[188:191]
  s_waitcnt lgkmcnt(4)
  v_mfma_f32_16x16x32_bf16 v[192:195], v[80:83], a[64:67], v[192:195]
  s_waitcnt vmcnt(12)
  ds_read_b64_tr_b16 v[72:73], v7 offset:40960
  ds_read_b128 a[96:99], v2 offset:8192
  v_mfma_f32_16x16x32_bf16 v[196:199], v[80:83], a[68:71], v[196:199]
  ds_read_b64_tr_b16 v[74:75], v7 offset:45056
  ds_read_b128 a[100:103], v2 offset:10240
  v_mfma_f32_16x16x32_bf16 v[200:203], v[80:83], a[72:75], v[200:203]
  ds_read_b64_tr_b16 v[76:77], v7 offset:41984
  ds_read_b128 a[104:107], v2 offset:12288
  v_mfma_f32_16x16x32_bf16 v[204:207], v[80:83], a[76:79], v[204:207]
  ds_read_b64_tr_b16 v[78:79], v7 offset:46080
  ds_read_b128 a[108:111], v2 offset:14336
  v_mfma_f32_16x16x32_bf16 v[208:211], v[84:87], a[64:67], v[208:211]
  ds_read_b128 a[112:115], v3 offset:8192
  ds_read_b128 a[116:119], v3 offset:10240
  v_mfma_f32_16x16x32_bf16 v[212:215], v[84:87], a[68:71], v[212:215]
  ds_read_b128 a[120:123], v3 offset:12288
  s_waitcnt lgkmcnt(14)
  ds_read_b128 a[124:127], v3 offset:14336
  v_mfma_f32_16x16x32_bf16 v[216:219], v[84:87], a[72:75], v[216:219]
  s_bfe_u32 s49, s59, 0x40014
  s_mul_i32 s49, s49, 589824
  s_add_u32 s49, s49, s47
  v_mfma_f32_16x16x32_bf16 v[220:223], v[84:87], a[76:79], v[220:223]
  s_waitcnt lgkmcnt(12)
  s_add_u32 m0, s48, 81920
  s_add_u32 s49, s49, 0
  v_mfma_f32_16x16x32_bf16 v[96:99], v[88:91], a[80:83], v[96:99]
  buffer_load_dwordx4 v11, s[8:11], s49 offen lds
  v_mfma_f32_16x16x32_bf16 v[100:103], v[88:91], a[84:87], v[100:103]
  buffer_load_dwordx4 v11, s[12:15], s49 offen offset:1024 lds
  v_mfma_f32_16x16x32_bf16 v[104:107], v[88:91], a[88:91], v[104:107]
  ds_read_b64_tr_b16 v[80:81], v8 offset:40960
  ds_read_b64_tr_b16 v[82:83], v8 offset:45056
  v_mfma_f32_16x16x32_bf16 v[108:111], v[88:91], a[92:95], v[108:111]
  s_bfe_u32 s49, s59, 0x40014
  ds_read_b64_tr_b16 v[84:85], v8 offset:41984
  s_mul_i32 s49, s49, 589824
  v_mfma_f32_16x16x32_bf16 v[112:115], v[92:95], a[80:83], v[112:115]
  s_add_u32 s49, s49, s47
  s_waitcnt lgkmcnt(14)
  ds_read_b64_tr_b16 v[86:87], v8 offset:46080
  v_mfma_f32_16x16x32_bf16 v[116:119], v[92:95], a[84:87], v[116:119]
  s_add_u32 m0, s48, 90112
  s_add_u32 s49, s49, 294912
  v_mfma_f32_16x16x32_bf16 v[120:123], v[92:95], a[88:91], v[120:123]
  buffer_load_dwordx4 v11, s[8:11], s49 offen lds
  v_mfma_f32_16x16x32_bf16 v[124:127], v[92:95], a[92:95], v[124:127]
  s_waitcnt lgkmcnt(9)
  buffer_load_dwordx4 v11, s[12:15], s49 offen offset:1024 lds
  v_mfma_f32_16x16x32_bf16 v[128:131], v[72:75], a[80:83], v[128:131]
  ds_read_b64_tr_b16 v[88:89], v9 offset:40960
  ds_read_b64_tr_b16 v[90:91], v9 offset:45056
  v_mfma_f32_16x16x32_bf16 v[132:135], v[72:75], a[84:87], v[132:135]
  ds_read_b64_tr_b16 v[92:93], v9 offset:41984
  ds_read_b64_tr_b16 v[94:95], v9 offset:46080
  v_mfma_f32_16x16x32_bf16 v[136:139], v[72:75], a[88:91], v[136:139]
  s_waitcnt lgkmcnt(8)
  s_bfe_u32 s32, s59, 0x40014
  s_lshl_b32 s32, s32, 7
  v_mfma_f32_16x16x32_bf16 v[140:143], v[72:75], a[92:95], v[140:143]
  s_add_u32 m0, s33, 8192
  s_nop 0
  v_mfma_f32_16x16x32_bf16 v[144:147], v[76:79], a[80:83], v[144:147]
  buffer_load_dwordx4 v18, s[4:7], s32 offen lds
  v_mfma_f32_16x16x32_bf16 v[148:151], v[76:79], a[84:87], v[148:151]
  buffer_load_dwordx4 v19, s[4:7], s32 offen offset:1024 lds
  v_mfma_f32_16x16x32_bf16 v[152:155], v[76:79], a[88:91], v[152:155]
  v_mfma_f32_16x16x32_bf16 v[156:159], v[76:79], a[92:95], v[156:159]
  s_barrier
  s_waitcnt lgkmcnt(4)
  v_mfma_f32_16x16x32_bf16 v[160:163], v[80:83], a[80:83], v[160:163]
  ds_read_b64_tr_b16 v[72:73], v6 offset:49152
  ds_read_b64_tr_b16 v[74:75], v6 offset:53248
  v_mfma_f32_16x16x32_bf16 v[164:167], v[80:83], a[84:87], v[164:167]
  buffer_load_dwordx4 v20, s[4:7], s32 offen offset:2048 lds
  v_mfma_f32_16x16x32_bf16 v[168:171], v[80:83], a[88:91], v[168:171]
  ds_read_b64_tr_b16 v[76:77], v6 offset:50176
  ds_read_b64_tr_b16 v[78:79], v6 offset:54272
  v_mfma_f32_16x16x32_bf16 v[172:175], v[80:83], a[92:95], v[172:175]
  v_mfma_f32_16x16x32_bf16 v[176:179], v[84:87], a[80:83], v[176:179]
  buffer_load_dwordx4 v21, s[4:7], s32 offen offset:3072 lds
  v_mfma_f32_16x16x32_bf16 v[180:183], v[84:87], a[84:87], v[180:183]
  v_mfma_f32_16x16x32_bf16 v[184:187], v[84:87], a[88:91], v[184:187]
  v_mfma_f32_16x16x32_bf16 v[188:191], v[84:87], a[92:95], v[188:191]
  s_waitcnt lgkmcnt(4)
  v_mfma_f32_16x16x32_bf16 v[192:195], v[88:91], a[80:83], v[192:195]
  s_add_u32 m0, s33, 12288
  s_nop 0
  buffer_load_dwordx4 v22, s[4:7], s32 offen lds
  v_mfma_f32_16x16x32_bf16 v[196:199], v[88:91], a[84:87], v[196:199]
  ds_read_b64_tr_b16 v[80:81], v7 offset:49152
  ds_read_b64_tr_b16 v[82:83], v7 offset:53248
  v_mfma_f32_16x16x32_bf16 v[200:203], v[88:91], a[88:91], v[200:203]
  ds_read_b64_tr_b16 v[84:85], v7 offset:50176
  ds_read_b64_tr_b16 v[86:87], v7 offset:54272
  v_mfma_f32_16x16x32_bf16 v[204:207], v[88:91], a[92:95], v[204:207]
  buffer_load_dwordx4 v23, s[4:7], s32 offen offset:1024 lds
  v_mfma_f32_16x16x32_bf16 v[208:211], v[92:95], a[80:83], v[208:211]
  v_mfma_f32_16x16x32_bf16 v[212:215], v[92:95], a[84:87], v[212:215]
  v_mfma_f32_16x16x32_bf16 v[216:219], v[92:95], a[88:91], v[216:219]
  v_mfma_f32_16x16x32_bf16 v[220:223], v[92:95], a[92:95], v[220:223]
  s_waitcnt lgkmcnt(4)
  buffer_load_dwordx4 v24, s[4:7], s32 offen offset:2048 lds
  v_mfma_f32_16x16x32_bf16 v[96:99], v[72:75], a[96:99], v[96:99]
  ds_read_b64_tr_b16 v[88:89], v8 offset:49152
  ds_read_b64_tr_b16 v[90:91], v8 offset:53248
  v_mfma_f32_16x16x32_bf16 v[100:103], v[72:75], a[100:103], v[100:103]
  ds_read_b64_tr_b16 v[92:93], v8 offset:50176
  ds_read_b64_tr_b16 v[94:95], v8 offset:54272
  v_mfma_f32_16x16x32_bf16 v[104:107], v[72:75], a[104:107], v[104:107]
  buffer_load_dwordx4 v25, s[4:7], s32 offen offset:3072 lds
  v_mfma_f32_16x16x32_bf16 v[108:111], v[72:75], a[108:111], v[108:111]
  v_mfma_f32_16x16x32_bf16 v[112:115], v[76:79], a[96:99], v[112:115]
  v_mfma_f32_16x16x32_bf16 v[116:119], v[76:79], a[100:103], v[116:119]
  v_mfma_f32_16x16x32_bf16 v[120:123], v[76:79], a[104:107], v[120:123]
  v_mfma_f32_16x16x32_bf16 v[124:127], v[76:79], a[108:111], v[124:127]
  s_waitcnt lgkmcnt(4)
  v_mfma_f32_16x16x32_bf16 v[128:131], v[80:83], a[96:99], v[128:131]
  ds_read_b64_tr_b16 v[72:73], v9 offset:49152
  ds_read_b64_tr_b16 v[74:75], v9 offset:53248
  v_mfma_f32_16x16x32_bf16 v[132:135], v[80:83], a[100:103], v[132:135]
  ds_read_b64_tr_b16 v[76:77], v9 offset:50176
  ds_read_b64_tr_b16 v[78:79], v9 offset:54272
  v_mfma_f32_16x16x32_bf16 v[136:139], v[80:83], a[104:107], v[136:139]
  v_mfma_f32_16x16x32_bf16 v[140:143], v[80:83], a[108:111], v[140:143]
  v_mfma_f32_16x16x32_bf16 v[144:147], v[84:87], a[96:99], v[144:147]
  v_mfma_f32_16x16x32_bf16 v[148:151], v[84:87], a[100:103], v[148:151]
  v_mfma_f32_16x16x32_bf16 v[152:155], v[84:87], a[104:107], v[152:155]
  v_mfma_f32_16x16x32_bf16 v[156:159], v[84:87], a[108:111], v[156:159]
  s_waitcnt lgkmcnt(4)
  v_mfma_f32_16x16x32_bf16 v[160:163], v[88:91], a[96:99], v[160:163]
  s_waitcnt vmcnt(12)
  ds_read_b64_tr_b16 v[80:81], v6 offset:57344
  ds_read_b128 a[128:131], v2 offset:0
  v_mfma_f32_16x16x32_bf16 v[164:167], v[88:91], a[100:103], v[164:167]
  ds_read_b64_tr_b16 v[82:83], v6 offset:61440
  ds_read_b128 a[132:135], v2 offset:2048
  v_mfma_f32_16x16x32_bf16 v[168:171], v[88:91], a[104:107], v[168:171]
  ds_read_b64_tr_b16 v[84:85], v6 offset:58368
  ds_read_b128 a[136:139], v2 offset:4096
  v_mfma_f32_16x16x32_bf16 v[172:175], v[88:91], a[108:111], v[172:175]
  ds_read_b64_tr_b16 v[86:87], v6 offset:62464
  ds_read_b128 a[140:143], v2 offset:6144
  v_mfma_f32_16x16x32_bf16 v[176:179], v[92:95], a[96:99], v[176:179]
  ds_read_b128 a[144:147], v3 offset:0
  ds_read_b128 a[148:151], v3 offset:2048
  v_mfma_f32_16x16x32_bf16 v[180:183], v[92:95], a[100:103], v[180:183]
  ds_read_b128 a[152:155], v3 offset:4096
  s_waitcnt lgkmcnt(14)
  ds_read_b128 a[156:159], v3 offset:6144
  v_mfma_f32_16x16x32_bf16 v[184:187], v[92:95], a[104:107], v[184:187]
  v_mfma_f32_16x16x32_bf16 v[188:191], v[92:95], a[108:111], v[188:191]
  s_waitcnt lgkmcnt(12)
  v_mfma_f32_16x16x32_bf16 v[192:195], v[72:75], a[96:99], v[192:195]
  ds_read_b64_tr_b16 v[88:89], v7 offset:57344
  ds_read_b64_tr_b16 v[90:91], v7 offset:61440
  v_mfma_f32_16x16x32_bf16 v[196:199], v[72:75], a[100:103], v[196:199]
  ds_read_b64_tr_b16 v[92:93], v7 offset:58368
  s_waitcnt lgkmcnt(14)
  ds_read_b64_tr_b16 v[94:95], v7 offset:62464
  v_mfma_f32_16x16x32_bf16 v[200:203], v[72:75], a[104:107], v[200:203]
  v_mfma_f32_16x16x32_bf16 v[204:207], v[72:75], a[108:111], v[204:207]
  v_mfma_f32_16x16x32_bf16 v[208:211], v[76:79], a[96:99], v[208:211]
  v_mfma_f32_16x16x32_bf16 v[212:215], v[76:79], a[100:103], v[212:215]
  v_mfma_f32_16x16x32_bf16 v[216:219], v[76:79], a[104:107], v[216:219]
  s_waitcnt lgkmcnt(4)
  s_bfe_u32 s32, s59, 0x40018
  s_lshl_b32 s32, s32, 7
  v_mfma_f32_16x16x32_bf16 v[220:223], v[76:79], a[108:111], v[220:223]
  s_add_u32 m0, s33, 0
  s_nop 0
  v_mfma_f32_16x16x32_bf16 v[96:99], v[80:83], a[112:115], v[96:99]
  buffer_load_dwordx4 v18, s[4:7], s32 offen lds
  v_mfma_f32_16x16x32_bf16 v[100:103], v[80:83], a[116:119], v[100:103]
  buffer_load_dwordx4 v19, s[4:7], s32 offen offset:1024 lds
  v_mfma_f32_16x16x32_bf16 v[104:107], v[80:83], a[120:123], v[104:107]
  ds_read_b64_tr_b16 v[72:73], v8 offset:57344
  ds_read_b64_tr_b16 v[74:75], v8 offset:61440
  v_mfma_f32_16x16x32_bf16 v[108:111], v[80:83], a[124:127], v[108:111]
  ds_read_b64_tr_b16 v[76:77], v8 offset:58368
  ds_read_b64_tr_b16 v[78:79], v8 offset:62464
  v_mfma_f32_16x16x32_bf16 v[112:115], v[84:87], a[112:115], v[112:115]
  v_mfma_f32_16x16x32_bf16 v[116:119], v[84:87], a[116:119], v[116:119]
  buffer_load_dwordx4 v20, s[4:7], s32 offen offset:2048 lds
  v_mfma_f32_16x16x32_bf16 v[120:123], v[84:87], a[120:123], v[120:123]
  v_mfma_f32_16x16x32_bf16 v[124:127], v[84:87], a[124:127], v[124:127]
  s_waitcnt lgkmcnt(4)
  v_mfma_f32_16x16x32_bf16 v[128:131], v[88:91], a[112:115], v[128:131]
  buffer_load_dwordx4 v21, s[4:7], s32 offen offset:3072 lds
  v_mfma_f32_16x16x32_bf16 v[132:135], v[88:91], a[116:119], v[132:135]
  ds_read_b64_tr_b16 v[80:81], v9 offset:57344
  ds_read_b64_tr_b16 v[82:83], v9 offset:61440
  v_mfma_f32_16x16x32_bf16 v[136:139], v[88:91], a[120:123], v[136:139]
  ds_read_b64_tr_b16 v[84:85], v9 offset:58368
  ds_read_b64_tr_b16 v[86:87], v9 offset:62464
  v_mfma_f32_16x16x32_bf16 v[140:143], v[88:91], a[124:127], v[140:143]
  v_mfma_f32_16x16x32_bf16 v[144:147], v[92:95], a[112:115], v[144:147]
  s_add_u32 m0, s33, 4096
  s_nop 0
  buffer_load_dwordx4 v22, s[4:7], s32 offen lds
  v_mfma_f32_16x16x32_bf16 v[148:151], v[92:95], a[116:119], v[148:151]
  v_mfma_f32_16x16x32_bf16 v[152:155], v[92:95], a[120:123], v[152:155]
  v_mfma_f32_16x16x32_bf16 v[156:159], v[92:95], a[124:127], v[156:159]
  buffer_load_dwordx4 v23, s[4:7], s32 offen offset:1024 lds
  s_barrier
  s_waitcnt lgkmcnt(4)
  v_mfma_f32_16x16x32_bf16 v[160:163], v[72:75], a[112:115], v[160:163]
  v_add_u32 v6, 49152, v6
  ds_read_b64_tr_b16 v[88:89], v6 offset:16384
  v_mfma_f32_16x16x32_bf16 v[164:167], v[72:75], a[116:119], v[164:167]
  ds_read_b64_tr_b16 v[90:91], v6 offset:20480
  ds_read_b64_tr_b16 v[92:93], v6 offset:17408
  v_mfma_f32_16x16x32_bf16 v[168:171], v[72:75], a[120:123], v[168:171]
  ds_read_b64_tr_b16 v[94:95], v6 offset:21504
  v_mfma_f32_16x16x32_bf16 v[172:175], v[72:75], a[124:127], v[172:175]
  buffer_load_dwordx4 v24, s[4:7], s32 offen offset:2048 lds
  v_mfma_f32_16x16x32_bf16 v[176:179], v[76:79], a[112:115], v[176:179]
  v_mfma_f32_16x16x32_bf16 v[180:183], v[76:79], a[116:119], v[180:183]
  v_mfma_f32_16x16x32_bf16 v[184:187], v[76:79], a[120:123], v[184:187]
  buffer_load_dwordx4 v25, s[4:7], s32 offen offset:3072 lds
  v_mfma_f32_16x16x32_bf16 v[188:191], v[76:79], a[124:127], v[188:191]
  s_waitcnt lgkmcnt(4)
  v_mfma_f32_16x16x32_bf16 v[192:195], v[80:83], a[112:115], v[192:195]
  v_add_u32 v7, 49152, v7
  ds_read_b64_tr_b16 v[72:73], v7 offset:16384
  v_mfma_f32_16x16x32_bf16 v[196:199], v[80:83], a[116:119], v[196:199]
  ds_read_b64_tr_b16 v[74:75], v7 offset:20480
  ds_read_b64_tr_b16 v[76:77], v7 offset:17408
  v_mfma_f32_16x16x32_bf16 v[200:203], v[80:83], a[120:123], v[200:203]
  s_bfe_u32 s49, s59, 0x40018
  ds_read_b64_tr_b16 v[78:79], v7 offset:21504
  s_mul_i32 s49, s49, 589824
  v_mfma_f32_16x16x32_bf16 v[204:207], v[80:83], a[124:127], v[204:207]
  s_add_u32 s49, s49, s47
  s_add_u32 m0, s48, 0
  s_add_u32 s49, s49, 0
  v_mfma_f32_16x16x32_bf16 v[208:211], v[84:87], a[112:115], v[208:211]
  buffer_load_dwordx4 v11, s[8:11], s49 offen lds
  v_mfma_f32_16x16x32_bf16 v[212:215], v[84:87], a[116:119], v[212:215]
  buffer_load_dwordx4 v11, s[12:15], s49 offen offset:1024 lds
  v_mfma_f32_16x16x32_bf16 v[216:219], v[84:87], a[120:123], v[216:219]
  v_mfma_f32_16x16x32_bf16 v[220:223], v[84:87], a[124:127], v[220:223]
  s_waitcnt lgkmcnt(4)
  v_mfma_f32_16x16x32_bf16 v[96:99], v[88:91], a[128:131], v[96:99]
  v_add_u32 v8, 49152, v8
  ds_read_b64_tr_b16 v[80:81], v8 offset:16384
  v_mfma_f32_16x16x32_bf16 v[100:103], v[88:91], a[132:135], v[100:103]
  s_bfe_u32 s49, s59, 0x40018
  ds_read_b64_tr_b16 v[82:83], v8 offset:20480
  s_mul_i32 s49, s49, 589824
  v_mfma_f32_16x16x32_bf16 v[104:107], v[88:91], a[136:139], v[104:107]
  s_add_u32 s49, s49, s47
  ds_read_b64_tr_b16 v[84:85], v8 offset:17408
  s_add_u32 m0, s48, 8192
  v_mfma_f32_16x16x32_bf16 v[108:111], v[88:91], a[140:143], v[108:111]
  s_add_u32 s49, s49, 294912
  buffer_load_dwordx4 v11, s[8:11], s49 offen lds
  v_mfma_f32_16x16x32_bf16 v[112:115], v[92:95], a[128:131], v[112:115]
  buffer_load_dwordx4 v11, s[12:15], s49 offen offset:1024 lds
  v_mfma_f32_16x16x32_bf16 v[116:119], v[92:95], a[132:135], v[116:119]
  ds_read_b64_tr_b16 v[86:87], v8 offset:21504
  v_mfma_f32_16x16x32_bf16 v[120:123], v[92:95], a[136:139], v[120:123]
  v_mfma_f32_16x16x32_bf16 v[124:127], v[92:95], a[140:143], v[124:127]
  s_waitcnt lgkmcnt(4)
  v_mfma_f32_16x16x32_bf16 v[128:131], v[72:75], a[128:131], v[128:131]
  s_waitcnt vmcnt(12)
  v_add_u32 v9, 49152, v9
  ds_read_b128 a[160:163], v2 offset:8192
  v_mfma_f32_16x16x32_bf16 v[132:135], v[72:75], a[132:135], v[132:135]
  ds_read_b64_tr_b16 v[88:89], v9 offset:16384
  ds_read_b128 a[164:167], v2 offset:10240
  v_mfma_f32_16x16x32_bf16 v[136:139], v[72:75], a[136:139], v[136:139]
  ds_read_b64_tr_b16 v[90:91], v9 offset:20480
  ds_read_b128 a[168:171], v2 offset:12288
  v_mfma_f32_16x16x32_bf16 v[140:143], v[72:75], a[140:143], v[140:143]
  ds_read_b64_tr_b16 v[92:93], v9 offset:17408
  ds_read_b128 a[172:175], v2 offset:14336
  v_mfma_f32_16x16x32_bf16 v[144:147], v[76:79], a[128:131], v[144:147]
  ds_read_b64_tr_b16 v[94:95], v9 offset:21504
  ds_read_b128 a[176:179], v3 offset:8192
  v_mfma_f32_16x16x32_bf16 v[148:151], v[76:79], a[132:135], v[148:151]
  ds_read_b128 a[180:183], v3 offset:10240
  ds_read_b128 a[184:187], v3 offset:12288
  v_mfma_f32_16x16x32_bf16 v[152:155], v[76:79], a[136:139], v[152:155]
  s_waitcnt lgkmcnt(14)
  ds_read_b128 a[188:191], v3 offset:14336
  v_mfma_f32_16x16x32_bf16 v[156:159], v[76:79], a[140:143], v[156:159]
  s_waitcnt lgkmcnt(12)
  v_mfma_f32_16x16x32_bf16 v[160:163], v[80:83], a[128:131], v[160:163]
  ds_read_b64_tr_b16 v[72:73], v6 offset:24576
  ds_read_b64_tr_b16 v[74:75], v6 offset:28672
  v_mfma_f32_16x16x32_bf16 v[164:167], v[80:83], a[132:135], v[164:167]
  ds_read_b64_tr_b16 v[76:77], v6 offset:25600
  s_waitcnt lgkmcnt(14)
  ds_read_b64_tr_b16 v[78:79], v6 offset:29696
  v_mfma_f32_16x16x32_bf16 v[168:171], v[80:83], a[136:139], v[168:171]
  v_mfma_f32_16x16x32_bf16 v[172:175], v[80:83], a[140:143], v[172:175]
  v_mfma_f32_16x16x32_bf16 v[176:179], v[84:87], a[128:131], v[176:179]
  v_mfma_f32_16x16x32_bf16 v[180:183], v[84:87], a[132:135], v[180:183]
  v_mfma_f32_16x16x32_bf16 v[184:187], v[84:87], a[136:139], v[184:187]
  s_waitcnt lgkmcnt(4)
  s_bfe_u32 s32, s59, 0x4001c
  s_lshl_b32 s32, s32, 7
  v_mfma_f32_16x16x32_bf16 v[188:191], v[84:87], a[140:143], v[188:191]
  s_add_u32 m0, s33, 8192
  s_nop 0
  v_mfma_f32_16x16x32_bf16 v[192:195], v[88:91], a[128:131], v[192:195]
  buffer_load_dwordx4 v18, s[4:7], s32 offen lds
  v_mfma_f32_16x16x32_bf16 v[196:199], v[88:91], a[132:135], v[196:199]
  buffer_load_dwordx4 v19, s[4:7], s32 offen offset:1024 lds
  v_mfma_f32_16x16x32_bf16 v[200:203], v[88:91], a[136:139], v[200:203]
  ds_read_b64_tr_b16 v[80:81], v7 offset:24576
  ds_read_b64_tr_b16 v[82:83], v7 offset:28672
  v_mfma_f32_16x16x32_bf16 v[204:207], v[88:91], a[140:143], v[204:207]
  ds_read_b64_tr_b16 v[84:85], v7 offset:25600
  ds_read_b64_tr_b16 v[86:87], v7 offset:29696
  v_mfma_f32_16x16x32_bf16 v[208:211], v[92:95], a[128:131], v[208:211]
  v_mfma_f32_16x16x32_bf16 v[212:215], v[92:95], a[132:135], v[212:215]
  buffer_load_dwordx4 v20, s[4:7], s32 offen offset:2048 lds
  v_mfma_f32_16x16x32_bf16 v[216:219], v[92:95], a[136:139], v[216:219]
  v_mfma_f32_16x16x32_bf16 v[220:223], v[92:95], a[140:143], v[220:223]
  s_waitcnt lgkmcnt(4)
  v_mfma_f32_16x16x32_bf16 v[96:99], v[72:75], a[144:147], v[96:99]
  buffer_load_dwordx4 v21, s[4:7], s32 offen offset:3072 lds
  v_mfma_f32_16x16x32_bf16 v[100:103], v[72:75], a[148:151], v[100:103]
  ds_read_b64_tr_b16 v[88:89], v8 offset:24576
  ds_read_b64_tr_b16 v[90:91], v8 offset:28672
  v_mfma_f32_16x16x32_bf16 v[104:107], v[72:75], a[152:155], v[104:107]
  ds_read_b64_tr_b16 v[92:93], v8 offset:25600
  ds_read_b64_tr_b16 v[94:95], v8 offset:29696
  v_mfma_f32_16x16x32_bf16 v[108:111], v[72:75], a[156:159], v[108:111]
  v_mfma_f32_16x16x32_bf16 v[112:115], v[76:79], a[144:147], v[112:115]
  s_add_u32 m0, s33, 12288
  s_nop 0
  buffer_load_dwordx4 v22, s[4:7], s32 offen lds
  v_mfma_f32_16x16x32_bf16 v[116:119], v[76:79], a[148:151], v[116:119]
  v_mfma_f32_16x16x32_bf16 v[120:123], v[76:79], a[152:155], v[120:123]
  v_mfma_f32_16x16x32_bf16 v[124:127], v[76:79], a[156:159], v[124:127]
  s_waitcnt lgkmcnt(4)
  buffer_load_dwordx4 v23, s[4:7], s32 offen offset:1024 lds
  v_mfma_f32_16x16x32_bf16 v[128:131], v[80:83], a[144:147], v[128:131]
  ds_read_b64_tr_b16 v[72:73], v9 offset:24576
  ds_read_b64_tr_b16 v[74:75], v9 offset:28672
  v_mfma_f32_16x16x32_bf16 v[132:135], v[80:83], a[148:151], v[132:135]
  ds_read_b64_tr_b16 v[76:77], v9 offset:25600
  ds_read_b64_tr_b16 v[78:79], v9 offset:29696
  v_mfma_f32_16x16x32_bf16 v[136:139], v[80:83], a[152:155], v[136:139]
  v_mfma_f32_16x16x32_bf16 v[140:143], v[80:83], a[156:159], v[140:143]
  buffer_load_dwordx4 v24, s[4:7], s32 offen offset:2048 lds
  v_mfma_f32_16x16x32_bf16 v[144:147], v[84:87], a[144:147], v[144:147]
  v_mfma_f32_16x16x32_bf16 v[148:151], v[84:87], a[148:151], v[148:151]
  v_mfma_f32_16x16x32_bf16 v[152:155], v[84:87], a[152:155], v[152:155]
  buffer_load_dwordx4 v25, s[4:7], s32 offen offset:3072 lds
  v_mfma_f32_16x16x32_bf16 v[156:159], v[84:87], a[156:159], v[156:159]
  s_barrier
  s_waitcnt lgkmcnt(4)
  v_mfma_f32_16x16x32_bf16 v[160:163], v[88:91], a[144:147], v[160:163]
  ds_read_b64_tr_b16 v[80:81], v6 offset:32768
  ds_read_b64_tr_b16 v[82:83], v6 offset:36864
  v_mfma_f32_16x16x32_bf16 v[164:167], v[88:91], a[148:151], v[164:167]
  ds_read_b64_tr_b16 v[84:85], v6 offset:33792
  ds_read_b64_tr_b16 v[86:87], v6 offset:37888
  v_mfma_f32_16x16x32_bf16 v[168:171], v[88:91], a[152:155], v[168:171]
  s_bfe_u32 s49, s59, 0x4001c
  s_mul_i32 s49, s49, 589824
  s_add_u32 s49, s49, s47
  v_mfma_f32_16x16x32_bf16 v[172:175], v[88:91], a[156:159], v[172:175]
  s_add_u32 m0, s48, 16384
  s_add_u32 s49, s49, 0
  v_mfma_f32_16x16x32_bf16 v[176:179], v[92:95], a[144:147], v[176:179]
  buffer_load_dwordx4 v11, s[8:11], s49 offen lds
  v_mfma_f32_16x16x32_bf16 v[180:183], v[92:95], a[148:151], v[180:183]
  buffer_load_dwordx4 v11, s[12:15], s49 offen offset:1024 lds
  v_mfma_f32_16x16x32_bf16 v[184:187], v[92:95], a[152:155], v[184:187]
  v_mfma_f32_16x16x32_bf16 v[188:191], v[92:95], a[156:159], v[188:191]
  s_waitcnt lgkmcnt(4)
  v_mfma_f32_16x16x32_bf16 v[192:195], v[72:75], a[144:147], v[192:195]
  ds_read_b64_tr_b16 v[88:89], v7 offset:32768
  ds_read_b64_tr_b16 v[90:91], v7 offset:36864
  v_mfma_f32_16x16x32_bf16 v[196:199], v[72:75], a[148:151], v[196:199]
  s_bfe_u32 s49, s59, 0x4001c
  ds_read_b64_tr_b16 v[92:93], v7 offset:33792
  s_mul_i32 s49, s49, 589824
  v_mfma_f32_16x16x32_bf16 v[200:203], v[72:75], a[152:155], v[200:203]
  s_add_u32 s49, s49, s47
  ds_read_b64_tr_b16 v[94:95], v7 offset:37888
  s_add_u32 m0, s48, 24576
  v_mfma_f32_16x16x32_bf16 v[204:207], v[72:75], a[156:159], v[204:207]
  s_add_u32 s49, s49, 294912
  buffer_load_dwordx4 v11, s[8:11], s49 offen lds
  v_mfma_f32_16x16x32_bf16 v[208:211], v[76:79], a[144:147], v[208:211]
  buffer_load_dwordx4 v11, s[12:15], s49 offen offset:1024 lds
  v_mfma_f32_16x16x32_bf16 v[212:215], v[76:79], a[148:151], v[212:215]
  v_mfma_f32_16x16x32_bf16 v[216:219], v[76:79], a[152:155], v[216:219]
  v_mfma_f32_16x16x32_bf16 v[220:223], v[76:79], a[156:159], v[220:223]
  s_waitcnt lgkmcnt(4)
  v_mfma_f32_16x16x32_bf16 v[96:99], v[80:83], a[160:163], v[96:99]
  s_waitcnt vmcnt(16)
  ds_read_b64_tr_b16 v[72:73], v8 offset:32768
  ds_read_b128 a[192:195], v2 offset:0
  v_mfma_f32_16x16x32_bf16 v[100:103], v[80:83], a[164:167], v[100:103]
  ds_read_b64_tr_b16 v[74:75], v8 offset:36864
  ds_read_b128 a[196:199], v2 offset:2048
  v_mfma_f32_16x16x32_bf16 v[104:107], v[80:83], a[168:171], v[104:107]
  ds_read_b64_tr_b16 v[76:77], v8 offset:33792
  ds_read_b128 a[200:203], v2 offset:4096
  v_mfma_f32_16x16x32_bf16 v[108:111], v[80:83], a[172:175], v[108:111]
  ds_read_b64_tr_b16 v[78:79], v8 offset:37888
  ds_read_b128 a[204:207], v2 offset:6144
  v_mfma_f32_16x16x32_bf16 v[112:115], v[84:87], a[160:163], v[112:115]
  ds_read_b128 a[208:211], v3 offset:0
  ds_read_b128 a[212:215], v3 offset:2048
  v_mfma_f32_16x16x32_bf16 v[116:119], v[84:87], a[164:167], v[116:119]
  ds_read_b128 a[216:219], v3 offset:4096
  s_waitcnt lgkmcnt(14)
  ds_read_b128 a[220:223], v3 offset:6144
  v_mfma_f32_16x16x32_bf16 v[120:123], v[84:87], a[168:171], v[120:123]
  v_mfma_f32_16x16x32_bf16 v[124:127], v[84:87], a[172:175], v[124:127]
  s_waitcnt lgkmcnt(12)
  v_mfma_f32_16x16x32_bf16 v[128:131], v[88:91], a[160:163], v[128:131]
  ds_read_b64_tr_b16 v[80:81], v9 offset:32768
  ds_read_b64_tr_b16 v[82:83], v9 offset:36864
  v_mfma_f32_16x16x32_bf16 v[132:135], v[88:91], a[164:167], v[132:135]
  ds_read_b64_tr_b16 v[84:85], v9 offset:33792
  s_waitcnt lgkmcnt(14)
  ds_read_b64_tr_b16 v[86:87], v9 offset:37888
  v_mfma_f32_16x16x32_bf16 v[136:139], v[88:91], a[168:171], v[136:139]
  v_mfma_f32_16x16x32_bf16 v[140:143], v[88:91], a[172:175], v[140:143]
  v_mfma_f32_16x16x32_bf16 v[144:147], v[92:95], a[160:163], v[144:147]
  v_mfma_f32_16x16x32_bf16 v[148:151], v[92:95], a[164:167], v[148:151]
  v_mfma_f32_16x16x32_bf16 v[152:155], v[92:95], a[168:171], v[152:155]
  s_waitcnt lgkmcnt(4)
  s_mov_b32 s32, s3
  s_lshl_b32 s32, s32, 7
  v_mfma_f32_16x16x32_bf16 v[156:159], v[92:95], a[172:175], v[156:159]
  s_add_u32 m0, s33, 0
  s_nop 0
  v_mfma_f32_16x16x32_bf16 v[160:163], v[72:75], a[160:163], v[160:163]
  buffer_load_dwordx4 v18, s[4:7], s32 offen lds
  v_mfma_f32_16x16x32_bf16 v[164:167], v[72:75], a[164:167], v[164:167]
  buffer_load_dwordx4 v19, s[4:7], s32 offen offset:1024 lds
  v_mfma_f32_16x16x32_bf16 v[168:171], v[72:75], a[168:171], v[168:171]
  ds_read_b64_tr_b16 v[88:89], v6 offset:40960
  ds_read_b64_tr_b16 v[90:91], v6 offset:45056
  v_mfma_f32_16x16x32_bf16 v[172:175], v[72:75], a[172:175], v[172:175]
  ds_read_b64_tr_b16 v[92:93], v6 offset:41984
  ds_read_b64_tr_b16 v[94:95], v6 offset:46080
  v_mfma_f32_16x16x32_bf16 v[176:179], v[76:79], a[160:163], v[176:179]
  v_mfma_f32_16x16x32_bf16 v[180:183], v[76:79], a[164:167], v[180:183]
  buffer_load_dwordx4 v20, s[4:7], s32 offen offset:2048 lds
  v_mfma_f32_16x16x32_bf16 v[184:187], v[76:79], a[168:171], v[184:187]
  v_mfma_f32_16x16x32_bf16 v[188:191], v[76:79], a[172:175], v[188:191]
  s_waitcnt lgkmcnt(4)
  v_mfma_f32_16x16x32_bf16 v[192:195], v[80:83], a[160:163], v[192:195]
  buffer_load_dwordx4 v21, s[4:7], s32 offen offset:3072 lds
  v_mfma_f32_16x16x32_bf16 v[196:199], v[80:83], a[164:167], v[196:199]
  ds_read_b64_tr_b16 v[72:73], v7 offset:40960
  ds_read_b64_tr_b16 v[74:75], v7 offset:45056
  v_mfma_f32_16x16x32_bf16 v[200:203], v[80:83], a[168:171], v[200:203]
  ds_read_b64_tr_b16 v[76:77], v7 offset:41984
  ds_read_b64_tr_b16 v[78:79], v7 offset:46080
  v_mfma_f32_16x16x32_bf16 v[204:207], v[80:83], a[172:175], v[204:207]
  v_mfma_f32_16x16x32_bf16 v[208:211], v[84:87], a[160:163], v[208:211]
  s_add_u32 m0, s33, 4096
  s_nop 0
  buffer_load_dwordx4 v22, s[4:7], s32 offen lds
  v_mfma_f32_16x16x32_bf16 v[212:215], v[84:87], a[164:167], v[212:215]
  v_mfma_f32_16x16x32_bf16 v[216:219], v[84:87], a[168:171], v[216:219]
  v_mfma_f32_16x16x32_bf16 v[220:223], v[84:87], a[172:175], v[220:223]
  s_waitcnt lgkmcnt(4)
  buffer_load_dwordx4 v23, s[4:7], s32 offen offset:1024 lds
  v_mfma_f32_16x16x32_bf16 v[96:99], v[88:91], a[176:179], v[96:99]
  ds_read_b64_tr_b16 v[80:81], v8 offset:40960
  ds_read_b64_tr_b16 v[82:83], v8 offset:45056
  v_mfma_f32_16x16x32_bf16 v[100:103], v[88:91], a[180:183], v[100:103]
  ds_read_b64_tr_b16 v[84:85], v8 offset:41984
  ds_read_b64_tr_b16 v[86:87], v8 offset:46080
  v_mfma_f32_16x16x32_bf16 v[104:107], v[88:91], a[184:187], v[104:107]
  v_mfma_f32_16x16x32_bf16 v[108:111], v[88:91], a[188:191], v[108:111]
  buffer_load_dwordx4 v24, s[4:7], s32 offen offset:2048 lds
  v_mfma_f32_16x16x32_bf16 v[112:115], v[92:95], a[176:179], v[112:115]
  v_mfma_f32_16x16x32_bf16 v[116:119], v[92:95], a[180:183], v[116:119]
  v_mfma_f32_16x16x32_bf16 v[120:123], v[92:95], a[184:187], v[120:123]
  buffer_load_dwordx4 v25, s[4:7], s32 offen offset:3072 lds
  v_mfma_f32_16x16x32_bf16 v[124:127], v[92:95], a[188:191], v[124:127]
  s_waitcnt lgkmcnt(4)
  v_mfma_f32_16x16x32_bf16 v[128:131], v[72:75], a[176:179], v[128:131]
  ds_read_b64_tr_b16 v[88:89], v9 offset:40960
  ds_read_b64_tr_b16 v[90:91], v9 offset:45056
  v_mfma_f32_16x16x32_bf16 v[132:135], v[72:75], a[180:183], v[132:135]
  ds_read_b64_tr_b16 v[92:93], v9 offset:41984
  ds_read_b64_tr_b16 v[94:95], v9 offset:46080
  v_mfma_f32_16x16x32_bf16 v[136:139], v[72:75], a[184:187], v[136:139]
  s_mov_b32 s49, s3
  s_mul_i32 s49, s49, 589824
  s_add_u32 s49, s49, s47
  v_mfma_f32_16x16x32_bf16 v[140:143], v[72:75], a[188:191], v[140:143]
  s_add_u32 m0, s48, 32768
  s_add_u32 s49, s49, 0
  v_mfma_f32_16x16x32_bf16 v[144:147], v[76:79], a[176:179], v[144:147]
  buffer_load_dwordx4 v11, s[8:11], s49 offen lds
  v_mfma_f32_16x16x32_bf16 v[148:151], v[76:79], a[180:183], v[148:151]
  buffer_load_dwordx4 v11, s[12:15], s49 offen offset:1024 lds
  v_mfma_f32_16x16x32_bf16 v[152:155], v[76:79], a[184:187], v[152:155]
  v_mfma_f32_16x16x32_bf16 v[156:159], v[76:79], a[188:191], v[156:159]
  s_waitcnt vmcnt(22)
  s_barrier
  s_waitcnt lgkmcnt(4)
  v_mfma_f32_16x16x32_bf16 v[160:163], v[80:83], a[176:179], v[160:163]
  v_subrev_u32 v6, 49152, v6
  ds_read_b64_tr_b16 v[72:73], v6 offset:0
  v_mfma_f32_16x16x32_bf16 v[164:167], v[80:83], a[180:183], v[164:167]
  s_mov_b32 s49, s3
  ds_read_b64_tr_b16 v[74:75], v6 offset:4096
  s_mul_i32 s49, s49, 589824
  v_mfma_f32_16x16x32_bf16 v[168:171], v[80:83], a[184:187], v[168:171]
  s_add_u32 s49, s49, s47
  ds_read_b64_tr_b16 v[76:77], v6 offset:1024
  s_add_u32 m0, s48, 40960
  v_mfma_f32_16x16x32_bf16 v[172:175], v[80:83], a[188:191], v[172:175]
  s_add_u32 s49, s49, 294912
  buffer_load_dwordx4 v11, s[8:11], s49 offen lds
  v_mfma_f32_16x16x32_bf16 v[176:179], v[84:87], a[176:179], v[176:179]
  buffer_load_dwordx4 v11, s[12:15], s49 offen offset:1024 lds
  v_mfma_f32_16x16x32_bf16 v[180:183], v[84:87], a[180:183], v[180:183]
  ds_read_b64_tr_b16 v[78:79], v6 offset:5120
  v_mfma_f32_16x16x32_bf16 v[184:187], v[84:87], a[184:187], v[184:187]
  v_mfma_f32_16x16x32_bf16 v[188:191], v[84:87], a[188:191], v[188:191]
  s_waitcnt lgkmcnt(4)
  v_mfma_f32_16x16x32_bf16 v[192:195], v[88:91], a[176:179], v[192:195]
  s_waitcnt vmcnt(16)
  v_subrev_u32 v7, 49152, v7
  ds_read_b128 a[224:227], v2 offset:8192
  v_mfma_f32_16x16x32_bf16 v[196:199], v[88:91], a[180:183], v[196:199]
  ds_read_b64_tr_b16 v[80:81], v7 offset:0
  ds_read_b128 a[228:231], v2 offset:10240
  v_mfma_f32_16x16x32_bf16 v[200:203], v[88:91], a[184:187], v[200:203]
  ds_read_b64_tr_b16 v[82:83], v7 offset:4096
  ds_read_b128 a[232:235], v2 offset:12288
  v_mfma_f32_16x16x32_bf16 v[204:207], v[88:91], a[188:191], v[204:207]
  ds_read_b64_tr_b16 v[84:85], v7 offset:1024
  ds_read_b128 a[236:239], v2 offset:14336
  v_mfma_f32_16x16x32_bf16 v[208:211], v[92:95], a[176:179], v[208:211]
  ds_read_b64_tr_b16 v[86:87], v7 offset:5120
  ds_read_b128 a[240:243], v3 offset:8192
  v_mfma_f32_16x16x32_bf16 v[212:215], v[92:95], a[180:183], v[212:215]
  ds_read_b128 a[244:247], v3 offset:10240
  ds_read_b128 a[248:251], v3 offset:12288
  v_mfma_f32_16x16x32_bf16 v[216:219], v[92:95], a[184:187], v[216:219]
  s_waitcnt lgkmcnt(14)
  ds_read_b128 a[252:255], v3 offset:14336
  v_mfma_f32_16x16x32_bf16 v[220:223], v[92:95], a[188:191], v[220:223]
  s_waitcnt lgkmcnt(12)
  v_mfma_f32_16x16x32_bf16 v[96:99], v[72:75], a[192:195], v[96:99]
  v_subrev_u32 v8, 49152, v8
  ds_read_b64_tr_b16 v[88:89], v8 offset:0
  v_mfma_f32_16x16x32_bf16 v[100:103], v[72:75], a[196:199], v[100:103]
  ds_read_b64_tr_b16 v[90:91], v8 offset:4096
  ds_read_b64_tr_b16 v[92:93], v8 offset:1024
  v_mfma_f32_16x16x32_bf16 v[104:107], v[72:75], a[200:203], v[104:107]
  s_waitcnt lgkmcnt(14)
  ds_read_b64_tr_b16 v[94:95], v8 offset:5120
  v_mfma_f32_16x16x32_bf16 v[108:111], v[72:75], a[204:207], v[108:111]
  v_mfma_f32_16x16x32_bf16 v[112:115], v[76:79], a[192:195], v[112:115]
  v_mfma_f32_16x16x32_bf16 v[116:119], v[76:79], a[196:199], v[116:119]
  v_mfma_f32_16x16x32_bf16 v[120:123], v[76:79], a[200:203], v[120:123]
  v_mfma_f32_16x16x32_bf16 v[124:127], v[76:79], a[204:207], v[124:127]
  s_waitcnt lgkmcnt(8)
  v_mfma_f32_16x16x32_bf16 v[128:131], v[80:83], a[192:195], v[128:131]
  v_subrev_u32 v9, 49152, v9
  ds_read_b64_tr_b16 v[72:73], v9 offset:0
  v_mfma_f32_16x16x32_bf16 v[132:135], v[80:83], a[196:199], v[132:135]
  ds_read_b64_tr_b16 v[74:75], v9 offset:4096
  ds_read_b64_tr_b16 v[76:77], v9 offset:1024
  v_mfma_f32_16x16x32_bf16 v[136:139], v[80:83], a[200:203], v[136:139]
  ds_read_b64_tr_b16 v[78:79], v9 offset:5120
  v_mfma_f32_16x16x32_bf16 v[140:143], v[80:83], a[204:207], v[140:143]
  v_mfma_f32_16x16x32_bf16 v[144:147], v[84:87], a[192:195], v[144:147]
  v_mfma_f32_16x16x32_bf16 v[148:151], v[84:87], a[196:199], v[148:151]
  v_mfma_f32_16x16x32_bf16 v[152:155], v[84:87], a[200:203], v[152:155]
  v_mfma_f32_16x16x32_bf16 v[156:159], v[84:87], a[204:207], v[156:159]
  s_waitcnt lgkmcnt(4)
  v_mfma_f32_16x16x32_bf16 v[160:163], v[88:91], a[192:195], v[160:163]
  ds_read_b64_tr_b16 v[80:81], v6 offset:8192
  ds_read_b64_tr_b16 v[82:83], v6 offset:12288
  v_mfma_f32_16x16x32_bf16 v[164:167], v[88:91], a[196:199], v[164:167]
  ds_read_b64_tr_b16 v[84:85], v6 offset:9216
  ds_read_b64_tr_b16 v[86:87], v6 offset:13312
  v_mfma_f32_16x16x32_bf16 v[168:171], v[88:91], a[200:203], v[168:171]
  v_mfma_f32_16x16x32_bf16 v[172:175], v[88:91], a[204:207], v[172:175]
  v_mfma_f32_16x16x32_bf16 v[176:179], v[92:95], a[192:195], v[176:179]
  v_mfma_f32_16x16x32_bf16 v[180:183], v[92:95], a[196:199], v[180:183]
  v_mfma_f32_16x16x32_bf16 v[184:187], v[92:95], a[200:203], v[184:187]
  v_mfma_f32_16x16x32_bf16 v[188:191], v[92:95], a[204:207], v[188:191]
  s_waitcnt lgkmcnt(4)
  v_mfma_f32_16x16x32_bf16 v[192:195], v[72:75], a[192:195], v[192:195]
  ds_read_b64_tr_b16 v[88:89], v7 offset:8192
  ds_read_b64_tr_b16 v[90:91], v7 offset:12288
  v_mfma_f32_16x16x32_bf16 v[196:199], v[72:75], a[196:199], v[196:199]
  ds_read_b64_tr_b16 v[92:93], v7 offset:9216
  ds_read_b64_tr_b16 v[94:95], v7 offset:13312
  v_mfma_f32_16x16x32_bf16 v[200:203], v[72:75], a[200:203], v[200:203]
  v_mfma_f32_16x16x32_bf16 v[204:207], v[72:75], a[204:207], v[204:207]
  v_mfma_f32_16x16x32_bf16 v[208:211], v[76:79], a[192:195], v[208:211]
  v_mfma_f32_16x16x32_bf16 v[212:215], v[76:79], a[196:199], v[212:215]
  v_mfma_f32_16x16x32_bf16 v[216:219], v[76:79], a[200:203], v[216:219]
  v_mfma_f32_16x16x32_bf16 v[220:223], v[76:79], a[204:207], v[220:223]
  s_waitcnt lgkmcnt(4)
  v_mfma_f32_16x16x32_bf16 v[96:99], v[80:83], a[208:211], v[96:99]
  ds_read_b64_tr_b16 v[72:73], v8 offset:8192
  ds_read_b64_tr_b16 v[74:75], v8 offset:12288
  v_mfma_f32_16x16x32_bf16 v[100:103], v[80:83], a[212:215], v[100:103]
  ds_read_b64_tr_b16 v[76:77], v8 offset:9216
  ds_read_b64_tr_b16 v[78:79], v8 offset:13312
  v_mfma_f32_16x16x32_bf16 v[104:107], v[80:83], a[216:219], v[104:107]
  v_mfma_f32_16x16x32_bf16 v[108:111], v[80:83], a[220:223], v[108:111]
  v_mfma_f32_16x16x32_bf16 v[112:115], v[84:87], a[208:211], v[112:115]
  v_mfma_f32_16x16x32_bf16 v[116:119], v[84:87], a[212:215], v[116:119]
  v_mfma_f32_16x16x32_bf16 v[120:123], v[84:87], a[216:219], v[120:123]
  v_mfma_f32_16x16x32_bf16 v[124:127], v[84:87], a[220:223], v[124:127]
  s_waitcnt lgkmcnt(4)
  v_mfma_f32_16x16x32_bf16 v[128:131], v[88:91], a[208:211], v[128:131]
  ds_read_b64_tr_b16 v[80:81], v9 offset:8192
  ds_read_b64_tr_b16 v[82:83], v9 offset:12288
  v_mfma_f32_16x16x32_bf16 v[132:135], v[88:91], a[212:215], v[132:135]
  ds_read_b64_tr_b16 v[84:85], v9 offset:9216
  ds_read_b64_tr_b16 v[86:87], v9 offset:13312
  v_mfma_f32_16x16x32_bf16 v[136:139], v[88:91], a[216:219], v[136:139]
  v_mfma_f32_16x16x32_bf16 v[140:143], v[88:91], a[220:223], v[140:143]
  v_mfma_f32_16x16x32_bf16 v[144:147], v[92:95], a[208:211], v[144:147]
  v_mfma_f32_16x16x32_bf16 v[148:151], v[92:95], a[212:215], v[148:151]
  v_mfma_f32_16x16x32_bf16 v[152:155], v[92:95], a[216:219], v[152:155]
  v_mfma_f32_16x16x32_bf16 v[156:159], v[92:95], a[220:223], v[156:159]
  s_waitcnt vmcnt(0)
  s_barrier
  s_waitcnt lgkmcnt(4)
  v_mfma_f32_16x16x32_bf16 v[160:163], v[72:75], a[208:211], v[160:163]
  ds_read_b64_tr_b16 v[88:89], v6 offset:16384
  ds_read_b128 v[224:227], v2 offset:0
  v_mfma_f32_16x16x32_bf16 v[164:167], v[72:75], a[212:215], v[164:167]
  ds_read_b64_tr_b16 v[90:91], v6 offset:20480
  ds_read_b128 v[228:231], v2 offset:2048
  v_mfma_f32_16x16x32_bf16 v[168:171], v[72:75], a[216:219], v[168:171]
  ds_read_b64_tr_b16 v[92:93], v6 offset:17408
  ds_read_b128 v[232:235], v2 offset:4096
  v_mfma_f32_16x16x32_bf16 v[172:175], v[72:75], a[220:223], v[172:175]
  ds_read_b64_tr_b16 v[94:95], v6 offset:21504
  ds_read_b128 v[236:239], v2 offset:6144
  v_mfma_f32_16x16x32_bf16 v[176:179], v[76:79], a[208:211], v[176:179]
  ds_read_b128 v[240:243], v3 offset:0
  ds_read_b128 v[244:247], v3 offset:2048
  v_mfma_f32_16x16x32_bf16 v[180:183], v[76:79], a[212:215], v[180:183]
  ds_read_b128 v[248:251], v3 offset:4096
  s_waitcnt lgkmcnt(14)
  ds_read_b128 v[252:255], v3 offset:6144
  v_mfma_f32_16x16x32_bf16 v[184:187], v[76:79], a[216:219], v[184:187]
  s_bfe_u32 s49, s59, 0x40000
  s_mul_i32 s49, s49, 589824
  s_add_u32 s49, s49, s47
  v_mfma_f32_16x16x32_bf16 v[188:191], v[76:79], a[220:223], v[188:191]
  s_waitcnt lgkmcnt(12)
  s_add_u32 m0, s48, 49152
  s_add_u32 s49, s49, 128
  v_mfma_f32_16x16x32_bf16 v[192:195], v[80:83], a[208:211], v[192:195]
  buffer_load_dwordx4 v11, s[8:11], s49 offen lds
  v_mfma_f32_16x16x32_bf16 v[196:199], v[80:83], a[212:215], v[196:199]
  buffer_load_dwordx4 v11, s[12:15], s49 offen offset:1024 lds
  v_mfma_f32_16x16x32_bf16 v[200:203], v[80:83], a[216:219], v[200:203]
  s_bfe_u32 s49, s59, 0x40000
  ds_read_b64_tr_b16 v[72:73], v6 offset:24576
  s_mul_i32 s49, s49, 589824
  v_mfma_f32_16x16x32_bf16 v[204:207], v[80:83], a[220:223], v[204:207]
  s_add_u32 s49, s49, s47
  ds_read_b64_tr_b16 v[74:75], v6 offset:28672
  s_add_u32 m0, s48, 57344
  v_mfma_f32_16x16x32_bf16 v[208:211], v[84:87], a[208:211], v[208:211]
  s_add_u32 s49, s49, 295040
  buffer_load_dwordx4 v11, s[8:11], s49 offen lds
  v_mfma_f32_16x16x32_bf16 v[212:215], v[84:87], a[212:215], v[212:215]
  buffer_load_dwordx4 v11, s[12:15], s49 offen offset:1024 lds
  v_mfma_f32_16x16x32_bf16 v[216:219], v[84:87], a[216:219], v[216:219]
  s_bfe_u32 s49, s59, 0x40004
  ds_read_b64_tr_b16 v[76:77], v6 offset:25600
  s_waitcnt lgkmcnt(14)
  ds_read_b64_tr_b16 v[78:79], v6 offset:29696
  v_mfma_f32_16x16x32_bf16 v[220:223], v[84:87], a[220:223], v[220:223]
  s_waitcnt lgkmcnt(9)
  s_mul_i32 s49, s49, 589824
  s_add_u32 s49, s49, s47
  v_mfma_f32_16x16x32_bf16 v[96:99], v[88:91], a[224:227], v[96:99]
  s_add_u32 m0, s48, 65536
  ds_read_b64_tr_b16 v[80:81], v6 offset:32768
  s_add_u32 s49, s49, 128
  v_mfma_f32_16x16x32_bf16 v[100:103], v[88:91], a[228:231], v[100:103]
  buffer_load_dwordx4 v11, s[8:11], s49 offen lds
  v_mfma_f32_16x16x32_bf16 v[104:107], v[88:91], a[232:235], v[104:107]
  buffer_load_dwordx4 v11, s[12:15], s49 offen offset:1024 lds
  v_mfma_f32_16x16x32_bf16 v[108:111], v[88:91], a[236:239], v[108:111]
  s_bfe_u32 s49, s59, 0x40004
  ds_read_b64_tr_b16 v[82:83], v6 offset:36864
  s_mul_i32 s49, s49, 589824
  v_mfma_f32_16x16x32_bf16 v[112:115], v[92:95], a[224:227], v[112:115]
  s_add_u32 s49, s49, s47
  ds_read_b64_tr_b16 v[84:85], v6 offset:33792
  s_add_u32 m0, s48, 73728
  v_mfma_f32_16x16x32_bf16 v[116:119], v[92:95], a[228:231], v[116:119]
  s_add_u32 s49, s49, 295040
  buffer_load_dwordx4 v11, s[8:11], s49 offen lds
  v_mfma_f32_16x16x32_bf16 v[120:123], v[92:95], a[232:235], v[120:123]
  buffer_load_dwordx4 v11, s[12:15], s49 offen offset:1024 lds
  v_mfma_f32_16x16x32_bf16 v[124:127], v[92:95], a[236:239], v[124:127]
  s_waitcnt lgkmcnt(3)
  ds_read_b64_tr_b16 v[86:87], v6 offset:37888
  v_mfma_f32_16x16x32_bf16 v[96:99], v[72:75], a[240:243], v[96:99]
  ds_read_b64_tr_b16 v[88:89], v6 offset:40960
  ds_read_b64_tr_b16 v[90:91], v6 offset:45056
  v_mfma_f32_16x16x32_bf16 v[100:103], v[72:75], a[244:247], v[100:103]
  s_bfe_u32 s49, s59, 0x40008
  ds_read_b64_tr_b16 v[92:93], v6 offset:41984
  s_mul_i32 s49, s49, 589824
  v_mfma_f32_16x16x32_bf16 v[104:107], v[72:75], a[248:251], v[104:107]
  s_add_u32 s49, s49, s47
  ds_read_b64_tr_b16 v[94:95], v6 offset:46080
  s_add_u32 m0, s48, 81920
  v_mfma_f32_16x16x32_bf16 v[108:111], v[72:75], a[252:255], v[108:111]
  s_add_u32 s49, s49, 128
  buffer_load_dwordx4 v11, s[8:11], s49 offen lds
  v_mfma_f32_16x16x32_bf16 v[112:115], v[76:79], a[240:243], v[112:115]
  buffer_load_dwordx4 v11, s[12:15], s49 offen offset:1024 lds
  v_mfma_f32_16x16x32_bf16 v[116:119], v[76:79], a[244:247], v[116:119]
  v_mfma_f32_16x16x32_bf16 v[120:123], v[76:79], a[248:251], v[120:123]
  v_mfma_f32_16x16x32_bf16 v[124:127], v[76:79], a[252:255], v[124:127]
  s_waitcnt lgkmcnt(4)
  s_bfe_u32 s49, s59, 0x40008
  s_mul_i32 s49, s49, 589824
  v_mfma_f32_16x16x32_bf16 v[96:99], v[80:83], v[224:227], v[96:99]
  s_add_u32 s49, s49, s47
  ds_read_b64_tr_b16 v[72:73], v7 offset:16384
  s_add_u32 m0, s48, 90112
  v_mfma_f32_16x16x32_bf16 v[100:103], v[80:83], v[228:231], v[100:103]
  s_add_u32 s49, s49, 295040
  buffer_load_dwordx4 v11, s[8:11], s49 offen lds
  v_mfma_f32_16x16x32_bf16 v[104:107], v[80:83], v[232:235], v[104:107]
  buffer_load_dwordx4 v11, s[12:15], s49 offen offset:1024 lds
  v_mfma_f32_16x16x32_bf16 v[108:111], v[80:83], v[236:239], v[108:111]
  ds_read_b64_tr_b16 v[74:75], v7 offset:20480
  ds_read_b64_tr_b16 v[76:77], v7 offset:17408
  v_mfma_f32_16x16x32_bf16 v[112:115], v[84:87], v[224:227], v[112:115]
  ds_read_b64_tr_b16 v[78:79], v7 offset:21504
  v_mfma_f32_16x16x32_bf16 v[116:119], v[84:87], v[228:231], v[116:119]
  v_mfma_f32_16x16x32_bf16 v[120:123], v[84:87], v[232:235], v[120:123]
  v_mfma_f32_16x16x32_bf16 v[124:127], v[84:87], v[236:239], v[124:127]
  s_waitcnt lgkmcnt(4)
  v_mfma_f32_16x16x32_bf16 v[96:99], v[88:91], v[240:243], v[96:99]
  ds_read_b64_tr_b16 v[80:81], v7 offset:24576
  ds_read_b64_tr_b16 v[82:83], v7 offset:28672
  v_mfma_f32_16x16x32_bf16 v[100:103], v[88:91], v[244:247], v[100:103]
  ds_read_b64_tr_b16 v[84:85], v7 offset:25600
  ds_read_b64_tr_b16 v[86:87], v7 offset:29696
  v_mfma_f32_16x16x32_bf16 v[104:107], v[88:91], v[248:251], v[104:107]
  v_mfma_f32_16x16x32_bf16 v[108:111], v[88:91], v[252:255], v[108:111]
  v_mfma_f32_16x16x32_bf16 v[112:115], v[92:95], v[240:243], v[112:115]
  v_mfma_f32_16x16x32_bf16 v[116:119], v[92:95], v[244:247], v[116:119]
  v_mfma_f32_16x16x32_bf16 v[120:123], v[92:95], v[248:251], v[120:123]
  v_mfma_f32_16x16x32_bf16 v[124:127], v[92:95], v[252:255], v[124:127]
  s_barrier
  s_waitcnt lgkmcnt(4)
  v_mfma_f32_16x16x32_bf16 v[128:131], v[72:75], a[224:227], v[128:131]
  ds_read_b64_tr_b16 v[88:89], v7 offset:32768
  ds_read_b64_tr_b16 v[90:91], v7 offset:36864
  v_mfma_f32_16x16x32_bf16 v[132:135], v[72:75], a[228:231], v[132:135]
  s_bfe_u32 s49, s59, 0x4000c
  ds_read_b64_tr_b16 v[92:93], v7 offset:33792
  s_mul_i32 s49, s49, 589824
  v_mfma_f32_16x16x32_bf16 v[136:139], v[72:75], a[232:235], v[136:139]
  s_add_u32 s49, s49, s47
  ds_read_b64_tr_b16 v[94:95], v7 offset:37888
  v_mul_f32 v40, s46, v96
  v_mfma_f32_16x16x32_bf16 v[140:143], v[72:75], a[236:239], v[140:143]
  s_add_u32 m0, s48, 98304
  v_mul_f32 v41, s46, v97
  v_mul_f32 v42, s46, v98
  v_mfma_f32_16x16x32_bf16 v[144:147], v[76:79], a[224:227], v[144:147]
  s_add_u32 s49, s49, 128
  buffer_load_dwordx4 v11, s[8:11], s49 offen lds
  v_mfma_f32_16x16x32_bf16 v[148:151], v[76:79], a[228:231], v[148:151]
  buffer_load_dwordx4 v11, s[12:15], s49 offen offset:1024 lds
  v_mfma_f32_16x16x32_bf16 v[152:155], v[76:79], a[232:235], v[152:155]
  v_mul_f32 v43, s46, v99
  v_mfma_f32_16x16x32_bf16 v[156:159], v[76:79], a[236:239], v[156:159]
  s_waitcnt lgkmcnt(4)
  v_exp_f32 v40, v40
  v_mfma_f32_16x16x32_bf16 v[128:131], v[80:83], a[240:243], v[128:131]
  v_exp_f32 v41, v41
  v_mfma_f32_16x16x32_bf16 v[132:135], v[80:83], a[244:247], v[132:135]
  s_bfe_u32 s49, s59, 0x4000c
  v_exp_f32 v42, v42
  v_mfma_f32_16x16x32_bf16 v[136:139], v[80:83], a[248:251], v[136:139]
  s_mul_i32 s49, s49, 589824
  ds_read_b64_tr_b16 v[72:73], v7 offset:40960
  s_add_u32 s49, s49, s47
  v_mfma_f32_16x16x32_bf16 v[140:143], v[80:83], a[252:255], v[140:143]
  s_add_u32 m0, s48, 106496
  ds_read_b64_tr_b16 v[74:75], v7 offset:45056
  s_add_u32 s49, s49, 295040
  v_mfma_f32_16x16x32_bf16 v[144:147], v[84:87], a[240:243], v[144:147]
  buffer_load_dwordx4 v11, s[8:11], s49 offen lds
  v_mfma_f32_16x16x32_bf16 v[148:151], v[84:87], a[244:247], v[148:151]
  buffer_load_dwordx4 v11, s[12:15], s49 offen offset:1024 lds
  v_mfma_f32_16x16x32_bf16 v[152:155], v[84:87], a[248:251], v[152:155]
  ds_read_b64_tr_b16 v[76:77], v7 offset:41984
  ds_read_b64_tr_b16 v[78:79], v7 offset:46080
  v_mfma_f32_16x16x32_bf16 v[156:159], v[84:87], a[252:255], v[156:159]
  s_waitcnt lgkmcnt(4)
  v_exp_f32 v43, v43
  v_mfma_f32_16x16x32_bf16 v[128:131], v[88:91], v[224:227], v[128:131]
  ds_read_b64_tr_b16 v[80:81], v8 offset:16384
  v_mul_f32 v112, v96, v112
  v_mfma_f32_16x16x32_bf16 v[132:135], v[88:91], v[228:231], v[132:135]
  s_bfe_u32 s49, s59, 0x40010
  ds_read_b64_tr_b16 v[82:83], v8 offset:20480
  v_mul_f32 v113, v97, v113
  v_mfma_f32_16x16x32_bf16 v[136:139], v[88:91], v[232:235], v[136:139]
  s_mul_i32 s49, s49, 589824
  ds_read_b64_tr_b16 v[84:85], v8 offset:17408
  v_mul_f32 v114, v98, v114
  v_mfma_f32_16x16x32_bf16 v[140:143], v[88:91], v[236:239], v[140:143]
  s_add_u32 s49, s49, s47
  ds_read_b64_tr_b16 v[86:87], v8 offset:21504
  v_mul_f32 v115, v99, v115
  v_mfma_f32_16x16x32_bf16 v[144:147], v[92:95], v[224:227], v[144:147]
  s_add_u32 m0, s48, 114688
  v_add_f32 v40, 1.0, v40
  v_add_f32 v41, 1.0, v41
  v_mfma_f32_16x16x32_bf16 v[148:151], v[92:95], v[228:231], v[148:151]
  s_add_u32 s49, s49, 128
  buffer_load_dwordx4 v11, s[8:11], s49 offen lds
  v_mfma_f32_16x16x32_bf16 v[152:155], v[92:95], v[232:235], v[152:155]
  buffer_load_dwordx4 v11, s[12:15], s49 offen offset:1024 lds
  v_mfma_f32_16x16x32_bf16 v[156:159], v[92:95], v[236:239], v[156:159]
  s_waitcnt lgkmcnt(4)
  v_add_f32 v42, 1.0, v42
  v_add_f32 v43, 1.0, v43
  v_mfma_f32_16x16x32_bf16 v[128:131], v[72:75], v[240:243], v[128:131]
  v_rcp_f32 v40, v40
  v_mfma_f32_16x16x32_bf16 v[132:135], v[72:75], v[244:247], v[132:135]
  s_bfe_u32 s49, s59, 0x40010
  v_rcp_f32 v41, v41
  v_mfma_f32_16x16x32_bf16 v[136:139], v[72:75], v[248:251], v[136:139]
  s_mul_i32 s49, s49, 589824
  ds_read_b64_tr_b16 v[88:89], v8 offset:24576
  s_add_u32 s49, s49, s47
  v_mfma_f32_16x16x32_bf16 v[140:143], v[72:75], v[252:255], v[140:143]
  s_add_u32 m0, s48, 122880
  ds_read_b64_tr_b16 v[90:91], v8 offset:28672
  s_add_u32 s49, s49, 295040
  v_mfma_f32_16x16x32_bf16 v[144:147], v[76:79], v[240:243], v[144:147]
  buffer_load_dwordx4 v11, s[8:11], s49 offen lds
  v_mfma_f32_16x16x32_bf16 v[148:151], v[76:79], v[244:247], v[148:151]
  buffer_load_dwordx4 v11, s[12:15], s49 offen offset:1024 lds
  v_mfma_f32_16x16x32_bf16 v[152:155], v[76:79], v[248:251], v[152:155]
  ds_read_b64_tr_b16 v[92:93], v8 offset:25600
  ds_read_b64_tr_b16 v[94:95], v8 offset:29696
  v_mfma_f32_16x16x32_bf16 v[156:159], v[76:79], v[252:255], v[156:159]
  s_waitcnt lgkmcnt(4)
  v_rcp_f32 v42, v42
  v_mfma_f32_16x16x32_bf16 v[160:163], v[80:83], a[224:227], v[160:163]
  v_rcp_f32 v43, v43
  v_mfma_f32_16x16x32_bf16 v[164:167], v[80:83], a[228:231], v[164:167]
  s_bfe_u32 s49, s59, 0x40014
  ds_read_b64_tr_b16 v[72:73], v8 offset:32768
  v_mul_f32 v112, v112, v40
  v_mfma_f32_16x16x32_bf16 v[168:171], v[80:83], a[232:235], v[168:171]
  s_mul_i32 s49, s49, 589824
  ds_read_b64_tr_b16 v[74:75], v8 offset:36864
  v_mul_f32 v113, v113, v41
  v_mfma_f32_16x16x32_bf16 v[172:175], v[80:83], a[236:239], v[172:175]
  s_add_u32 s49, s49, s47
  ds_read_b64_tr_b16 v[76:77], v8 offset:33792
  v_mul_f32 v114, v114, v42
  v_mfma_f32_16x16x32_bf16 v[176:179], v[84:87], a[224:227], v[176:179]
  s_add_u32 m0, s48, 131072
  ds_read_b64_tr_b16 v[78:79], v8 offset:37888
  v_mul_f32 v115, v115, v43
  v_mfma_f32_16x16x32_bf16 v[180:183], v[84:87], a[228:231], v[180:183]
  s_add_u32 s49, s49, 128
  buffer_load_dwordx4 v11, s[8:11], s49 offen lds
  v_mfma_f32_16x16x32_bf16 v[184:187], v[84:87], a[232:235], v[184:187]
  buffer_load_dwordx4 v11, s[12:15], s49 offen offset:1024 lds
  v_mfma_f32_16x16x32_bf16 v[188:191], v[84:87], a[236:239], v[188:191]
  s_waitcnt lgkmcnt(4)
  v_cvt_pk_bf16_f32 v56, v112, v113
  v_cvt_pk_bf16_f32 v57, v114, v115
  v_mfma_f32_16x16x32_bf16 v[160:163], v[88:91], a[240:243], v[160:163]
  ds_read_b64_tr_b16 v[80:81], v8 offset:40960
  v_mul_f32 v40, s46, v100
  v_mfma_f32_16x16x32_bf16 v[164:167], v[88:91], a[244:247], v[164:167]
  s_bfe_u32 s49, s59, 0x40014
  ds_read_b64_tr_b16 v[82:83], v8 offset:45056
  v_mul_f32 v41, s46, v101
  v_mfma_f32_16x16x32_bf16 v[168:171], v[88:91], a[248:251], v[168:171]
  s_mul_i32 s49, s49, 589824
  ds_read_b64_tr_b16 v[84:85], v8 offset:41984
  v_mul_f32 v42, s46, v102
  v_mfma_f32_16x16x32_bf16 v[172:175], v[88:91], a[252:255], v[172:175]
  s_add_u32 s49, s49, s47
  ds_read_b64_tr_b16 v[86:87], v8 offset:46080
  v_mul_f32 v43, s46, v103
  v_mfma_f32_16x16x32_bf16 v[176:179], v[92:95], a[240:243], v[176:179]
  s_add_u32 m0, s48, 139264
  v_exp_f32 v40, v40
  v_mfma_f32_16x16x32_bf16 v[180:183], v[92:95], a[244:247], v[180:183]
  s_add_u32 s49, s49, 295040
  buffer_load_dwordx4 v11, s[8:11], s49 offen lds
  v_mfma_f32_16x16x32_bf16 v[184:187], v[92:95], a[248:251], v[184:187]
  buffer_load_dwordx4 v11, s[12:15], s49 offen offset:1024 lds
  v_mfma_f32_16x16x32_bf16 v[188:191], v[92:95], a[252:255], v[188:191]
  s_waitcnt lgkmcnt(4)
  v_exp_f32 v41, v41
  v_mfma_f32_16x16x32_bf16 v[160:163], v[72:75], v[224:227], v[160:163]
  v_exp_f32 v42, v42
  v_mfma_f32_16x16x32_bf16 v[164:167], v[72:75], v[228:231], v[164:167]
  v_exp_f32 v43, v43
  v_mfma_f32_16x16x32_bf16 v[168:171], v[72:75], v[232:235], v[168:171]
  ds_read_b64_tr_b16 v[88:89], v9 offset:16384
  v_mul_f32 v116, v100, v116
  v_mfma_f32_16x16x32_bf16 v[172:175], v[72:75], v[236:239], v[172:175]
  ds_read_b64_tr_b16 v[90:91], v9 offset:20480
  v_mul_f32 v117, v101, v117
  v_mfma_f32_16x16x32_bf16 v[176:179], v[76:79], v[224:227], v[176:179]
  ds_read_b64_tr_b16 v[92:93], v9 offset:17408
  v_mul_f32 v118, v102, v118
  v_mfma_f32_16x16x32_bf16 v[180:183], v[76:79], v[228:231], v[180:183]
  ds_read_b64_tr_b16 v[94:95], v9 offset:21504
  v_mul_f32 v119, v103, v119
  v_mfma_f32_16x16x32_bf16 v[184:187], v[76:79], v[232:235], v[184:187]
  v_add_f32 v40, 1.0, v40
  v_add_f32 v41, 1.0, v41
  v_mfma_f32_16x16x32_bf16 v[188:191], v[76:79], v[236:239], v[188:191]
  s_waitcnt lgkmcnt(4)
  v_add_f32 v42, 1.0, v42
  v_add_f32 v43, 1.0, v43
  v_mfma_f32_16x16x32_bf16 v[160:163], v[80:83], v[240:243], v[160:163]
  v_rcp_f32 v40, v40
  v_mfma_f32_16x16x32_bf16 v[164:167], v[80:83], v[244:247], v[164:167]
  v_rcp_f32 v41, v41
  v_mfma_f32_16x16x32_bf16 v[168:171], v[80:83], v[248:251], v[168:171]
  ds_read_b64_tr_b16 v[72:73], v9 offset:24576
  ds_read_b64_tr_b16 v[74:75], v9 offset:28672
  v_mfma_f32_16x16x32_bf16 v[172:175], v[80:83], v[252:255], v[172:175]
  v_rcp_f32 v42, v42
  v_mfma_f32_16x16x32_bf16 v[176:179], v[84:87], v[240:243], v[176:179]
  ds_read_b64_tr_b16 v[76:77], v9 offset:25600
  ds_read_b64_tr_b16 v[78:79], v9 offset:29696
  v_mfma_f32_16x16x32_bf16 v[180:183], v[84:87], v[244:247], v[180:183]
  v_rcp_f32 v43, v43
  v_mfma_f32_16x16x32_bf16 v[184:187], v[84:87], v[248:251], v[184:187]
  v_mul_f32 v116, v116, v40
  v_mul_f32 v117, v117, v41
  v_mfma_f32_16x16x32_bf16 v[188:191], v[84:87], v[252:255], v[188:191]
  s_waitcnt lgkmcnt(4)
  v_mul_f32 v118, v118, v42
  v_mul_f32 v119, v119, v43
  v_mfma_f32_16x16x32_bf16 v[192:195], v[88:91], a[224:227], v[192:195]
  s_bfe_u32 s49, s59, 0x40000
  ds_read_b64_tr_b16 v[80:81], v9 offset:32768
  v_cvt_pk_bf16_f32 v60, v116, v117
  v_mfma_f32_16x16x32_bf16 v[196:199], v[88:91], a[228:231], v[196:199]
  s_mul_i32 s49, s49, 589824
  ds_read_b64_tr_b16 v[82:83], v9 offset:36864
  v_cvt_pk_bf16_f32 v61, v118, v119
  v_mfma_f32_16x16x32_bf16 v[200:203], v[88:91], a[232:235], v[200:203]
  s_add_u32 m0, s60, 147456
  ds_read_b64_tr_b16 v[84:85], v9 offset:33792
  v_mul_f32 v40, s46, v104
  v_mfma_f32_16x16x32_bf16 v[204:207], v[88:91], a[236:239], v[204:207]
  s_add_u32 s49, s49, s58
  buffer_load_dwordx4 v12, s[20:23], s49 offen lds
  v_mfma_f32_16x16x32_bf16 v[208:211], v[92:95], a[224:227], v[208:211]
  ds_read_b64_tr_b16 v[86:87], v9 offset:37888
  v_mul_f32 v41, s46, v105
  v_mfma_f32_16x16x32_bf16 v[212:215], v[92:95], a[228:231], v[212:215]
  v_mul_f32 v42, s46, v106
  v_mul_f32 v43, s46, v107
  v_mfma_f32_16x16x32_bf16 v[216:219], v[92:95], a[232:235], v[216:219]
  v_exp_f32 v40, v40
  v_mfma_f32_16x16x32_bf16 v[220:223], v[92:95], a[236:239], v[220:223]
  s_waitcnt lgkmcnt(4)
  v_exp_f32 v41, v41
  v_mfma_f32_16x16x32_bf16 v[192:195], v[72:75], a[240:243], v[192:195]
  v_exp_f32 v42, v42
  v_mfma_f32_16x16x32_bf16 v[196:199], v[72:75], a[244:247], v[196:199]
  v_exp_f32 v43, v43
  v_mfma_f32_16x16x32_bf16 v[200:203], v[72:75], a[248:251], v[200:203]
  ds_read_b64_tr_b16 v[88:89], v9 offset:40960
  v_mul_f32 v120, v104, v120
  v_mfma_f32_16x16x32_bf16 v[204:207], v[72:75], a[252:255], v[204:207]
  ds_read_b64_tr_b16 v[90:91], v9 offset:45056
  v_mul_f32 v121, v105, v121
  v_mfma_f32_16x16x32_bf16 v[208:211], v[76:79], a[240:243], v[208:211]
  s_bfe_u32 s49, s59, 0x40004
  ds_read_b64_tr_b16 v[92:93], v9 offset:41984
  v_mul_f32 v122, v106, v122
  v_mfma_f32_16x16x32_bf16 v[212:215], v[76:79], a[244:247], v[212:215]
  s_mul_i32 s49, s49, 589824
  ds_read_b64_tr_b16 v[94:95], v9 offset:46080
  v_mul_f32 v123, v107, v123
  v_mfma_f32_16x16x32_bf16 v[216:219], v[76:79], a[248:251], v[216:219]
  s_add_u32 m0, s60, 151552
  v_add_f32 v40, 1.0, v40
  v_add_f32 v41, 1.0, v41
  v_mfma_f32_16x16x32_bf16 v[220:223], v[76:79], a[252:255], v[220:223]
  s_add_u32 s49, s49, s58
  buffer_load_dwordx4 v12, s[20:23], s49 offen lds
  s_waitcnt vmcnt(14)
  s_barrier
  s_waitcnt lgkmcnt(4)
  v_mfma_f32_16x16x32_bf16 v[192:195], v[80:83], v[224:227], v[192:195]
  ds_read_b64_tr_b16 v[72:73], v6 offset:49152
  v_add_f32 v42, 1.0, v42
  v_mfma_f32_16x16x32_bf16 v[196:199], v[80:83], v[228:231], v[196:199]
  ds_read_b64_tr_b16 v[74:75], v6 offset:53248
  v_add_f32 v43, 1.0, v43
  v_mfma_f32_16x16x32_bf16 v[200:203], v[80:83], v[232:235], v[200:203]
  v_rcp_f32 v40, v40
  v_mfma_f32_16x16x32_bf16 v[204:207], v[80:83], v[236:239], v[204:207]
  v_rcp_f32 v41, v41
  v_mfma_f32_16x16x32_bf16 v[208:211], v[84:87], v[224:227], v[208:211]
  ds_read_b64_tr_b16 v[76:77], v6 offset:50176
  ds_read_b64_tr_b16 v[78:79], v6 offset:54272
  v_mfma_f32_16x16x32_bf16 v[212:215], v[84:87], v[228:231], v[212:215]
  v_rcp_f32 v42, v42
  v_mfma_f32_16x16x32_bf16 v[216:219], v[84:87], v[232:235], v[216:219]
  v_rcp_f32 v43, v43
  v_mfma_f32_16x16x32_bf16 v[220:223], v[84:87], v[236:239], v[220:223]
  s_waitcnt lgkmcnt(4)
  v_mul_f32 v120, v120, v40
  v_mul_f32 v121, v121, v41
  v_mfma_f32_16x16x32_bf16 v[192:195], v[88:91], v[240:243], v[192:195]
  s_bfe_u32 s49, s59, 0x40008
  ds_read_b64_tr_b16 v[80:81], v6 offset:57344
  v_mul_f32 v122, v122, v42
  v_mfma_f32_16x16x32_bf16 v[196:199], v[88:91], v[244:247], v[196:199]
  s_mul_i32 s49, s49, 589824
  ds_read_b64_tr_b16 v[82:83], v6 offset:61440
  v_mul_f32 v123, v123, v43
  v_mfma_f32_16x16x32_bf16 v[200:203], v[88:91], v[248:251], v[200:203]
  s_add_u32 m0, s60, 155648
  ds_read_b64_tr_b16 v[84:85], v6 offset:58368
  v_cvt_pk_bf16_f32 v64, v120, v121
  v_mfma_f32_16x16x32_bf16 v[204:207], v[88:91], v[252:255], v[204:207]
  s_add_u32 s49, s49, s58
  buffer_load_dwordx4 v12, s[20:23], s49 offen lds
  v_mfma_f32_16x16x32_bf16 v[208:211], v[92:95], v[240:243], v[208:211]
  ds_read_b64_tr_b16 v[86:87], v6 offset:62464
  v_cvt_pk_bf16_f32 v65, v122, v123
  v_mfma_f32_16x16x32_bf16 v[212:215], v[92:95], v[244:247], v[212:215]
  v_mul_f32 v40, s46, v108
  v_mul_f32 v41, s46, v109
  v_mfma_f32_16x16x32_bf16 v[216:219], v[92:95], v[248:251], v[216:219]
  v_mul_f32 v42, s46, v110
  v_mul_f32 v43, s46, v111
  v_mfma_f32_16x16x32_bf16 v[220:223], v[92:95], v[252:255], v[220:223]
  s_waitcnt lgkmcnt(4)
  v_exp_f32 v40, v40
  v_exp_f32 v41, v41
  v_exp_f32 v42, v42
  v_exp_f32 v43, v43
  v_mul_f32 v124, v108, v124
  v_mul_f32 v125, v109, v125
  v_mul_f32 v126, v110, v126
  v_mul_f32 v127, v111, v127
  v_add_f32 v40, 1.0, v40
  v_add_f32 v41, 1.0, v41
  v_add_f32 v42, 1.0, v42
  v_add_f32 v43, 1.0, v43
  v_rcp_f32 v40, v40
  v_rcp_f32 v41, v41
  v_rcp_f32 v42, v42
  v_rcp_f32 v43, v43
  v_mul_f32 v124, v124, v40
  v_mul_f32 v125, v125, v41
  v_mul_f32 v126, v126, v42
  v_mul_f32 v127, v127, v43
  v_cvt_pk_bf16_f32 v68, v124, v125
  v_cvt_pk_bf16_f32 v69, v126, v127
  v_mfma_f32_16x16x32_bf16 v[96:99], v[72:75], a[0:3], 0
  v_add_u32 v6, 49152, v6
  v_mul_f32 v40, s46, v128
  v_mfma_f32_16x16x32_bf16 v[100:103], v[72:75], a[4:7], 0
  ds_read_b64_tr_b16 v[88:89], v6 offset:16384
  v_mul_f32 v41, s46, v129
  v_mfma_f32_16x16x32_bf16 v[104:107], v[72:75], a[8:11], 0
  v_mov_b32 v33, 0
  global_load_dword v34, v33, s[100:101] sc1
  v_mfma_f32_16x16x32_bf16 v[108:111], v[72:75], a[12:15], 0
  ds_read_b64_tr_b16 v[90:91], v6 offset:20480
  v_mul_f32 v42, s46, v130
  v_mfma_f32_16x16x32_bf16 v[112:115], v[76:79], a[0:3], 0
  s_bfe_u32 s49, s59, 0x4000c
  ds_read_b64_tr_b16 v[92:93], v6 offset:17408
  v_mul_f32 v43, s46, v131
  v_mfma_f32_16x16x32_bf16 v[116:119], v[76:79], a[4:7], 0
  s_mul_i32 s49, s49, 589824
  ds_read_b64_tr_b16 v[94:95], v6 offset:21504
  s_add_u32 m0, s60, 159744
  v_mfma_f32_16x16x32_bf16 v[120:123], v[76:79], a[8:11], 0
  s_add_u32 s49, s49, s58
  buffer_load_dwordx4 v12, s[20:23], s49 offen lds
  v_mfma_f32_16x16x32_bf16 v[124:127], v[76:79], a[12:15], 0
  s_waitcnt lgkmcnt(4)
  v_exp_f32 v40, v40
  v_mfma_f32_16x16x32_bf16 v[96:99], v[80:83], a[16:19], v[96:99]
  v_exp_f32 v41, v41
  v_mfma_f32_16x16x32_bf16 v[100:103], v[80:83], a[20:23], v[100:103]
  v_exp_f32 v42, v42
  v_mfma_f32_16x16x32_bf16 v[104:107], v[80:83], a[24:27], v[104:107]
  ds_read_b64_tr_b16 v[72:73], v6 offset:24576
  ds_read_b64_tr_b16 v[74:75], v6 offset:28672
  v_mfma_f32_16x16x32_bf16 v[108:111], v[80:83], a[28:31], v[108:111]
  v_exp_f32 v43, v43
  v_mfma_f32_16x16x32_bf16 v[112:115], v[84:87], a[16:19], v[112:115]
  ds_read_b64_tr_b16 v[76:77], v6 offset:25600
  v_mul_f32 v144, v128, v144
  v_mfma_f32_16x16x32_bf16 v[116:119], v[84:87], a[20:23], v[116:119]
  ds_read_b64_tr_b16 v[78:79], v6 offset:29696
  v_mul_f32 v145, v129, v145
  v_mfma_f32_16x16x32_bf16 v[120:123], v[84:87], a[24:27], v[120:123]
  v_mul_f32 v146, v130, v146
  v_mul_f32 v147, v131, v147
  v_mfma_f32_16x16x32_bf16 v[124:127], v[84:87], a[28:31], v[124:127]
  s_waitcnt lgkmcnt(4)
  v_add_f32 v40, 1.0, v40
  v_add_f32 v41, 1.0, v41
  v_mfma_f32_16x16x32_bf16 v[96:99], v[88:91], a[32:35], v[96:99]
  ds_read_b64_tr_b16 v[80:81], v6 offset:32768
  v_add_f32 v42, 1.0, v42
  v_mfma_f32_16x16x32_bf16 v[100:103], v[88:91], a[36:39], v[100:103]
  ds_read_b64_tr_b16 v[82:83], v6 offset:36864
  v_add_f32 v43, 1.0, v43
  v_mfma_f32_16x16x32_bf16 v[104:107], v[88:91], a[40:43], v[104:107]
  v_rcp_f32 v40, v40
  v_mfma_f32_16x16x32_bf16 v[108:111], v[88:91], a[44:47], v[108:111]
  v_rcp_f32 v41, v41
  v_mfma_f32_16x16x32_bf16 v[112:115], v[92:95], a[32:35], v[112:115]
  ds_read_b64_tr_b16 v[84:85], v6 offset:33792
  ds_read_b64_tr_b16 v[86:87], v6 offset:37888
  v_mfma_f32_16x16x32_bf16 v[116:119], v[92:95], a[36:39], v[116:119]
  v_rcp_f32 v42, v42
  v_mfma_f32_16x16x32_bf16 v[120:123], v[92:95], a[40:43], v[120:123]
  v_rcp_f32 v43, v43
  v_mfma_f32_16x16x32_bf16 v[124:127], v[92:95], a[44:47], v[124:127]
  s_waitcnt lgkmcnt(4)
  v_mul_f32 v144, v144, v40
  v_mul_f32 v145, v145, v41
  v_mfma_f32_16x16x32_bf16 v[96:99], v[72:75], a[48:51], v[96:99]
  ds_read_b64_tr_b16 v[88:89], v6 offset:40960
  v_mul_f32 v146, v146, v42
  v_mfma_f32_16x16x32_bf16 v[100:103], v[72:75], a[52:55], v[100:103]
  ds_read_b64_tr_b16 v[90:91], v6 offset:45056
  v_mul_f32 v147, v147, v43
  v_mfma_f32_16x16x32_bf16 v[104:107], v[72:75], a[56:59], v[104:107]
  ds_read_b64_tr_b16 v[92:93], v6 offset:41984
  v_cvt_pk_bf16_f32 v58, v144, v145
  v_mfma_f32_16x16x32_bf16 v[108:111], v[72:75], a[60:63], v[108:111]
  ds_read_b64_tr_b16 v[94:95], v6 offset:46080
  v_cvt_pk_bf16_f32 v59, v146, v147
  v_mfma_f32_16x16x32_bf16 v[112:115], v[76:79], a[48:51], v[112:115]
  buffer_store_dwordx4 v[56:59], v14, s[16:19], s50 offen offset:0 sc1
  v_mfma_f32_16x16x32_bf16 v[116:119], v[76:79], a[52:55], v[116:119]
  v_mul_f32 v40, s46, v132
  v_mul_f32 v41, s46, v133
  v_mfma_f32_16x16x32_bf16 v[120:123], v[76:79], a[56:59], v[120:123]
  v_mul_f32 v42, s46, v134
  v_mul_f32 v43, s46, v135
  v_mfma_f32_16x16x32_bf16 v[124:127], v[76:79], a[60:63], v[124:127]
  v_exp_f32 v40, v40
  s_waitcnt vmcnt(6)
  s_barrier
  s_waitcnt lgkmcnt(4)
  v_mfma_f32_16x16x32_bf16 v[96:99], v[80:83], a[64:67], v[96:99]
  v_exp_f32 v41, v41
  v_mfma_f32_16x16x32_bf16 v[100:103], v[80:83], a[68:71], v[100:103]
  s_bfe_u32 s49, s59, 0x40018
  v_exp_f32 v42, v42
  v_mfma_f32_16x16x32_bf16 v[104:107], v[80:83], a[72:75], v[104:107]
  s_mul_i32 s49, s49, 589824
  ds_read_b64_tr_b16 v[72:73], v6 offset:49152
  s_add_u32 s49, s49, s47
  v_mfma_f32_16x16x32_bf16 v[108:111], v[80:83], a[76:79], v[108:111]
  s_add_u32 m0, s48, 0
  ds_read_b64_tr_b16 v[74:75], v6 offset:53248
  s_add_u32 s49, s49, 128
  v_mfma_f32_16x16x32_bf16 v[112:115], v[84:87], a[64:67], v[112:115]
  buffer_load_dwordx4 v11, s[8:11], s49 offen lds
  v_mfma_f32_16x16x32_bf16 v[116:119], v[84:87], a[68:71], v[116:119]
  buffer_load_dwordx4 v11, s[12:15], s49 offen offset:1024 lds
  v_mfma_f32_16x16x32_bf16 v[120:123], v[84:87], a[72:75], v[120:123]
  ds_read_b64_tr_b16 v[76:77], v6 offset:50176
  ds_read_b64_tr_b16 v[78:79], v6 offset:54272
  v_mfma_f32_16x16x32_bf16 v[124:127], v[84:87], a[76:79], v[124:127]
  s_waitcnt lgkmcnt(4)
  v_exp_f32 v43, v43
  v_mfma_f32_16x16x32_bf16 v[96:99], v[88:91], a[80:83], v[96:99]
  ds_read_b64_tr_b16 v[80:81], v6 offset:57344
  v_mul_f32 v148, v132, v148
  v_mfma_f32_16x16x32_bf16 v[100:103], v[88:91], a[84:87], v[100:103]
  ds_read_b64_tr_b16 v[82:83], v6 offset:61440
  v_mul_f32 v149, v133, v149
  v_mfma_f32_16x16x32_bf16 v[104:107], v[88:91], a[88:91], v[104:107]
  ds_read_b64_tr_b16 v[84:85], v6 offset:58368
  v_mul_f32 v150, v134, v150
  v_mfma_f32_16x16x32_bf16 v[108:111], v[88:91], a[92:95], v[108:111]
  ds_read_b64_tr_b16 v[86:87], v6 offset:62464
  v_mul_f32 v151, v135, v151
  v_mfma_f32_16x16x32_bf16 v[112:115], v[92:95], a[80:83], v[112:115]
  v_add_f32 v40, 1.0, v40
  v_add_f32 v41, 1.0, v41
  v_mfma_f32_16x16x32_bf16 v[116:119], v[92:95], a[84:87], v[116:119]
  v_add_f32 v42, 1.0, v42
  v_add_f32 v43, 1.0, v43
  v_mfma_f32_16x16x32_bf16 v[120:123], v[92:95], a[88:91], v[120:123]
  v_rcp_f32 v40, v40
  v_mfma_f32_16x16x32_bf16 v[124:127], v[92:95], a[92:95], v[124:127]
  s_waitcnt lgkmcnt(4)
  v_rcp_f32 v41, v41
  v_mfma_f32_16x16x32_bf16 v[96:99], v[72:75], a[96:99], v[96:99]
  v_rcp_f32 v42, v42
  v_mfma_f32_16x16x32_bf16 v[100:103], v[72:75], a[100:103], v[100:103]
  v_rcp_f32 v43, v43
  v_mfma_f32_16x16x32_bf16 v[104:107], v[72:75], a[104:107], v[104:107]
  v_add_u32 v6, 49152, v6
  v_mul_f32 v148, v148, v40
  v_mfma_f32_16x16x32_bf16 v[108:111], v[72:75], a[108:111], v[108:111]
  ds_read_b64_tr_b16 v[88:89], v6 offset:16384
  v_mul_f32 v149, v149, v41
  v_mfma_f32_16x16x32_bf16 v[112:115], v[76:79], a[96:99], v[112:115]
  ds_read_b64_tr_b16 v[90:91], v6 offset:20480
  v_mul_f32 v150, v150, v42
  v_mfma_f32_16x16x32_bf16 v[116:119], v[76:79], a[100:103], v[116:119]
  ds_read_b64_tr_b16 v[92:93], v6 offset:17408
  v_mul_f32 v151, v151, v43
  v_mfma_f32_16x16x32_bf16 v[120:123], v[76:79], a[104:107], v[120:123]
  ds_read_b64_tr_b16 v[94:95], v6 offset:21504
  v_cvt_pk_bf16_f32 v62, v148, v149
  v_mfma_f32_16x16x32_bf16 v[124:127], v[76:79], a[108:111], v[124:127]
  s_waitcnt lgkmcnt(4)
  v_cvt_pk_bf16_f32 v63, v150, v151
  v_mfma_f32_16x16x32_bf16 v[96:99], v[80:83], a[112:115], v[96:99]
  buffer_store_dwordx4 v[60:63], v14, s[16:19], s51 offen offset:0 sc1
  v_mfma_f32_16x16x32_bf16 v[100:103], v[80:83], a[116:119], v[100:103]
  s_bfe_u32 s49, s59, 0x40018
  ds_read_b64_tr_b16 v[72:73], v6 offset:24576
  v_mul_f32 v40, s46, v136
  v_mfma_f32_16x16x32_bf16 v[104:107], v[80:83], a[120:123], v[104:107]
  s_mul_i32 s49, s49, 589824
  ds_read_b64_tr_b16 v[74:75], v6 offset:28672
  v_mul_f32 v41, s46, v137
  v_mfma_f32_16x16x32_bf16 v[108:111], v[80:83], a[124:127], v[108:111]
  s_add_u32 s49, s49, s47
  ds_read_b64_tr_b16 v[76:77], v6 offset:25600
  v_mul_f32 v42, s46, v138
  v_mfma_f32_16x16x32_bf16 v[112:115], v[84:87], a[112:115], v[112:115]
  s_add_u32 m0, s48, 8192
  ds_read_b64_tr_b16 v[78:79], v6 offset:29696
  v_mul_f32 v43, s46, v139
  v_mfma_f32_16x16x32_bf16 v[116:119], v[84:87], a[116:119], v[116:119]
  s_add_u32 s49, s49, 295040
  buffer_load_dwordx4 v11, s[8:11], s49 offen lds
  v_mfma_f32_16x16x32_bf16 v[120:123], v[84:87], a[120:123], v[120:123]
  buffer_load_dwordx4 v11, s[12:15], s49 offen offset:1024 lds
  v_mfma_f32_16x16x32_bf16 v[124:127], v[84:87], a[124:127], v[124:127]
  s_waitcnt lgkmcnt(4)
  v_exp_f32 v40, v40
  v_mfma_f32_16x16x32_bf16 v[96:99], v[88:91], a[128:131], v[96:99]
  v_exp_f32 v41, v41
  v_mfma_f32_16x16x32_bf16 v[100:103], v[88:91], a[132:135], v[100:103]
  v_exp_f32 v42, v42
  v_mfma_f32_16x16x32_bf16 v[104:107], v[88:91], a[136:139], v[104:107]
  ds_read_b64_tr_b16 v[80:81], v6 offset:32768
  ds_read_b64_tr_b16 v[82:83], v6 offset:36864
  v_mfma_f32_16x16x32_bf16 v[108:111], v[88:91], a[140:143], v[108:111]
  v_exp_f32 v43, v43
  v_mfma_f32_16x16x32_bf16 v[112:115], v[92:95], a[128:131], v[112:115]
  ds_read_b64_tr_b16 v[84:85], v6 offset:33792
  v_mul_f32 v152, v136, v152
  v_mfma_f32_16x16x32_bf16 v[116:119], v[92:95], a[132:135], v[116:119]
  ds_read_b64_tr_b16 v[86:87], v6 offset:37888
  v_mul_f32 v153, v137, v153
  v_mfma_f32_16x16x32_bf16 v[120:123], v[92:95], a[136:139], v[120:123]
  v_mul_f32 v154, v138, v154
  v_mul_f32 v155, v139, v155
  v_mfma_f32_16x16x32_bf16 v[124:127], v[92:95], a[140:143], v[124:127]
  s_waitcnt lgkmcnt(4)
  v_add_f32 v40, 1.0, v40
  v_add_f32 v41, 1.0, v41
  v_mfma_f32_16x16x32_bf16 v[96:99], v[72:75], a[144:147], v[96:99]
  ds_read_b64_tr_b16 v[88:89], v6 offset:40960
  v_add_f32 v42, 1.0, v42
  v_mfma_f32_16x16x32_bf16 v[100:103], v[72:75], a[148:151], v[100:103]
  ds_read_b64_tr_b16 v[90:91], v6 offset:45056
  v_add_f32 v43, 1.0, v43
  v_mfma_f32_16x16x32_bf16 v[104:107], v[72:75], a[152:155], v[104:107]
  v_rcp_f32 v40, v40
  v_mfma_f32_16x16x32_bf16 v[108:111], v[72:75], a[156:159], v[108:111]
  v_rcp_f32 v41, v41
  v_mfma_f32_16x16x32_bf16 v[112:115], v[76:79], a[144:147], v[112:115]
  ds_read_b64_tr_b16 v[92:93], v6 offset:41984
  ds_read_b64_tr_b16 v[94:95], v6 offset:46080
  v_mfma_f32_16x16x32_bf16 v[116:119], v[76:79], a[148:151], v[116:119]
  v_rcp_f32 v42, v42
  v_mfma_f32_16x16x32_bf16 v[120:123], v[76:79], a[152:155], v[120:123]
  v_rcp_f32 v43, v43
  v_mfma_f32_16x16x32_bf16 v[124:127], v[76:79], a[156:159], v[124:127]
  s_waitcnt lgkmcnt(4)
  v_mul_f32 v152, v152, v40
  v_mul_f32 v153, v153, v41
  v_mfma_f32_16x16x32_bf16 v[96:99], v[80:83], a[160:163], v[96:99]
  ds_read_b64_tr_b16 v[72:73], v7 offset:49152
  v_mul_f32 v154, v154, v42
  v_mfma_f32_16x16x32_bf16 v[100:103], v[80:83], a[164:167], v[100:103]
  s_bfe_u32 s49, s59, 0x4001c
  ds_read_b64_tr_b16 v[74:75], v7 offset:53248
  v_mul_f32 v155, v155, v43
  v_mfma_f32_16x16x32_bf16 v[104:107], v[80:83], a[168:171], v[104:107]
  s_mul_i32 s49, s49, 589824
  ds_read_b64_tr_b16 v[76:77], v7 offset:50176
  v_cvt_pk_bf16_f32 v66, v152, v153
  v_mfma_f32_16x16x32_bf16 v[108:111], v[80:83], a[172:175], v[108:111]
  s_add_u32 s49, s49, s47
  ds_read_b64_tr_b16 v[78:79], v7 offset:54272
  v_cvt_pk_bf16_f32 v67, v154, v155
  v_mfma_f32_16x16x32_bf16 v[112:115], v[84:87], a[160:163], v[112:115]
  s_add_u32 m0, s48, 16384
  buffer_store_dwordx4 v[64:67], v14, s[16:19], s52 offen offset:0 sc1
  v_mfma_f32_16x16x32_bf16 v[116:119], v[84:87], a[164:167], v[116:119]
  s_add_u32 s49, s49, 128
  buffer_load_dwordx4 v11, s[8:11], s49 offen lds
  v_mfma_f32_16x16x32_bf16 v[120:123], v[84:87], a[168:171], v[120:123]
  buffer_load_dwordx4 v11, s[12:15], s49 offen offset:1024 lds
  v_mfma_f32_16x16x32_bf16 v[124:127], v[84:87], a[172:175], v[124:127]
  s_waitcnt lgkmcnt(4)
  v_mul_f32 v40, s46, v140
  v_mul_f32 v41, s46, v141
  v_mfma_f32_16x16x32_bf16 v[96:99], v[88:91], a[176:179], v[96:99]
  ds_read_b64_tr_b16 v[80:81], v7 offset:57344
  v_mul_f32 v42, s46, v142
  v_mfma_f32_16x16x32_bf16 v[100:103], v[88:91], a[180:183], v[100:103]
  ds_read_b64_tr_b16 v[82:83], v7 offset:61440
  v_mul_f32 v43, s46, v143
  v_mfma_f32_16x16x32_bf16 v[104:107], v[88:91], a[184:187], v[104:107]
  v_exp_f32 v40, v40
  v_mfma_f32_16x16x32_bf16 v[108:111], v[88:91], a[188:191], v[108:111]
  v_exp_f32 v41, v41
  v_mfma_f32_16x16x32_bf16 v[112:115], v[92:95], a[176:179], v[112:115]
  ds_read_b64_tr_b16 v[84:85], v7 offset:58368
  ds_read_b64_tr_b16 v[86:87], v7 offset:62464
  v_mfma_f32_16x16x32_bf16 v[116:119], v[92:95], a[180:183], v[116:119]
  v_exp_f32 v42, v42
  v_mfma_f32_16x16x32_bf16 v[120:123], v[92:95], a[184:187], v[120:123]
  v_exp_f32 v43, v43
  v_mfma_f32_16x16x32_bf16 v[124:127], v[92:95], a[188:191], v[124:127]
  s_waitcnt lgkmcnt(4)
  v_mul_f32 v156, v140, v156
  v_mul_f32 v157, v141, v157
  v_mul_f32 v158, v142, v158
  v_mul_f32 v159, v143, v159
  v_add_f32 v40, 1.0, v40
  v_add_f32 v41, 1.0, v41
  v_add_f32 v42, 1.0, v42
  v_add_f32 v43, 1.0, v43
  v_rcp_f32 v40, v40
  v_rcp_f32 v41, v41
  v_rcp_f32 v42, v42
  v_rcp_f32 v43, v43
  v_mul_f32 v156, v156, v40
  v_mul_f32 v157, v157, v41
  v_mul_f32 v158, v158, v42
  v_mul_f32 v159, v159, v43
  v_cvt_pk_bf16_f32 v70, v156, v157
  v_cvt_pk_bf16_f32 v71, v158, v159
  buffer_store_dwordx4 v[68:71], v14, s[16:19], s53 offen offset:0 sc1
  v_mfma_f32_16x16x32_bf16 v[128:131], v[72:75], a[0:3], 0
  v_add_u32 v7, 49152, v7
  v_mul_f32 v40, s46, v160
  v_mfma_f32_16x16x32_bf16 v[132:135], v[72:75], a[4:7], 0
  ds_read_b64_tr_b16 v[88:89], v7 offset:16384
  v_mul_f32 v41, s46, v161
  v_mfma_f32_16x16x32_bf16 v[136:139], v[72:75], a[8:11], 0
  ds_read_b64_tr_b16 v[90:91], v7 offset:20480
  v_mul_f32 v42, s46, v162
  v_mfma_f32_16x16x32_bf16 v[140:143], v[72:75], a[12:15], 0
  ds_read_b64_tr_b16 v[92:93], v7 offset:17408
  v_mul_f32 v43, s46, v163
  v_mfma_f32_16x16x32_bf16 v[144:147], v[76:79], a[0:3], 0
  v_exp_f32 v40, v40
  v_mfma_f32_16x16x32_bf16 v[148:151], v[76:79], a[4:7], 0
  ds_read_b64_tr_b16 v[94:95], v7 offset:21504
  v_mfma_f32_16x16x32_bf16 v[152:155], v[76:79], a[8:11], 0
  v_exp_f32 v41, v41
  v_mfma_f32_16x16x32_bf16 v[156:159], v[76:79], a[12:15], 0
  s_waitcnt lgkmcnt(4)
  v_exp_f32 v42, v42
  v_mfma_f32_16x16x32_bf16 v[128:131], v[80:83], a[16:19], v[128:131]
  v_exp_f32 v43, v43
  v_mfma_f32_16x16x32_bf16 v[132:135], v[80:83], a[20:23], v[132:135]
  s_bfe_u32 s49, s59, 0x4001c
  ds_read_b64_tr_b16 v[72:73], v7 offset:24576
  v_mul_f32 v176, v160, v176
  v_mfma_f32_16x16x32_bf16 v[136:139], v[80:83], a[24:27], v[136:139]
  s_mul_i32 s49, s49, 589824
  ds_read_b64_tr_b16 v[74:75], v7 offset:28672
  v_mul_f32 v177, v161, v177
  v_mfma_f32_16x16x32_bf16 v[140:143], v[80:83], a[28:31], v[140:143]
  s_add_u32 s49, s49, s47
  ds_read_b64_tr_b16 v[76:77], v7 offset:25600
  v_mul_f32 v178, v162, v178
  v_mfma_f32_16x16x32_bf16 v[144:147], v[84:87], a[16:19], v[144:147]
  s_add_u32 m0, s48, 24576
  ds_read_b64_tr_b16 v[78:79], v7 offset:29696
  v_mul_f32 v179, v163, v179
  v_mfma_f32_16x16x32_bf16 v[148:151], v[84:87], a[20:23], v[148:151]
  s_add_u32 s49, s49, 295040
  buffer_load_dwordx4 v11, s[8:11], s49 offen lds
  v_mfma_f32_16x16x32_bf16 v[152:155], v[84:87], a[24:27], v[152:155]
  buffer_load_dwordx4 v11, s[12:15], s49 offen offset:1024 lds
  v_mfma_f32_16x16x32_bf16 v[156:159], v[84:87], a[28:31], v[156:159]
  s_waitcnt lgkmcnt(4)
  v_add_f32 v40, 1.0, v40
  v_add_f32 v41, 1.0, v41
  v_mfma_f32_16x16x32_bf16 v[128:131], v[88:91], a[32:35], v[128:131]
  ds_read_b64_tr_b16 v[80:81], v7 offset:32768
  v_add_f32 v42, 1.0, v42
  v_mfma_f32_16x16x32_bf16 v[132:135], v[88:91], a[36:39], v[132:135]
  ds_read_b64_tr_b16 v[82:83], v7 offset:36864
  v_add_f32 v43, 1.0, v43
  v_mfma_f32_16x16x32_bf16 v[136:139], v[88:91], a[40:43], v[136:139]
  v_rcp_f32 v40, v40
  v_mfma_f32_16x16x32_bf16 v[140:143], v[88:91], a[44:47], v[140:143]
  v_rcp_f32 v41, v41
  v_mfma_f32_16x16x32_bf16 v[144:147], v[92:95], a[32:35], v[144:147]
  ds_read_b64_tr_b16 v[84:85], v7 offset:33792
  ds_read_b64_tr_b16 v[86:87], v7 offset:37888
  v_mfma_f32_16x16x32_bf16 v[148:151], v[92:95], a[36:39], v[148:151]
  v_rcp_f32 v42, v42
  v_mfma_f32_16x16x32_bf16 v[152:155], v[92:95], a[40:43], v[152:155]
  v_rcp_f32 v43, v43
  v_mfma_f32_16x16x32_bf16 v[156:159], v[92:95], a[44:47], v[156:159]
  s_waitcnt lgkmcnt(4)
  v_mul_f32 v176, v176, v40
  v_mul_f32 v177, v177, v41
  v_mfma_f32_16x16x32_bf16 v[128:131], v[72:75], a[48:51], v[128:131]
  ds_read_b64_tr_b16 v[88:89], v7 offset:40960
  v_mul_f32 v178, v178, v42
  v_mfma_f32_16x16x32_bf16 v[132:135], v[72:75], a[52:55], v[132:135]
  ds_read_b64_tr_b16 v[90:91], v7 offset:45056
  v_mul_f32 v179, v179, v43
  v_mfma_f32_16x16x32_bf16 v[136:139], v[72:75], a[56:59], v[136:139]
  ds_read_b64_tr_b16 v[92:93], v7 offset:41984
  v_cvt_pk_bf16_f32 v56, v176, v177
  v_mfma_f32_16x16x32_bf16 v[140:143], v[72:75], a[60:63], v[140:143]
  ds_read_b64_tr_b16 v[94:95], v7 offset:46080
  v_cvt_pk_bf16_f32 v57, v178, v179
  v_mfma_f32_16x16x32_bf16 v[144:147], v[76:79], a[48:51], v[144:147]
  v_mul_f32 v40, s46, v164
  v_mul_f32 v41, s46, v165
  v_mfma_f32_16x16x32_bf16 v[148:151], v[76:79], a[52:55], v[148:151]
  v_mul_f32 v42, s46, v166
  v_mul_f32 v43, s46, v167
  v_mfma_f32_16x16x32_bf16 v[152:155], v[76:79], a[56:59], v[152:155]
  v_exp_f32 v40, v40
  v_mfma_f32_16x16x32_bf16 v[156:159], v[76:79], a[60:63], v[156:159]
  s_waitcnt lgkmcnt(4)
  v_exp_f32 v41, v41
  v_mfma_f32_16x16x32_bf16 v[128:131], v[80:83], a[64:67], v[128:131]
  v_exp_f32 v42, v42
  v_mfma_f32_16x16x32_bf16 v[132:135], v[80:83], a[68:71], v[132:135]
  s_mov_b32 s49, s3
  v_exp_f32 v43, v43
  v_mfma_f32_16x16x32_bf16 v[136:139], v[80:83], a[72:75], v[136:139]
  s_mul_i32 s49, s49, 589824
  ds_read_b64_tr_b16 v[72:73], v7 offset:49152
  v_mul_f32 v180, v164, v180
  v_mfma_f32_16x16x32_bf16 v[140:143], v[80:83], a[76:79], v[140:143]
  s_add_u32 s49, s49, s47
  ds_read_b64_tr_b16 v[74:75], v7 offset:53248
  v_mul_f32 v181, v165, v181
  v_mfma_f32_16x16x32_bf16 v[144:147], v[84:87], a[64:67], v[144:147]
  s_add_u32 m0, s48, 32768
  ds_read_b64_tr_b16 v[76:77], v7 offset:50176
  v_mul_f32 v182, v166, v182
  v_mfma_f32_16x16x32_bf16 v[148:151], v[84:87], a[68:71], v[148:151]
  s_add_u32 s49, s49, 128
  buffer_load_dwordx4 v11, s[8:11], s49 offen lds
  v_mfma_f32_16x16x32_bf16 v[152:155], v[84:87], a[72:75], v[152:155]
  buffer_load_dwordx4 v11, s[12:15], s49 offen offset:1024 lds
  v_mfma_f32_16x16x32_bf16 v[156:159], v[84:87], a[76:79], v[156:159]
  s_waitcnt lgkmcnt(3)
  ds_read_b64_tr_b16 v[78:79], v7 offset:54272
  v_mul_f32 v183, v167, v183
  v_mfma_f32_16x16x32_bf16 v[128:131], v[88:91], a[80:83], v[128:131]
  ds_read_b64_tr_b16 v[80:81], v7 offset:57344
  v_add_f32 v40, 1.0, v40
  v_mfma_f32_16x16x32_bf16 v[132:135], v[88:91], a[84:87], v[132:135]
  ds_read_b64_tr_b16 v[82:83], v7 offset:61440
  v_add_f32 v41, 1.0, v41
  v_mfma_f32_16x16x32_bf16 v[136:139], v[88:91], a[88:91], v[136:139]
  ds_read_b64_tr_b16 v[84:85], v7 offset:58368
  v_add_f32 v42, 1.0, v42
  v_mfma_f32_16x16x32_bf16 v[140:143], v[88:91], a[92:95], v[140:143]
  ds_read_b64_tr_b16 v[86:87], v7 offset:62464
  v_add_f32 v43, 1.0, v43
  v_mfma_f32_16x16x32_bf16 v[144:147], v[92:95], a[80:83], v[144:147]
  v_rcp_f32 v40, v40
  v_mfma_f32_16x16x32_bf16 v[148:151], v[92:95], a[84:87], v[148:151]
  v_rcp_f32 v41, v41
  v_mfma_f32_16x16x32_bf16 v[152:155], v[92:95], a[88:91], v[152:155]
  v_rcp_f32 v42, v42
  v_mfma_f32_16x16x32_bf16 v[156:159], v[92:95], a[92:95], v[156:159]
  s_waitcnt lgkmcnt(4)
  v_rcp_f32 v43, v43
  v_mfma_f32_16x16x32_bf16 v[128:131], v[72:75], a[96:99], v[128:131]
  v_add_u32 v7, 49152, v7
  v_mul_f32 v180, v180, v40
  v_mfma_f32_16x16x32_bf16 v[132:135], v[72:75], a[100:103], v[132:135]
  ds_read_b64_tr_b16 v[88:89], v7 offset:16384
  v_mul_f32 v181, v181, v41
  v_mfma_f32_16x16x32_bf16 v[136:139], v[72:75], a[104:107], v[136:139]
  ds_read_b64_tr_b16 v[90:91], v7 offset:20480
  v_mul_f32 v182, v182, v42
  v_mfma_f32_16x16x32_bf16 v[140:143], v[72:75], a[108:111], v[140:143]
  ds_read_b64_tr_b16 v[92:93], v7 offset:17408
  v_mul_f32 v183, v183, v43
  v_mfma_f32_16x16x32_bf16 v[144:147], v[76:79], a[96:99], v[144:147]
  ds_read_b64_tr_b16 v[94:95], v7 offset:21504
  v_cvt_pk_bf16_f32 v60, v180, v181
  v_mfma_f32_16x16x32_bf16 v[148:151], v[76:79], a[100:103], v[148:151]
  v_cvt_pk_bf16_f32 v61, v182, v183
  v_mul_f32 v40, s46, v168
  v_mfma_f32_16x16x32_bf16 v[152:155], v[76:79], a[104:107], v[152:155]
  v_mul_f32 v41, s46, v169
  v_mul_f32 v42, s46, v170
  v_mfma_f32_16x16x32_bf16 v[156:159], v[76:79], a[108:111], v[156:159]
  s_waitcnt lgkmcnt(4)
  v_mul_f32 v43, s46, v171
  v_mfma_f32_16x16x32_bf16 v[128:131], v[80:83], a[112:115], v[128:131]
  v_exp_f32 v40, v40
  v_mfma_f32_16x16x32_bf16 v[132:135], v[80:83], a[116:119], v[132:135]
  s_mov_b32 s49, s3
  v_exp_f32 v41, v41
  v_mfma_f32_16x16x32_bf16 v[136:139], v[80:83], a[120:123], v[136:139]
  s_mul_i32 s49, s49, 589824
  ds_read_b64_tr_b16 v[72:73], v7 offset:24576
  s_add_u32 s49, s49, s47
  v_mfma_f32_16x16x32_bf16 v[140:143], v[80:83], a[124:127], v[140:143]
  s_add_u32 m0, s48, 40960
  ds_read_b64_tr_b16 v[74:75], v7 offset:28672
  s_add_u32 s49, s49, 295040
  v_mfma_f32_16x16x32_bf16 v[144:147], v[84:87], a[112:115], v[144:147]
  buffer_load_dwordx4 v11, s[8:11], s49 offen lds
  v_mfma_f32_16x16x32_bf16 v[148:151], v[84:87], a[116:119], v[148:151]
  buffer_load_dwordx4 v11, s[12:15], s49 offen offset:1024 lds
  v_mfma_f32_16x16x32_bf16 v[152:155], v[84:87], a[120:123], v[152:155]
  ds_read_b64_tr_b16 v[76:77], v7 offset:25600
  ds_read_b64_tr_b16 v[78:79], v7 offset:29696
  v_mfma_f32_16x16x32_bf16 v[156:159], v[84:87], a[124:127], v[156:159]
  s_waitcnt lgkmcnt(4)
  v_exp_f32 v42, v42
  v_mfma_f32_16x16x32_bf16 v[128:131], v[88:91], a[128:131], v[128:131]
  s_lshl_b32 s63, s42, 4
  v_exp_f32 v43, v43
  v_mfma_f32_16x16x32_bf16 v[132:135], v[88:91], a[132:135], v[132:135]
  s_lshl_b32 s64, s35, 2
  ds_read_b64_tr_b16 v[80:81], v7 offset:32768
  v_mul_f32 v184, v168, v184
  v_mfma_f32_16x16x32_bf16 v[136:139], v[88:91], a[136:139], v[136:139]
  s_add_u32 s63, s63, s64
  ds_read_b64_tr_b16 v[82:83], v7 offset:36864
  v_mul_f32 v185, v169, v185
  v_mfma_f32_16x16x32_bf16 v[140:143], v[88:91], a[140:143], v[140:143]
  s_lshr_b32 s64, s40, 1
  ds_read_b64_tr_b16 v[84:85], v7 offset:33792
  v_mul_f32 v186, v170, v186
  v_mfma_f32_16x16x32_bf16 v[144:147], v[92:95], a[128:131], v[144:147]
  s_lshl_b32 s64, s64, 1
  ds_read_b64_tr_b16 v[86:87], v7 offset:37888
  v_mul_f32 v187, v171, v187
  v_mfma_f32_16x16x32_bf16 v[148:151], v[92:95], a[132:135], v[148:151]
  s_add_u32 s63, s63, s64
  v_add_f32 v40, 1.0, v40
  v_add_f32 v41, 1.0, v41
  v_mfma_f32_16x16x32_bf16 v[152:155], v[92:95], a[136:139], v[152:155]
  s_mul_i32 s63, s63, 1152
  v_add_f32 v42, 1.0, v42
  v_add_f32 v43, 1.0, v43
  v_mfma_f32_16x16x32_bf16 v[156:159], v[92:95], a[140:143], v[156:159]
  s_waitcnt lgkmcnt(4)
  v_rcp_f32 v40, v40
  v_mfma_f32_16x16x32_bf16 v[128:131], v[72:75], a[144:147], v[128:131]
  s_cmp_gt_u32 s42, 18
  s_cselect_b32 s63, 0x40000000, s63
  v_lshlrev_b32 v31, 7, v0
  v_mfma_f32_16x16x32_bf16 v[132:135], v[72:75], a[148:151], v[132:135]
  s_mov_b64 exec, 0x3ffff
  buffer_load_dword v36, v31, s[24:27], s63 offen
  s_mov_b64 exec, -1
  v_mfma_f32_16x16x32_bf16 v[136:139], v[72:75], a[152:155], v[136:139]
  ds_read_b64_tr_b16 v[88:89], v7 offset:40960
  ds_read_b64_tr_b16 v[90:91], v7 offset:45056
  v_mfma_f32_16x16x32_bf16 v[140:143], v[72:75], a[156:159], v[140:143]
  v_rcp_f32 v41, v41
  v_mfma_f32_16x16x32_bf16 v[144:147], v[76:79], a[144:147], v[144:147]
  ds_read_b64_tr_b16 v[92:93], v7 offset:41984
  ds_read_b64_tr_b16 v[94:95], v7 offset:46080
  v_mfma_f32_16x16x32_bf16 v[148:151], v[76:79], a[148:151], v[148:151]
  v_rcp_f32 v42, v42
  v_mfma_f32_16x16x32_bf16 v[152:155], v[76:79], a[152:155], v[152:155]
  v_rcp_f32 v43, v43
  v_mfma_f32_16x16x32_bf16 v[156:159], v[76:79], a[156:159], v[156:159]
  s_waitcnt lgkmcnt(4)
  v_mul_f32 v184, v184, v40
  v_mul_f32 v185, v185, v41
  v_mfma_f32_16x16x32_bf16 v[128:131], v[80:83], a[160:163], v[128:131]
  ds_read_b64_tr_b16 v[72:73], v8 offset:49152
  v_mul_f32 v186, v186, v42
  v_mfma_f32_16x16x32_bf16 v[132:135], v[80:83], a[164:167], v[132:135]
  ds_read_b64_tr_b16 v[74:75], v8 offset:53248
  v_mul_f32 v187, v187, v43
  v_mfma_f32_16x16x32_bf16 v[136:139], v[80:83], a[168:171], v[136:139]
  ds_read_b64_tr_b16 v[76:77], v8 offset:50176
  v_cvt_pk_bf16_f32 v64, v184, v185
  v_mfma_f32_16x16x32_bf16 v[140:143], v[80:83], a[172:175], v[140:143]
  ds_read_b64_tr_b16 v[78:79], v8 offset:54272
  v_cvt_pk_bf16_f32 v65, v186, v187
  v_mfma_f32_16x16x32_bf16 v[144:147], v[84:87], a[160:163], v[144:147]
  v_mul_f32 v40, s46, v172
  v_mul_f32 v41, s46, v173
  v_mfma_f32_16x16x32_bf16 v[148:151], v[84:87], a[164:167], v[148:151]
  v_mul_f32 v42, s46, v174
  v_mul_f32 v43, s46, v175
  v_mfma_f32_16x16x32_bf16 v[152:155], v[84:87], a[168:171], v[152:155]
  v_exp_f32 v40, v40
  v_mfma_f32_16x16x32_bf16 v[156:159], v[84:87], a[172:175], v[156:159]
  s_waitcnt lgkmcnt(4)
  v_exp_f32 v41, v41
  v_mfma_f32_16x16x32_bf16 v[128:131], v[88:91], a[176:179], v[128:131]
  v_exp_f32 v42, v42
  v_mfma_f32_16x16x32_bf16 v[132:135], v[88:91], a[180:183], v[132:135]
  v_exp_f32 v43, v43
  v_mfma_f32_16x16x32_bf16 v[136:139], v[88:91], a[184:187], v[136:139]
  ds_read_b64_tr_b16 v[80:81], v8 offset:57344
  v_mul_f32 v188, v172, v188
  v_mfma_f32_16x16x32_bf16 v[140:143], v[88:91], a[188:191], v[140:143]
  ds_read_b64_tr_b16 v[82:83], v8 offset:61440
  v_mul_f32 v189, v173, v189
  v_mfma_f32_16x16x32_bf16 v[144:147], v[92:95], a[176:179], v[144:147]
  ds_read_b64_tr_b16 v[84:85], v8 offset:58368
  v_mul_f32 v190, v174, v190
  v_mfma_f32_16x16x32_bf16 v[148:151], v[92:95], a[180:183], v[148:151]
  ds_read_b64_tr_b16 v[86:87], v8 offset:62464
  v_mul_f32 v191, v175, v191
  v_mfma_f32_16x16x32_bf16 v[152:155], v[92:95], a[184:187], v[152:155]
  v_add_f32 v40, 1.0, v40
  v_add_f32 v41, 1.0, v41
  v_mfma_f32_16x16x32_bf16 v[156:159], v[92:95], a[188:191], v[156:159]
  s_waitcnt lgkmcnt(4)
  v_add_f32 v42, 1.0, v42
  v_add_f32 v43, 1.0, v43
  v_rcp_f32 v40, v40
  v_rcp_f32 v41, v41
  v_rcp_f32 v42, v42
  v_rcp_f32 v43, v43
  v_mul_f32 v188, v188, v40
  v_mul_f32 v189, v189, v41
  v_mul_f32 v190, v190, v42
  v_mul_f32 v191, v191, v43
  v_cvt_pk_bf16_f32 v68, v188, v189
  v_cvt_pk_bf16_f32 v69, v190, v191
  v_mfma_f32_16x16x32_bf16 v[160:163], v[72:75], a[0:3], 0
  s_lshr_b32 s63, s68, 1
  v_add_u32 v8, 49152, v8
  v_mul_f32 v40, s46, v192
  v_mfma_f32_16x16x32_bf16 v[164:167], v[72:75], a[4:7], 0
  s_mul_i32 s63, s63, 1152
  ds_read_b64_tr_b16 v[88:89], v8 offset:16384
  v_mul_f32 v41, s46, v193
  v_mfma_f32_16x16x32_bf16 v[168:171], v[72:75], a[8:11], 0
  s_lshr_b32 s64, s2, 3
  ds_read_b64_tr_b16 v[90:91], v8 offset:20480
  v_mul_f32 v42, s46, v194
  v_mfma_f32_16x16x32_bf16 v[172:175], v[72:75], a[12:15], 0
  s_and_b32 s65, s68, 1
  ds_read_b64_tr_b16 v[92:93], v8 offset:17408
  v_mul_f32 v43, s46, v195
  v_mfma_f32_16x16x32_bf16 v[176:179], v[76:79], a[0:3], 0
  s_mul_i32 s65, s65, 576
  v_exp_f32 v40, v40
  v_mfma_f32_16x16x32_bf16 v[180:183], v[76:79], a[4:7], 0
  s_add_u32 s63, s63, s65
  ds_read_b64_tr_b16 v[94:95], v8 offset:21504
  s_mul_i32 s65, s64, 18
  v_mfma_f32_16x16x32_bf16 v[184:187], v[76:79], a[8:11], 0
  s_add_u32 s63, s63, s65
  v_exp_f32 v41, v41
  v_mfma_f32_16x16x32_bf16 v[188:191], v[76:79], a[12:15], 0
  s_waitcnt lgkmcnt(4)
  v_exp_f32 v42, v42
  v_mfma_f32_16x16x32_bf16 v[160:163], v[80:83], a[16:19], v[160:163]
  s_mul_i32 s63, s63, 1152
  v_exp_f32 v43, v43
  v_mfma_f32_16x16x32_bf16 v[164:167], v[80:83], a[20:23], v[164:167]
  s_mul_i32 s65, s40, 41
  ds_read_b64_tr_b16 v[72:73], v8 offset:24576
  v_add_u32 v32, s65, v0
  v_mfma_f32_16x16x32_bf16 v[168:171], v[80:83], a[24:27], v[168:171]
  ds_read_b64_tr_b16 v[74:75], v8 offset:28672
  v_min_u32 v31, 161, v32
  v_mfma_f32_16x16x32_bf16 v[172:175], v[80:83], a[28:31], v[172:175]
  ds_read_b64_tr_b16 v[76:77], v8 offset:25600
  v_lshlrev_b32 v31, 7, v31
  v_mfma_f32_16x16x32_bf16 v[176:179], v[84:87], a[16:19], v[176:179]
  ds_read_b64_tr_b16 v[78:79], v8 offset:29696
  v_add_u32 v31, s63, v31
  v_mfma_f32_16x16x32_bf16 v[180:183], v[84:87], a[20:23], v[180:183]
  s_mov_b64 exec, 0xffff
  global_load_dword v36, v31, s[28:29]
  s_mov_b64 exec, -1
  v_mfma_f32_16x16x32_bf16 v[184:187], v[84:87], a[24:27], v[184:187]
  v_add_u32 v32, 16, v32
  v_mul_f32 v208, v192, v208
  v_mfma_f32_16x16x32_bf16 v[188:191], v[84:87], a[28:31], v[188:191]
  s_waitcnt lgkmcnt(4)
  v_mul_f32 v209, v193, v209
  v_mul_f32 v210, v194, v210
  v_mfma_f32_16x16x32_bf16 v[160:163], v[88:91], a[32:35], v[160:163]
  ds_read_b64_tr_b16 v[80:81], v8 offset:32768
  v_mul_f32 v211, v195, v211
  v_mfma_f32_16x16x32_bf16 v[164:167], v[88:91], a[36:39], v[164:167]
  ds_read_b64_tr_b16 v[82:83], v8 offset:36864
  v_add_f32 v40, 1.0, v40
  v_mfma_f32_16x16x32_bf16 v[168:171], v[88:91], a[40:43], v[168:171]
  ds_read_b64_tr_b16 v[84:85], v8 offset:33792
  v_add_f32 v41, 1.0, v41
  v_mfma_f32_16x16x32_bf16 v[172:175], v[88:91], a[44:47], v[172:175]
  ds_read_b64_tr_b16 v[86:87], v8 offset:37888
  v_add_f32 v42, 1.0, v42
  v_mfma_f32_16x16x32_bf16 v[176:179], v[92:95], a[32:35], v[176:179]
  v_add_f32 v43, 1.0, v43
  v_mfma_f32_16x16x32_bf16 v[180:183], v[92:95], a[36:39], v[180:183]
  v_rcp_f32 v40, v40
  v_mfma_f32_16x16x32_bf16 v[184:187], v[92:95], a[40:43], v[184:187]
  v_rcp_f32 v41, v41
  v_mfma_f32_16x16x32_bf16 v[188:191], v[92:95], a[44:47], v[188:191]
  s_waitcnt lgkmcnt(4)
  v_rcp_f32 v42, v42
  v_mfma_f32_16x16x32_bf16 v[160:163], v[72:75], a[48:51], v[160:163]
  v_rcp_f32 v43, v43
  v_mfma_f32_16x16x32_bf16 v[164:167], v[72:75], a[52:55], v[164:167]
  ds_read_b64_tr_b16 v[88:89], v8 offset:40960
  v_min_u32 v31, 161, v32
  v_mfma_f32_16x16x32_bf16 v[168:171], v[72:75], a[56:59], v[168:171]
  ds_read_b64_tr_b16 v[90:91], v8 offset:45056
  v_lshlrev_b32 v31, 7, v31
  v_mfma_f32_16x16x32_bf16 v[172:175], v[72:75], a[60:63], v[172:175]
  ds_read_b64_tr_b16 v[92:93], v8 offset:41984
  v_add_u32 v31, s63, v31
  v_mfma_f32_16x16x32_bf16 v[176:179], v[76:79], a[48:51], v[176:179]
  s_mov_b64 exec, 0xffff
  global_load_dword v36, v31, s[28:29]
  s_mov_b64 exec, -1
  v_mfma_f32_16x16x32_bf16 v[180:183], v[76:79], a[52:55], v[180:183]
  ds_read_b64_tr_b16 v[94:95], v8 offset:46080
  v_add_u32 v32, 16, v32
  v_mfma_f32_16x16x32_bf16 v[184:187], v[76:79], a[56:59], v[184:187]
  v_mul_f32 v208, v208, v40
  v_mul_f32 v209, v209, v41
  v_mfma_f32_16x16x32_bf16 v[188:191], v[76:79], a[60:63], v[188:191]
  s_waitcnt lgkmcnt(4)
  v_mul_f32 v210, v210, v42
  v_mul_f32 v211, v211, v43
  v_mfma_f32_16x16x32_bf16 v[160:163], v[80:83], a[64:67], v[160:163]
  ds_read_b64_tr_b16 v[72:73], v8 offset:49152
  v_cvt_pk_bf16_f32 v58, v208, v209
  v_mfma_f32_16x16x32_bf16 v[164:167], v[80:83], a[68:71], v[164:167]
  ds_read_b64_tr_b16 v[74:75], v8 offset:53248
  v_cvt_pk_bf16_f32 v59, v210, v211
  v_mfma_f32_16x16x32_bf16 v[168:171], v[80:83], a[72:75], v[168:171]
  buffer_store_dwordx4 v[56:59], v14, s[16:19], s50 offen offset:1024 sc1
  v_mfma_f32_16x16x32_bf16 v[172:175], v[80:83], a[76:79], v[172:175]
  ds_read_b64_tr_b16 v[76:77], v8 offset:50176
  v_mul_f32 v40, s46, v196
  v_mfma_f32_16x16x32_bf16 v[176:179], v[84:87], a[64:67], v[176:179]
  ds_read_b64_tr_b16 v[78:79], v8 offset:54272
  v_mul_f32 v41, s46, v197
  v_mfma_f32_16x16x32_bf16 v[180:183], v[84:87], a[68:71], v[180:183]
  v_mul_f32 v42, s46, v198
  v_mul_f32 v43, s46, v199
  v_mfma_f32_16x16x32_bf16 v[184:187], v[84:87], a[72:75], v[184:187]
  v_exp_f32 v40, v40
  v_mfma_f32_16x16x32_bf16 v[188:191], v[84:87], a[76:79], v[188:191]
  s_waitcnt lgkmcnt(4)
  v_exp_f32 v41, v41
  v_mfma_f32_16x16x32_bf16 v[160:163], v[88:91], a[80:83], v[160:163]
  v_exp_f32 v42, v42
  v_mfma_f32_16x16x32_bf16 v[164:167], v[88:91], a[84:87], v[164:167]
  v_exp_f32 v43, v43
  v_mfma_f32_16x16x32_bf16 v[168:171], v[88:91], a[88:91], v[168:171]
  ds_read_b64_tr_b16 v[80:81], v8 offset:57344
  v_mul_f32 v212, v196, v212
  v_mfma_f32_16x16x32_bf16 v[172:175], v[88:91], a[92:95], v[172:175]
  ds_read_b64_tr_b16 v[82:83], v8 offset:61440
  v_mul_f32 v213, v197, v213
  v_mfma_f32_16x16x32_bf16 v[176:179], v[92:95], a[80:83], v[176:179]
  ds_read_b64_tr_b16 v[84:85], v8 offset:58368
  v_mul_f32 v214, v198, v214
  v_mfma_f32_16x16x32_bf16 v[180:183], v[92:95], a[84:87], v[180:183]
  ds_read_b64_tr_b16 v[86:87], v8 offset:62464
  v_mul_f32 v215, v199, v215
  v_mfma_f32_16x16x32_bf16 v[184:187], v[92:95], a[88:91], v[184:187]
  v_add_f32 v40, 1.0, v40
  v_add_f32 v41, 1.0, v41
  v_mfma_f32_16x16x32_bf16 v[188:191], v[92:95], a[92:95], v[188:191]
  s_waitcnt lgkmcnt(4)
  v_add_f32 v42, 1.0, v42
  v_add_f32 v43, 1.0, v43
  v_mfma_f32_16x16x32_bf16 v[160:163], v[72:75], a[96:99], v[160:163]
  v_rcp_f32 v40, v40
  v_mfma_f32_16x16x32_bf16 v[164:167], v[72:75], a[100:103], v[164:167]
  v_rcp_f32 v41, v41
  v_mfma_f32_16x16x32_bf16 v[168:171], v[72:75], a[104:107], v[168:171]
  v_rcp_f32 v42, v42
  v_mfma_f32_16x16x32_bf16 v[172:175], v[72:75], a[108:111], v[172:175]
  v_rcp_f32 v43, v43
  v_mfma_f32_16x16x32_bf16 v[176:179], v[76:79], a[96:99], v[176:179]
  v_add_u32 v8, 49152, v8
  v_min_u32 v31, 161, v32
  v_mfma_f32_16x16x32_bf16 v[180:183], v[76:79], a[100:103], v[180:183]
  ds_read_b64_tr_b16 v[88:89], v8 offset:16384
  v_lshlrev_b32 v31, 7, v31
  v_mfma_f32_16x16x32_bf16 v[184:187], v[76:79], a[104:107], v[184:187]
  ds_read_b64_tr_b16 v[90:91], v8 offset:20480
  v_add_u32 v31, s63, v31
  v_mfma_f32_16x16x32_bf16 v[188:191], v[76:79], a[108:111], v[188:191]
  s_waitcnt lgkmcnt(2)
  ds_read_b64_tr_b16 v[92:93], v8 offset:17408
  ds_read_b64_tr_b16 v[94:95], v8 offset:21504
  v_mfma_f32_16x16x32_bf16 v[160:163], v[80:83], a[112:115], v[160:163]
  s_mov_b64 exec, 0xffff
  global_load_dword v36, v31, s[28:29]
  s_mov_b64 exec, -1
  v_mfma_f32_16x16x32_bf16 v[164:167], v[80:83], a[116:119], v[164:167]
  ds_read_b64_tr_b16 v[72:73], v8 offset:24576
  v_add_u32 v32, 16, v32
  v_mfma_f32_16x16x32_bf16 v[168:171], v[80:83], a[120:123], v[168:171]
  ds_read_b64_tr_b16 v[74:75], v8 offset:28672
  v_mul_f32 v212, v212, v40
  v_mfma_f32_16x16x32_bf16 v[172:175], v[80:83], a[124:127], v[172:175]
  ds_read_b64_tr_b16 v[76:77], v8 offset:25600
  v_mul_f32 v213, v213, v41
  v_mfma_f32_16x16x32_bf16 v[176:179], v[84:87], a[112:115], v[176:179]
  ds_read_b64_tr_b16 v[78:79], v8 offset:29696
  v_mul_f32 v214, v214, v42
  v_mfma_f32_16x16x32_bf16 v[180:183], v[84:87], a[116:119], v[180:183]
  v_mul_f32 v215, v215, v43
  v_cvt_pk_bf16_f32 v62, v212, v213
  v_mfma_f32_16x16x32_bf16 v[184:187], v[84:87], a[120:123], v[184:187]
  v_cvt_pk_bf16_f32 v63, v214, v215
  v_mfma_f32_16x16x32_bf16 v[188:191], v[84:87], a[124:127], v[188:191]
  s_waitcnt lgkmcnt(4)
  buffer_store_dwordx4 v[60:63], v14, s[16:19], s51 offen offset:1024 sc1
  v_mfma_f32_16x16x32_bf16 v[160:163], v[88:91], a[128:131], v[160:163]
  ds_read_b64_tr_b16 v[80:81], v8 offset:32768
  v_mul_f32 v40, s46, v200
  v_mfma_f32_16x16x32_bf16 v[164:167], v[88:91], a[132:135], v[164:167]
  ds_read_b64_tr_b16 v[82:83], v8 offset:36864
  v_mul_f32 v41, s46, v201
  v_mfma_f32_16x16x32_bf16 v[168:171], v[88:91], a[136:139], v[168:171]
  ds_read_b64_tr_b16 v[84:85], v8 offset:33792
  v_mul_f32 v42, s46, v202
  v_mfma_f32_16x16x32_bf16 v[172:175], v[88:91], a[140:143], v[172:175]
  ds_read_b64_tr_b16 v[86:87], v8 offset:37888
  v_mul_f32 v43, s46, v203
  v_mfma_f32_16x16x32_bf16 v[176:179], v[92:95], a[128:131], v[176:179]
  v_exp_f32 v40, v40
  v_mfma_f32_16x16x32_bf16 v[180:183], v[92:95], a[132:135], v[180:183]
  v_exp_f32 v41, v41
  v_mfma_f32_16x16x32_bf16 v[184:187], v[92:95], a[136:139], v[184:187]
  v_exp_f32 v42, v42
  v_mfma_f32_16x16x32_bf16 v[188:191], v[92:95], a[140:143], v[188:191]
  s_waitcnt lgkmcnt(4)
  v_exp_f32 v43, v43
  v_mfma_f32_16x16x32_bf16 v[160:163], v[72:75], a[144:147], v[160:163]
  s_lshr_b32 s65, s64, 1
  ds_read_b64_tr_b16 v[88:89], v8 offset:40960
  v_mul_f32 v216, v200, v216
  v_mfma_f32_16x16x32_bf16 v[164:167], v[72:75], a[148:151], v[164:167]
  s_lshl_b32 s65, s65, 5
  ds_read_b64_tr_b16 v[90:91], v8 offset:45056
  v_mul_f32 v217, v201, v217
  v_mfma_f32_16x16x32_bf16 v[168:171], v[72:75], a[152:155], v[168:171]
  s_lshl_b32 s66, s40, 3
  ds_read_b64_tr_b16 v[92:93], v8 offset:41984
  v_mul_f32 v218, v202, v218
  v_mfma_f32_16x16x32_bf16 v[172:175], v[72:75], a[156:159], v[172:175]
  s_add_u32 s65, s65, s66
  ds_read_b64_tr_b16 v[94:95], v8 offset:46080
  v_mul_f32 v219, v203, v219
  v_mfma_f32_16x16x32_bf16 v[176:179], v[76:79], a[144:147], v[176:179]
  s_lshl_b32 s65, s65, 13
  v_add_f32 v40, 1.0, v40
  v_add_f32 v41, 1.0, v41
  v_mfma_f32_16x16x32_bf16 v[180:183], v[76:79], a[148:151], v[180:183]
  s_and_b32 s66, s68, 1
  v_add_f32 v42, 1.0, v42
  v_add_f32 v43, 1.0, v43
  v_mfma_f32_16x16x32_bf16 v[184:187], v[76:79], a[152:155], v[184:187]
  s_lshl_b32 s66, s66, 12
  v_rcp_f32 v40, v40
  v_mfma_f32_16x16x32_bf16 v[188:191], v[76:79], a[156:159], v[188:191]
  s_waitcnt lgkmcnt(4)
  v_rcp_f32 v41, v41
  v_mfma_f32_16x16x32_bf16 v[160:163], v[80:83], a[160:163], v[160:163]
  s_add_u32 s65, s65, s66
  v_rcp_f32 v42, v42
  v_mfma_f32_16x16x32_bf16 v[164:167], v[80:83], a[164:167], v[164:167]
  s_lshr_b32 s66, s68, 1
  v_rcp_f32 v43, v43
  v_mfma_f32_16x16x32_bf16 v[168:171], v[80:83], a[168:171], v[168:171]
  s_lshl_b32 s66, s66, 9
  ds_read_b64_tr_b16 v[72:73], v9 offset:49152
  v_mul_f32 v216, v216, v40
  v_mfma_f32_16x16x32_bf16 v[172:175], v[80:83], a[172:175], v[172:175]
  s_add_u32 s65, s65, s66
  ds_read_b64_tr_b16 v[74:75], v9 offset:53248
  v_bfe_u32 v31, v0, 2, 2
  v_mfma_f32_16x16x32_bf16 v[176:179], v[84:87], a[160:163], v[176:179]
  ds_read_b64_tr_b16 v[76:77], v9 offset:50176
  v_lshlrev_b32 v31, 13, v31
  v_mfma_f32_16x16x32_bf16 v[180:183], v[84:87], a[164:167], v[180:183]
  ds_read_b64_tr_b16 v[78:79], v9 offset:54272
  v_and_b32 v32, 3, v0
  v_mfma_f32_16x16x32_bf16 v[184:187], v[84:87], a[168:171], v[184:187]
  v_lshl_add_u32 v31, v32, 7, v31
  v_add_u32 v31, s65, v31
  v_mfma_f32_16x16x32_bf16 v[188:191], v[84:87], a[172:175], v[188:191]
  s_waitcnt lgkmcnt(4)
  v_mul_f32 v217, v217, v41
  v_mul_f32 v218, v218, v42
  v_mfma_f32_16x16x32_bf16 v[160:163], v[88:91], a[176:179], v[160:163]
  s_bitcmp1_b32 s64, 0
  s_cselect_b32 s100, s70, s30
  s_cselect_b32 s101, s71, s31
  v_mfma_f32_16x16x32_bf16 v[164:167], v[88:91], a[180:183], v[164:167]
  s_mov_b64 exec, 0xffff
  global_load_dword v36, v31, s[100:101]
  s_mov_b64 exec, -1
  v_mfma_f32_16x16x32_bf16 v[168:171], v[88:91], a[184:187], v[168:171]
  ds_read_b64_tr_b16 v[80:81], v9 offset:57344
  v_mul_f32 v219, v219, v43
  v_mfma_f32_16x16x32_bf16 v[172:175], v[88:91], a[188:191], v[172:175]
  ds_read_b64_tr_b16 v[82:83], v9 offset:61440
  v_cvt_pk_bf16_f32 v66, v216, v217
  v_mfma_f32_16x16x32_bf16 v[176:179], v[92:95], a[176:179], v[176:179]
  ds_read_b64_tr_b16 v[84:85], v9 offset:58368
  v_cvt_pk_bf16_f32 v67, v218, v219
  v_mfma_f32_16x16x32_bf16 v[180:183], v[92:95], a[180:183], v[180:183]
  ds_read_b64_tr_b16 v[86:87], v9 offset:62464
  v_mfma_f32_16x16x32_bf16 v[184:187], v[92:95], a[184:187], v[184:187]
  buffer_store_dwordx4 v[64:67], v14, s[16:19], s52 offen offset:1024 sc1
  v_mfma_f32_16x16x32_bf16 v[188:191], v[92:95], a[188:191], v[188:191]
  s_waitcnt lgkmcnt(4)
  v_mul_f32 v40, s46, v204
  v_mul_f32 v41, s46, v205
  v_mul_f32 v42, s46, v206
  v_mul_f32 v43, s46, v207
  v_exp_f32 v40, v40
  v_exp_f32 v41, v41
  v_exp_f32 v42, v42
  v_exp_f32 v43, v43
  v_mul_f32 v220, v204, v220
  v_mul_f32 v221, v205, v221
  v_mul_f32 v222, v206, v222
  v_mul_f32 v223, v207, v223
  v_add_f32 v40, 1.0, v40
  v_add_f32 v41, 1.0, v41
  v_add_f32 v42, 1.0, v42
  v_add_f32 v43, 1.0, v43
  v_rcp_f32 v40, v40
  v_rcp_f32 v41, v41
  v_rcp_f32 v42, v42
  v_rcp_f32 v43, v43
  v_mul_f32 v220, v220, v40
  v_mul_f32 v221, v221, v41
  v_mul_f32 v222, v222, v42
  v_mul_f32 v223, v223, v43
  v_cvt_pk_bf16_f32 v70, v220, v221
  v_cvt_pk_bf16_f32 v71, v222, v223
  buffer_store_dwordx4 v[68:71], v14, s[16:19], s53 offen offset:1024 sc1
  v_mfma_f32_16x16x32_bf16 v[192:195], v[72:75], a[0:3], 0
  v_add_u32 v9, 49152, v9
  v_add_u32 v31, 32768, v31
  v_mfma_f32_16x16x32_bf16 v[196:199], v[72:75], a[4:7], 0
  s_mov_b64 exec, 0xffff
  global_load_dword v36, v31, s[100:101]
  s_mov_b64 exec, -1
  v_mfma_f32_16x16x32_bf16 v[200:203], v[72:75], a[8:11], 0
  ds_read_b64_tr_b16 v[88:89], v9 offset:16384
  ds_read_b64_tr_b16 v[90:91], v9 offset:20480
  v_mfma_f32_16x16x32_bf16 v[204:207], v[72:75], a[12:15], 0
  ds_read_b64_tr_b16 v[92:93], v9 offset:17408
  ds_read_b64_tr_b16 v[94:95], v9 offset:21504
  v_mfma_f32_16x16x32_bf16 v[208:211], v[76:79], a[0:3], 0
  v_mfma_f32_16x16x32_bf16 v[212:215], v[76:79], a[4:7], 0
  v_mfma_f32_16x16x32_bf16 v[216:219], v[76:79], a[8:11], 0
  v_mfma_f32_16x16x32_bf16 v[220:223], v[76:79], a[12:15], 0
  s_waitcnt lgkmcnt(4)
  v_mfma_f32_16x16x32_bf16 v[192:195], v[80:83], a[16:19], v[192:195]
  ds_read_b64_tr_b16 v[72:73], v9 offset:24576
  ds_read_b64_tr_b16 v[74:75], v9 offset:28672
  v_mfma_f32_16x16x32_bf16 v[196:199], v[80:83], a[20:23], v[196:199]
  ds_read_b64_tr_b16 v[76:77], v9 offset:25600
  ds_read_b64_tr_b16 v[78:79], v9 offset:29696
  v_mfma_f32_16x16x32_bf16 v[200:203], v[80:83], a[24:27], v[200:203]
  v_mfma_f32_16x16x32_bf16 v[204:207], v[80:83], a[28:31], v[204:207]
  v_mfma_f32_16x16x32_bf16 v[208:211], v[84:87], a[16:19], v[208:211]
  v_mfma_f32_16x16x32_bf16 v[212:215], v[84:87], a[20:23], v[212:215]
  v_mfma_f32_16x16x32_bf16 v[216:219], v[84:87], a[24:27], v[216:219]
  v_mfma_f32_16x16x32_bf16 v[220:223], v[84:87], a[28:31], v[220:223]
  s_waitcnt lgkmcnt(4)
  v_mfma_f32_16x16x32_bf16 v[192:195], v[88:91], a[32:35], v[192:195]
  ds_read_b64_tr_b16 v[80:81], v9 offset:32768
  ds_read_b64_tr_b16 v[82:83], v9 offset:36864
  v_mfma_f32_16x16x32_bf16 v[196:199], v[88:91], a[36:39], v[196:199]
  ds_read_b64_tr_b16 v[84:85], v9 offset:33792
  ds_read_b64_tr_b16 v[86:87], v9 offset:37888
  v_mfma_f32_16x16x32_bf16 v[200:203], v[88:91], a[40:43], v[200:203]
  v_mfma_f32_16x16x32_bf16 v[204:207], v[88:91], a[44:47], v[204:207]
  v_mfma_f32_16x16x32_bf16 v[208:211], v[92:95], a[32:35], v[208:211]
  v_mfma_f32_16x16x32_bf16 v[212:215], v[92:95], a[36:39], v[212:215]
  v_mfma_f32_16x16x32_bf16 v[216:219], v[92:95], a[40:43], v[216:219]
  v_mfma_f32_16x16x32_bf16 v[220:223], v[92:95], a[44:47], v[220:223]
  s_waitcnt lgkmcnt(4)
  v_mfma_f32_16x16x32_bf16 v[192:195], v[72:75], a[48:51], v[192:195]
  ds_read_b64_tr_b16 v[88:89], v9 offset:40960
  ds_read_b64_tr_b16 v[90:91], v9 offset:45056
  v_mfma_f32_16x16x32_bf16 v[196:199], v[72:75], a[52:55], v[196:199]
  ds_read_b64_tr_b16 v[92:93], v9 offset:41984
  ds_read_b64_tr_b16 v[94:95], v9 offset:46080
  v_mfma_f32_16x16x32_bf16 v[200:203], v[72:75], a[56:59], v[200:203]
  v_mfma_f32_16x16x32_bf16 v[204:207], v[72:75], a[60:63], v[204:207]
  v_mfma_f32_16x16x32_bf16 v[208:211], v[76:79], a[48:51], v[208:211]
  v_mfma_f32_16x16x32_bf16 v[212:215], v[76:79], a[52:55], v[212:215]
  v_mfma_f32_16x16x32_bf16 v[216:219], v[76:79], a[56:59], v[216:219]
  v_mfma_f32_16x16x32_bf16 v[220:223], v[76:79], a[60:63], v[220:223]
  s_waitcnt lgkmcnt(4)
  v_mfma_f32_16x16x32_bf16 v[192:195], v[80:83], a[64:67], v[192:195]
  ds_read_b64_tr_b16 v[72:73], v9 offset:49152
  ds_read_b64_tr_b16 v[74:75], v9 offset:53248
  v_mfma_f32_16x16x32_bf16 v[196:199], v[80:83], a[68:71], v[196:199]
  ds_read_b64_tr_b16 v[76:77], v9 offset:50176
  ds_read_b64_tr_b16 v[78:79], v9 offset:54272
  v_mfma_f32_16x16x32_bf16 v[200:203], v[80:83], a[72:75], v[200:203]
  v_mfma_f32_16x16x32_bf16 v[204:207], v[80:83], a[76:79], v[204:207]
  v_mfma_f32_16x16x32_bf16 v[208:211], v[84:87], a[64:67], v[208:211]
  v_mfma_f32_16x16x32_bf16 v[212:215], v[84:87], a[68:71], v[212:215]
  v_mfma_f32_16x16x32_bf16 v[216:219], v[84:87], a[72:75], v[216:219]
  v_mfma_f32_16x16x32_bf16 v[220:223], v[84:87], a[76:79], v[220:223]
  s_waitcnt lgkmcnt(4)
  v_mfma_f32_16x16x32_bf16 v[192:195], v[88:91], a[80:83], v[192:195]
  ds_read_b64_tr_b16 v[80:81], v9 offset:57344
  ds_read_b64_tr_b16 v[82:83], v9 offset:61440
  v_mfma_f32_16x16x32_bf16 v[196:199], v[88:91], a[84:87], v[196:199]
  ds_read_b64_tr_b16 v[84:85], v9 offset:58368
  ds_read_b64_tr_b16 v[86:87], v9 offset:62464
  v_mfma_f32_16x16x32_bf16 v[200:203], v[88:91], a[88:91], v[200:203]
  v_mfma_f32_16x16x32_bf16 v[204:207], v[88:91], a[92:95], v[204:207]
  v_mfma_f32_16x16x32_bf16 v[208:211], v[92:95], a[80:83], v[208:211]
  v_mfma_f32_16x16x32_bf16 v[212:215], v[92:95], a[84:87], v[212:215]
  v_mfma_f32_16x16x32_bf16 v[216:219], v[92:95], a[88:91], v[216:219]
  v_mfma_f32_16x16x32_bf16 v[220:223], v[92:95], a[92:95], v[220:223]
  s_waitcnt lgkmcnt(4)
  v_mfma_f32_16x16x32_bf16 v[192:195], v[72:75], a[96:99], v[192:195]
  v_add_u32 v9, 49152, v9
  ds_read_b64_tr_b16 v[88:89], v9 offset:16384
  v_mfma_f32_16x16x32_bf16 v[196:199], v[72:75], a[100:103], v[196:199]
  ds_read_b64_tr_b16 v[90:91], v9 offset:20480
  ds_read_b64_tr_b16 v[92:93], v9 offset:17408
  v_mfma_f32_16x16x32_bf16 v[200:203], v[72:75], a[104:107], v[200:203]
  ds_read_b64_tr_b16 v[94:95], v9 offset:21504
  v_mfma_f32_16x16x32_bf16 v[204:207], v[72:75], a[108:111], v[204:207]
  v_mfma_f32_16x16x32_bf16 v[208:211], v[76:79], a[96:99], v[208:211]
  v_mfma_f32_16x16x32_bf16 v[212:215], v[76:79], a[100:103], v[212:215]
  v_mfma_f32_16x16x32_bf16 v[216:219], v[76:79], a[104:107], v[216:219]
  v_mfma_f32_16x16x32_bf16 v[220:223], v[76:79], a[108:111], v[220:223]
  s_waitcnt lgkmcnt(4)
  v_mfma_f32_16x16x32_bf16 v[192:195], v[80:83], a[112:115], v[192:195]
  ds_read_b64_tr_b16 v[72:73], v9 offset:24576
  ds_read_b64_tr_b16 v[74:75], v9 offset:28672
  v_mfma_f32_16x16x32_bf16 v[196:199], v[80:83], a[116:119], v[196:199]
  ds_read_b64_tr_b16 v[76:77], v9 offset:25600
  ds_read_b64_tr_b16 v[78:79], v9 offset:29696
  v_mfma_f32_16x16x32_bf16 v[200:203], v[80:83], a[120:123], v[200:203]
  v_mfma_f32_16x16x32_bf16 v[204:207], v[80:83], a[124:127], v[204:207]
  v_mfma_f32_16x16x32_bf16 v[208:211], v[84:87], a[112:115], v[208:211]
  v_mfma_f32_16x16x32_bf16 v[212:215], v[84:87], a[116:119], v[212:215]
  v_mfma_f32_16x16x32_bf16 v[216:219], v[84:87], a[120:123], v[216:219]
  v_mfma_f32_16x16x32_bf16 v[220:223], v[84:87], a[124:127], v[220:223]
  s_waitcnt lgkmcnt(4)
  v_mfma_f32_16x16x32_bf16 v[192:195], v[88:91], a[128:131], v[192:195]
  ds_read_b64_tr_b16 v[80:81], v9 offset:32768
  ds_read_b64_tr_b16 v[82:83], v9 offset:36864
  v_mfma_f32_16x16x32_bf16 v[196:199], v[88:91], a[132:135], v[196:199]
  ds_read_b64_tr_b16 v[84:85], v9 offset:33792
  ds_read_b64_tr_b16 v[86:87], v9 offset:37888
  v_mfma_f32_16x16x32_bf16 v[200:203], v[88:91], a[136:139], v[200:203]
  v_mfma_f32_16x16x32_bf16 v[204:207], v[88:91], a[140:143], v[204:207]
  v_mfma_f32_16x16x32_bf16 v[208:211], v[92:95], a[128:131], v[208:211]
  v_mfma_f32_16x16x32_bf16 v[212:215], v[92:95], a[132:135], v[212:215]
  v_mfma_f32_16x16x32_bf16 v[216:219], v[92:95], a[136:139], v[216:219]
  v_mfma_f32_16x16x32_bf16 v[220:223], v[92:95], a[140:143], v[220:223]
  s_waitcnt lgkmcnt(4)
  v_mfma_f32_16x16x32_bf16 v[192:195], v[72:75], a[144:147], v[192:195]
  ds_read_b64_tr_b16 v[88:89], v9 offset:40960
  ds_read_b64_tr_b16 v[90:91], v9 offset:45056
  v_mfma_f32_16x16x32_bf16 v[196:199], v[72:75], a[148:151], v[196:199]
  ds_read_b64_tr_b16 v[92:93], v9 offset:41984
  ds_read_b64_tr_b16 v[94:95], v9 offset:46080
  v_mfma_f32_16x16x32_bf16 v[200:203], v[72:75], a[152:155], v[200:203]
  v_mfma_f32_16x16x32_bf16 v[204:207], v[72:75], a[156:159], v[204:207]
  v_mfma_f32_16x16x32_bf16 v[208:211], v[76:79], a[144:147], v[208:211]
  v_mfma_f32_16x16x32_bf16 v[212:215], v[76:79], a[148:151], v[212:215]
  v_mfma_f32_16x16x32_bf16 v[216:219], v[76:79], a[152:155], v[216:219]
  v_mfma_f32_16x16x32_bf16 v[220:223], v[76:79], a[156:159], v[220:223]
  s_waitcnt vmcnt(10)
  s_barrier
  s_waitcnt lgkmcnt(4)
  v_mfma_f32_16x16x32_bf16 v[192:195], v[80:83], a[160:163], v[192:195]
  v_subrev_u32 v6, 98304, v6
  ds_read_b64_tr_b16 v[72:73], v6 offset:0
  v_mfma_f32_16x16x32_bf16 v[196:199], v[80:83], a[164:167], v[196:199]
  s_bfe_u32 s49, s59, 0x40010
  ds_read_b64_tr_b16 v[74:75], v6 offset:4096
  s_mul_i32 s49, s49, 589824
  v_mfma_f32_16x16x32_bf16 v[200:203], v[80:83], a[168:171], v[200:203]
  s_add_u32 m0, s60, 49152
  ds_read_b64_tr_b16 v[76:77], v6 offset:1024
  s_add_u32 s49, s49, s58
  v_mfma_f32_16x16x32_bf16 v[204:207], v[80:83], a[172:175], v[204:207]
  buffer_load_dwordx4 v12, s[20:23], s49 offen lds
  v_mfma_f32_16x16x32_bf16 v[208:211], v[84:87], a[160:163], v[208:211]
  ds_read_b64_tr_b16 v[78:79], v6 offset:5120
  v_mfma_f32_16x16x32_bf16 v[212:215], v[84:87], a[164:167], v[212:215]
  v_mfma_f32_16x16x32_bf16 v[216:219], v[84:87], a[168:171], v[216:219]
  v_mfma_f32_16x16x32_bf16 v[220:223], v[84:87], a[172:175], v[220:223]
  s_waitcnt lgkmcnt(4)
  s_bfe_u32 s49, s59, 0x40014
  s_mul_i32 s49, s49, 589824
  v_mfma_f32_16x16x32_bf16 v[192:195], v[88:91], a[176:179], v[192:195]
  s_add_u32 m0, s60, 53248
  ds_read_b64_tr_b16 v[80:81], v6 offset:8192
  s_add_u32 s49, s49, s58
  v_mfma_f32_16x16x32_bf16 v[196:199], v[88:91], a[180:183], v[196:199]
  buffer_load_dwordx4 v12, s[20:23], s49 offen lds
  v_mfma_f32_16x16x32_bf16 v[200:203], v[88:91], a[184:187], v[200:203]
  ds_read_b64_tr_b16 v[82:83], v6 offset:12288
  ds_read_b64_tr_b16 v[84:85], v6 offset:9216
  v_mfma_f32_16x16x32_bf16 v[204:207], v[88:91], a[188:191], v[204:207]
  ds_read_b64_tr_b16 v[86:87], v6 offset:13312
  v_mfma_f32_16x16x32_bf16 v[208:211], v[92:95], a[176:179], v[208:211]
  v_mfma_f32_16x16x32_bf16 v[212:215], v[92:95], a[180:183], v[212:215]
  s_bfe_u32 s49, s59, 0x40018
  s_mul_i32 s49, s49, 589824
  s_add_u32 m0, s60, 57344
  v_mfma_f32_16x16x32_bf16 v[216:219], v[92:95], a[184:187], v[216:219]
  s_add_u32 s49, s49, s58
  buffer_load_dwordx4 v12, s[20:23], s49 offen lds
  v_mfma_f32_16x16x32_bf16 v[220:223], v[92:95], a[188:191], v[220:223]
  s_waitcnt lgkmcnt(4)
  v_mfma_f32_16x16x32_bf16 v[96:99], v[72:75], a[192:195], v[96:99]
  ds_read_b64_tr_b16 v[88:89], v6 offset:16384
  ds_read_b64_tr_b16 v[90:91], v6 offset:20480
  v_mfma_f32_16x16x32_bf16 v[100:103], v[72:75], a[196:199], v[100:103]
  ds_read_b64_tr_b16 v[92:93], v6 offset:17408
  ds_read_b64_tr_b16 v[94:95], v6 offset:21504
  v_mfma_f32_16x16x32_bf16 v[104:107], v[72:75], a[200:203], v[104:107]
  v_mfma_f32_16x16x32_bf16 v[108:111], v[72:75], a[204:207], v[108:111]
  s_bfe_u32 s49, s59, 0x4001c
  s_mul_i32 s49, s49, 589824
  s_add_u32 m0, s60, 61440
  v_mfma_f32_16x16x32_bf16 v[112:115], v[76:79], a[192:195], v[112:115]
  s_add_u32 s49, s49, s58
  buffer_load_dwordx4 v12, s[20:23], s49 offen lds
  v_mfma_f32_16x16x32_bf16 v[116:119], v[76:79], a[196:199], v[116:119]
  v_mfma_f32_16x16x32_bf16 v[120:123], v[76:79], a[200:203], v[120:123]
  v_mfma_f32_16x16x32_bf16 v[124:127], v[76:79], a[204:207], v[124:127]
  s_barrier
  s_waitcnt lgkmcnt(4)
  v_mfma_f32_16x16x32_bf16 v[96:99], v[80:83], a[208:211], v[96:99]
  ds_read_b64_tr_b16 v[72:73], v6 offset:24576
  ds_read_b64_tr_b16 v[74:75], v6 offset:28672
  v_mfma_f32_16x16x32_bf16 v[100:103], v[80:83], a[212:215], v[100:103]
  s_mov_b32 s49, s3
  ds_read_b64_tr_b16 v[76:77], v6 offset:25600
  s_mul_i32 s49, s49, 589824
  v_mfma_f32_16x16x32_bf16 v[104:107], v[80:83], a[216:219], v[104:107]
  s_add_u32 m0, s60, 65536
  ds_read_b64_tr_b16 v[78:79], v6 offset:29696
  s_add_u32 s49, s49, s58
  v_mfma_f32_16x16x32_bf16 v[108:111], v[80:83], a[220:223], v[108:111]
  buffer_load_dwordx4 v12, s[20:23], s49 offen lds
  v_mfma_f32_16x16x32_bf16 v[112:115], v[84:87], a[208:211], v[112:115]
  v_mfma_f32_16x16x32_bf16 v[116:119], v[84:87], a[212:215], v[116:119]
  v_mfma_f32_16x16x32_bf16 v[120:123], v[84:87], a[216:219], v[120:123]
  v_mfma_f32_16x16x32_bf16 v[124:127], v[84:87], a[220:223], v[124:127]
  s_cmp_gt_u32 s42, 18
  s_cbranch_scc1 gated_mix__spectral_fnet__swiglu_ffn__prompt_kernel_nog3
  s_lshl_b32 s38, s2, 7
  s_add_u32 s38, s38, 33300480
  s_waitcnt lgkmcnt(4)
  v_mfma_f32_16x16x32_bf16 v[96:99], v[88:91], a[224:227], v[96:99]
  ds_read_b64_tr_b16 v[80:81], v6 offset:32768
  ds_read_b64_tr_b16 v[82:83], v6 offset:36864
  v_mfma_f32_16x16x32_bf16 v[100:103], v[88:91], a[228:231], v[100:103]
  ds_read_b64_tr_b16 v[84:85], v6 offset:33792
  ds_read_b64_tr_b16 v[86:87], v6 offset:37888
  v_mfma_f32_16x16x32_bf16 v[104:107], v[88:91], a[232:235], v[104:107]
  s_bfe_u32 s49, s59, 0x40000
  s_add_u32 m0, s34, 0
  s_lshl_b32 s49, s49, 7
  v_mfma_f32_16x16x32_bf16 v[108:111], v[88:91], a[236:239], v[108:111]
  buffer_load_dwordx4 v13, s[24:27], s49 offen lds
  v_mfma_f32_16x16x32_bf16 v[112:115], v[92:95], a[224:227], v[112:115]
  v_mfma_f32_16x16x32_bf16 v[116:119], v[92:95], a[228:231], v[116:119]
  s_bfe_u32 s49, s59, 0x40004
  s_add_u32 m0, s34, 2048
  s_lshl_b32 s49, s49, 7
  v_mfma_f32_16x16x32_bf16 v[120:123], v[92:95], a[232:235], v[120:123]
  buffer_load_dwordx4 v13, s[24:27], s49 offen lds
  v_mfma_f32_16x16x32_bf16 v[124:127], v[92:95], a[236:239], v[124:127]
  s_waitcnt lgkmcnt(4)
  v_mfma_f32_16x16x32_bf16 v[96:99], v[72:75], a[240:243], v[96:99]
  s_bfe_u32 s49, s59, 0x40008
  ds_read_b64_tr_b16 v[88:89], v6 offset:40960
  s_add_u32 m0, s34, 4096
  v_mfma_f32_16x16x32_bf16 v[100:103], v[72:75], a[244:247], v[100:103]
  s_lshl_b32 s49, s49, 7
  buffer_load_dwordx4 v13, s[24:27], s49 offen lds
  v_mfma_f32_16x16x32_bf16 v[104:107], v[72:75], a[248:251], v[104:107]
  ds_read_b64_tr_b16 v[90:91], v6 offset:45056
  ds_read_b64_tr_b16 v[92:93], v6 offset:41984
  v_mfma_f32_16x16x32_bf16 v[108:111], v[72:75], a[252:255], v[108:111]
  s_bfe_u32 s49, s59, 0x4000c
  ds_read_b64_tr_b16 v[94:95], v6 offset:46080
  s_add_u32 m0, s34, 6144
  v_mfma_f32_16x16x32_bf16 v[112:115], v[76:79], a[240:243], v[112:115]
  s_lshl_b32 s49, s49, 7
  buffer_load_dwordx4 v13, s[24:27], s49 offen lds
  v_mfma_f32_16x16x32_bf16 v[116:119], v[76:79], a[244:247], v[116:119]
  v_mfma_f32_16x16x32_bf16 v[120:123], v[76:79], a[248:251], v[120:123]
  s_bfe_u32 s49, s59, 0x40010
  s_add_u32 m0, s34, 8192
  s_lshl_b32 s49, s49, 7
  v_mfma_f32_16x16x32_bf16 v[124:127], v[76:79], a[252:255], v[124:127]
  s_waitcnt lgkmcnt(4)
  buffer_load_dwordx4 v13, s[24:27], s49 offen lds
  v_mfma_f32_16x16x32_bf16 v[96:99], v[80:83], v[224:227], v[96:99]
  v_subrev_u32 v7, 98304, v7
  ds_read_b64_tr_b16 v[72:73], v7 offset:0
  v_mfma_f32_16x16x32_bf16 v[100:103], v[80:83], v[228:231], v[100:103]
  s_bfe_u32 s49, s59, 0x40014
  ds_read_b64_tr_b16 v[74:75], v7 offset:4096
  s_add_u32 m0, s34, 10240
  v_mfma_f32_16x16x32_bf16 v[104:107], v[80:83], v[232:235], v[104:107]
  s_lshl_b32 s49, s49, 7
  buffer_load_dwordx4 v13, s[24:27], s49 offen lds
  v_mfma_f32_16x16x32_bf16 v[108:111], v[80:83], v[236:239], v[108:111]
  ds_read_b64_tr_b16 v[76:77], v7 offset:1024
  ds_read_b64_tr_b16 v[78:79], v7 offset:5120
  v_mfma_f32_16x16x32_bf16 v[112:115], v[84:87], v[224:227], v[112:115]
  s_bfe_u32 s49, s59, 0x40018
  s_add_u32 m0, s34, 12288
  s_lshl_b32 s49, s49, 7
  v_mfma_f32_16x16x32_bf16 v[116:119], v[84:87], v[228:231], v[116:119]
  buffer_load_dwordx4 v13, s[24:27], s49 offen lds
  v_mfma_f32_16x16x32_bf16 v[120:123], v[84:87], v[232:235], v[120:123]
  v_mfma_f32_16x16x32_bf16 v[124:127], v[84:87], v[236:239], v[124:127]
  s_waitcnt lgkmcnt(4)
  s_bfe_u32 s49, s59, 0x4001c
  s_add_u32 m0, s34, 14336
  v_mfma_f32_16x16x32_bf16 v[96:99], v[88:91], v[240:243], v[96:99]
  s_lshl_b32 s49, s49, 7
  buffer_load_dwordx4 v13, s[24:27], s49 offen lds
  v_mfma_f32_16x16x32_bf16 v[100:103], v[88:91], v[244:247], v[100:103]
  ds_read_b64_tr_b16 v[80:81], v7 offset:8192
  ds_read_b64_tr_b16 v[82:83], v7 offset:12288
  v_mfma_f32_16x16x32_bf16 v[104:107], v[88:91], v[248:251], v[104:107]
  s_mov_b32 s49, s3
  ds_read_b64_tr_b16 v[84:85], v7 offset:9216
  s_add_u32 m0, s34, 16384
  v_mfma_f32_16x16x32_bf16 v[108:111], v[88:91], v[252:255], v[108:111]
  s_lshl_b32 s49, s49, 7
  buffer_load_dwordx4 v13, s[24:27], s49 offen lds
  v_mfma_f32_16x16x32_bf16 v[112:115], v[92:95], v[240:243], v[112:115]
  ds_read_b64_tr_b16 v[86:87], v7 offset:13312
  v_mfma_f32_16x16x32_bf16 v[116:119], v[92:95], v[244:247], v[116:119]
  v_mfma_f32_16x16x32_bf16 v[120:123], v[92:95], v[248:251], v[120:123]
  v_mfma_f32_16x16x32_bf16 v[124:127], v[92:95], v[252:255], v[124:127]
  s_waitcnt lgkmcnt(4)
  v_mfma_f32_16x16x32_bf16 v[128:131], v[72:75], a[192:195], v[128:131]
  ds_read_b64_tr_b16 v[88:89], v7 offset:16384
  ds_read_b64_tr_b16 v[90:91], v7 offset:20480
  v_mfma_f32_16x16x32_bf16 v[132:135], v[72:75], a[196:199], v[132:135]
  ds_read_b64_tr_b16 v[92:93], v7 offset:17408
  ds_read_b64_tr_b16 v[94:95], v7 offset:21504
  v_mfma_f32_16x16x32_bf16 v[136:139], v[72:75], a[200:203], v[136:139]
  v_mul_f32 v40, s46, v96
  v_mul_f32 v41, s46, v97
  v_mfma_f32_16x16x32_bf16 v[140:143], v[72:75], a[204:207], v[140:143]
  v_mul_f32 v42, s46, v98
  v_mul_f32 v43, s46, v99
  v_mfma_f32_16x16x32_bf16 v[144:147], v[76:79], a[192:195], v[144:147]
  v_exp_f32 v40, v40
  v_mfma_f32_16x16x32_bf16 v[148:151], v[76:79], a[196:199], v[148:151]
  v_exp_f32 v41, v41
  v_mfma_f32_16x16x32_bf16 v[152:155], v[76:79], a[200:203], v[152:155]
  v_exp_f32 v42, v42
  v_mfma_f32_16x16x32_bf16 v[156:159], v[76:79], a[204:207], v[156:159]
  s_waitcnt lgkmcnt(4)
  v_exp_f32 v43, v43
  v_mfma_f32_16x16x32_bf16 v[128:131], v[80:83], a[208:211], v[128:131]
  ds_read_b64_tr_b16 v[72:73], v7 offset:24576
  v_mul_f32 v112, v96, v112
  v_mfma_f32_16x16x32_bf16 v[132:135], v[80:83], a[212:215], v[132:135]
  ds_read_b64_tr_b16 v[74:75], v7 offset:28672
  v_mul_f32 v113, v97, v113
  v_mfma_f32_16x16x32_bf16 v[136:139], v[80:83], a[216:219], v[136:139]
  ds_read_b64_tr_b16 v[76:77], v7 offset:25600
  v_mul_f32 v114, v98, v114
  v_mfma_f32_16x16x32_bf16 v[140:143], v[80:83], a[220:223], v[140:143]
  ds_read_b64_tr_b16 v[78:79], v7 offset:29696
  v_mul_f32 v115, v99, v115
  v_mfma_f32_16x16x32_bf16 v[144:147], v[84:87], a[208:211], v[144:147]
  v_add_f32 v40, 1.0, v40
  v_add_f32 v41, 1.0, v41
  v_mfma_f32_16x16x32_bf16 v[148:151], v[84:87], a[212:215], v[148:151]
  v_add_f32 v42, 1.0, v42
  v_add_f32 v43, 1.0, v43
  v_mfma_f32_16x16x32_bf16 v[152:155], v[84:87], a[216:219], v[152:155]
  v_rcp_f32 v40, v40
  v_mfma_f32_16x16x32_bf16 v[156:159], v[84:87], a[220:223], v[156:159]
  s_waitcnt lgkmcnt(4)
  v_rcp_f32 v41, v41
  v_mfma_f32_16x16x32_bf16 v[128:131], v[88:91], a[224:227], v[128:131]
  v_rcp_f32 v42, v42
  v_mfma_f32_16x16x32_bf16 v[132:135], v[88:91], a[228:231], v[132:135]
  v_rcp_f32 v43, v43
  v_mfma_f32_16x16x32_bf16 v[136:139], v[88:91], a[232:235], v[136:139]
  ds_read_b64_tr_b16 v[80:81], v7 offset:32768
  v_mul_f32 v112, v112, v40
  v_mfma_f32_16x16x32_bf16 v[140:143], v[88:91], a[236:239], v[140:143]
  ds_read_b64_tr_b16 v[82:83], v7 offset:36864
  v_mul_f32 v113, v113, v41
  v_mfma_f32_16x16x32_bf16 v[144:147], v[92:95], a[224:227], v[144:147]
  ds_read_b64_tr_b16 v[84:85], v7 offset:33792
  v_mul_f32 v114, v114, v42
  v_mfma_f32_16x16x32_bf16 v[148:151], v[92:95], a[228:231], v[148:151]
  ds_read_b64_tr_b16 v[86:87], v7 offset:37888
  v_mul_f32 v115, v115, v43
  v_mfma_f32_16x16x32_bf16 v[152:155], v[92:95], a[232:235], v[152:155]
  v_cvt_pk_bf16_f32 v56, v112, v113
  v_cvt_pk_bf16_f32 v57, v114, v115
  v_mfma_f32_16x16x32_bf16 v[156:159], v[92:95], a[236:239], v[156:159]
  s_waitcnt lgkmcnt(4)
  v_mul_f32 v40, s46, v100
  v_mul_f32 v41, s46, v101
  v_mfma_f32_16x16x32_bf16 v[128:131], v[72:75], a[240:243], v[128:131]
  ds_read_b64_tr_b16 v[88:89], v7 offset:40960
  v_mul_f32 v42, s46, v102
  v_mfma_f32_16x16x32_bf16 v[132:135], v[72:75], a[244:247], v[132:135]
  ds_read_b64_tr_b16 v[90:91], v7 offset:45056
  v_mul_f32 v43, s46, v103
  v_mfma_f32_16x16x32_bf16 v[136:139], v[72:75], a[248:251], v[136:139]
  v_exp_f32 v40, v40
  v_mfma_f32_16x16x32_bf16 v[140:143], v[72:75], a[252:255], v[140:143]
  v_exp_f32 v41, v41
  v_mfma_f32_16x16x32_bf16 v[144:147], v[76:79], a[240:243], v[144:147]
  ds_read_b64_tr_b16 v[92:93], v7 offset:41984
  ds_read_b64_tr_b16 v[94:95], v7 offset:46080
  v_mfma_f32_16x16x32_bf16 v[148:151], v[76:79], a[244:247], v[148:151]
  v_exp_f32 v42, v42
  v_mfma_f32_16x16x32_bf16 v[152:155], v[76:79], a[248:251], v[152:155]
  v_exp_f32 v43, v43
  v_mfma_f32_16x16x32_bf16 v[156:159], v[76:79], a[252:255], v[156:159]
  s_waitcnt lgkmcnt(4)
  v_mul_f32 v116, v100, v116
  v_mul_f32 v117, v101, v117
  v_mfma_f32_16x16x32_bf16 v[128:131], v[80:83], v[224:227], v[128:131]
  v_subrev_u32 v8, 98304, v8
  v_and_b32 v26, 15, v0
  v_mfma_f32_16x16x32_bf16 v[132:135], v[80:83], v[228:231], v[132:135]
  ds_read_b64_tr_b16 v[72:73], v8 offset:0
  v_lshrrev_b32 v27, 4, v0
  v_mfma_f32_16x16x32_bf16 v[136:139], v[80:83], v[232:235], v[136:139]
  s_lshl_b32 s36, s42, 4
  ds_read_b64_tr_b16 v[74:75], v8 offset:4096
  v_add_u32 v28, s36, v26
  v_mfma_f32_16x16x32_bf16 v[140:143], v[80:83], v[236:239], v[140:143]
  ds_read_b64_tr_b16 v[76:77], v8 offset:1024
  v_sub_u32 v29, 0x240, v28
  v_mfma_f32_16x16x32_bf16 v[144:147], v[84:87], v[224:227], v[144:147]
  ds_read_b64_tr_b16 v[78:79], v8 offset:5120
  v_lshrrev_b32 v16, 4, v29
  v_mfma_f32_16x16x32_bf16 v[148:151], v[84:87], v[228:231], v[148:151]
  v_lshlrev_b32 v16, 10, v16
  v_and_b32 v29, 15, v29
  v_mfma_f32_16x16x32_bf16 v[152:155], v[84:87], v[232:235], v[152:155]
  v_lshl_add_u32 v29, v27, 4, v29
  v_lshl_add_u32 v16, v29, 4, v16
  v_mfma_f32_16x16x32_bf16 v[156:159], v[84:87], v[236:239], v[156:159]
  s_waitcnt lgkmcnt(4)
  v_add_u32 v29, -1, v28
  v_mov_b32 v30, 0x40000000
  v_mfma_f32_16x16x32_bf16 v[128:131], v[88:91], v[240:243], v[128:131]
  ds_read_b64_tr_b16 v[80:81], v8 offset:8192
  v_cmp_gt_u32 vcc, 0x11f, v29
  v_mfma_f32_16x16x32_bf16 v[132:135], v[88:91], v[244:247], v[132:135]
  s_lshl_b32 s36, s42, 10
  ds_read_b64_tr_b16 v[82:83], v8 offset:12288
  v_add_u32 v17, s36, v14
  v_mfma_f32_16x16x32_bf16 v[136:139], v[88:91], v[248:251], v[136:139]
  ds_read_b64_tr_b16 v[84:85], v8 offset:9216
  v_cndmask_b32 v16, v30, v16, vcc
  v_mfma_f32_16x16x32_bf16 v[140:143], v[88:91], v[252:255], v[140:143]
  ds_read_b64_tr_b16 v[86:87], v8 offset:13312
  v_cmp_gt_u32 vcc, 0x121, v28
  v_mfma_f32_16x16x32_bf16 v[144:147], v[92:95], v[240:243], v[144:147]
  s_nop 1
  v_cndmask_b32 v17, v30, v17, vcc
  v_mul_f32 v118, v102, v118
  v_mfma_f32_16x16x32_bf16 v[148:151], v[92:95], v[244:247], v[148:151]
  v_mul_f32 v119, v103, v119
  v_add_f32 v40, 1.0, v40
  v_mfma_f32_16x16x32_bf16 v[152:155], v[92:95], v[248:251], v[152:155]
  v_add_f32 v41, 1.0, v41
  v_add_f32 v42, 1.0, v42
  v_mfma_f32_16x16x32_bf16 v[156:159], v[92:95], v[252:255], v[156:159]
  s_waitcnt lgkmcnt(4)
  v_add_f32 v43, 1.0, v43
  v_mfma_f32_16x16x32_bf16 v[160:163], v[72:75], a[192:195], v[160:163]
  v_rcp_f32 v40, v40
  v_mfma_f32_16x16x32_bf16 v[164:167], v[72:75], a[196:199], v[164:167]
  v_rcp_f32 v41, v41
  v_mfma_f32_16x16x32_bf16 v[168:171], v[72:75], a[200:203], v[168:171]
  ds_read_b64_tr_b16 v[88:89], v8 offset:16384
  ds_read_b64_tr_b16 v[90:91], v8 offset:20480
  v_mfma_f32_16x16x32_bf16 v[172:175], v[72:75], a[204:207], v[172:175]
  v_rcp_f32 v42, v42
  v_mfma_f32_16x16x32_bf16 v[176:179], v[76:79], a[192:195], v[176:179]
  ds_read_b64_tr_b16 v[92:93], v8 offset:17408
  ds_read_b64_tr_b16 v[94:95], v8 offset:21504
  v_mfma_f32_16x16x32_bf16 v[180:183], v[76:79], a[196:199], v[180:183]
  v_rcp_f32 v43, v43
  v_mfma_f32_16x16x32_bf16 v[184:187], v[76:79], a[200:203], v[184:187]
  v_mul_f32 v116, v116, v40
  v_mul_f32 v117, v117, v41
  v_mfma_f32_16x16x32_bf16 v[188:191], v[76:79], a[204:207], v[188:191]
  s_waitcnt lgkmcnt(4)
  v_mul_f32 v118, v118, v42
  v_mul_f32 v119, v119, v43
  v_mfma_f32_16x16x32_bf16 v[160:163], v[80:83], a[208:211], v[160:163]
  ds_read_b64_tr_b16 v[72:73], v8 offset:24576
  v_cvt_pk_bf16_f32 v60, v116, v117
  v_mfma_f32_16x16x32_bf16 v[164:167], v[80:83], a[212:215], v[164:167]
  ds_read_b64_tr_b16 v[74:75], v8 offset:28672
  v_cvt_pk_bf16_f32 v61, v118, v119
  v_mfma_f32_16x16x32_bf16 v[168:171], v[80:83], a[216:219], v[168:171]
  ds_read_b64_tr_b16 v[76:77], v8 offset:25600
  v_mul_f32 v40, s46, v104
  v_mfma_f32_16x16x32_bf16 v[172:175], v[80:83], a[220:223], v[172:175]
  ds_read_b64_tr_b16 v[78:79], v8 offset:29696
  v_mul_f32 v41, s46, v105
  v_mfma_f32_16x16x32_bf16 v[176:179], v[84:87], a[208:211], v[176:179]
  v_mul_f32 v42, s46, v106
  v_mul_f32 v43, s46, v107
  v_mfma_f32_16x16x32_bf16 v[180:183], v[84:87], a[212:215], v[180:183]
  v_exp_f32 v40, v40
  v_mfma_f32_16x16x32_bf16 v[184:187], v[84:87], a[216:219], v[184:187]
  v_exp_f32 v41, v41
  v_mfma_f32_16x16x32_bf16 v[188:191], v[84:87], a[220:223], v[188:191]
  s_waitcnt lgkmcnt(4)
  v_exp_f32 v42, v42
  v_mfma_f32_16x16x32_bf16 v[160:163], v[88:91], a[224:227], v[160:163]
  v_exp_f32 v43, v43
  v_mfma_f32_16x16x32_bf16 v[164:167], v[88:91], a[228:231], v[164:167]
  ds_read_b64_tr_b16 v[80:81], v8 offset:32768
  v_mul_f32 v120, v104, v120
  v_mfma_f32_16x16x32_bf16 v[168:171], v[88:91], a[232:235], v[168:171]
  ds_read_b64_tr_b16 v[82:83], v8 offset:36864
  v_mul_f32 v121, v105, v121
  v_mfma_f32_16x16x32_bf16 v[172:175], v[88:91], a[236:239], v[172:175]
  ds_read_b64_tr_b16 v[84:85], v8 offset:33792
  v_mul_f32 v122, v106, v122
  v_mfma_f32_16x16x32_bf16 v[176:179], v[92:95], a[224:227], v[176:179]
  ds_read_b64_tr_b16 v[86:87], v8 offset:37888
  v_mul_f32 v123, v107, v123
  v_mfma_f32_16x16x32_bf16 v[180:183], v[92:95], a[228:231], v[180:183]
  v_add_f32 v40, 1.0, v40
  v_add_f32 v41, 1.0, v41
  v_mfma_f32_16x16x32_bf16 v[184:187], v[92:95], a[232:235], v[184:187]
  v_add_f32 v42, 1.0, v42
  v_add_f32 v43, 1.0, v43
  v_mfma_f32_16x16x32_bf16 v[188:191], v[92:95], a[236:239], v[188:191]
  s_waitcnt lgkmcnt(4)
  v_rcp_f32 v40, v40
  v_mfma_f32_16x16x32_bf16 v[160:163], v[72:75], a[240:243], v[160:163]
  v_rcp_f32 v41, v41
  v_mfma_f32_16x16x32_bf16 v[164:167], v[72:75], a[244:247], v[164:167]
  v_rcp_f32 v42, v42
  v_mfma_f32_16x16x32_bf16 v[168:171], v[72:75], a[248:251], v[168:171]
  ds_read_b64_tr_b16 v[88:89], v8 offset:40960
  ds_read_b64_tr_b16 v[90:91], v8 offset:45056
  v_mfma_f32_16x16x32_bf16 v[172:175], v[72:75], a[252:255], v[172:175]
  v_rcp_f32 v43, v43
  v_mfma_f32_16x16x32_bf16 v[176:179], v[76:79], a[240:243], v[176:179]
  ds_read_b64_tr_b16 v[92:93], v8 offset:41984
  v_mul_f32 v120, v120, v40
  v_mfma_f32_16x16x32_bf16 v[180:183], v[76:79], a[244:247], v[180:183]
  ds_read_b64_tr_b16 v[94:95], v8 offset:46080
  v_mul_f32 v121, v121, v41
  v_mfma_f32_16x16x32_bf16 v[184:187], v[76:79], a[248:251], v[184:187]
  v_mul_f32 v122, v122, v42
  v_mul_f32 v123, v123, v43
  v_mfma_f32_16x16x32_bf16 v[188:191], v[76:79], a[252:255], v[188:191]
  s_waitcnt lgkmcnt(4)
  v_cvt_pk_bf16_f32 v64, v120, v121
  v_cvt_pk_bf16_f32 v65, v122, v123
  v_mfma_f32_16x16x32_bf16 v[160:163], v[80:83], v[224:227], v[160:163]
  v_subrev_u32 v9, 98304, v9
  v_mul_f32 v40, s46, v108
  v_mfma_f32_16x16x32_bf16 v[164:167], v[80:83], v[228:231], v[164:167]
  ds_read_b64_tr_b16 v[72:73], v9 offset:0
  v_mul_f32 v41, s46, v109
  v_mfma_f32_16x16x32_bf16 v[168:171], v[80:83], v[232:235], v[168:171]
  ds_read_b64_tr_b16 v[74:75], v9 offset:4096
  v_mul_f32 v42, s46, v110
  v_mfma_f32_16x16x32_bf16 v[172:175], v[80:83], v[236:239], v[172:175]
  ds_read_b64_tr_b16 v[76:77], v9 offset:1024
  v_mul_f32 v43, s46, v111
  v_mfma_f32_16x16x32_bf16 v[176:179], v[84:87], v[224:227], v[176:179]
  v_exp_f32 v40, v40
  v_mfma_f32_16x16x32_bf16 v[180:183], v[84:87], v[228:231], v[180:183]
  ds_read_b64_tr_b16 v[78:79], v9 offset:5120
  v_mfma_f32_16x16x32_bf16 v[184:187], v[84:87], v[232:235], v[184:187]
  v_exp_f32 v41, v41
  v_mfma_f32_16x16x32_bf16 v[188:191], v[84:87], v[236:239], v[188:191]
  s_waitcnt lgkmcnt(4)
  v_exp_f32 v42, v42
  v_mfma_f32_16x16x32_bf16 v[160:163], v[88:91], v[240:243], v[160:163]
  v_exp_f32 v43, v43
  v_mfma_f32_16x16x32_bf16 v[164:167], v[88:91], v[244:247], v[164:167]
  ds_read_b64_tr_b16 v[80:81], v9 offset:8192
  v_mul_f32 v124, v108, v124
  v_mfma_f32_16x16x32_bf16 v[168:171], v[88:91], v[248:251], v[168:171]
  ds_read_b64_tr_b16 v[82:83], v9 offset:12288
  v_mul_f32 v125, v109, v125
  v_mfma_f32_16x16x32_bf16 v[172:175], v[88:91], v[252:255], v[172:175]
  ds_read_b64_tr_b16 v[84:85], v9 offset:9216
  v_mul_f32 v126, v110, v126
  v_mfma_f32_16x16x32_bf16 v[176:179], v[92:95], v[240:243], v[176:179]
  ds_read_b64_tr_b16 v[86:87], v9 offset:13312
  v_mul_f32 v127, v111, v127
  v_mfma_f32_16x16x32_bf16 v[180:183], v[92:95], v[244:247], v[180:183]
  v_add_f32 v40, 1.0, v40
  v_add_f32 v41, 1.0, v41
  v_mfma_f32_16x16x32_bf16 v[184:187], v[92:95], v[248:251], v[184:187]
  v_add_f32 v42, 1.0, v42
  v_add_f32 v43, 1.0, v43
  v_mfma_f32_16x16x32_bf16 v[188:191], v[92:95], v[252:255], v[188:191]
  s_waitcnt lgkmcnt(4)
  v_rcp_f32 v40, v40
  v_mfma_f32_16x16x32_bf16 v[192:195], v[72:75], a[192:195], v[192:195]
  v_rcp_f32 v41, v41
  v_mfma_f32_16x16x32_bf16 v[196:199], v[72:75], a[196:199], v[196:199]
  v_rcp_f32 v42, v42
  v_mfma_f32_16x16x32_bf16 v[200:203], v[72:75], a[200:203], v[200:203]
  ds_read_b64_tr_b16 v[88:89], v9 offset:16384
  ds_read_b64_tr_b16 v[90:91], v9 offset:20480
  v_mfma_f32_16x16x32_bf16 v[204:207], v[72:75], a[204:207], v[204:207]
  v_rcp_f32 v43, v43
  v_mfma_f32_16x16x32_bf16 v[208:211], v[76:79], a[192:195], v[208:211]
  ds_read_b64_tr_b16 v[92:93], v9 offset:17408
  v_mul_f32 v124, v124, v40
  v_mfma_f32_16x16x32_bf16 v[212:215], v[76:79], a[196:199], v[212:215]
  ds_read_b64_tr_b16 v[94:95], v9 offset:21504
  v_mul_f32 v125, v125, v41
  v_mfma_f32_16x16x32_bf16 v[216:219], v[76:79], a[200:203], v[216:219]
  v_mul_f32 v126, v126, v42
  v_mul_f32 v127, v127, v43
  v_mfma_f32_16x16x32_bf16 v[220:223], v[76:79], a[204:207], v[220:223]
  s_waitcnt lgkmcnt(4)
  v_cvt_pk_bf16_f32 v68, v124, v125
  v_cvt_pk_bf16_f32 v69, v126, v127
  v_mfma_f32_16x16x32_bf16 v[192:195], v[80:83], a[208:211], v[192:195]
  ds_read_b64_tr_b16 v[72:73], v9 offset:24576
  v_mul_f32 v40, s46, v128
  v_mfma_f32_16x16x32_bf16 v[196:199], v[80:83], a[212:215], v[196:199]
  ds_read_b64_tr_b16 v[74:75], v9 offset:28672
  v_mul_f32 v41, s46, v129
  v_mfma_f32_16x16x32_bf16 v[200:203], v[80:83], a[216:219], v[200:203]
  ds_read_b64_tr_b16 v[76:77], v9 offset:25600
  v_mul_f32 v42, s46, v130
  v_mfma_f32_16x16x32_bf16 v[204:207], v[80:83], a[220:223], v[204:207]
  ds_read_b64_tr_b16 v[78:79], v9 offset:29696
  v_mul_f32 v43, s46, v131
  v_mfma_f32_16x16x32_bf16 v[208:211], v[84:87], a[208:211], v[208:211]
  v_exp_f32 v40, v40
  v_mfma_f32_16x16x32_bf16 v[212:215], v[84:87], a[212:215], v[212:215]
  v_exp_f32 v41, v41
  v_mfma_f32_16x16x32_bf16 v[216:219], v[84:87], a[216:219], v[216:219]
  v_exp_f32 v42, v42
  v_mfma_f32_16x16x32_bf16 v[220:223], v[84:87], a[220:223], v[220:223]
  s_waitcnt lgkmcnt(4)
  v_exp_f32 v43, v43
  v_mfma_f32_16x16x32_bf16 v[192:195], v[88:91], a[224:227], v[192:195]
  ds_read_b64_tr_b16 v[80:81], v9 offset:32768
  v_mul_f32 v144, v128, v144
  v_mfma_f32_16x16x32_bf16 v[196:199], v[88:91], a[228:231], v[196:199]
  ds_read_b64_tr_b16 v[82:83], v9 offset:36864
  v_mul_f32 v145, v129, v145
  v_mfma_f32_16x16x32_bf16 v[200:203], v[88:91], a[232:235], v[200:203]
  ds_read_b64_tr_b16 v[84:85], v9 offset:33792
  v_mul_f32 v146, v130, v146
  v_mfma_f32_16x16x32_bf16 v[204:207], v[88:91], a[236:239], v[204:207]
  ds_read_b64_tr_b16 v[86:87], v9 offset:37888
  v_mul_f32 v147, v131, v147
  v_mfma_f32_16x16x32_bf16 v[208:211], v[92:95], a[224:227], v[208:211]
  v_add_f32 v40, 1.0, v40
  v_add_f32 v41, 1.0, v41
  v_mfma_f32_16x16x32_bf16 v[212:215], v[92:95], a[228:231], v[212:215]
  v_add_f32 v42, 1.0, v42
  v_add_f32 v43, 1.0, v43
  v_mfma_f32_16x16x32_bf16 v[216:219], v[92:95], a[232:235], v[216:219]
  v_rcp_f32 v40, v40
  v_mfma_f32_16x16x32_bf16 v[220:223], v[92:95], a[236:239], v[220:223]
  s_waitcnt lgkmcnt(4)
  v_rcp_f32 v41, v41
  v_mfma_f32_16x16x32_bf16 v[192:195], v[72:75], a[240:243], v[192:195]
  v_rcp_f32 v42, v42
  v_mfma_f32_16x16x32_bf16 v[196:199], v[72:75], a[244:247], v[196:199]
  v_rcp_f32 v43, v43
  v_mfma_f32_16x16x32_bf16 v[200:203], v[72:75], a[248:251], v[200:203]
  ds_read_b64_tr_b16 v[88:89], v9 offset:40960
  v_mul_f32 v144, v144, v40
  v_mfma_f32_16x16x32_bf16 v[204:207], v[72:75], a[252:255], v[204:207]
  ds_read_b64_tr_b16 v[90:91], v9 offset:45056
  v_mul_f32 v145, v145, v41
  v_mfma_f32_16x16x32_bf16 v[208:211], v[76:79], a[240:243], v[208:211]
  ds_read_b64_tr_b16 v[92:93], v9 offset:41984
  v_mul_f32 v146, v146, v42
  v_mfma_f32_16x16x32_bf16 v[212:215], v[76:79], a[244:247], v[212:215]
  ds_read_b64_tr_b16 v[94:95], v9 offset:46080
  v_mul_f32 v147, v147, v43
  v_mfma_f32_16x16x32_bf16 v[216:219], v[76:79], a[248:251], v[216:219]
  v_cvt_pk_bf16_f32 v58, v144, v145
  v_cvt_pk_bf16_f32 v59, v146, v147
  v_mfma_f32_16x16x32_bf16 v[220:223], v[76:79], a[252:255], v[220:223]
  buffer_store_dwordx4 v[56:59], v14, s[16:19], s50 offen offset:2048 sc1
  s_waitcnt vmcnt(1)
  s_barrier
  s_cmp_lg_u32 s40, 0
  s_cbranch_scc1 gated_mix__spectral_fnet__swiglu_ffn__prompt_kernel_l1_a
  v_mov_b32 v52, 1
  v_mov_b32 v53, 0
  s_mov_b64 exec, 1
  buffer_store_dword v52, v53, s[16:19], s38 offen offset:0 sc1
  s_mov_b64 exec, -1
gated_mix__spectral_fnet__swiglu_ffn__prompt_kernel_l1_a:
  s_waitcnt lgkmcnt(4)
  v_mfma_f32_16x16x32_bf16 v[192:195], v[80:83], v[224:227], v[192:195]
  ds_read_b128 v[72:75], v4 offset:0
  v_mul_f32 v40, s46, v132
  v_mfma_f32_16x16x32_bf16 v[196:199], v[80:83], v[228:231], v[196:199]
  ds_read_b128 v[76:79], v4 offset:18432
  v_mul_f32 v41, s46, v133
  v_mfma_f32_16x16x32_bf16 v[200:203], v[80:83], v[232:235], v[200:203]
  v_mul_f32 v42, s46, v134
  v_mul_f32 v43, s46, v135
  v_mfma_f32_16x16x32_bf16 v[204:207], v[80:83], v[236:239], v[204:207]
  v_exp_f32 v40, v40
  v_mfma_f32_16x16x32_bf16 v[208:211], v[84:87], v[224:227], v[208:211]
  v_exp_f32 v41, v41
  v_mfma_f32_16x16x32_bf16 v[212:215], v[84:87], v[228:231], v[212:215]
  v_exp_f32 v42, v42
  v_mfma_f32_16x16x32_bf16 v[216:219], v[84:87], v[232:235], v[216:219]
  v_exp_f32 v43, v43
  v_mfma_f32_16x16x32_bf16 v[220:223], v[84:87], v[236:239], v[220:223]
  s_waitcnt lgkmcnt(2)
  v_mul_f32 v148, v132, v148
  v_mul_f32 v149, v133, v149
  v_mfma_f32_16x16x32_bf16 v[192:195], v[88:91], v[240:243], v[192:195]
  ds_read_b128 v[80:83], v5 offset:0
  v_mul_f32 v150, v134, v150
  v_mfma_f32_16x16x32_bf16 v[196:199], v[88:91], v[244:247], v[196:199]
  ds_read_b128 v[84:87], v5 offset:18432
  v_mul_f32 v151, v135, v151
  v_mfma_f32_16x16x32_bf16 v[200:203], v[88:91], v[248:251], v[200:203]
  v_add_f32 v40, 1.0, v40
  v_add_f32 v41, 1.0, v41
  v_mfma_f32_16x16x32_bf16 v[204:207], v[88:91], v[252:255], v[204:207]
  v_add_f32 v42, 1.0, v42
  v_add_f32 v43, 1.0, v43
  v_mfma_f32_16x16x32_bf16 v[208:211], v[92:95], v[240:243], v[208:211]
  v_rcp_f32 v40, v40
  v_mfma_f32_16x16x32_bf16 v[212:215], v[92:95], v[244:247], v[212:215]
  v_rcp_f32 v41, v41
  v_mfma_f32_16x16x32_bf16 v[216:219], v[92:95], v[248:251], v[216:219]
  v_rcp_f32 v42, v42
  v_mfma_f32_16x16x32_bf16 v[220:223], v[92:95], v[252:255], v[220:223]
  s_waitcnt lgkmcnt(2)
  v_rcp_f32 v43, v43
  v_mfma_f32_16x16x32_bf16 v[96:99], a[0:3], v[72:75], 0
  ds_read_b128 v[88:91], v4 offset:2048
  v_mul_f32 v148, v148, v40
  v_mfma_f32_16x16x32_bf16 v[100:103], a[4:7], v[72:75], 0
  ds_read_b128 v[92:95], v4 offset:20480
  v_mul_f32 v149, v149, v41
  v_mfma_f32_16x16x32_bf16 v[104:107], a[8:11], v[72:75], 0
  v_mul_f32 v150, v150, v42
  v_mul_f32 v151, v151, v43
  v_mfma_f32_16x16x32_bf16 v[108:111], a[12:15], v[72:75], 0
  v_cvt_pk_bf16_f32 v62, v148, v149
  v_cvt_pk_bf16_f32 v63, v150, v151
  v_mfma_f32_16x16x32_bf16 v[112:115], a[0:3], v[76:79], 0
  buffer_store_dwordx4 v[60:63], v14, s[16:19], s51 offen offset:2048 sc1
  v_mfma_f32_16x16x32_bf16 v[116:119], a[4:7], v[76:79], 0
  v_mul_f32 v40, s46, v136
  v_mul_f32 v41, s46, v137
  v_mfma_f32_16x16x32_bf16 v[120:123], a[8:11], v[76:79], 0
  v_mul_f32 v42, s46, v138
  v_mul_f32 v43, s46, v139
  v_mfma_f32_16x16x32_bf16 v[124:127], a[12:15], v[76:79], 0
  s_waitcnt lgkmcnt(2)
  v_exp_f32 v40, v40
  v_mfma_f32_16x16x32_bf16 v[96:99], a[16:19], v[80:83], v[96:99]
  v_exp_f32 v41, v41
  v_mfma_f32_16x16x32_bf16 v[100:103], a[20:23], v[80:83], v[100:103]
  v_exp_f32 v42, v42
  v_mfma_f32_16x16x32_bf16 v[104:107], a[24:27], v[80:83], v[104:107]
  v_exp_f32 v43, v43
  v_mfma_f32_16x16x32_bf16 v[108:111], a[28:31], v[80:83], v[108:111]
  ds_read_b128 v[72:75], v5 offset:2048
  v_mul_f32 v152, v136, v152
  v_mfma_f32_16x16x32_bf16 v[112:115], a[16:19], v[84:87], v[112:115]
  ds_read_b128 v[76:79], v5 offset:20480
  v_mul_f32 v153, v137, v153
  v_mfma_f32_16x16x32_bf16 v[116:119], a[20:23], v[84:87], v[116:119]
  v_mul_f32 v154, v138, v154
  v_mul_f32 v155, v139, v155
  v_mfma_f32_16x16x32_bf16 v[120:123], a[24:27], v[84:87], v[120:123]
  v_add_f32 v40, 1.0, v40
  v_add_f32 v41, 1.0, v41
  v_mfma_f32_16x16x32_bf16 v[124:127], a[28:31], v[84:87], v[124:127]
  s_waitcnt lgkmcnt(2)
  v_add_f32 v42, 1.0, v42
  v_add_f32 v43, 1.0, v43
  s_getpc_b64 s[100:101]
.Lpf2:
  s_add_u32 s100, s100, gated_mix__spectral_fnet__swiglu_ffn__prompt_kernel_p2-.Lpf2
  s_addc_u32 s101, s101, 0
  v_min_u32 v37, gated_mix__spectral_fnet__swiglu_ffn__prompt_kernel_end-gated_mix__spectral_fnet__swiglu_ffn__prompt_kernel_p2-4, v39
  global_load_dword v38, v37, s[100:101]
  v_add_u32 v37, 32768, v39
  v_min_u32 v37, gated_mix__spectral_fnet__swiglu_ffn__prompt_kernel_end-gated_mix__spectral_fnet__swiglu_ffn__prompt_kernel_p2-4, v37
  global_load_dword v36, v37, s[100:101]
  v_mfma_f32_16x16x32_bf16 v[96:99], a[32:35], v[88:91], v[96:99]
  v_rcp_f32 v40, v40
  v_mfma_f32_16x16x32_bf16 v[100:103], a[36:39], v[88:91], v[100:103]
  v_rcp_f32 v41, v41
  v_mfma_f32_16x16x32_bf16 v[104:107], a[40:43], v[88:91], v[104:107]
  v_rcp_f32 v42, v42
  v_mfma_f32_16x16x32_bf16 v[108:111], a[44:47], v[88:91], v[108:111]
  v_rcp_f32 v43, v43
  v_mfma_f32_16x16x32_bf16 v[112:115], a[32:35], v[92:95], v[112:115]
  ds_read_b128 v[80:83], v4 offset:4096
  v_mul_f32 v152, v152, v40
  v_mfma_f32_16x16x32_bf16 v[116:119], a[36:39], v[92:95], v[116:119]
  ds_read_b128 v[84:87], v4 offset:22528
  v_mul_f32 v153, v153, v41
  v_mfma_f32_16x16x32_bf16 v[120:123], a[40:43], v[92:95], v[120:123]
  v_mul_f32 v154, v154, v42
  v_mul_f32 v155, v155, v43
  v_mfma_f32_16x16x32_bf16 v[124:127], a[44:47], v[92:95], v[124:127]
  s_waitcnt lgkmcnt(2)
  v_cvt_pk_bf16_f32 v66, v152, v153
  v_cvt_pk_bf16_f32 v67, v154, v155
  v_mfma_f32_16x16x32_bf16 v[96:99], a[48:51], v[72:75], v[96:99]
  buffer_store_dwordx4 v[64:67], v14, s[16:19], s52 offen offset:2048 sc1
  v_mfma_f32_16x16x32_bf16 v[100:103], a[52:55], v[72:75], v[100:103]
  ds_read_b128 v[88:91], v5 offset:4096
  v_mul_f32 v40, s46, v140
  v_mfma_f32_16x16x32_bf16 v[104:107], a[56:59], v[72:75], v[104:107]
  ds_read_b128 v[92:95], v5 offset:22528
  v_mul_f32 v41, s46, v141
  v_mfma_f32_16x16x32_bf16 v[108:111], a[60:63], v[72:75], v[108:111]
  v_mul_f32 v42, s46, v142
  v_mul_f32 v43, s46, v143
  v_mfma_f32_16x16x32_bf16 v[112:115], a[48:51], v[76:79], v[112:115]
  v_exp_f32 v40, v40
  v_mfma_f32_16x16x32_bf16 v[116:119], a[52:55], v[76:79], v[116:119]
  v_exp_f32 v41, v41
  v_mfma_f32_16x16x32_bf16 v[120:123], a[56:59], v[76:79], v[120:123]
  v_exp_f32 v42, v42
  v_mfma_f32_16x16x32_bf16 v[124:127], a[60:63], v[76:79], v[124:127]
  s_waitcnt lgkmcnt(2)
  v_exp_f32 v43, v43
  v_mfma_f32_16x16x32_bf16 v[96:99], a[64:67], v[80:83], v[96:99]
  ds_read_b128 v[72:75], v4 offset:6144
  v_mul_f32 v156, v140, v156
  v_mfma_f32_16x16x32_bf16 v[100:103], a[68:71], v[80:83], v[100:103]
  ds_read_b128 v[76:79], v4 offset:24576
  v_mul_f32 v157, v141, v157
  v_mfma_f32_16x16x32_bf16 v[104:107], a[72:75], v[80:83], v[104:107]
  v_mul_f32 v158, v142, v158
  v_mul_f32 v159, v143, v159
  v_mfma_f32_16x16x32_bf16 v[108:111], a[76:79], v[80:83], v[108:111]
  v_add_f32 v40, 1.0, v40
  v_add_f32 v41, 1.0, v41
  v_mfma_f32_16x16x32_bf16 v[112:115], a[64:67], v[84:87], v[112:115]
  v_add_f32 v42, 1.0, v42
  v_add_f32 v43, 1.0, v43
  v_mfma_f32_16x16x32_bf16 v[116:119], a[68:71], v[84:87], v[116:119]
  v_rcp_f32 v40, v40
  v_mfma_f32_16x16x32_bf16 v[120:123], a[72:75], v[84:87], v[120:123]
  v_rcp_f32 v41, v41
  v_mfma_f32_16x16x32_bf16 v[124:127], a[76:79], v[84:87], v[124:127]
  s_waitcnt lgkmcnt(2)
  v_rcp_f32 v42, v42
  v_mfma_f32_16x16x32_bf16 v[96:99], a[80:83], v[88:91], v[96:99]
  v_rcp_f32 v43, v43
  v_mfma_f32_16x16x32_bf16 v[100:103], a[84:87], v[88:91], v[100:103]
  ds_read_b128 v[80:83], v5 offset:6144
  v_mul_f32 v156, v156, v40
  v_mfma_f32_16x16x32_bf16 v[104:107], a[88:91], v[88:91], v[104:107]
  ds_read_b128 v[84:87], v5 offset:24576
  v_mul_f32 v157, v157, v41
  v_mfma_f32_16x16x32_bf16 v[108:111], a[92:95], v[88:91], v[108:111]
  v_mul_f32 v158, v158, v42
  v_mul_f32 v159, v159, v43
  v_mfma_f32_16x16x32_bf16 v[112:115], a[80:83], v[92:95], v[112:115]
  v_cvt_pk_bf16_f32 v70, v156, v157
  v_cvt_pk_bf16_f32 v71, v158, v159
  v_mfma_f32_16x16x32_bf16 v[116:119], a[84:87], v[92:95], v[116:119]
  buffer_store_dwordx4 v[68:71], v14, s[16:19], s53 offen offset:2048 sc1
  v_mfma_f32_16x16x32_bf16 v[120:123], a[88:91], v[92:95], v[120:123]
  v_mul_f32 v40, s46, v160
  v_mul_f32 v41, s46, v161
  v_mfma_f32_16x16x32_bf16 v[124:127], a[92:95], v[92:95], v[124:127]
  s_waitcnt lgkmcnt(2)
  v_mul_f32 v42, s46, v162
  v_mul_f32 v43, s46, v163
  v_mfma_f32_16x16x32_bf16 v[96:99], a[96:99], v[72:75], v[96:99]
  v_exp_f32 v40, v40
  v_mfma_f32_16x16x32_bf16 v[100:103], a[100:103], v[72:75], v[100:103]
  v_exp_f32 v41, v41
  v_mfma_f32_16x16x32_bf16 v[104:107], a[104:107], v[72:75], v[104:107]
  v_exp_f32 v42, v42
  v_mfma_f32_16x16x32_bf16 v[108:111], a[108:111], v[72:75], v[108:111]
  v_exp_f32 v43, v43
  v_mfma_f32_16x16x32_bf16 v[112:115], a[96:99], v[76:79], v[112:115]
  ds_read_b128 v[88:91], v4 offset:8192
  v_mul_f32 v176, v160, v176
  v_mfma_f32_16x16x32_bf16 v[116:119], a[100:103], v[76:79], v[116:119]
  ds_read_b128 v[92:95], v4 offset:26624
  v_mul_f32 v177, v161, v177
  v_mfma_f32_16x16x32_bf16 v[120:123], a[104:107], v[76:79], v[120:123]
  v_mul_f32 v178, v162, v178
  v_mul_f32 v179, v163, v179
  v_mfma_f32_16x16x32_bf16 v[124:127], a[108:111], v[76:79], v[124:127]
  s_waitcnt lgkmcnt(2)
  v_add_f32 v40, 1.0, v40
  v_add_f32 v41, 1.0, v41
  v_mfma_f32_16x16x32_bf16 v[96:99], a[112:115], v[80:83], v[96:99]
  ds_read_b128 v[72:75], v5 offset:8192
  v_add_f32 v42, 1.0, v42
  v_mfma_f32_16x16x32_bf16 v[100:103], a[116:119], v[80:83], v[100:103]
  ds_read_b128 v[76:79], v5 offset:26624
  v_add_f32 v43, 1.0, v43
  v_mfma_f32_16x16x32_bf16 v[104:107], a[120:123], v[80:83], v[104:107]
  v_rcp_f32 v40, v40
  v_mfma_f32_16x16x32_bf16 v[108:111], a[124:127], v[80:83], v[108:111]
  v_rcp_f32 v41, v41
  v_mfma_f32_16x16x32_bf16 v[112:115], a[112:115], v[84:87], v[112:115]
  v_rcp_f32 v42, v42
  v_mfma_f32_16x16x32_bf16 v[116:119], a[116:119], v[84:87], v[116:119]
  v_rcp_f32 v43, v43
  v_mfma_f32_16x16x32_bf16 v[120:123], a[120:123], v[84:87], v[120:123]
  v_mul_f32 v176, v176, v40
  v_mul_f32 v177, v177, v41
  v_mfma_f32_16x16x32_bf16 v[124:127], a[124:127], v[84:87], v[124:127]
  s_waitcnt lgkmcnt(2)
  v_mul_f32 v178, v178, v42
  v_mul_f32 v179, v179, v43
  v_mfma_f32_16x16x32_bf16 v[96:99], a[128:131], v[88:91], v[96:99]
  ds_read_b128 v[80:83], v4 offset:10240
  v_cvt_pk_bf16_f32 v56, v176, v177
  v_mfma_f32_16x16x32_bf16 v[100:103], a[132:135], v[88:91], v[100:103]
  ds_read_b128 v[84:87], v4 offset:28672
  v_cvt_pk_bf16_f32 v57, v178, v179
  v_mfma_f32_16x16x32_bf16 v[104:107], a[136:139], v[88:91], v[104:107]
  v_mul_f32 v40, s46, v164
  v_mul_f32 v41, s46, v165
  v_mfma_f32_16x16x32_bf16 v[108:111], a[140:143], v[88:91], v[108:111]
  v_mul_f32 v42, s46, v166
  v_mul_f32 v43, s46, v167
  v_mfma_f32_16x16x32_bf16 v[112:115], a[128:131], v[92:95], v[112:115]
  v_exp_f32 v40, v40
  v_mfma_f32_16x16x32_bf16 v[116:119], a[132:135], v[92:95], v[116:119]
  v_exp_f32 v41, v41
  v_mfma_f32_16x16x32_bf16 v[120:123], a[136:139], v[92:95], v[120:123]
  v_exp_f32 v42, v42
  v_mfma_f32_16x16x32_bf16 v[124:127], a[140:143], v[92:95], v[124:127]
  s_waitcnt lgkmcnt(2)
  v_exp_f32 v43, v43
  v_mfma_f32_16x16x32_bf16 v[96:99], a[144:147], v[72:75], v[96:99]
  ds_read_b128 v[88:91], v5 offset:10240
  v_mul_f32 v180, v164, v180
  v_mfma_f32_16x16x32_bf16 v[100:103], a[148:151], v[72:75], v[100:103]
  ds_read_b128 v[92:95], v5 offset:28672
  v_mul_f32 v181, v165, v181
  v_mfma_f32_16x16x32_bf16 v[104:107], a[152:155], v[72:75], v[104:107]
  v_mul_f32 v182, v166, v182
  v_mul_f32 v183, v167, v183
  v_mfma_f32_16x16x32_bf16 v[108:111], a[156:159], v[72:75], v[108:111]
  v_add_f32 v40, 1.0, v40
  v_add_f32 v41, 1.0, v41
  v_mfma_f32_16x16x32_bf16 v[112:115], a[144:147], v[76:79], v[112:115]
  v_add_f32 v42, 1.0, v42
  v_add_f32 v43, 1.0, v43
  v_mfma_f32_16x16x32_bf16 v[116:119], a[148:151], v[76:79], v[116:119]
  v_rcp_f32 v40, v40
  v_mfma_f32_16x16x32_bf16 v[120:123], a[152:155], v[76:79], v[120:123]
  v_rcp_f32 v41, v41
  v_mfma_f32_16x16x32_bf16 v[124:127], a[156:159], v[76:79], v[124:127]
  s_waitcnt lgkmcnt(2)
  v_rcp_f32 v42, v42
  v_mfma_f32_16x16x32_bf16 v[96:99], a[160:163], v[80:83], v[96:99]
  v_rcp_f32 v43, v43
  v_mfma_f32_16x16x32_bf16 v[100:103], a[164:167], v[80:83], v[100:103]
  ds_read_b128 v[72:75], v4 offset:12288
  v_mul_f32 v180, v180, v40
  v_mfma_f32_16x16x32_bf16 v[104:107], a[168:171], v[80:83], v[104:107]
  ds_read_b128 v[76:79], v4 offset:30720
  v_mul_f32 v181, v181, v41
  v_mfma_f32_16x16x32_bf16 v[108:111], a[172:175], v[80:83], v[108:111]
  v_mul_f32 v182, v182, v42
  v_mul_f32 v183, v183, v43
  v_mfma_f32_16x16x32_bf16 v[112:115], a[160:163], v[84:87], v[112:115]
  v_cvt_pk_bf16_f32 v60, v180, v181
  v_cvt_pk_bf16_f32 v61, v182, v183
  v_mfma_f32_16x16x32_bf16 v[116:119], a[164:167], v[84:87], v[116:119]
  v_mul_f32 v40, s46, v168
  v_mul_f32 v41, s46, v169
  v_mfma_f32_16x16x32_bf16 v[120:123], a[168:171], v[84:87], v[120:123]
  v_mul_f32 v42, s46, v170
  v_mul_f32 v43, s46, v171
  v_mfma_f32_16x16x32_bf16 v[124:127], a[172:175], v[84:87], v[124:127]
  s_waitcnt lgkmcnt(2)
  v_exp_f32 v40, v40
  v_mfma_f32_16x16x32_bf16 v[96:99], a[176:179], v[88:91], v[96:99]
  v_exp_f32 v41, v41
  v_mfma_f32_16x16x32_bf16 v[100:103], a[180:183], v[88:91], v[100:103]
  v_exp_f32 v42, v42
  v_mfma_f32_16x16x32_bf16 v[104:107], a[184:187], v[88:91], v[104:107]
  v_exp_f32 v43, v43
  v_mfma_f32_16x16x32_bf16 v[108:111], a[188:191], v[88:91], v[108:111]
  ds_read_b128 v[80:83], v5 offset:12288
  v_mul_f32 v184, v168, v184
  v_mfma_f32_16x16x32_bf16 v[112:115], a[176:179], v[92:95], v[112:115]
  ds_read_b128 v[84:87], v5 offset:30720
  v_mul_f32 v185, v169, v185
  v_mfma_f32_16x16x32_bf16 v[116:119], a[180:183], v[92:95], v[116:119]
  v_mul_f32 v186, v170, v186
  v_mul_f32 v187, v171, v187
  v_mfma_f32_16x16x32_bf16 v[120:123], a[184:187], v[92:95], v[120:123]
  v_add_f32 v40, 1.0, v40
  v_add_f32 v41, 1.0, v41
  v_mfma_f32_16x16x32_bf16 v[124:127], a[188:191], v[92:95], v[124:127]
  s_waitcnt lgkmcnt(2)
  v_add_f32 v42, 1.0, v42
  v_add_f32 v43, 1.0, v43
  v_mfma_f32_16x16x32_bf16 v[96:99], a[192:195], v[72:75], v[96:99]
  v_rcp_f32 v40, v40
  v_mfma_f32_16x16x32_bf16 v[100:103], a[196:199], v[72:75], v[100:103]
  v_rcp_f32 v41, v41
  v_mfma_f32_16x16x32_bf16 v[104:107], a[200:203], v[72:75], v[104:107]
  v_rcp_f32 v42, v42
  v_mfma_f32_16x16x32_bf16 v[108:111], a[204:207], v[72:75], v[108:111]
  v_rcp_f32 v43, v43
  v_mfma_f32_16x16x32_bf16 v[112:115], a[192:195], v[76:79], v[112:115]
  ds_read_b128 v[88:91], v4 offset:14336
  v_mul_f32 v184, v184, v40
  v_mfma_f32_16x16x32_bf16 v[116:119], a[196:199], v[76:79], v[116:119]
  ds_read_b128 v[92:95], v4 offset:32768
  v_mul_f32 v185, v185, v41
  v_mfma_f32_16x16x32_bf16 v[120:123], a[200:203], v[76:79], v[120:123]
  v_mul_f32 v186, v186, v42
  v_mul_f32 v187, v187, v43
  v_mfma_f32_16x16x32_bf16 v[124:127], a[204:207], v[76:79], v[124:127]
  s_waitcnt lgkmcnt(2)
  v_cvt_pk_bf16_f32 v64, v184, v185
  v_cvt_pk_bf16_f32 v65, v186, v187
  v_mfma_f32_16x16x32_bf16 v[96:99], a[208:211], v[80:83], v[96:99]
  ds_read_b128 v[72:75], v5 offset:14336
  v_mul_f32 v40, s46, v172
  v_mfma_f32_16x16x32_bf16 v[100:103], a[212:215], v[80:83], v[100:103]
  ds_read_b128 v[76:79], v5 offset:32768
  v_mul_f32 v41, s46, v173
  v_mfma_f32_16x16x32_bf16 v[104:107], a[216:219], v[80:83], v[104:107]
  v_mul_f32 v42, s46, v174
  v_mul_f32 v43, s46, v175
  v_mfma_f32_16x16x32_bf16 v[108:111], a[220:223], v[80:83], v[108:111]
  v_exp_f32 v40, v40
  v_mfma_f32_16x16x32_bf16 v[112:115], a[208:211], v[84:87], v[112:115]
  v_exp_f32 v41, v41
  v_mfma_f32_16x16x32_bf16 v[116:119], a[212:215], v[84:87], v[116:119]
  v_exp_f32 v42, v42
  v_mfma_f32_16x16x32_bf16 v[120:123], a[216:219], v[84:87], v[120:123]
  v_exp_f32 v43, v43
  v_mfma_f32_16x16x32_bf16 v[124:127], a[220:223], v[84:87], v[124:127]
  s_waitcnt lgkmcnt(2)
  v_mul_f32 v188, v172, v188
  v_mul_f32 v189, v173, v189
  v_mfma_f32_16x16x32_bf16 v[96:99], a[224:227], v[88:91], v[96:99]
  ds_read_b128 v[80:83], v4 offset:16384
  v_mul_f32 v190, v174, v190
  v_mfma_f32_16x16x32_bf16 v[100:103], a[228:231], v[88:91], v[100:103]
  ds_read_b128 v[84:87], v4 offset:34816
  v_mul_f32 v191, v175, v191
  v_mfma_f32_16x16x32_bf16 v[104:107], a[232:235], v[88:91], v[104:107]
  v_add_f32 v40, 1.0, v40
  v_add_f32 v41, 1.0, v41
  v_mfma_f32_16x16x32_bf16 v[108:111], a[236:239], v[88:91], v[108:111]
  v_add_f32 v42, 1.0, v42
  v_add_f32 v43, 1.0, v43
  v_mfma_f32_16x16x32_bf16 v[112:115], a[224:227], v[92:95], v[112:115]
  v_rcp_f32 v40, v40
  v_mfma_f32_16x16x32_bf16 v[116:119], a[228:231], v[92:95], v[116:119]
  v_rcp_f32 v41, v41
  v_mfma_f32_16x16x32_bf16 v[120:123], a[232:235], v[92:95], v[120:123]
  v_rcp_f32 v42, v42
  v_mfma_f32_16x16x32_bf16 v[124:127], a[236:239], v[92:95], v[124:127]
  s_waitcnt lgkmcnt(2)
  v_rcp_f32 v43, v43
  v_mfma_f32_16x16x32_bf16 v[96:99], a[240:243], v[72:75], v[96:99]
  ds_read_b128 v[88:91], v5 offset:16384
  v_mul_f32 v188, v188, v40
  v_mfma_f32_16x16x32_bf16 v[100:103], a[244:247], v[72:75], v[100:103]
  ds_read_b128 v[92:95], v5 offset:34816
  v_mul_f32 v189, v189, v41
  v_mfma_f32_16x16x32_bf16 v[104:107], a[248:251], v[72:75], v[104:107]
  v_mul_f32 v190, v190, v42
  v_mul_f32 v191, v191, v43
  v_mfma_f32_16x16x32_bf16 v[108:111], a[252:255], v[72:75], v[108:111]
  v_cvt_pk_bf16_f32 v68, v188, v189
  v_cvt_pk_bf16_f32 v69, v190, v191
  v_mfma_f32_16x16x32_bf16 v[112:115], a[240:243], v[76:79], v[112:115]
  v_mul_f32 v40, s46, v192
  v_mul_f32 v41, s46, v193
  v_mfma_f32_16x16x32_bf16 v[116:119], a[244:247], v[76:79], v[116:119]
  v_mul_f32 v42, s46, v194
  v_mul_f32 v43, s46, v195
  v_mfma_f32_16x16x32_bf16 v[120:123], a[248:251], v[76:79], v[120:123]
  v_exp_f32 v40, v40
  v_mfma_f32_16x16x32_bf16 v[124:127], a[252:255], v[76:79], v[124:127]
  v_exp_f32 v41, v41
  s_barrier
  s_waitcnt lgkmcnt(2)
  v_mfma_f32_16x16x32_bf16 v[96:99], v[224:227], v[80:83], v[96:99]
  v_exp_f32 v42, v42
  v_mfma_f32_16x16x32_bf16 v[100:103], v[228:231], v[80:83], v[100:103]
  v_exp_f32 v43, v43
  v_mfma_f32_16x16x32_bf16 v[104:107], v[232:235], v[80:83], v[104:107]
  v_add_u32 v10, 147456, v10
  v_mul_f32 v208, v192, v208
  v_mfma_f32_16x16x32_bf16 v[108:111], v[236:239], v[80:83], v[108:111]
  ds_read_b64_tr_b16 v[72:73], v10 offset:0
  v_mul_f32 v209, v193, v209
  v_mfma_f32_16x16x32_bf16 v[112:115], v[224:227], v[84:87], v[112:115]
  ds_read_b64_tr_b16 v[74:75], v10 offset:512
  v_mul_f32 v210, v194, v210
  v_mfma_f32_16x16x32_bf16 v[116:119], v[228:231], v[84:87], v[116:119]
  ds_read_b64_tr_b16 v[76:77], v10 offset:1024
  v_mul_f32 v211, v195, v211
  v_mfma_f32_16x16x32_bf16 v[120:123], v[232:235], v[84:87], v[120:123]
  ds_read_b64_tr_b16 v[78:79], v10 offset:1536
  v_add_f32 v40, 1.0, v40
  v_mfma_f32_16x16x32_bf16 v[124:127], v[236:239], v[84:87], v[124:127]
  s_waitcnt lgkmcnt(4)
  v_add_f32 v41, 1.0, v41
  v_add_f32 v42, 1.0, v42
  v_mfma_f32_16x16x32_bf16 v[96:99], v[240:243], v[88:91], v[96:99]
  ds_read_b64_tr_b16 v[80:81], v10 offset:2048
  v_add_f32 v43, 1.0, v43
  v_mfma_f32_16x16x32_bf16 v[100:103], v[244:247], v[88:91], v[100:103]
  v_rcp_f32 v40, v40
  v_mfma_f32_16x16x32_bf16 v[104:107], v[248:251], v[88:91], v[104:107]
  v_rcp_f32 v41, v41
  v_mfma_f32_16x16x32_bf16 v[108:111], v[252:255], v[88:91], v[108:111]
  ds_read_b64_tr_b16 v[82:83], v10 offset:2560
  ds_read_b64_tr_b16 v[84:85], v10 offset:3072
  v_mfma_f32_16x16x32_bf16 v[112:115], v[240:243], v[92:95], v[112:115]
  v_rcp_f32 v42, v42
  v_mfma_f32_16x16x32_bf16 v[116:119], v[244:247], v[92:95], v[116:119]
  ds_read_b64_tr_b16 v[86:87], v10 offset:3584
  v_mfma_f32_16x16x32_bf16 v[120:123], v[248:251], v[92:95], v[120:123]
  v_rcp_f32 v43, v43
  v_mfma_f32_16x16x32_bf16 v[124:127], v[252:255], v[92:95], v[124:127]
  s_waitcnt lgkmcnt(4)
  v_mul_f32 v208, v208, v40
  v_mul_f32 v209, v209, v41
  v_mfma_f32_16x16x32_bf16 v[128:131], v[72:75], a[0:3], 0
  ds_read_b64_tr_b16 v[88:89], v10 offset:4096
  v_mul_f32 v210, v210, v42
  v_mfma_f32_16x16x32_bf16 v[132:135], v[72:75], a[4:7], 0
  ds_read_b64_tr_b16 v[90:91], v10 offset:4608
  v_mul_f32 v211, v211, v43
  v_mfma_f32_16x16x32_bf16 v[136:139], v[72:75], a[8:11], 0
  ds_read_b64_tr_b16 v[92:93], v10 offset:5120
  v_mov_b32 v48, v96
  v_mfma_f32_16x16x32_bf16 v[140:143], v[72:75], a[12:15], 0
  ds_read_b64_tr_b16 v[94:95], v10 offset:5632
  v_mov_b32 v49, v104
  v_mfma_f32_16x16x32_bf16 v[144:147], v[76:79], a[0:3], 0
  v_add_f32 v96, v96, v104
  v_sub_f32 v112, v120, v112
  v_mfma_f32_16x16x32_bf16 v[148:151], v[76:79], a[4:7], 0
  v_add_f32 v97, v97, v105
  v_sub_f32 v113, v121, v113
  v_mfma_f32_16x16x32_bf16 v[152:155], v[76:79], a[8:11], 0
  v_add_f32 v98, v98, v106
  v_sub_f32 v114, v122, v114
  v_mfma_f32_16x16x32_bf16 v[156:159], v[76:79], a[12:15], 0
  s_waitcnt lgkmcnt(4)
  v_add_f32 v99, v99, v107
  v_sub_f32 v115, v123, v115
  v_mfma_f32_16x16x32_bf16 v[128:131], v[80:83], a[16:19], v[128:131]
  ds_read_b64_tr_b16 v[72:73], v10 offset:6144
  v_add_f32 v100, v100, v108
  v_mfma_f32_16x16x32_bf16 v[132:135], v[80:83], a[20:23], v[132:135]
  ds_read_b64_tr_b16 v[74:75], v10 offset:6656
  v_sub_f32 v116, v124, v116
  v_mfma_f32_16x16x32_bf16 v[136:139], v[80:83], a[24:27], v[136:139]
  ds_read_b64_tr_b16 v[76:77], v10 offset:7168
  v_add_f32 v101, v101, v109
  v_mfma_f32_16x16x32_bf16 v[140:143], v[80:83], a[28:31], v[140:143]
  ds_read_b64_tr_b16 v[78:79], v10 offset:7680
  v_sub_f32 v117, v125, v117
  v_mfma_f32_16x16x32_bf16 v[144:147], v[84:87], a[16:19], v[144:147]
  v_add_f32 v102, v102, v110
  v_sub_f32 v118, v126, v118
  v_mfma_f32_16x16x32_bf16 v[148:151], v[84:87], a[20:23], v[148:151]
  v_add_f32 v103, v103, v111
  v_sub_f32 v119, v127, v119
  v_mfma_f32_16x16x32_bf16 v[152:155], v[84:87], a[24:27], v[152:155]
  v_cmp_gt_u32 vcc, 16, v0
  s_cmp_eq_u32 s45, 0
  s_cselect_b64 s[36:37], -1, 0
  v_mfma_f32_16x16x32_bf16 v[156:159], v[84:87], a[28:31], v[156:159]
  s_waitcnt lgkmcnt(4)
  v_mov_b32 v50, 0x80008000
  v_mov_b32 v51, 0x80000000
  v_mfma_f32_16x16x32_bf16 v[128:131], v[88:91], a[32:35], v[128:131]
  s_and_b64 s[36:37], s[36:37], vcc
  ds_read_b64_tr_b16 v[80:81], v10 offset:8192
  v_cndmask_b32 v96, v96, v48, s[36:37]
  v_mfma_f32_16x16x32_bf16 v[132:135], v[88:91], a[36:39], v[132:135]
  ds_read_b64_tr_b16 v[82:83], v10 offset:8704
  v_cndmask_b32 v112, v112, v49, s[36:37]
  v_mfma_f32_16x16x32_bf16 v[136:139], v[88:91], a[40:43], v[136:139]
  ds_read_b64_tr_b16 v[84:85], v10 offset:9216
  v_cndmask_b32 v51, v50, v51, s[36:37]
  v_mfma_f32_16x16x32_bf16 v[140:143], v[88:91], a[44:47], v[140:143]
  ds_read_b64_tr_b16 v[86:87], v10 offset:9728
  v_cvt_pk_bf16_f32 v18, v96, v97
  v_mfma_f32_16x16x32_bf16 v[144:147], v[92:95], a[32:35], v[144:147]
  v_cvt_pk_bf16_f32 v22, v112, v113
  v_cvt_pk_bf16_f32 v19, v98, v99
  v_mfma_f32_16x16x32_bf16 v[148:151], v[92:95], a[36:39], v[148:151]
  v_cvt_pk_bf16_f32 v23, v114, v115
  v_cvt_pk_bf16_f32 v20, v100, v101
  v_mfma_f32_16x16x32_bf16 v[152:155], v[92:95], a[40:43], v[152:155]
  v_cvt_pk_bf16_f32 v24, v116, v117
  v_cvt_pk_bf16_f32 v21, v102, v103
  v_mfma_f32_16x16x32_bf16 v[156:159], v[92:95], a[44:47], v[156:159]
  s_waitcnt lgkmcnt(4)
  v_cvt_pk_bf16_f32 v25, v118, v119
  v_mfma_f32_16x16x32_bf16 v[128:131], v[72:75], a[48:51], v[128:131]
  buffer_store_dwordx4 v[18:21], v17, s[16:19], s61 offen sc1
  v_mfma_f32_16x16x32_bf16 v[132:135], v[72:75], a[52:55], v[132:135]
  buffer_store_dwordx4 v[18:21], v16, s[16:19], s61 offen sc1
  v_mfma_f32_16x16x32_bf16 v[136:139], v[72:75], a[56:59], v[136:139]
  ds_read_b64_tr_b16 v[88:89], v10 offset:10240
  v_xor_b32 v44, v22, v51
  v_mfma_f32_16x16x32_bf16 v[140:143], v[72:75], a[60:63], v[140:143]
  ds_read_b64_tr_b16 v[90:91], v10 offset:10752
  v_xor_b32 v45, v23, v50
  v_mfma_f32_16x16x32_bf16 v[144:147], v[76:79], a[48:51], v[144:147]
  ds_read_b64_tr_b16 v[92:93], v10 offset:11264
  v_xor_b32 v46, v24, v50
  v_mfma_f32_16x16x32_bf16 v[148:151], v[76:79], a[52:55], v[148:151]
  ds_read_b64_tr_b16 v[94:95], v10 offset:11776
  v_xor_b32 v47, v25, v50
  v_mfma_f32_16x16x32_bf16 v[152:155], v[76:79], a[56:59], v[152:155]
  buffer_store_dwordx4 v[22:25], v17, s[16:19], s62 offen sc1
  v_mfma_f32_16x16x32_bf16 v[156:159], v[76:79], a[60:63], v[156:159]
  s_waitcnt lgkmcnt(4)
  buffer_store_dwordx4 v[44:47], v16, s[16:19], s62 offen sc1
  v_mfma_f32_16x16x32_bf16 v[128:131], v[80:83], a[64:67], v[128:131]
  ds_read_b64_tr_b16 v[72:73], v10 offset:12288
  v_cvt_pk_bf16_f32 v58, v208, v209
  v_mfma_f32_16x16x32_bf16 v[132:135], v[80:83], a[68:71], v[132:135]
  ds_read_b64_tr_b16 v[74:75], v10 offset:12800
  v_cvt_pk_bf16_f32 v59, v210, v211
  v_mfma_f32_16x16x32_bf16 v[136:139], v[80:83], a[72:75], v[136:139]
  buffer_store_dwordx4 v[56:59], v14, s[16:19], s50 offen offset:3072 sc1
  v_mfma_f32_16x16x32_bf16 v[140:143], v[80:83], a[76:79], v[140:143]
  ds_read_b64_tr_b16 v[76:77], v10 offset:13312
  v_mul_f32 v40, s46, v196
  v_mfma_f32_16x16x32_bf16 v[144:147], v[84:87], a[64:67], v[144:147]
  ds_read_b64_tr_b16 v[78:79], v10 offset:13824
  v_mul_f32 v41, s46, v197
  v_mfma_f32_16x16x32_bf16 v[148:151], v[84:87], a[68:71], v[148:151]
  v_mul_f32 v42, s46, v198
  v_mul_f32 v43, s46, v199
  v_mfma_f32_16x16x32_bf16 v[152:155], v[84:87], a[72:75], v[152:155]
  v_exp_f32 v40, v40
  v_mfma_f32_16x16x32_bf16 v[156:159], v[84:87], a[76:79], v[156:159]
  s_waitcnt lgkmcnt(4)
  v_exp_f32 v41, v41
  v_mfma_f32_16x16x32_bf16 v[128:131], v[88:91], a[80:83], v[128:131]
  v_exp_f32 v42, v42
  v_mfma_f32_16x16x32_bf16 v[132:135], v[88:91], a[84:87], v[132:135]
  v_exp_f32 v43, v43
  v_mfma_f32_16x16x32_bf16 v[136:139], v[88:91], a[88:91], v[136:139]
  ds_read_b64_tr_b16 v[80:81], v10 offset:14336
  v_mul_f32 v212, v196, v212
  v_mfma_f32_16x16x32_bf16 v[140:143], v[88:91], a[92:95], v[140:143]
  ds_read_b64_tr_b16 v[82:83], v10 offset:14848
  v_mul_f32 v213, v197, v213
  v_mfma_f32_16x16x32_bf16 v[144:147], v[92:95], a[80:83], v[144:147]
  ds_read_b64_tr_b16 v[84:85], v10 offset:15360
  v_mul_f32 v214, v198, v214
  v_mfma_f32_16x16x32_bf16 v[148:151], v[92:95], a[84:87], v[148:151]
  ds_read_b64_tr_b16 v[86:87], v10 offset:15872
  v_mul_f32 v215, v199, v215
  v_mfma_f32_16x16x32_bf16 v[152:155], v[92:95], a[88:91], v[152:155]
  v_add_f32 v40, 1.0, v40
  v_add_f32 v41, 1.0, v41
  v_mfma_f32_16x16x32_bf16 v[156:159], v[92:95], a[92:95], v[156:159]
  v_add_f32 v42, 1.0, v42
  v_add_f32 v43, 1.0, v43
  s_barrier
  s_waitcnt lgkmcnt(4)
  v_mfma_f32_16x16x32_bf16 v[128:131], v[72:75], a[96:99], v[128:131]
  s_lshr_b32 s39, s2, 3
  v_rcp_f32 v40, v40
  v_mfma_f32_16x16x32_bf16 v[132:135], v[72:75], a[100:103], v[132:135]
  s_mul_i32 s39, s39, 43
  v_rcp_f32 v41, v41
  v_mfma_f32_16x16x32_bf16 v[136:139], v[72:75], a[104:107], v[136:139]
  s_lshr_b32 s39, s39, 8
  v_rcp_f32 v42, v42
  v_mfma_f32_16x16x32_bf16 v[140:143], v[72:75], a[108:111], v[140:143]
  s_and_b32 s39, s39, 3
  v_rcp_f32 v43, v43
  v_mfma_f32_16x16x32_bf16 v[144:147], v[76:79], a[96:99], v[144:147]
  s_lshl_b32 s39, s39, 6
  v_subrev_u32 v10, 98304, v10
  ds_read_b64_tr_b16 v[88:89], v10 offset:0
  v_mfma_f32_16x16x32_bf16 v[148:151], v[76:79], a[100:103], v[148:151]
  s_add_u32 s39, s39, s68
  ds_read_b64_tr_b16 v[90:91], v10 offset:512
  v_and_b32 v33, 7, v0
  v_mfma_f32_16x16x32_bf16 v[152:155], v[76:79], a[104:107], v[152:155]
  ds_read_b64_tr_b16 v[92:93], v10 offset:1024
  v_lshlrev_b32 v33, 3, v33
  v_mfma_f32_16x16x32_bf16 v[156:159], v[76:79], a[108:111], v[156:159]
  s_waitcnt lgkmcnt(3)
  ds_read_b64_tr_b16 v[94:95], v10 offset:1536
  v_add_u32 v33, s39, v33
  v_mfma_f32_16x16x32_bf16 v[128:131], v[80:83], a[112:115], v[128:131]
  ds_read_b64_tr_b16 v[72:73], v10 offset:2048
  v_lshlrev_b32 v33, 7, v33
  v_mfma_f32_16x16x32_bf16 v[132:135], v[80:83], a[116:119], v[132:135]
  s_mov_b32 s39, 33300480
  buffer_load_dword v35, v33, s[16:19], s39 offen sc1
  v_mfma_f32_16x16x32_bf16 v[136:139], v[80:83], a[120:123], v[136:139]
  ds_read_b64_tr_b16 v[74:75], v10 offset:2560
  v_mul_f32 v212, v212, v40
  v_mfma_f32_16x16x32_bf16 v[140:143], v[80:83], a[124:127], v[140:143]
  ds_read_b64_tr_b16 v[76:77], v10 offset:3072
  v_mul_f32 v213, v213, v41
  v_mfma_f32_16x16x32_bf16 v[144:147], v[84:87], a[112:115], v[144:147]
  ds_read_b64_tr_b16 v[78:79], v10 offset:3584
  v_mul_f32 v214, v214, v42
  v_mfma_f32_16x16x32_bf16 v[148:151], v[84:87], a[116:119], v[148:151]
  v_mul_f32 v215, v215, v43
  v_cvt_pk_bf16_f32 v62, v212, v213
  v_mfma_f32_16x16x32_bf16 v[152:155], v[84:87], a[120:123], v[152:155]
  v_cvt_pk_bf16_f32 v63, v214, v215
  v_mfma_f32_16x16x32_bf16 v[156:159], v[84:87], a[124:127], v[156:159]
  s_waitcnt lgkmcnt(4)
  buffer_store_dwordx4 v[60:63], v14, s[16:19], s51 offen offset:3072 sc1
  v_mfma_f32_16x16x32_bf16 v[128:131], v[88:91], a[128:131], v[128:131]
  ds_read_b64_tr_b16 v[80:81], v10 offset:4096
  v_mul_f32 v40, s46, v200
  v_mfma_f32_16x16x32_bf16 v[132:135], v[88:91], a[132:135], v[132:135]
  ds_read_b64_tr_b16 v[82:83], v10 offset:4608
  v_mul_f32 v41, s46, v201
  v_mfma_f32_16x16x32_bf16 v[136:139], v[88:91], a[136:139], v[136:139]
  ds_read_b64_tr_b16 v[84:85], v10 offset:5120
  v_mul_f32 v42, s46, v202
  v_mfma_f32_16x16x32_bf16 v[140:143], v[88:91], a[140:143], v[140:143]
  ds_read_b64_tr_b16 v[86:87], v10 offset:5632
  v_mul_f32 v43, s46, v203
  v_mfma_f32_16x16x32_bf16 v[144:147], v[92:95], a[128:131], v[144:147]
  v_exp_f32 v40, v40
  v_mfma_f32_16x16x32_bf16 v[148:151], v[92:95], a[132:135], v[148:151]
  v_exp_f32 v41, v41
  v_mfma_f32_16x16x32_bf16 v[152:155], v[92:95], a[136:139], v[152:155]
  v_exp_f32 v42, v42
  v_mfma_f32_16x16x32_bf16 v[156:159], v[92:95], a[140:143], v[156:159]
  s_waitcnt lgkmcnt(4)
  v_exp_f32 v43, v43
  v_mfma_f32_16x16x32_bf16 v[128:131], v[72:75], a[144:147], v[128:131]
  ds_read_b64_tr_b16 v[88:89], v10 offset:6144
  v_mul_f32 v216, v200, v216
  v_mfma_f32_16x16x32_bf16 v[132:135], v[72:75], a[148:151], v[132:135]
  ds_read_b64_tr_b16 v[90:91], v10 offset:6656
  v_mul_f32 v217, v201, v217
  v_mfma_f32_16x16x32_bf16 v[136:139], v[72:75], a[152:155], v[136:139]
  ds_read_b64_tr_b16 v[92:93], v10 offset:7168
  v_mul_f32 v218, v202, v218
  v_mfma_f32_16x16x32_bf16 v[140:143], v[72:75], a[156:159], v[140:143]
  ds_read_b64_tr_b16 v[94:95], v10 offset:7680
  v_mul_f32 v219, v203, v219
  v_mfma_f32_16x16x32_bf16 v[144:147], v[76:79], a[144:147], v[144:147]
  v_add_f32 v40, 1.0, v40
  v_add_f32 v41, 1.0, v41
  v_mfma_f32_16x16x32_bf16 v[148:151], v[76:79], a[148:151], v[148:151]
  v_add_f32 v42, 1.0, v42
  v_add_f32 v43, 1.0, v43
  v_mfma_f32_16x16x32_bf16 v[152:155], v[76:79], a[152:155], v[152:155]
  v_rcp_f32 v40, v40
  v_mfma_f32_16x16x32_bf16 v[156:159], v[76:79], a[156:159], v[156:159]
  s_waitcnt lgkmcnt(4)
  v_rcp_f32 v41, v41
  v_mfma_f32_16x16x32_bf16 v[128:131], v[80:83], a[160:163], v[128:131]
  v_rcp_f32 v42, v42
  v_mfma_f32_16x16x32_bf16 v[132:135], v[80:83], a[164:167], v[132:135]
  v_rcp_f32 v43, v43
  v_mfma_f32_16x16x32_bf16 v[136:139], v[80:83], a[168:171], v[136:139]
  ds_read_b64_tr_b16 v[72:73], v10 offset:8192
  v_mul_f32 v216, v216, v40
  v_mfma_f32_16x16x32_bf16 v[140:143], v[80:83], a[172:175], v[140:143]
  ds_read_b64_tr_b16 v[74:75], v10 offset:8704
  v_mul_f32 v217, v217, v41
  v_mfma_f32_16x16x32_bf16 v[144:147], v[84:87], a[160:163], v[144:147]
  ds_read_b64_tr_b16 v[76:77], v10 offset:9216
  v_mul_f32 v218, v218, v42
  v_mfma_f32_16x16x32_bf16 v[148:151], v[84:87], a[164:167], v[148:151]
  ds_read_b64_tr_b16 v[78:79], v10 offset:9728
  v_mul_f32 v219, v219, v43
  v_mfma_f32_16x16x32_bf16 v[152:155], v[84:87], a[168:171], v[152:155]
  v_cvt_pk_bf16_f32 v66, v216, v217
  v_cvt_pk_bf16_f32 v67, v218, v219
  v_mfma_f32_16x16x32_bf16 v[156:159], v[84:87], a[172:175], v[156:159]
  s_waitcnt lgkmcnt(4)
  buffer_store_dwordx4 v[64:67], v14, s[16:19], s52 offen offset:3072 sc1
  v_mfma_f32_16x16x32_bf16 v[128:131], v[88:91], a[176:179], v[128:131]
  ds_read_b64_tr_b16 v[80:81], v10 offset:10240
  v_mul_f32 v40, s46, v204
  v_mfma_f32_16x16x32_bf16 v[132:135], v[88:91], a[180:183], v[132:135]
  ds_read_b64_tr_b16 v[82:83], v10 offset:10752
  v_mul_f32 v41, s46, v205
  v_mfma_f32_16x16x32_bf16 v[136:139], v[88:91], a[184:187], v[136:139]
  ds_read_b64_tr_b16 v[84:85], v10 offset:11264
  v_mul_f32 v42, s46, v206
  v_mfma_f32_16x16x32_bf16 v[140:143], v[88:91], a[188:191], v[140:143]
  ds_read_b64_tr_b16 v[86:87], v10 offset:11776
  v_mul_f32 v43, s46, v207
  v_mfma_f32_16x16x32_bf16 v[144:147], v[92:95], a[176:179], v[144:147]
  v_exp_f32 v40, v40
  v_mfma_f32_16x16x32_bf16 v[148:151], v[92:95], a[180:183], v[148:151]
  v_exp_f32 v41, v41
  v_mfma_f32_16x16x32_bf16 v[152:155], v[92:95], a[184:187], v[152:155]
  v_exp_f32 v42, v42
  v_mfma_f32_16x16x32_bf16 v[156:159], v[92:95], a[188:191], v[156:159]
  s_waitcnt lgkmcnt(4)
  v_exp_f32 v43, v43
  v_mfma_f32_16x16x32_bf16 v[128:131], v[72:75], a[192:195], v[128:131]
  ds_read_b64_tr_b16 v[88:89], v10 offset:12288
  v_mul_f32 v220, v204, v220
  v_mfma_f32_16x16x32_bf16 v[132:135], v[72:75], a[196:199], v[132:135]
  ds_read_b64_tr_b16 v[90:91], v10 offset:12800
  v_mul_f32 v221, v205, v221
  v_mfma_f32_16x16x32_bf16 v[136:139], v[72:75], a[200:203], v[136:139]
  ds_read_b64_tr_b16 v[92:93], v10 offset:13312
  v_mul_f32 v222, v206, v222
  v_mfma_f32_16x16x32_bf16 v[140:143], v[72:75], a[204:207], v[140:143]
  ds_read_b64_tr_b16 v[94:95], v10 offset:13824
  v_mul_f32 v223, v207, v223
  v_mfma_f32_16x16x32_bf16 v[144:147], v[76:79], a[192:195], v[144:147]
  v_add_f32 v40, 1.0, v40
  v_add_f32 v41, 1.0, v41
  v_mfma_f32_16x16x32_bf16 v[148:151], v[76:79], a[196:199], v[148:151]
  v_add_f32 v42, 1.0, v42
  v_add_f32 v43, 1.0, v43
  v_mfma_f32_16x16x32_bf16 v[152:155], v[76:79], a[200:203], v[152:155]
  v_rcp_f32 v40, v40
  v_mfma_f32_16x16x32_bf16 v[156:159], v[76:79], a[204:207], v[156:159]
  s_waitcnt lgkmcnt(4)
  v_rcp_f32 v41, v41
  v_mfma_f32_16x16x32_bf16 v[128:131], v[80:83], a[208:211], v[128:131]
  v_rcp_f32 v42, v42
  v_mfma_f32_16x16x32_bf16 v[132:135], v[80:83], a[212:215], v[132:135]
  v_rcp_f32 v43, v43
  v_mfma_f32_16x16x32_bf16 v[136:139], v[80:83], a[216:219], v[136:139]
  ds_read_b64_tr_b16 v[72:73], v10 offset:14336
  v_mul_f32 v220, v220, v40
  v_mfma_f32_16x16x32_bf16 v[140:143], v[80:83], a[220:223], v[140:143]
  ds_read_b64_tr_b16 v[74:75], v10 offset:14848
  v_mul_f32 v221, v221, v41
  v_mfma_f32_16x16x32_bf16 v[144:147], v[84:87], a[208:211], v[144:147]
  ds_read_b64_tr_b16 v[76:77], v10 offset:15360
  v_mul_f32 v222, v222, v42
  v_mfma_f32_16x16x32_bf16 v[148:151], v[84:87], a[212:215], v[148:151]
  ds_read_b64_tr_b16 v[78:79], v10 offset:15872
  v_mul_f32 v223, v223, v43
  v_mfma_f32_16x16x32_bf16 v[152:155], v[84:87], a[216:219], v[152:155]
  v_cvt_pk_bf16_f32 v70, v220, v221
  v_cvt_pk_bf16_f32 v71, v222, v223
  v_mfma_f32_16x16x32_bf16 v[156:159], v[84:87], a[220:223], v[156:159]
  s_waitcnt lgkmcnt(4)
  buffer_store_dwordx4 v[68:71], v14, s[16:19], s53 offen offset:3072 sc1
  v_mfma_f32_16x16x32_bf16 v[128:131], v[88:91], a[224:227], v[128:131]
  ds_read_b64_tr_b16 v[80:81], v10 offset:16384
  ds_read_b64_tr_b16 v[82:83], v10 offset:16896
  v_mfma_f32_16x16x32_bf16 v[132:135], v[88:91], a[228:231], v[132:135]
  ds_read_b64_tr_b16 v[84:85], v10 offset:17408
  ds_read_b64_tr_b16 v[86:87], v10 offset:17920
  v_mfma_f32_16x16x32_bf16 v[136:139], v[88:91], a[232:235], v[136:139]
  v_mfma_f32_16x16x32_bf16 v[140:143], v[88:91], a[236:239], v[140:143]
  v_mfma_f32_16x16x32_bf16 v[144:147], v[92:95], a[224:227], v[144:147]
  v_mfma_f32_16x16x32_bf16 v[148:151], v[92:95], a[228:231], v[148:151]
  v_mfma_f32_16x16x32_bf16 v[152:155], v[92:95], a[232:235], v[152:155]
  v_mfma_f32_16x16x32_bf16 v[156:159], v[92:95], a[236:239], v[156:159]
  s_waitcnt lgkmcnt(4)
  v_mfma_f32_16x16x32_bf16 v[128:131], v[72:75], a[240:243], v[128:131]
  ds_read_b64_tr_b16 v[88:89], v10 offset:18432
  ds_read_b64_tr_b16 v[90:91], v10 offset:18944
  v_mfma_f32_16x16x32_bf16 v[132:135], v[72:75], a[244:247], v[132:135]
  ds_read_b64_tr_b16 v[92:93], v10 offset:19456
  ds_read_b64_tr_b16 v[94:95], v10 offset:19968
  v_mfma_f32_16x16x32_bf16 v[136:139], v[72:75], a[248:251], v[136:139]
  v_mfma_f32_16x16x32_bf16 v[140:143], v[72:75], a[252:255], v[140:143]
  v_mfma_f32_16x16x32_bf16 v[144:147], v[76:79], a[240:243], v[144:147]
  v_mfma_f32_16x16x32_bf16 v[148:151], v[76:79], a[244:247], v[148:151]
  v_mfma_f32_16x16x32_bf16 v[152:155], v[76:79], a[248:251], v[152:155]
  v_mfma_f32_16x16x32_bf16 v[156:159], v[76:79], a[252:255], v[156:159]
  s_waitcnt lgkmcnt(4)
  v_mfma_f32_16x16x32_bf16 v[128:131], v[80:83], v[224:227], v[128:131]
  v_mfma_f32_16x16x32_bf16 v[132:135], v[80:83], v[228:231], v[132:135]
  v_mfma_f32_16x16x32_bf16 v[136:139], v[80:83], v[232:235], v[136:139]
  v_mfma_f32_16x16x32_bf16 v[140:143], v[80:83], v[236:239], v[140:143]
  v_mfma_f32_16x16x32_bf16 v[144:147], v[84:87], v[224:227], v[144:147]
  v_mfma_f32_16x16x32_bf16 v[148:151], v[84:87], v[228:231], v[148:151]
  v_mfma_f32_16x16x32_bf16 v[152:155], v[84:87], v[232:235], v[152:155]
  v_mfma_f32_16x16x32_bf16 v[156:159], v[84:87], v[236:239], v[156:159]
  s_waitcnt lgkmcnt(0)
  v_mfma_f32_16x16x32_bf16 v[128:131], v[88:91], v[240:243], v[128:131]
  v_mfma_f32_16x16x32_bf16 v[132:135], v[88:91], v[244:247], v[132:135]
  v_mfma_f32_16x16x32_bf16 v[136:139], v[88:91], v[248:251], v[136:139]
  v_mfma_f32_16x16x32_bf16 v[140:143], v[88:91], v[252:255], v[140:143]
  v_mfma_f32_16x16x32_bf16 v[144:147], v[92:95], v[240:243], v[144:147]
  v_mfma_f32_16x16x32_bf16 v[148:151], v[92:95], v[244:247], v[148:151]
  v_mfma_f32_16x16x32_bf16 v[152:155], v[92:95], v[248:251], v[152:155]
  v_mfma_f32_16x16x32_bf16 v[156:159], v[92:95], v[252:255], v[156:159]
  s_nop 0
  v_mul_f32 v40, s46, v128
  v_mul_f32 v41, s46, v129
  v_mul_f32 v42, s46, v130
  v_mul_f32 v43, s46, v131
  v_exp_f32 v40, v40
  v_exp_f32 v41, v41
  v_exp_f32 v42, v42
  v_exp_f32 v43, v43
  v_mul_f32 v144, v128, v144
  v_mul_f32 v145, v129, v145
  v_mul_f32 v146, v130, v146
  v_mul_f32 v147, v131, v147
  v_add_f32 v40, 1.0, v40
  v_add_f32 v41, 1.0, v41
  v_add_f32 v42, 1.0, v42
  v_add_f32 v43, 1.0, v43
  v_rcp_f32 v40, v40
  v_rcp_f32 v41, v41
  v_rcp_f32 v42, v42
  v_rcp_f32 v43, v43
  v_mul_f32 v144, v144, v40
  v_mul_f32 v145, v145, v41
  v_mul_f32 v146, v146, v42
  v_mul_f32 v147, v147, v43
  v_cvt_pk_bf16_f32 v56, v144, v145
  v_cvt_pk_bf16_f32 v57, v146, v147
  v_mul_f32 v40, s46, v132
  v_mul_f32 v41, s46, v133
  v_mul_f32 v42, s46, v134
  v_mul_f32 v43, s46, v135
  v_exp_f32 v40, v40
  v_exp_f32 v41, v41
  v_exp_f32 v42, v42
  v_exp_f32 v43, v43
  v_mul_f32 v148, v132, v148
  v_mul_f32 v149, v133, v149
  v_mul_f32 v150, v134, v150
  v_mul_f32 v151, v135, v151
  v_add_f32 v40, 1.0, v40
  v_add_f32 v41, 1.0, v41
  v_add_f32 v42, 1.0, v42
  v_add_f32 v43, 1.0, v43
  v_rcp_f32 v40, v40
  v_rcp_f32 v41, v41
  v_rcp_f32 v42, v42
  v_rcp_f32 v43, v43
  v_mul_f32 v148, v148, v40
  v_mul_f32 v149, v149, v41
  v_mul_f32 v150, v150, v42
  v_mul_f32 v151, v151, v43
  v_cvt_pk_bf16_f32 v60, v148, v149
  v_cvt_pk_bf16_f32 v61, v150, v151
  v_mul_f32 v40, s46, v136
  v_mul_f32 v41, s46, v137
  v_mul_f32 v42, s46, v138
  v_mul_f32 v43, s46, v139
  v_exp_f32 v40, v40
  v_exp_f32 v41, v41
  v_exp_f32 v42, v42
  v_exp_f32 v43, v43
  v_mul_f32 v152, v136, v152
  v_mul_f32 v153, v137, v153
  v_mul_f32 v154, v138, v154
  v_mul_f32 v155, v139, v155
  v_add_f32 v40, 1.0, v40
  v_add_f32 v41, 1.0, v41
  v_add_f32 v42, 1.0, v42
  v_add_f32 v43, 1.0, v43
  v_rcp_f32 v40, v40
  v_rcp_f32 v41, v41
  v_rcp_f32 v42, v42
  v_rcp_f32 v43, v43
  v_mul_f32 v152, v152, v40
  v_mul_f32 v153, v153, v41
  v_mul_f32 v154, v154, v42
  v_mul_f32 v155, v155, v43
  v_cvt_pk_bf16_f32 v64, v152, v153
  v_cvt_pk_bf16_f32 v65, v154, v155
  v_mul_f32 v40, s46, v140
  v_mul_f32 v41, s46, v141
  v_mul_f32 v42, s46, v142
  v_mul_f32 v43, s46, v143
  v_exp_f32 v40, v40
  v_exp_f32 v41, v41
  v_exp_f32 v42, v42
  v_exp_f32 v43, v43
  v_mul_f32 v156, v140, v156
  v_mul_f32 v157, v141, v157
  v_mul_f32 v158, v142, v158
  v_mul_f32 v159, v143, v159
  v_add_f32 v40, 1.0, v40
  v_add_f32 v41, 1.0, v41
  v_add_f32 v42, 1.0, v42
  v_add_f32 v43, 1.0, v43
  v_rcp_f32 v40, v40
  v_rcp_f32 v41, v41
  v_rcp_f32 v42, v42
  v_rcp_f32 v43, v43
  v_mul_f32 v156, v156, v40
  v_mul_f32 v157, v157, v41
  v_mul_f32 v158, v158, v42
  v_mul_f32 v159, v159, v43
  v_cvt_pk_bf16_f32 v68, v156, v157
  v_cvt_pk_bf16_f32 v69, v158, v159
  s_waitcnt vmcnt(3)
  v_cmp_eq_u32 vcc, 1, v35
  v_readfirstlane_b32 s36, v34
  s_nop 3
  s_cmp_eq_u64 vcc, -1
  s_cselect_b32 s37, 1, 0
  s_cmp_ge_u32 s36, 256
  s_cselect_b32 s36, 1, 0
  s_and_b32 s37, s37, s36
  s_mov_b32 s24, s54
  s_mov_b32 s25, s55
  s_mov_b32 s26, s56
  s_mov_b32 s27, s57
  v_mov_b32 v55, v15
  s_branch gated_mix__spectral_fnet__swiglu_ffn__prompt_kernel_p2
gated_mix__spectral_fnet__swiglu_ffn__prompt_kernel_nog3:
  s_lshl_b32 s38, s2, 7
  s_add_u32 s38, s38, 33300480
  s_waitcnt lgkmcnt(4)
  v_mfma_f32_16x16x32_bf16 v[96:99], v[88:91], a[224:227], v[96:99]
  ds_read_b64_tr_b16 v[80:81], v6 offset:32768
  ds_read_b64_tr_b16 v[82:83], v6 offset:36864
  v_mfma_f32_16x16x32_bf16 v[100:103], v[88:91], a[228:231], v[100:103]
  ds_read_b64_tr_b16 v[84:85], v6 offset:33792
  ds_read_b64_tr_b16 v[86:87], v6 offset:37888
  v_mfma_f32_16x16x32_bf16 v[104:107], v[88:91], a[232:235], v[104:107]
  v_mfma_f32_16x16x32_bf16 v[108:111], v[88:91], a[236:239], v[108:111]
  v_mfma_f32_16x16x32_bf16 v[112:115], v[92:95], a[224:227], v[112:115]
  v_mfma_f32_16x16x32_bf16 v[116:119], v[92:95], a[228:231], v[116:119]
  v_mfma_f32_16x16x32_bf16 v[120:123], v[92:95], a[232:235], v[120:123]
  v_mfma_f32_16x16x32_bf16 v[124:127], v[92:95], a[236:239], v[124:127]
  s_waitcnt lgkmcnt(4)
  v_mfma_f32_16x16x32_bf16 v[96:99], v[72:75], a[240:243], v[96:99]
  ds_read_b64_tr_b16 v[88:89], v6 offset:40960
  ds_read_b64_tr_b16 v[90:91], v6 offset:45056
  v_mfma_f32_16x16x32_bf16 v[100:103], v[72:75], a[244:247], v[100:103]
  ds_read_b64_tr_b16 v[92:93], v6 offset:41984
  ds_read_b64_tr_b16 v[94:95], v6 offset:46080
  v_mfma_f32_16x16x32_bf16 v[104:107], v[72:75], a[248:251], v[104:107]
  v_mfma_f32_16x16x32_bf16 v[108:111], v[72:75], a[252:255], v[108:111]
  v_mfma_f32_16x16x32_bf16 v[112:115], v[76:79], a[240:243], v[112:115]
  v_mfma_f32_16x16x32_bf16 v[116:119], v[76:79], a[244:247], v[116:119]
  v_mfma_f32_16x16x32_bf16 v[120:123], v[76:79], a[248:251], v[120:123]
  v_mfma_f32_16x16x32_bf16 v[124:127], v[76:79], a[252:255], v[124:127]
  s_waitcnt lgkmcnt(4)
  v_mfma_f32_16x16x32_bf16 v[96:99], v[80:83], v[224:227], v[96:99]
  v_subrev_u32 v7, 98304, v7
  ds_read_b64_tr_b16 v[72:73], v7 offset:0
  v_mfma_f32_16x16x32_bf16 v[100:103], v[80:83], v[228:231], v[100:103]
  ds_read_b64_tr_b16 v[74:75], v7 offset:4096
  ds_read_b64_tr_b16 v[76:77], v7 offset:1024
  v_mfma_f32_16x16x32_bf16 v[104:107], v[80:83], v[232:235], v[104:107]
  ds_read_b64_tr_b16 v[78:79], v7 offset:5120
  v_mfma_f32_16x16x32_bf16 v[108:111], v[80:83], v[236:239], v[108:111]
  v_mfma_f32_16x16x32_bf16 v[112:115], v[84:87], v[224:227], v[112:115]
  v_mfma_f32_16x16x32_bf16 v[116:119], v[84:87], v[228:231], v[116:119]
  v_mfma_f32_16x16x32_bf16 v[120:123], v[84:87], v[232:235], v[120:123]
  v_mfma_f32_16x16x32_bf16 v[124:127], v[84:87], v[236:239], v[124:127]
  s_waitcnt lgkmcnt(4)
  v_mfma_f32_16x16x32_bf16 v[96:99], v[88:91], v[240:243], v[96:99]
  ds_read_b64_tr_b16 v[80:81], v7 offset:8192
  ds_read_b64_tr_b16 v[82:83], v7 offset:12288
  v_mfma_f32_16x16x32_bf16 v[100:103], v[88:91], v[244:247], v[100:103]
  ds_read_b64_tr_b16 v[84:85], v7 offset:9216
  ds_read_b64_tr_b16 v[86:87], v7 offset:13312
  v_mfma_f32_16x16x32_bf16 v[104:107], v[88:91], v[248:251], v[104:107]
  v_mfma_f32_16x16x32_bf16 v[108:111], v[88:91], v[252:255], v[108:111]
  v_mfma_f32_16x16x32_bf16 v[112:115], v[92:95], v[240:243], v[112:115]
  v_mfma_f32_16x16x32_bf16 v[116:119], v[92:95], v[244:247], v[116:119]
  v_mfma_f32_16x16x32_bf16 v[120:123], v[92:95], v[248:251], v[120:123]
  v_mfma_f32_16x16x32_bf16 v[124:127], v[92:95], v[252:255], v[124:127]
  s_waitcnt lgkmcnt(4)
  v_mfma_f32_16x16x32_bf16 v[128:131], v[72:75], a[192:195], v[128:131]
  ds_read_b64_tr_b16 v[88:89], v7 offset:16384
  ds_read_b64_tr_b16 v[90:91], v7 offset:20480
  v_mfma_f32_16x16x32_bf16 v[132:135], v[72:75], a[196:199], v[132:135]
  ds_read_b64_tr_b16 v[92:93], v7 offset:17408
  ds_read_b64_tr_b16 v[94:95], v7 offset:21504
  v_mfma_f32_16x16x32_bf16 v[136:139], v[72:75], a[200:203], v[136:139]
  v_mul_f32 v40, s46, v96
  v_mul_f32 v41, s46, v97
  v_mfma_f32_16x16x32_bf16 v[140:143], v[72:75], a[204:207], v[140:143]
  v_mul_f32 v42, s46, v98
  v_mul_f32 v43, s46, v99
  v_mfma_f32_16x16x32_bf16 v[144:147], v[76:79], a[192:195], v[144:147]
  v_exp_f32 v40, v40
  v_mfma_f32_16x16x32_bf16 v[148:151], v[76:79], a[196:199], v[148:151]
  v_exp_f32 v41, v41
  v_mfma_f32_16x16x32_bf16 v[152:155], v[76:79], a[200:203], v[152:155]
  v_exp_f32 v42, v42
  v_mfma_f32_16x16x32_bf16 v[156:159], v[76:79], a[204:207], v[156:159]
  s_waitcnt lgkmcnt(4)
  v_exp_f32 v43, v43
  v_mfma_f32_16x16x32_bf16 v[128:131], v[80:83], a[208:211], v[128:131]
  ds_read_b64_tr_b16 v[72:73], v7 offset:24576
  v_mul_f32 v112, v96, v112
  v_mfma_f32_16x16x32_bf16 v[132:135], v[80:83], a[212:215], v[132:135]
  ds_read_b64_tr_b16 v[74:75], v7 offset:28672
  v_mul_f32 v113, v97, v113
  v_mfma_f32_16x16x32_bf16 v[136:139], v[80:83], a[216:219], v[136:139]
  ds_read_b64_tr_b16 v[76:77], v7 offset:25600
  v_mul_f32 v114, v98, v114
  v_mfma_f32_16x16x32_bf16 v[140:143], v[80:83], a[220:223], v[140:143]
  ds_read_b64_tr_b16 v[78:79], v7 offset:29696
  v_mul_f32 v115, v99, v115
  v_mfma_f32_16x16x32_bf16 v[144:147], v[84:87], a[208:211], v[144:147]
  v_add_f32 v40, 1.0, v40
  v_add_f32 v41, 1.0, v41
  v_mfma_f32_16x16x32_bf16 v[148:151], v[84:87], a[212:215], v[148:151]
  v_add_f32 v42, 1.0, v42
  v_add_f32 v43, 1.0, v43
  v_mfma_f32_16x16x32_bf16 v[152:155], v[84:87], a[216:219], v[152:155]
  v_rcp_f32 v40, v40
  v_mfma_f32_16x16x32_bf16 v[156:159], v[84:87], a[220:223], v[156:159]
  s_waitcnt lgkmcnt(4)
  v_rcp_f32 v41, v41
  v_mfma_f32_16x16x32_bf16 v[128:131], v[88:91], a[224:227], v[128:131]
  v_rcp_f32 v42, v42
  v_mfma_f32_16x16x32_bf16 v[132:135], v[88:91], a[228:231], v[132:135]
  v_rcp_f32 v43, v43
  v_mfma_f32_16x16x32_bf16 v[136:139], v[88:91], a[232:235], v[136:139]
  ds_read_b64_tr_b16 v[80:81], v7 offset:32768
  v_mul_f32 v112, v112, v40
  v_mfma_f32_16x16x32_bf16 v[140:143], v[88:91], a[236:239], v[140:143]
  ds_read_b64_tr_b16 v[82:83], v7 offset:36864
  v_mul_f32 v113, v113, v41
  v_mfma_f32_16x16x32_bf16 v[144:147], v[92:95], a[224:227], v[144:147]
  ds_read_b64_tr_b16 v[84:85], v7 offset:33792
  v_mul_f32 v114, v114, v42
  v_mfma_f32_16x16x32_bf16 v[148:151], v[92:95], a[228:231], v[148:151]
  ds_read_b64_tr_b16 v[86:87], v7 offset:37888
  v_mul_f32 v115, v115, v43
  v_mfma_f32_16x16x32_bf16 v[152:155], v[92:95], a[232:235], v[152:155]
  v_cvt_pk_bf16_f32 v56, v112, v113
  v_cvt_pk_bf16_f32 v57, v114, v115
  v_mfma_f32_16x16x32_bf16 v[156:159], v[92:95], a[236:239], v[156:159]
  s_waitcnt lgkmcnt(4)
  v_mul_f32 v40, s46, v100
  v_mul_f32 v41, s46, v101
  v_mfma_f32_16x16x32_bf16 v[128:131], v[72:75], a[240:243], v[128:131]
  ds_read_b64_tr_b16 v[88:89], v7 offset:40960
  v_mul_f32 v42, s46, v102
  v_mfma_f32_16x16x32_bf16 v[132:135], v[72:75], a[244:247], v[132:135]
  ds_read_b64_tr_b16 v[90:91], v7 offset:45056
  v_mul_f32 v43, s46, v103
  v_mfma_f32_16x16x32_bf16 v[136:139], v[72:75], a[248:251], v[136:139]
  v_exp_f32 v40, v40
  v_mfma_f32_16x16x32_bf16 v[140:143], v[72:75], a[252:255], v[140:143]
  v_exp_f32 v41, v41
  v_mfma_f32_16x16x32_bf16 v[144:147], v[76:79], a[240:243], v[144:147]
  ds_read_b64_tr_b16 v[92:93], v7 offset:41984
  ds_read_b64_tr_b16 v[94:95], v7 offset:46080
  v_mfma_f32_16x16x32_bf16 v[148:151], v[76:79], a[244:247], v[148:151]
  v_exp_f32 v42, v42
  v_mfma_f32_16x16x32_bf16 v[152:155], v[76:79], a[248:251], v[152:155]
  v_exp_f32 v43, v43
  v_mfma_f32_16x16x32_bf16 v[156:159], v[76:79], a[252:255], v[156:159]
  s_waitcnt lgkmcnt(4)
  v_mul_f32 v116, v100, v116
  v_mul_f32 v117, v101, v117
  v_mfma_f32_16x16x32_bf16 v[128:131], v[80:83], v[224:227], v[128:131]
  v_subrev_u32 v8, 98304, v8
  v_mul_f32 v118, v102, v118
  v_mfma_f32_16x16x32_bf16 v[132:135], v[80:83], v[228:231], v[132:135]
  ds_read_b64_tr_b16 v[72:73], v8 offset:0
  v_mul_f32 v119, v103, v119
  v_mfma_f32_16x16x32_bf16 v[136:139], v[80:83], v[232:235], v[136:139]
  ds_read_b64_tr_b16 v[74:75], v8 offset:4096
  v_add_f32 v40, 1.0, v40
  v_mfma_f32_16x16x32_bf16 v[140:143], v[80:83], v[236:239], v[140:143]
  ds_read_b64_tr_b16 v[76:77], v8 offset:1024
  v_add_f32 v41, 1.0, v41
  v_mfma_f32_16x16x32_bf16 v[144:147], v[84:87], v[224:227], v[144:147]
  ds_read_b64_tr_b16 v[78:79], v8 offset:5120
  v_add_f32 v42, 1.0, v42
  v_mfma_f32_16x16x32_bf16 v[148:151], v[84:87], v[228:231], v[148:151]
  v_add_f32 v43, 1.0, v43
  v_mfma_f32_16x16x32_bf16 v[152:155], v[84:87], v[232:235], v[152:155]
  v_rcp_f32 v40, v40
  v_mfma_f32_16x16x32_bf16 v[156:159], v[84:87], v[236:239], v[156:159]
  s_waitcnt lgkmcnt(4)
  v_rcp_f32 v41, v41
  v_mfma_f32_16x16x32_bf16 v[128:131], v[88:91], v[240:243], v[128:131]
  v_rcp_f32 v42, v42
  v_mfma_f32_16x16x32_bf16 v[132:135], v[88:91], v[244:247], v[132:135]
  v_rcp_f32 v43, v43
  v_mfma_f32_16x16x32_bf16 v[136:139], v[88:91], v[248:251], v[136:139]
  ds_read_b64_tr_b16 v[80:81], v8 offset:8192
  v_mul_f32 v116, v116, v40
  v_mfma_f32_16x16x32_bf16 v[140:143], v[88:91], v[252:255], v[140:143]
  ds_read_b64_tr_b16 v[82:83], v8 offset:12288
  v_mul_f32 v117, v117, v41
  v_mfma_f32_16x16x32_bf16 v[144:147], v[92:95], v[240:243], v[144:147]
  ds_read_b64_tr_b16 v[84:85], v8 offset:9216
  v_mul_f32 v118, v118, v42
  v_mfma_f32_16x16x32_bf16 v[148:151], v[92:95], v[244:247], v[148:151]
  ds_read_b64_tr_b16 v[86:87], v8 offset:13312
  v_mul_f32 v119, v119, v43
  v_mfma_f32_16x16x32_bf16 v[152:155], v[92:95], v[248:251], v[152:155]
  v_cvt_pk_bf16_f32 v60, v116, v117
  v_cvt_pk_bf16_f32 v61, v118, v119
  v_mfma_f32_16x16x32_bf16 v[156:159], v[92:95], v[252:255], v[156:159]
  s_waitcnt lgkmcnt(4)
  v_mul_f32 v40, s46, v104
  v_mul_f32 v41, s46, v105
  v_mfma_f32_16x16x32_bf16 v[160:163], v[72:75], a[192:195], v[160:163]
  ds_read_b64_tr_b16 v[88:89], v8 offset:16384
  v_mul_f32 v42, s46, v106
  v_mfma_f32_16x16x32_bf16 v[164:167], v[72:75], a[196:199], v[164:167]
  ds_read_b64_tr_b16 v[90:91], v8 offset:20480
  v_mul_f32 v43, s46, v107
  v_mfma_f32_16x16x32_bf16 v[168:171], v[72:75], a[200:203], v[168:171]
  v_exp_f32 v40, v40
  v_mfma_f32_16x16x32_bf16 v[172:175], v[72:75], a[204:207], v[172:175]
  v_exp_f32 v41, v41
  v_mfma_f32_16x16x32_bf16 v[176:179], v[76:79], a[192:195], v[176:179]
  ds_read_b64_tr_b16 v[92:93], v8 offset:17408
  ds_read_b64_tr_b16 v[94:95], v8 offset:21504
  v_mfma_f32_16x16x32_bf16 v[180:183], v[76:79], a[196:199], v[180:183]
  v_exp_f32 v42, v42
  v_mfma_f32_16x16x32_bf16 v[184:187], v[76:79], a[200:203], v[184:187]
  v_exp_f32 v43, v43
  v_mfma_f32_16x16x32_bf16 v[188:191], v[76:79], a[204:207], v[188:191]
  s_waitcnt lgkmcnt(4)
  v_mul_f32 v120, v104, v120
  v_mul_f32 v121, v105, v121
  v_mfma_f32_16x16x32_bf16 v[160:163], v[80:83], a[208:211], v[160:163]
  ds_read_b64_tr_b16 v[72:73], v8 offset:24576
  v_mul_f32 v122, v106, v122
  v_mfma_f32_16x16x32_bf16 v[164:167], v[80:83], a[212:215], v[164:167]
  ds_read_b64_tr_b16 v[74:75], v8 offset:28672
  v_mul_f32 v123, v107, v123
  v_mfma_f32_16x16x32_bf16 v[168:171], v[80:83], a[216:219], v[168:171]
  ds_read_b64_tr_b16 v[76:77], v8 offset:25600
  v_add_f32 v40, 1.0, v40
  v_mfma_f32_16x16x32_bf16 v[172:175], v[80:83], a[220:223], v[172:175]
  ds_read_b64_tr_b16 v[78:79], v8 offset:29696
  v_add_f32 v41, 1.0, v41
  v_mfma_f32_16x16x32_bf16 v[176:179], v[84:87], a[208:211], v[176:179]
  v_add_f32 v42, 1.0, v42
  v_add_f32 v43, 1.0, v43
  v_mfma_f32_16x16x32_bf16 v[180:183], v[84:87], a[212:215], v[180:183]
  v_rcp_f32 v40, v40
  v_mfma_f32_16x16x32_bf16 v[184:187], v[84:87], a[216:219], v[184:187]
  v_rcp_f32 v41, v41
  v_mfma_f32_16x16x32_bf16 v[188:191], v[84:87], a[220:223], v[188:191]
  s_waitcnt lgkmcnt(4)
  v_rcp_f32 v42, v42
  v_mfma_f32_16x16x32_bf16 v[160:163], v[88:91], a[224:227], v[160:163]
  v_rcp_f32 v43, v43
  v_mfma_f32_16x16x32_bf16 v[164:167], v[88:91], a[228:231], v[164:167]
  ds_read_b64_tr_b16 v[80:81], v8 offset:32768
  v_mul_f32 v120, v120, v40
  v_mfma_f32_16x16x32_bf16 v[168:171], v[88:91], a[232:235], v[168:171]
  ds_read_b64_tr_b16 v[82:83], v8 offset:36864
  v_mul_f32 v121, v121, v41
  v_mfma_f32_16x16x32_bf16 v[172:175], v[88:91], a[236:239], v[172:175]
  ds_read_b64_tr_b16 v[84:85], v8 offset:33792
  v_mul_f32 v122, v122, v42
  v_mfma_f32_16x16x32_bf16 v[176:179], v[92:95], a[224:227], v[176:179]
  ds_read_b64_tr_b16 v[86:87], v8 offset:37888
  v_mul_f32 v123, v123, v43
  v_mfma_f32_16x16x32_bf16 v[180:183], v[92:95], a[228:231], v[180:183]
  v_cvt_pk_bf16_f32 v64, v120, v121
  v_cvt_pk_bf16_f32 v65, v122, v123
  v_mfma_f32_16x16x32_bf16 v[184:187], v[92:95], a[232:235], v[184:187]
  v_mul_f32 v40, s46, v108
  v_mul_f32 v41, s46, v109
  v_mfma_f32_16x16x32_bf16 v[188:191], v[92:95], a[236:239], v[188:191]
  s_waitcnt lgkmcnt(4)
  v_mul_f32 v42, s46, v110
  v_mul_f32 v43, s46, v111
  v_mfma_f32_16x16x32_bf16 v[160:163], v[72:75], a[240:243], v[160:163]
  v_exp_f32 v40, v40
  v_mfma_f32_16x16x32_bf16 v[164:167], v[72:75], a[244:247], v[164:167]
  v_exp_f32 v41, v41
  v_mfma_f32_16x16x32_bf16 v[168:171], v[72:75], a[248:251], v[168:171]
  ds_read_b64_tr_b16 v[88:89], v8 offset:40960
  ds_read_b64_tr_b16 v[90:91], v8 offset:45056
  v_mfma_f32_16x16x32_bf16 v[172:175], v[72:75], a[252:255], v[172:175]
  v_exp_f32 v42, v42
  v_mfma_f32_16x16x32_bf16 v[176:179], v[76:79], a[240:243], v[176:179]
  ds_read_b64_tr_b16 v[92:93], v8 offset:41984
  ds_read_b64_tr_b16 v[94:95], v8 offset:46080
  v_mfma_f32_16x16x32_bf16 v[180:183], v[76:79], a[244:247], v[180:183]
  v_exp_f32 v43, v43
  v_mfma_f32_16x16x32_bf16 v[184:187], v[76:79], a[248:251], v[184:187]
  v_mul_f32 v124, v108, v124
  v_mul_f32 v125, v109, v125
  v_mfma_f32_16x16x32_bf16 v[188:191], v[76:79], a[252:255], v[188:191]
  s_waitcnt lgkmcnt(4)
  v_mul_f32 v126, v110, v126
  v_mul_f32 v127, v111, v127
  v_mfma_f32_16x16x32_bf16 v[160:163], v[80:83], v[224:227], v[160:163]
  v_subrev_u32 v9, 98304, v9
  v_add_f32 v40, 1.0, v40
  v_mfma_f32_16x16x32_bf16 v[164:167], v[80:83], v[228:231], v[164:167]
  ds_read_b64_tr_b16 v[72:73], v9 offset:0
  v_add_f32 v41, 1.0, v41
  v_mfma_f32_16x16x32_bf16 v[168:171], v[80:83], v[232:235], v[168:171]
  ds_read_b64_tr_b16 v[74:75], v9 offset:4096
  v_add_f32 v42, 1.0, v42
  v_mfma_f32_16x16x32_bf16 v[172:175], v[80:83], v[236:239], v[172:175]
  ds_read_b64_tr_b16 v[76:77], v9 offset:1024
  v_add_f32 v43, 1.0, v43
  v_mfma_f32_16x16x32_bf16 v[176:179], v[84:87], v[224:227], v[176:179]
  v_rcp_f32 v40, v40
  v_mfma_f32_16x16x32_bf16 v[180:183], v[84:87], v[228:231], v[180:183]
  ds_read_b64_tr_b16 v[78:79], v9 offset:5120
  v_mfma_f32_16x16x32_bf16 v[184:187], v[84:87], v[232:235], v[184:187]
  v_rcp_f32 v41, v41
  v_mfma_f32_16x16x32_bf16 v[188:191], v[84:87], v[236:239], v[188:191]
  s_waitcnt lgkmcnt(4)
  v_rcp_f32 v42, v42
  v_mfma_f32_16x16x32_bf16 v[160:163], v[88:91], v[240:243], v[160:163]
  v_rcp_f32 v43, v43
  v_mfma_f32_16x16x32_bf16 v[164:167], v[88:91], v[244:247], v[164:167]
  ds_read_b64_tr_b16 v[80:81], v9 offset:8192
  v_mul_f32 v124, v124, v40
  v_mfma_f32_16x16x32_bf16 v[168:171], v[88:91], v[248:251], v[168:171]
  ds_read_b64_tr_b16 v[82:83], v9 offset:12288
  v_mul_f32 v125, v125, v41
  v_mfma_f32_16x16x32_bf16 v[172:175], v[88:91], v[252:255], v[172:175]
  ds_read_b64_tr_b16 v[84:85], v9 offset:9216
  v_mul_f32 v126, v126, v42
  v_mfma_f32_16x16x32_bf16 v[176:179], v[92:95], v[240:243], v[176:179]
  ds_read_b64_tr_b16 v[86:87], v9 offset:13312
  v_mul_f32 v127, v127, v43
  v_mfma_f32_16x16x32_bf16 v[180:183], v[92:95], v[244:247], v[180:183]
  v_cvt_pk_bf16_f32 v68, v124, v125
  v_cvt_pk_bf16_f32 v69, v126, v127
  v_mfma_f32_16x16x32_bf16 v[184:187], v[92:95], v[248:251], v[184:187]
  v_mul_f32 v40, s46, v128
  v_mul_f32 v41, s46, v129
  v_mfma_f32_16x16x32_bf16 v[188:191], v[92:95], v[252:255], v[188:191]
  s_waitcnt lgkmcnt(4)
  v_mul_f32 v42, s46, v130
  v_mul_f32 v43, s46, v131
  v_mfma_f32_16x16x32_bf16 v[192:195], v[72:75], a[192:195], v[192:195]
  v_exp_f32 v40, v40
  v_mfma_f32_16x16x32_bf16 v[196:199], v[72:75], a[196:199], v[196:199]
  v_exp_f32 v41, v41
  v_mfma_f32_16x16x32_bf16 v[200:203], v[72:75], a[200:203], v[200:203]
  ds_read_b64_tr_b16 v[88:89], v9 offset:16384
  ds_read_b64_tr_b16 v[90:91], v9 offset:20480
  v_mfma_f32_16x16x32_bf16 v[204:207], v[72:75], a[204:207], v[204:207]
  v_exp_f32 v42, v42
  v_mfma_f32_16x16x32_bf16 v[208:211], v[76:79], a[192:195], v[208:211]
  ds_read_b64_tr_b16 v[92:93], v9 offset:17408
  ds_read_b64_tr_b16 v[94:95], v9 offset:21504
  v_mfma_f32_16x16x32_bf16 v[212:215], v[76:79], a[196:199], v[212:215]
  v_exp_f32 v43, v43
  v_mfma_f32_16x16x32_bf16 v[216:219], v[76:79], a[200:203], v[216:219]
  v_mul_f32 v144, v128, v144
  v_mul_f32 v145, v129, v145
  v_mfma_f32_16x16x32_bf16 v[220:223], v[76:79], a[204:207], v[220:223]
  s_waitcnt lgkmcnt(4)
  v_mul_f32 v146, v130, v146
  v_mul_f32 v147, v131, v147
  v_mfma_f32_16x16x32_bf16 v[192:195], v[80:83], a[208:211], v[192:195]
  ds_read_b64_tr_b16 v[72:73], v9 offset:24576
  v_add_f32 v40, 1.0, v40
  v_mfma_f32_16x16x32_bf16 v[196:199], v[80:83], a[212:215], v[196:199]
  ds_read_b64_tr_b16 v[74:75], v9 offset:28672
  v_add_f32 v41, 1.0, v41
  v_mfma_f32_16x16x32_bf16 v[200:203], v[80:83], a[216:219], v[200:203]
  ds_read_b64_tr_b16 v[76:77], v9 offset:25600
  v_add_f32 v42, 1.0, v42
  v_mfma_f32_16x16x32_bf16 v[204:207], v[80:83], a[220:223], v[204:207]
  ds_read_b64_tr_b16 v[78:79], v9 offset:29696
  v_add_f32 v43, 1.0, v43
  v_mfma_f32_16x16x32_bf16 v[208:211], v[84:87], a[208:211], v[208:211]
  v_rcp_f32 v40, v40
  v_mfma_f32_16x16x32_bf16 v[212:215], v[84:87], a[212:215], v[212:215]
  v_rcp_f32 v41, v41
  v_mfma_f32_16x16x32_bf16 v[216:219], v[84:87], a[216:219], v[216:219]
  v_rcp_f32 v42, v42
  v_mfma_f32_16x16x32_bf16 v[220:223], v[84:87], a[220:223], v[220:223]
  s_waitcnt lgkmcnt(4)
  v_rcp_f32 v43, v43
  v_mfma_f32_16x16x32_bf16 v[192:195], v[88:91], a[224:227], v[192:195]
  ds_read_b64_tr_b16 v[80:81], v9 offset:32768
  v_mul_f32 v144, v144, v40
  v_mfma_f32_16x16x32_bf16 v[196:199], v[88:91], a[228:231], v[196:199]
  ds_read_b64_tr_b16 v[82:83], v9 offset:36864
  v_mul_f32 v145, v145, v41
  v_mfma_f32_16x16x32_bf16 v[200:203], v[88:91], a[232:235], v[200:203]
  ds_read_b64_tr_b16 v[84:85], v9 offset:33792
  v_mul_f32 v146, v146, v42
  v_mfma_f32_16x16x32_bf16 v[204:207], v[88:91], a[236:239], v[204:207]
  ds_read_b64_tr_b16 v[86:87], v9 offset:37888
  v_mul_f32 v147, v147, v43
  v_mfma_f32_16x16x32_bf16 v[208:211], v[92:95], a[224:227], v[208:211]
  v_cvt_pk_bf16_f32 v58, v144, v145
  v_cvt_pk_bf16_f32 v59, v146, v147
  v_mfma_f32_16x16x32_bf16 v[212:215], v[92:95], a[228:231], v[212:215]
  buffer_store_dwordx4 v[56:59], v14, s[16:19], s50 offen offset:2048 sc1
  v_mfma_f32_16x16x32_bf16 v[216:219], v[92:95], a[232:235], v[216:219]
  v_mul_f32 v40, s46, v132
  v_mul_f32 v41, s46, v133
  v_mfma_f32_16x16x32_bf16 v[220:223], v[92:95], a[236:239], v[220:223]
  s_waitcnt lgkmcnt(4)
  v_mul_f32 v42, s46, v134
  v_mul_f32 v43, s46, v135
  v_mfma_f32_16x16x32_bf16 v[192:195], v[72:75], a[240:243], v[192:195]
  v_exp_f32 v40, v40
  v_mfma_f32_16x16x32_bf16 v[196:199], v[72:75], a[244:247], v[196:199]
  v_exp_f32 v41, v41
  v_mfma_f32_16x16x32_bf16 v[200:203], v[72:75], a[248:251], v[200:203]
  ds_read_b64_tr_b16 v[88:89], v9 offset:40960
  ds_read_b64_tr_b16 v[90:91], v9 offset:45056
  v_mfma_f32_16x16x32_bf16 v[204:207], v[72:75], a[252:255], v[204:207]
  v_exp_f32 v42, v42
  v_mfma_f32_16x16x32_bf16 v[208:211], v[76:79], a[240:243], v[208:211]
  ds_read_b64_tr_b16 v[92:93], v9 offset:41984
  ds_read_b64_tr_b16 v[94:95], v9 offset:46080
  v_mfma_f32_16x16x32_bf16 v[212:215], v[76:79], a[244:247], v[212:215]
  v_exp_f32 v43, v43
  v_mfma_f32_16x16x32_bf16 v[216:219], v[76:79], a[248:251], v[216:219]
  v_mul_f32 v148, v132, v148
  v_mul_f32 v149, v133, v149
  v_mfma_f32_16x16x32_bf16 v[220:223], v[76:79], a[252:255], v[220:223]
  v_mul_f32 v150, v134, v150
  v_mul_f32 v151, v135, v151
  s_barrier
  s_waitcnt lgkmcnt(4)
  v_mfma_f32_16x16x32_bf16 v[192:195], v[80:83], v[224:227], v[192:195]
  v_add_u32 v10, 147456, v10
  v_add_f32 v40, 1.0, v40
  v_mfma_f32_16x16x32_bf16 v[196:199], v[80:83], v[228:231], v[196:199]
  ds_read_b64_tr_b16 v[72:73], v10 offset:0
  v_add_f32 v41, 1.0, v41
  v_mfma_f32_16x16x32_bf16 v[200:203], v[80:83], v[232:235], v[200:203]
  ds_read_b64_tr_b16 v[74:75], v10 offset:512
  v_add_f32 v42, 1.0, v42
  v_mfma_f32_16x16x32_bf16 v[204:207], v[80:83], v[236:239], v[204:207]
  ds_read_b64_tr_b16 v[76:77], v10 offset:1024
  v_add_f32 v43, 1.0, v43
  v_mfma_f32_16x16x32_bf16 v[208:211], v[84:87], v[224:227], v[208:211]
  v_rcp_f32 v40, v40
  v_mfma_f32_16x16x32_bf16 v[212:215], v[84:87], v[228:231], v[212:215]
  ds_read_b64_tr_b16 v[78:79], v10 offset:1536
  v_mfma_f32_16x16x32_bf16 v[216:219], v[84:87], v[232:235], v[216:219]
  v_rcp_f32 v41, v41
  v_mfma_f32_16x16x32_bf16 v[220:223], v[84:87], v[236:239], v[220:223]
  s_waitcnt lgkmcnt(4)
  v_rcp_f32 v42, v42
  v_mfma_f32_16x16x32_bf16 v[192:195], v[88:91], v[240:243], v[192:195]
  v_rcp_f32 v43, v43
  v_mfma_f32_16x16x32_bf16 v[196:199], v[88:91], v[244:247], v[196:199]
  ds_read_b64_tr_b16 v[80:81], v10 offset:2048
  v_mul_f32 v148, v148, v40
  v_mfma_f32_16x16x32_bf16 v[200:203], v[88:91], v[248:251], v[200:203]
  ds_read_b64_tr_b16 v[82:83], v10 offset:2560
  v_mul_f32 v149, v149, v41
  v_mfma_f32_16x16x32_bf16 v[204:207], v[88:91], v[252:255], v[204:207]
  ds_read_b64_tr_b16 v[84:85], v10 offset:3072
  v_mul_f32 v150, v150, v42
  v_mfma_f32_16x16x32_bf16 v[208:211], v[92:95], v[240:243], v[208:211]
  ds_read_b64_tr_b16 v[86:87], v10 offset:3584
  v_mul_f32 v151, v151, v43
  v_mfma_f32_16x16x32_bf16 v[212:215], v[92:95], v[244:247], v[212:215]
  v_cvt_pk_bf16_f32 v62, v148, v149
  v_cvt_pk_bf16_f32 v63, v150, v151
  v_mfma_f32_16x16x32_bf16 v[216:219], v[92:95], v[248:251], v[216:219]
  buffer_store_dwordx4 v[60:63], v14, s[16:19], s51 offen offset:2048 sc1
  v_mfma_f32_16x16x32_bf16 v[220:223], v[92:95], v[252:255], v[220:223]
  s_waitcnt lgkmcnt(4)
  v_mul_f32 v40, s46, v136
  v_mul_f32 v41, s46, v137
  v_mfma_f32_16x16x32_bf16 v[96:99], v[72:75], a[0:3], 0
  ds_read_b64_tr_b16 v[88:89], v10 offset:4096
  v_mul_f32 v42, s46, v138
  v_mfma_f32_16x16x32_bf16 v[100:103], v[72:75], a[4:7], 0
  ds_read_b64_tr_b16 v[90:91], v10 offset:4608
  v_mul_f32 v43, s46, v139
  v_mfma_f32_16x16x32_bf16 v[104:107], v[72:75], a[8:11], 0
  v_exp_f32 v40, v40
  v_mfma_f32_16x16x32_bf16 v[108:111], v[72:75], a[12:15], 0
  v_exp_f32 v41, v41
  v_mfma_f32_16x16x32_bf16 v[112:115], v[76:79], a[0:3], 0
  ds_read_b64_tr_b16 v[92:93], v10 offset:5120
  ds_read_b64_tr_b16 v[94:95], v10 offset:5632
  v_mfma_f32_16x16x32_bf16 v[116:119], v[76:79], a[4:7], 0
  v_exp_f32 v42, v42
  v_mfma_f32_16x16x32_bf16 v[120:123], v[76:79], a[8:11], 0
  v_exp_f32 v43, v43
  v_mfma_f32_16x16x32_bf16 v[124:127], v[76:79], a[12:15], 0
  s_waitcnt lgkmcnt(4)
  v_mul_f32 v152, v136, v152
  v_mul_f32 v153, v137, v153
  v_mfma_f32_16x16x32_bf16 v[96:99], v[80:83], a[16:19], v[96:99]
  ds_read_b64_tr_b16 v[72:73], v10 offset:6144
  v_mul_f32 v154, v138, v154
  v_mfma_f32_16x16x32_bf16 v[100:103], v[80:83], a[20:23], v[100:103]
  ds_read_b64_tr_b16 v[74:75], v10 offset:6656
  v_mul_f32 v155, v139, v155
  v_mfma_f32_16x16x32_bf16 v[104:107], v[80:83], a[24:27], v[104:107]
  ds_read_b64_tr_b16 v[76:77], v10 offset:7168
  v_add_f32 v40, 1.0, v40
  v_mfma_f32_16x16x32_bf16 v[108:111], v[80:83], a[28:31], v[108:111]
  ds_read_b64_tr_b16 v[78:79], v10 offset:7680
  v_add_f32 v41, 1.0, v41
  v_mfma_f32_16x16x32_bf16 v[112:115], v[84:87], a[16:19], v[112:115]
  v_add_f32 v42, 1.0, v42
  v_add_f32 v43, 1.0, v43
  v_mfma_f32_16x16x32_bf16 v[116:119], v[84:87], a[20:23], v[116:119]
  v_rcp_f32 v40, v40
  v_mfma_f32_16x16x32_bf16 v[120:123], v[84:87], a[24:27], v[120:123]
  v_rcp_f32 v41, v41
  v_mfma_f32_16x16x32_bf16 v[124:127], v[84:87], a[28:31], v[124:127]
  s_waitcnt lgkmcnt(4)
  v_rcp_f32 v42, v42
  s_getpc_b64 s[100:101]
.Lpf3:
  s_add_u32 s100, s100, gated_mix__spectral_fnet__swiglu_ffn__prompt_kernel_p2-.Lpf3
  s_addc_u32 s101, s101, 0
  v_min_u32 v37, gated_mix__spectral_fnet__swiglu_ffn__prompt_kernel_end-gated_mix__spectral_fnet__swiglu_ffn__prompt_kernel_p2-4, v39
  global_load_dword v38, v37, s[100:101]
  v_add_u32 v37, 32768, v39
  v_min_u32 v37, gated_mix__spectral_fnet__swiglu_ffn__prompt_kernel_end-gated_mix__spectral_fnet__swiglu_ffn__prompt_kernel_p2-4, v37
  global_load_dword v36, v37, s[100:101]
  v_mfma_f32_16x16x32_bf16 v[96:99], v[88:91], a[32:35], v[96:99]
  v_rcp_f32 v43, v43
  v_mfma_f32_16x16x32_bf16 v[100:103], v[88:91], a[36:39], v[100:103]
  ds_read_b64_tr_b16 v[80:81], v10 offset:8192
  v_mul_f32 v152, v152, v40
  v_mfma_f32_16x16x32_bf16 v[104:107], v[88:91], a[40:43], v[104:107]
  ds_read_b64_tr_b16 v[82:83], v10 offset:8704
  v_mul_f32 v153, v153, v41
  v_mfma_f32_16x16x32_bf16 v[108:111], v[88:91], a[44:47], v[108:111]
  ds_read_b64_tr_b16 v[84:85], v10 offset:9216
  v_mul_f32 v154, v154, v42
  v_mfma_f32_16x16x32_bf16 v[112:115], v[92:95], a[32:35], v[112:115]
  ds_read_b64_tr_b16 v[86:87], v10 offset:9728
  v_mul_f32 v155, v155, v43
  v_mfma_f32_16x16x32_bf16 v[116:119], v[92:95], a[36:39], v[116:119]
  v_cvt_pk_bf16_f32 v66, v152, v153
  v_cvt_pk_bf16_f32 v67, v154, v155
  v_mfma_f32_16x16x32_bf16 v[120:123], v[92:95], a[40:43], v[120:123]
  buffer_store_dwordx4 v[64:67], v14, s[16:19], s52 offen offset:2048 sc1
  v_mfma_f32_16x16x32_bf16 v[124:127], v[92:95], a[44:47], v[124:127]
  s_waitcnt lgkmcnt(4)
  v_mul_f32 v40, s46, v140
  v_mul_f32 v41, s46, v141
  v_mfma_f32_16x16x32_bf16 v[96:99], v[72:75], a[48:51], v[96:99]
  ds_read_b64_tr_b16 v[88:89], v10 offset:10240
  v_mul_f32 v42, s46, v142
  v_mfma_f32_16x16x32_bf16 v[100:103], v[72:75], a[52:55], v[100:103]
  ds_read_b64_tr_b16 v[90:91], v10 offset:10752
  v_mul_f32 v43, s46, v143
  v_mfma_f32_16x16x32_bf16 v[104:107], v[72:75], a[56:59], v[104:107]
  v_exp_f32 v40, v40
  v_mfma_f32_16x16x32_bf16 v[108:111], v[72:75], a[60:63], v[108:111]
  v_exp_f32 v41, v41
  v_mfma_f32_16x16x32_bf16 v[112:115], v[76:79], a[48:51], v[112:115]
  ds_read_b64_tr_b16 v[92:93], v10 offset:11264
  ds_read_b64_tr_b16 v[94:95], v10 offset:11776
  v_mfma_f32_16x16x32_bf16 v[116:119], v[76:79], a[52:55], v[116:119]
  v_exp_f32 v42, v42
  v_mfma_f32_16x16x32_bf16 v[120:123], v[76:79], a[56:59], v[120:123]
  v_exp_f32 v43, v43
  v_mfma_f32_16x16x32_bf16 v[124:127], v[76:79], a[60:63], v[124:127]
  s_waitcnt lgkmcnt(4)
  v_mul_f32 v156, v140, v156
  v_mul_f32 v157, v141, v157
  v_mfma_f32_16x16x32_bf16 v[96:99], v[80:83], a[64:67], v[96:99]
  ds_read_b64_tr_b16 v[72:73], v10 offset:12288
  v_mul_f32 v158, v142, v158
  v_mfma_f32_16x16x32_bf16 v[100:103], v[80:83], a[68:71], v[100:103]
  ds_read_b64_tr_b16 v[74:75], v10 offset:12800
  v_mul_f32 v159, v143, v159
  v_mfma_f32_16x16x32_bf16 v[104:107], v[80:83], a[72:75], v[104:107]
  ds_read_b64_tr_b16 v[76:77], v10 offset:13312
  v_add_f32 v40, 1.0, v40
  v_mfma_f32_16x16x32_bf16 v[108:111], v[80:83], a[76:79], v[108:111]
  ds_read_b64_tr_b16 v[78:79], v10 offset:13824
  v_add_f32 v41, 1.0, v41
  v_mfma_f32_16x16x32_bf16 v[112:115], v[84:87], a[64:67], v[112:115]
  v_add_f32 v42, 1.0, v42
  v_add_f32 v43, 1.0, v43
  v_mfma_f32_16x16x32_bf16 v[116:119], v[84:87], a[68:71], v[116:119]
  v_rcp_f32 v40, v40
  v_mfma_f32_16x16x32_bf16 v[120:123], v[84:87], a[72:75], v[120:123]
  v_rcp_f32 v41, v41
  v_mfma_f32_16x16x32_bf16 v[124:127], v[84:87], a[76:79], v[124:127]
  s_waitcnt lgkmcnt(4)
  v_rcp_f32 v42, v42
  v_mfma_f32_16x16x32_bf16 v[96:99], v[88:91], a[80:83], v[96:99]
  v_rcp_f32 v43, v43
  v_mfma_f32_16x16x32_bf16 v[100:103], v[88:91], a[84:87], v[100:103]
  ds_read_b64_tr_b16 v[80:81], v10 offset:14336
  v_mul_f32 v156, v156, v40
  v_mfma_f32_16x16x32_bf16 v[104:107], v[88:91], a[88:91], v[104:107]
  ds_read_b64_tr_b16 v[82:83], v10 offset:14848
  v_mul_f32 v157, v157, v41
  v_mfma_f32_16x16x32_bf16 v[108:111], v[88:91], a[92:95], v[108:111]
  ds_read_b64_tr_b16 v[84:85], v10 offset:15360
  v_mul_f32 v158, v158, v42
  v_mfma_f32_16x16x32_bf16 v[112:115], v[92:95], a[80:83], v[112:115]
  ds_read_b64_tr_b16 v[86:87], v10 offset:15872
  v_mul_f32 v159, v159, v43
  v_mfma_f32_16x16x32_bf16 v[116:119], v[92:95], a[84:87], v[116:119]
  v_cvt_pk_bf16_f32 v70, v156, v157
  v_cvt_pk_bf16_f32 v71, v158, v159
  v_mfma_f32_16x16x32_bf16 v[120:123], v[92:95], a[88:91], v[120:123]
  buffer_store_dwordx4 v[68:71], v14, s[16:19], s53 offen offset:2048 sc1
  v_mfma_f32_16x16x32_bf16 v[124:127], v[92:95], a[92:95], v[124:127]
  v_mul_f32 v40, s46, v160
  v_mul_f32 v41, s46, v161
  s_waitcnt vmcnt(6)
  s_barrier
  s_cmp_lg_u32 s40, 0
  s_cbranch_scc1 gated_mix__spectral_fnet__swiglu_ffn__prompt_kernel_l1_b
  v_mov_b32 v52, 1
  v_mov_b32 v53, 0
  s_mov_b64 exec, 1
  buffer_store_dword v52, v53, s[16:19], s38 offen offset:0 sc1
  s_mov_b64 exec, -1
gated_mix__spectral_fnet__swiglu_ffn__prompt_kernel_l1_b:
  s_waitcnt lgkmcnt(4)
  v_mfma_f32_16x16x32_bf16 v[96:99], v[72:75], a[96:99], v[96:99]
  v_subrev_u32 v10, 98304, v10
  v_mul_f32 v42, s46, v162
  v_mfma_f32_16x16x32_bf16 v[100:103], v[72:75], a[100:103], v[100:103]
  ds_read_b64_tr_b16 v[88:89], v10 offset:0
  v_mul_f32 v43, s46, v163
  v_mfma_f32_16x16x32_bf16 v[104:107], v[72:75], a[104:107], v[104:107]
  v_exp_f32 v40, v40
  v_mfma_f32_16x16x32_bf16 v[108:111], v[72:75], a[108:111], v[108:111]
  ds_read_b64_tr_b16 v[90:91], v10 offset:512
  ds_read_b64_tr_b16 v[92:93], v10 offset:1024
  v_mfma_f32_16x16x32_bf16 v[112:115], v[76:79], a[96:99], v[112:115]
  v_exp_f32 v41, v41
  v_mfma_f32_16x16x32_bf16 v[116:119], v[76:79], a[100:103], v[116:119]
  ds_read_b64_tr_b16 v[94:95], v10 offset:1536
  v_mfma_f32_16x16x32_bf16 v[120:123], v[76:79], a[104:107], v[120:123]
  v_exp_f32 v42, v42
  v_mfma_f32_16x16x32_bf16 v[124:127], v[76:79], a[108:111], v[124:127]
  s_waitcnt lgkmcnt(4)
  v_exp_f32 v43, v43
  v_mfma_f32_16x16x32_bf16 v[96:99], v[80:83], a[112:115], v[96:99]
  ds_read_b64_tr_b16 v[72:73], v10 offset:2048
  v_mul_f32 v176, v160, v176
  v_mfma_f32_16x16x32_bf16 v[100:103], v[80:83], a[116:119], v[100:103]
  ds_read_b64_tr_b16 v[74:75], v10 offset:2560
  v_mul_f32 v177, v161, v177
  v_mfma_f32_16x16x32_bf16 v[104:107], v[80:83], a[120:123], v[104:107]
  ds_read_b64_tr_b16 v[76:77], v10 offset:3072
  v_mul_f32 v178, v162, v178
  v_mfma_f32_16x16x32_bf16 v[108:111], v[80:83], a[124:127], v[108:111]
  ds_read_b64_tr_b16 v[78:79], v10 offset:3584
  v_mul_f32 v179, v163, v179
  v_mfma_f32_16x16x32_bf16 v[112:115], v[84:87], a[112:115], v[112:115]
  v_add_f32 v40, 1.0, v40
  v_add_f32 v41, 1.0, v41
  v_mfma_f32_16x16x32_bf16 v[116:119], v[84:87], a[116:119], v[116:119]
  v_add_f32 v42, 1.0, v42
  v_add_f32 v43, 1.0, v43
  v_mfma_f32_16x16x32_bf16 v[120:123], v[84:87], a[120:123], v[120:123]
  v_rcp_f32 v40, v40
  v_mfma_f32_16x16x32_bf16 v[124:127], v[84:87], a[124:127], v[124:127]
  s_waitcnt lgkmcnt(4)
  v_rcp_f32 v41, v41
  v_mfma_f32_16x16x32_bf16 v[96:99], v[88:91], a[128:131], v[96:99]
  v_rcp_f32 v42, v42
  v_mfma_f32_16x16x32_bf16 v[100:103], v[88:91], a[132:135], v[100:103]
  v_rcp_f32 v43, v43
  v_mfma_f32_16x16x32_bf16 v[104:107], v[88:91], a[136:139], v[104:107]
  ds_read_b64_tr_b16 v[80:81], v10 offset:4096
  v_mul_f32 v176, v176, v40
  v_mfma_f32_16x16x32_bf16 v[108:111], v[88:91], a[140:143], v[108:111]
  ds_read_b64_tr_b16 v[82:83], v10 offset:4608
  v_mul_f32 v177, v177, v41
  v_mfma_f32_16x16x32_bf16 v[112:115], v[92:95], a[128:131], v[112:115]
  ds_read_b64_tr_b16 v[84:85], v10 offset:5120
  v_mul_f32 v178, v178, v42
  v_mfma_f32_16x16x32_bf16 v[116:119], v[92:95], a[132:135], v[116:119]
  ds_read_b64_tr_b16 v[86:87], v10 offset:5632
  v_mul_f32 v179, v179, v43
  v_mfma_f32_16x16x32_bf16 v[120:123], v[92:95], a[136:139], v[120:123]
  v_cvt_pk_bf16_f32 v56, v176, v177
  v_cvt_pk_bf16_f32 v57, v178, v179
  v_mfma_f32_16x16x32_bf16 v[124:127], v[92:95], a[140:143], v[124:127]
  s_waitcnt lgkmcnt(4)
  v_mul_f32 v40, s46, v164
  v_mul_f32 v41, s46, v165
  v_mfma_f32_16x16x32_bf16 v[96:99], v[72:75], a[144:147], v[96:99]
  ds_read_b64_tr_b16 v[88:89], v10 offset:6144
  v_mul_f32 v42, s46, v166
  v_mfma_f32_16x16x32_bf16 v[100:103], v[72:75], a[148:151], v[100:103]
  ds_read_b64_tr_b16 v[90:91], v10 offset:6656
  v_mul_f32 v43, s46, v167
  v_mfma_f32_16x16x32_bf16 v[104:107], v[72:75], a[152:155], v[104:107]
  v_exp_f32 v40, v40
  v_mfma_f32_16x16x32_bf16 v[108:111], v[72:75], a[156:159], v[108:111]
  v_exp_f32 v41, v41
  v_mfma_f32_16x16x32_bf16 v[112:115], v[76:79], a[144:147], v[112:115]
  ds_read_b64_tr_b16 v[92:93], v10 offset:7168
  ds_read_b64_tr_b16 v[94:95], v10 offset:7680
  v_mfma_f32_16x16x32_bf16 v[116:119], v[76:79], a[148:151], v[116:119]
  v_exp_f32 v42, v42
  v_mfma_f32_16x16x32_bf16 v[120:123], v[76:79], a[152:155], v[120:123]
  v_exp_f32 v43, v43
  v_mfma_f32_16x16x32_bf16 v[124:127], v[76:79], a[156:159], v[124:127]
  s_waitcnt lgkmcnt(4)
  v_mul_f32 v180, v164, v180
  v_mul_f32 v181, v165, v181
  v_mfma_f32_16x16x32_bf16 v[96:99], v[80:83], a[160:163], v[96:99]
  ds_read_b64_tr_b16 v[72:73], v10 offset:8192
  v_mul_f32 v182, v166, v182
  v_mfma_f32_16x16x32_bf16 v[100:103], v[80:83], a[164:167], v[100:103]
  ds_read_b64_tr_b16 v[74:75], v10 offset:8704
  v_mul_f32 v183, v167, v183
  v_mfma_f32_16x16x32_bf16 v[104:107], v[80:83], a[168:171], v[104:107]
  ds_read_b64_tr_b16 v[76:77], v10 offset:9216
  v_add_f32 v40, 1.0, v40
  v_mfma_f32_16x16x32_bf16 v[108:111], v[80:83], a[172:175], v[108:111]
  ds_read_b64_tr_b16 v[78:79], v10 offset:9728
  v_add_f32 v41, 1.0, v41
  v_mfma_f32_16x16x32_bf16 v[112:115], v[84:87], a[160:163], v[112:115]
  v_add_f32 v42, 1.0, v42
  v_add_f32 v43, 1.0, v43
  v_mfma_f32_16x16x32_bf16 v[116:119], v[84:87], a[164:167], v[116:119]
  v_rcp_f32 v40, v40
  v_mfma_f32_16x16x32_bf16 v[120:123], v[84:87], a[168:171], v[120:123]
  v_rcp_f32 v41, v41
  v_mfma_f32_16x16x32_bf16 v[124:127], v[84:87], a[172:175], v[124:127]
  s_waitcnt lgkmcnt(4)
  v_rcp_f32 v42, v42
  v_mfma_f32_16x16x32_bf16 v[96:99], v[88:91], a[176:179], v[96:99]
  v_rcp_f32 v43, v43
  v_mfma_f32_16x16x32_bf16 v[100:103], v[88:91], a[180:183], v[100:103]
  ds_read_b64_tr_b16 v[80:81], v10 offset:10240
  v_mul_f32 v180, v180, v40
  v_mfma_f32_16x16x32_bf16 v[104:107], v[88:91], a[184:187], v[104:107]
  ds_read_b64_tr_b16 v[82:83], v10 offset:10752
  v_mul_f32 v181, v181, v41
  v_mfma_f32_16x16x32_bf16 v[108:111], v[88:91], a[188:191], v[108:111]
  ds_read_b64_tr_b16 v[84:85], v10 offset:11264
  v_mul_f32 v182, v182, v42
  v_mfma_f32_16x16x32_bf16 v[112:115], v[92:95], a[176:179], v[112:115]
  ds_read_b64_tr_b16 v[86:87], v10 offset:11776
  v_mul_f32 v183, v183, v43
  v_mfma_f32_16x16x32_bf16 v[116:119], v[92:95], a[180:183], v[116:119]
  v_cvt_pk_bf16_f32 v60, v180, v181
  v_cvt_pk_bf16_f32 v61, v182, v183
  v_mfma_f32_16x16x32_bf16 v[120:123], v[92:95], a[184:187], v[120:123]
  v_mul_f32 v40, s46, v168
  v_mul_f32 v41, s46, v169
  v_mfma_f32_16x16x32_bf16 v[124:127], v[92:95], a[188:191], v[124:127]
  s_waitcnt lgkmcnt(4)
  v_mul_f32 v42, s46, v170
  v_mul_f32 v43, s46, v171
  v_mfma_f32_16x16x32_bf16 v[96:99], v[72:75], a[192:195], v[96:99]
  s_lshr_b32 s39, s2, 3
  v_exp_f32 v40, v40
  v_mfma_f32_16x16x32_bf16 v[100:103], v[72:75], a[196:199], v[100:103]
  s_mul_i32 s39, s39, 43
  v_exp_f32 v41, v41
  v_mfma_f32_16x16x32_bf16 v[104:107], v[72:75], a[200:203], v[104:107]
  s_lshr_b32 s39, s39, 8
  ds_read_b64_tr_b16 v[88:89], v10 offset:12288
  s_and_b32 s39, s39, 3
  v_mfma_f32_16x16x32_bf16 v[108:111], v[72:75], a[204:207], v[108:111]
  s_lshl_b32 s39, s39, 6
  ds_read_b64_tr_b16 v[90:91], v10 offset:12800
  s_add_u32 s39, s39, s68
  v_mfma_f32_16x16x32_bf16 v[112:115], v[76:79], a[192:195], v[112:115]
  ds_read_b64_tr_b16 v[92:93], v10 offset:13312
  v_and_b32 v33, 7, v0
  v_mfma_f32_16x16x32_bf16 v[116:119], v[76:79], a[196:199], v[116:119]
  ds_read_b64_tr_b16 v[94:95], v10 offset:13824
  v_lshlrev_b32 v33, 3, v33
  v_mfma_f32_16x16x32_bf16 v[120:123], v[76:79], a[200:203], v[120:123]
  v_exp_f32 v42, v42
  v_mfma_f32_16x16x32_bf16 v[124:127], v[76:79], a[204:207], v[124:127]
  s_waitcnt lgkmcnt(4)
  v_exp_f32 v43, v43
  v_mfma_f32_16x16x32_bf16 v[96:99], v[80:83], a[208:211], v[96:99]
  ds_read_b64_tr_b16 v[72:73], v10 offset:14336
  v_add_u32 v33, s39, v33
  v_mfma_f32_16x16x32_bf16 v[100:103], v[80:83], a[212:215], v[100:103]
  ds_read_b64_tr_b16 v[74:75], v10 offset:14848
  v_lshlrev_b32 v33, 7, v33
  v_mfma_f32_16x16x32_bf16 v[104:107], v[80:83], a[216:219], v[104:107]
  s_mov_b32 s39, 33300480
  buffer_load_dword v35, v33, s[16:19], s39 offen sc1
  v_mfma_f32_16x16x32_bf16 v[108:111], v[80:83], a[220:223], v[108:111]
  ds_read_b64_tr_b16 v[76:77], v10 offset:15360
  v_mul_f32 v184, v168, v184
  v_mfma_f32_16x16x32_bf16 v[112:115], v[84:87], a[208:211], v[112:115]
  ds_read_b64_tr_b16 v[78:79], v10 offset:15872
  v_mul_f32 v185, v169, v185
  v_mfma_f32_16x16x32_bf16 v[116:119], v[84:87], a[212:215], v[116:119]
  v_mul_f32 v186, v170, v186
  v_mul_f32 v187, v171, v187
  v_mfma_f32_16x16x32_bf16 v[120:123], v[84:87], a[216:219], v[120:123]
  v_add_f32 v40, 1.0, v40
  v_add_f32 v41, 1.0, v41
  v_mfma_f32_16x16x32_bf16 v[124:127], v[84:87], a[220:223], v[124:127]
  s_waitcnt lgkmcnt(4)
  v_add_f32 v42, 1.0, v42
  v_add_f32 v43, 1.0, v43
  v_mfma_f32_16x16x32_bf16 v[96:99], v[88:91], a[224:227], v[96:99]
  v_rcp_f32 v40, v40
  v_mfma_f32_16x16x32_bf16 v[100:103], v[88:91], a[228:231], v[100:103]
  v_rcp_f32 v41, v41
  v_mfma_f32_16x16x32_bf16 v[104:107], v[88:91], a[232:235], v[104:107]
  ds_read_b64_tr_b16 v[80:81], v10 offset:16384
  ds_read_b64_tr_b16 v[82:83], v10 offset:16896
  v_mfma_f32_16x16x32_bf16 v[108:111], v[88:91], a[236:239], v[108:111]
  v_rcp_f32 v42, v42
  v_mfma_f32_16x16x32_bf16 v[112:115], v[92:95], a[224:227], v[112:115]
  ds_read_b64_tr_b16 v[84:85], v10 offset:17408
  ds_read_b64_tr_b16 v[86:87], v10 offset:17920
  v_mfma_f32_16x16x32_bf16 v[116:119], v[92:95], a[228:231], v[116:119]
  v_rcp_f32 v43, v43
  v_mfma_f32_16x16x32_bf16 v[120:123], v[92:95], a[232:235], v[120:123]
  v_mul_f32 v184, v184, v40
  v_mul_f32 v185, v185, v41
  v_mfma_f32_16x16x32_bf16 v[124:127], v[92:95], a[236:239], v[124:127]
  s_waitcnt lgkmcnt(4)
  v_mul_f32 v186, v186, v42
  v_mul_f32 v187, v187, v43
  v_mfma_f32_16x16x32_bf16 v[96:99], v[72:75], a[240:243], v[96:99]
  ds_read_b64_tr_b16 v[88:89], v10 offset:18432
  v_cvt_pk_bf16_f32 v64, v184, v185
  v_mfma_f32_16x16x32_bf16 v[100:103], v[72:75], a[244:247], v[100:103]
  ds_read_b64_tr_b16 v[90:91], v10 offset:18944
  v_cvt_pk_bf16_f32 v65, v186, v187
  v_mfma_f32_16x16x32_bf16 v[104:107], v[72:75], a[248:251], v[104:107]
  ds_read_b64_tr_b16 v[92:93], v10 offset:19456
  v_mul_f32 v40, s46, v172
  v_mfma_f32_16x16x32_bf16 v[108:111], v[72:75], a[252:255], v[108:111]
  ds_read_b64_tr_b16 v[94:95], v10 offset:19968
  v_mul_f32 v41, s46, v173
  v_mfma_f32_16x16x32_bf16 v[112:115], v[76:79], a[240:243], v[112:115]
  v_mul_f32 v42, s46, v174
  v_mul_f32 v43, s46, v175
  v_mfma_f32_16x16x32_bf16 v[116:119], v[76:79], a[244:247], v[116:119]
  v_exp_f32 v40, v40
  v_mfma_f32_16x16x32_bf16 v[120:123], v[76:79], a[248:251], v[120:123]
  v_exp_f32 v41, v41
  v_mfma_f32_16x16x32_bf16 v[124:127], v[76:79], a[252:255], v[124:127]
  s_waitcnt lgkmcnt(4)
  v_exp_f32 v42, v42
  v_mfma_f32_16x16x32_bf16 v[96:99], v[80:83], v[224:227], v[96:99]
  v_exp_f32 v43, v43
  v_mfma_f32_16x16x32_bf16 v[100:103], v[80:83], v[228:231], v[100:103]
  v_mul_f32 v188, v172, v188
  v_mul_f32 v189, v173, v189
  v_mfma_f32_16x16x32_bf16 v[104:107], v[80:83], v[232:235], v[104:107]
  v_mul_f32 v190, v174, v190
  v_mul_f32 v191, v175, v191
  v_mfma_f32_16x16x32_bf16 v[108:111], v[80:83], v[236:239], v[108:111]
  v_add_f32 v40, 1.0, v40
  v_add_f32 v41, 1.0, v41
  v_mfma_f32_16x16x32_bf16 v[112:115], v[84:87], v[224:227], v[112:115]
  v_add_f32 v42, 1.0, v42
  v_add_f32 v43, 1.0, v43
  v_mfma_f32_16x16x32_bf16 v[116:119], v[84:87], v[228:231], v[116:119]
  v_rcp_f32 v40, v40
  v_mfma_f32_16x16x32_bf16 v[120:123], v[84:87], v[232:235], v[120:123]
  v_rcp_f32 v41, v41
  v_mfma_f32_16x16x32_bf16 v[124:127], v[84:87], v[236:239], v[124:127]
  s_waitcnt lgkmcnt(0)
  v_rcp_f32 v42, v42
  v_mfma_f32_16x16x32_bf16 v[96:99], v[88:91], v[240:243], v[96:99]
  v_rcp_f32 v43, v43
  v_mfma_f32_16x16x32_bf16 v[100:103], v[88:91], v[244:247], v[100:103]
  v_mul_f32 v188, v188, v40
  v_mul_f32 v189, v189, v41
  v_mfma_f32_16x16x32_bf16 v[104:107], v[88:91], v[248:251], v[104:107]
  v_mul_f32 v190, v190, v42
  v_mul_f32 v191, v191, v43
  v_mfma_f32_16x16x32_bf16 v[108:111], v[88:91], v[252:255], v[108:111]
  v_cvt_pk_bf16_f32 v68, v188, v189
  v_cvt_pk_bf16_f32 v69, v190, v191
  v_mfma_f32_16x16x32_bf16 v[112:115], v[92:95], v[240:243], v[112:115]
  v_mul_f32 v40, s46, v192
  v_mul_f32 v41, s46, v193
  v_mfma_f32_16x16x32_bf16 v[116:119], v[92:95], v[244:247], v[116:119]
  v_mul_f32 v42, s46, v194
  v_mul_f32 v43, s46, v195
  v_mfma_f32_16x16x32_bf16 v[120:123], v[92:95], v[248:251], v[120:123]
  v_exp_f32 v40, v40
  v_mfma_f32_16x16x32_bf16 v[124:127], v[92:95], v[252:255], v[124:127]
  v_exp_f32 v41, v41
  v_exp_f32 v42, v42
  v_exp_f32 v43, v43
  v_mul_f32 v208, v192, v208
  v_mul_f32 v209, v193, v209
  v_mul_f32 v210, v194, v210
  v_mul_f32 v211, v195, v211
  v_add_f32 v40, 1.0, v40
  v_add_f32 v41, 1.0, v41
  v_add_f32 v42, 1.0, v42
  v_add_f32 v43, 1.0, v43
  v_rcp_f32 v40, v40
  v_rcp_f32 v41, v41
  v_rcp_f32 v42, v42
  v_rcp_f32 v43, v43
  v_mul_f32 v208, v208, v40
  v_mul_f32 v209, v209, v41
  v_mul_f32 v210, v210, v42
  v_mul_f32 v211, v211, v43
  v_cvt_pk_bf16_f32 v58, v208, v209
  v_cvt_pk_bf16_f32 v59, v210, v211
  buffer_store_dwordx4 v[56:59], v14, s[16:19], s50 offen offset:3072 sc1
  v_mul_f32 v40, s46, v196
  v_mul_f32 v41, s46, v197
  v_mul_f32 v42, s46, v198
  v_mul_f32 v43, s46, v199
  v_exp_f32 v40, v40
  v_exp_f32 v41, v41
  v_exp_f32 v42, v42
  v_exp_f32 v43, v43
  v_mul_f32 v212, v196, v212
  v_mul_f32 v213, v197, v213
  v_mul_f32 v214, v198, v214
  v_mul_f32 v215, v199, v215
  v_add_f32 v40, 1.0, v40
  v_add_f32 v41, 1.0, v41
  v_add_f32 v42, 1.0, v42
  v_add_f32 v43, 1.0, v43
  v_rcp_f32 v40, v40
  v_rcp_f32 v41, v41
  v_rcp_f32 v42, v42
  v_rcp_f32 v43, v43
  v_mul_f32 v212, v212, v40
  v_mul_f32 v213, v213, v41
  v_mul_f32 v214, v214, v42
  v_mul_f32 v215, v215, v43
  v_cvt_pk_bf16_f32 v62, v212, v213
  v_cvt_pk_bf16_f32 v63, v214, v215
  buffer_store_dwordx4 v[60:63], v14, s[16:19], s51 offen offset:3072 sc1
  v_mul_f32 v40, s46, v200
  v_mul_f32 v41, s46, v201
  v_mul_f32 v42, s46, v202
  v_mul_f32 v43, s46, v203
  v_exp_f32 v40, v40
  v_exp_f32 v41, v41
  v_exp_f32 v42, v42
  v_exp_f32 v43, v43
  v_mul_f32 v216, v200, v216
  v_mul_f32 v217, v201, v217
  v_mul_f32 v218, v202, v218
  v_mul_f32 v219, v203, v219
  v_add_f32 v40, 1.0, v40
  v_add_f32 v41, 1.0, v41
  v_add_f32 v42, 1.0, v42
  v_add_f32 v43, 1.0, v43
  v_rcp_f32 v40, v40
  v_rcp_f32 v41, v41
  v_rcp_f32 v42, v42
  v_rcp_f32 v43, v43
  v_mul_f32 v216, v216, v40
  v_mul_f32 v217, v217, v41
  v_mul_f32 v218, v218, v42
  v_mul_f32 v219, v219, v43
  v_cvt_pk_bf16_f32 v66, v216, v217
  v_cvt_pk_bf16_f32 v67, v218, v219
  buffer_store_dwordx4 v[64:67], v14, s[16:19], s52 offen offset:3072 sc1
  v_mul_f32 v40, s46, v204
  v_mul_f32 v41, s46, v205
  v_mul_f32 v42, s46, v206
  v_mul_f32 v43, s46, v207
  v_exp_f32 v40, v40
  v_exp_f32 v41, v41
  v_exp_f32 v42, v42
  v_exp_f32 v43, v43
  v_mul_f32 v220, v204, v220
  v_mul_f32 v221, v205, v221
  v_mul_f32 v222, v206, v222
  v_mul_f32 v223, v207, v223
  v_add_f32 v40, 1.0, v40
  v_add_f32 v41, 1.0, v41
  v_add_f32 v42, 1.0, v42
  v_add_f32 v43, 1.0, v43
  v_rcp_f32 v40, v40
  v_rcp_f32 v41, v41
  v_rcp_f32 v42, v42
  v_rcp_f32 v43, v43
  v_mul_f32 v220, v220, v40
  v_mul_f32 v221, v221, v41
  v_mul_f32 v222, v222, v42
  v_mul_f32 v223, v223, v43
  v_cvt_pk_bf16_f32 v70, v220, v221
  v_cvt_pk_bf16_f32 v71, v222, v223
  buffer_store_dwordx4 v[68:71], v14, s[16:19], s53 offen offset:3072 sc1
  v_mul_f32 v40, s46, v96
  v_mul_f32 v41, s46, v97
  v_mul_f32 v42, s46, v98
  v_mul_f32 v43, s46, v99
  v_exp_f32 v40, v40
  v_exp_f32 v41, v41
  v_exp_f32 v42, v42
  v_exp_f32 v43, v43
  v_mul_f32 v112, v96, v112
  v_mul_f32 v113, v97, v113
  v_mul_f32 v114, v98, v114
  v_mul_f32 v115, v99, v115
  v_add_f32 v40, 1.0, v40
  v_add_f32 v41, 1.0, v41
  v_add_f32 v42, 1.0, v42
  v_add_f32 v43, 1.0, v43
  v_rcp_f32 v40, v40
  v_rcp_f32 v41, v41
  v_rcp_f32 v42, v42
  v_rcp_f32 v43, v43
  v_mul_f32 v112, v112, v40
  v_mul_f32 v113, v113, v41
  v_mul_f32 v114, v114, v42
  v_mul_f32 v115, v115, v43
  v_cvt_pk_bf16_f32 v56, v112, v113
  v_cvt_pk_bf16_f32 v57, v114, v115
  v_mul_f32 v40, s46, v100
  v_mul_f32 v41, s46, v101
  v_mul_f32 v42, s46, v102
  v_mul_f32 v43, s46, v103
  v_exp_f32 v40, v40
  v_exp_f32 v41, v41
  v_exp_f32 v42, v42
  v_exp_f32 v43, v43
  v_mul_f32 v116, v100, v116
  v_mul_f32 v117, v101, v117
  v_mul_f32 v118, v102, v118
  v_mul_f32 v119, v103, v119
  v_add_f32 v40, 1.0, v40
  v_add_f32 v41, 1.0, v41
  v_add_f32 v42, 1.0, v42
  v_add_f32 v43, 1.0, v43
  v_rcp_f32 v40, v40
  v_rcp_f32 v41, v41
  v_rcp_f32 v42, v42
  v_rcp_f32 v43, v43
  v_mul_f32 v116, v116, v40
  v_mul_f32 v117, v117, v41
  v_mul_f32 v118, v118, v42
  v_mul_f32 v119, v119, v43
  v_cvt_pk_bf16_f32 v60, v116, v117
  v_cvt_pk_bf16_f32 v61, v118, v119
  v_mul_f32 v40, s46, v104
  v_mul_f32 v41, s46, v105
  v_mul_f32 v42, s46, v106
  v_mul_f32 v43, s46, v107
  v_exp_f32 v40, v40
  v_exp_f32 v41, v41
  v_exp_f32 v42, v42
  v_exp_f32 v43, v43
  v_mul_f32 v120, v104, v120
  v_mul_f32 v121, v105, v121
  v_mul_f32 v122, v106, v122
  v_mul_f32 v123, v107, v123
  v_add_f32 v40, 1.0, v40
  v_add_f32 v41, 1.0, v41
  v_add_f32 v42, 1.0, v42
  v_add_f32 v43, 1.0, v43
  v_rcp_f32 v40, v40
  v_rcp_f32 v41, v41
  v_rcp_f32 v42, v42
  v_rcp_f32 v43, v43
  v_mul_f32 v120, v120, v40
  v_mul_f32 v121, v121, v41
  v_mul_f32 v122, v122, v42
  v_mul_f32 v123, v123, v43
  v_cvt_pk_bf16_f32 v64, v120, v121
  v_cvt_pk_bf16_f32 v65, v122, v123
  v_mul_f32 v40, s46, v108
  v_mul_f32 v41, s46, v109
  v_mul_f32 v42, s46, v110
  v_mul_f32 v43, s46, v111
  v_exp_f32 v40, v40
  v_exp_f32 v41, v41
  v_exp_f32 v42, v42
  v_exp_f32 v43, v43
  v_mul_f32 v124, v108, v124
  v_mul_f32 v125, v109, v125
  v_mul_f32 v126, v110, v126
  v_mul_f32 v127, v111, v127
  v_add_f32 v40, 1.0, v40
  v_add_f32 v41, 1.0, v41
  v_add_f32 v42, 1.0, v42
  v_add_f32 v43, 1.0, v43
  v_rcp_f32 v40, v40
  v_rcp_f32 v41, v41
  v_rcp_f32 v42, v42
  v_rcp_f32 v43, v43
  v_mul_f32 v124, v124, v40
  v_mul_f32 v125, v125, v41
  v_mul_f32 v126, v126, v42
  v_mul_f32 v127, v127, v43
  v_cvt_pk_bf16_f32 v68, v124, v125
  v_cvt_pk_bf16_f32 v69, v126, v127
  s_waitcnt vmcnt(4)
  v_cmp_eq_u32 vcc, 1, v35
  v_readfirstlane_b32 s36, v34
  s_nop 3
  s_cmp_eq_u64 vcc, -1
  s_cselect_b32 s37, 1, 0
  s_cmp_ge_u32 s36, 256
  s_cselect_b32 s36, 1, 0
  s_and_b32 s37, s37, s36
  s_mov_b32 s24, s54
  s_mov_b32 s25, s55
  s_mov_b32 s26, s56
  s_mov_b32 s27, s57
  v_mov_b32 v55, v15
  s_cmp_lg_u32 s42, 31
  s_cbranch_scc1 gated_mix__spectral_fnet__swiglu_ffn__prompt_kernel_nogate
  s_load_dwordx2 s[28:29], s[0:1], 72
  s_waitcnt lgkmcnt(0)
  s_mov_b32 s30, 1152
  s_mov_b32 s31, 0x20000
  v_lshrrev_b32 v26, 4, v0
  v_lshlrev_b32 v26, 4, v26
  s_bfe_u32 s63, s59, 0x40000
  s_lshl_b32 s63, s63, 7
  buffer_load_dwordx4 v[128:131], v26, s[28:31], s63 offen offset:0
  buffer_load_dwordx4 v[132:135], v26, s[28:31], s63 offen offset:64
  s_bfe_u32 s63, s59, 0x40004
  s_lshl_b32 s63, s63, 7
  buffer_load_dwordx4 v[136:139], v26, s[28:31], s63 offen offset:0
  buffer_load_dwordx4 v[140:143], v26, s[28:31], s63 offen offset:64
  s_bfe_u32 s63, s59, 0x40008
  s_lshl_b32 s63, s63, 7
  buffer_load_dwordx4 v[144:147], v26, s[28:31], s63 offen offset:0
  buffer_load_dwordx4 v[148:151], v26, s[28:31], s63 offen offset:64
  s_bfe_u32 s63, s59, 0x4000c
  s_lshl_b32 s63, s63, 7
  buffer_load_dwordx4 v[152:155], v26, s[28:31], s63 offen offset:0
  buffer_load_dwordx4 v[156:159], v26, s[28:31], s63 offen offset:64
  s_bfe_u32 s63, s59, 0x40010
  s_lshl_b32 s63, s63, 7
  buffer_load_dwordx4 v[160:163], v26, s[28:31], s63 offen offset:0
  buffer_load_dwordx4 v[164:167], v26, s[28:31], s63 offen offset:64
  s_bfe_u32 s63, s59, 0x40014
  s_lshl_b32 s63, s63, 7
  buffer_load_dwordx4 v[168:171], v26, s[28:31], s63 offen offset:0
  buffer_load_dwordx4 v[172:175], v26, s[28:31], s63 offen offset:64
  s_bfe_u32 s63, s59, 0x40018
  s_lshl_b32 s63, s63, 7
  buffer_load_dwordx4 v[176:179], v26, s[28:31], s63 offen offset:0
  buffer_load_dwordx4 v[180:183], v26, s[28:31], s63 offen offset:64
  s_bfe_u32 s63, s59, 0x4001c
  s_lshl_b32 s63, s63, 7
  buffer_load_dwordx4 v[184:187], v26, s[28:31], s63 offen offset:0
  buffer_load_dwordx4 v[188:191], v26, s[28:31], s63 offen offset:64
  s_mov_b32 s63, s3
  s_lshl_b32 s63, s63, 7
  buffer_load_dwordx4 v[192:195], v26, s[28:31], s63 offen offset:0
  buffer_load_dwordx4 v[196:199], v26, s[28:31], s63 offen offset:64
  s_waitcnt vmcnt(17)
  v_mfma_f32_16x16x32_bf16 v[96:99], v[128:131], a[0:3], 0
  v_mfma_f32_16x16x32_bf16 v[100:103], v[128:131], a[4:7], 0
  v_mfma_f32_16x16x32_bf16 v[104:107], v[128:131], a[8:11], 0
  v_mfma_f32_16x16x32_bf16 v[108:111], v[128:131], a[12:15], 0
  s_waitcnt vmcnt(16)
  v_mfma_f32_16x16x32_bf16 v[96:99], v[132:135], a[16:19], v[96:99]
  v_mfma_f32_16x16x32_bf16 v[100:103], v[132:135], a[20:23], v[100:103]
  v_mfma_f32_16x16x32_bf16 v[104:107], v[132:135], a[24:27], v[104:107]
  v_mfma_f32_16x16x32_bf16 v[108:111], v[132:135], a[28:31], v[108:111]
  s_waitcnt vmcnt(15)
  v_mfma_f32_16x16x32_bf16 v[96:99], v[136:139], a[32:35], v[96:99]
  v_mfma_f32_16x16x32_bf16 v[100:103], v[136:139], a[36:39], v[100:103]
  v_mfma_f32_16x16x32_bf16 v[104:107], v[136:139], a[40:43], v[104:107]
  v_mfma_f32_16x16x32_bf16 v[108:111], v[136:139], a[44:47], v[108:111]
  s_waitcnt vmcnt(14)
  v_mfma_f32_16x16x32_bf16 v[96:99], v[140:143], a[48:51], v[96:99]
  v_mfma_f32_16x16x32_bf16 v[100:103], v[140:143], a[52:55], v[100:103]
  v_mfma_f32_16x16x32_bf16 v[104:107], v[140:143], a[56:59], v[104:107]
  v_mfma_f32_16x16x32_bf16 v[108:111], v[140:143], a[60:63], v[108:111]
  s_waitcnt vmcnt(13)
  v_mfma_f32_16x16x32_bf16 v[96:99], v[144:147], a[64:67], v[96:99]
  v_mfma_f32_16x16x32_bf16 v[100:103], v[144:147], a[68:71], v[100:103]
  v_mfma_f32_16x16x32_bf16 v[104:107], v[144:147], a[72:75], v[104:107]
  v_mfma_f32_16x16x32_bf16 v[108:111], v[144:147], a[76:79], v[108:111]
  s_waitcnt vmcnt(12)
  v_mfma_f32_16x16x32_bf16 v[96:99], v[148:151], a[80:83], v[96:99]
  v_mfma_f32_16x16x32_bf16 v[100:103], v[148:151], a[84:87], v[100:103]
  v_mfma_f32_16x16x32_bf16 v[104:107], v[148:151], a[88:91], v[104:107]
  v_mfma_f32_16x16x32_bf16 v[108:111], v[148:151], a[92:95], v[108:111]
  s_waitcnt vmcnt(11)
  v_mfma_f32_16x16x32_bf16 v[96:99], v[152:155], a[96:99], v[96:99]
  v_mfma_f32_16x16x32_bf16 v[100:103], v[152:155], a[100:103], v[100:103]
  v_mfma_f32_16x16x32_bf16 v[104:107], v[152:155], a[104:107], v[104:107]
  v_mfma_f32_16x16x32_bf16 v[108:111], v[152:155], a[108:111], v[108:111]
  s_waitcnt vmcnt(10)
  v_mfma_f32_16x16x32_bf16 v[96:99], v[156:159], a[112:115], v[96:99]
  v_mfma_f32_16x16x32_bf16 v[100:103], v[156:159], a[116:119], v[100:103]
  v_mfma_f32_16x16x32_bf16 v[104:107], v[156:159], a[120:123], v[104:107]
  v_mfma_f32_16x16x32_bf16 v[108:111], v[156:159], a[124:127], v[108:111]
  s_waitcnt vmcnt(9)
  v_mfma_f32_16x16x32_bf16 v[96:99], v[160:163], a[128:131], v[96:99]
  v_mfma_f32_16x16x32_bf16 v[100:103], v[160:163], a[132:135], v[100:103]
  v_mfma_f32_16x16x32_bf16 v[104:107], v[160:163], a[136:139], v[104:107]
  v_mfma_f32_16x16x32_bf16 v[108:111], v[160:163], a[140:143], v[108:111]
  s_waitcnt vmcnt(8)
  v_mfma_f32_16x16x32_bf16 v[96:99], v[164:167], a[144:147], v[96:99]
  v_mfma_f32_16x16x32_bf16 v[100:103], v[164:167], a[148:151], v[100:103]
  v_mfma_f32_16x16x32_bf16 v[104:107], v[164:167], a[152:155], v[104:107]
  v_mfma_f32_16x16x32_bf16 v[108:111], v[164:167], a[156:159], v[108:111]
  s_waitcnt vmcnt(7)
  v_mfma_f32_16x16x32_bf16 v[96:99], v[168:171], a[160:163], v[96:99]
  v_mfma_f32_16x16x32_bf16 v[100:103], v[168:171], a[164:167], v[100:103]
  v_mfma_f32_16x16x32_bf16 v[104:107], v[168:171], a[168:171], v[104:107]
  v_mfma_f32_16x16x32_bf16 v[108:111], v[168:171], a[172:175], v[108:111]
  s_waitcnt vmcnt(6)
  v_mfma_f32_16x16x32_bf16 v[96:99], v[172:175], a[176:179], v[96:99]
  v_mfma_f32_16x16x32_bf16 v[100:103], v[172:175], a[180:183], v[100:103]
  v_mfma_f32_16x16x32_bf16 v[104:107], v[172:175], a[184:187], v[104:107]
  v_mfma_f32_16x16x32_bf16 v[108:111], v[172:175], a[188:191], v[108:111]
  s_waitcnt vmcnt(5)
  v_mfma_f32_16x16x32_bf16 v[96:99], v[176:179], a[192:195], v[96:99]
  v_mfma_f32_16x16x32_bf16 v[100:103], v[176:179], a[196:199], v[100:103]
  v_mfma_f32_16x16x32_bf16 v[104:107], v[176:179], a[200:203], v[104:107]
  v_mfma_f32_16x16x32_bf16 v[108:111], v[176:179], a[204:207], v[108:111]
  s_waitcnt vmcnt(4)
  v_mfma_f32_16x16x32_bf16 v[96:99], v[180:183], a[208:211], v[96:99]
  v_mfma_f32_16x16x32_bf16 v[100:103], v[180:183], a[212:215], v[100:103]
  v_mfma_f32_16x16x32_bf16 v[104:107], v[180:183], a[216:219], v[104:107]
  v_mfma_f32_16x16x32_bf16 v[108:111], v[180:183], a[220:223], v[108:111]
  s_waitcnt vmcnt(3)
  v_mfma_f32_16x16x32_bf16 v[96:99], v[184:187], a[224:227], v[96:99]
  v_mfma_f32_16x16x32_bf16 v[100:103], v[184:187], a[228:231], v[100:103]
  v_mfma_f32_16x16x32_bf16 v[104:107], v[184:187], a[232:235], v[104:107]
  v_mfma_f32_16x16x32_bf16 v[108:111], v[184:187], a[236:239], v[108:111]
  s_waitcnt vmcnt(2)
  v_mfma_f32_16x16x32_bf16 v[96:99], v[188:191], a[240:243], v[96:99]
  v_mfma_f32_16x16x32_bf16 v[100:103], v[188:191], a[244:247], v[100:103]
  v_mfma_f32_16x16x32_bf16 v[104:107], v[188:191], a[248:251], v[104:107]
  v_mfma_f32_16x16x32_bf16 v[108:111], v[188:191], a[252:255], v[108:111]
  s_waitcnt vmcnt(1)
  v_mfma_f32_16x16x32_bf16 v[96:99], v[192:195], v[224:227], v[96:99]
  v_mfma_f32_16x16x32_bf16 v[100:103], v[192:195], v[228:231], v[100:103]
  v_mfma_f32_16x16x32_bf16 v[104:107], v[192:195], v[232:235], v[104:107]
  v_mfma_f32_16x16x32_bf16 v[108:111], v[192:195], v[236:239], v[108:111]
  s_waitcnt vmcnt(0)
  v_mfma_f32_16x16x32_bf16 v[96:99], v[196:199], v[240:243], v[96:99]
  v_mfma_f32_16x16x32_bf16 v[100:103], v[196:199], v[244:247], v[100:103]
  v_mfma_f32_16x16x32_bf16 v[104:107], v[196:199], v[248:251], v[104:107]
  v_mfma_f32_16x16x32_bf16 v[108:111], v[196:199], v[252:255], v[108:111]
  v_lshrrev_b32 v41, 4, v0
  s_nop 3
  v_mov_b32 v40, v96
  v_cmp_eq_u32 vcc, 1, v41
  s_nop 1
  v_cndmask_b32 v40, v40, v100, vcc
  v_cmp_eq_u32 vcc, 2, v41
  s_nop 1
  v_cndmask_b32 v40, v40, v104, vcc
  v_cmp_eq_u32 vcc, 3, v41
  s_nop 1
  v_cndmask_b32 v40, v40, v108, vcc
  v_mul_f32 v40, s46, v40
  v_exp_f32 v40, v40
  s_nop 0
  v_add_f32 v40, 1.0, v40
  v_rcp_f32 v40, v40
  s_lshl_b32 s63, s41, 4
  s_lshl_b32 s64, s40, 2
  s_add_u32 s63, s63, s64
  s_lshl_b32 s63, s63, 6
  s_add_u32 s63, s63, 21233664
  v_lshlrev_b32 v41, 2, v0
  buffer_store_dword v40, v41, s[16:19], s63 offen sc1
gated_mix__spectral_fnet__swiglu_ffn__prompt_kernel_nogate:
gated_mix__spectral_fnet__swiglu_ffn__prompt_kernel_p2:
  s_barrier
  s_load_dwordx2 s[4:5], s[0:1], 96
  s_load_dwordx2 s[56:57], s[0:1], 88
  s_and_b32 s41, s2, 7
  s_lshr_b32 s42, s2, 3
  s_cmp_ge_u32 s42, 24
  s_cbranch_scc1 fnet_k2_kernel_dft
  s_load_dwordx2 s[8:9], s[0:1], 64
  s_mul_i32 s63, s42, 43
  s_lshr_b32 s63, s63, 7
  s_mul_i32 s64, s63, 3
  s_sub_u32 s61, s42, s64
  s_and_b32 s64, s41, 1
  s_lshl_b32 s64, s64, 3
  s_add_u32 s60, s64, s63
  s_lshr_b32 s62, s41, 1
  s_lshl_b32 s63, s60, 3
  s_lshl_b32 s64, s40, 1
  s_add_u32 s63, s63, s64
  s_mul_i32 s64, s63, 144
  s_mul_i32 s65, s62, 36
  s_add_u32 s64, s64, s65
  s_lshl_b32 s46, s64, 10
  s_add_u32 s47, s46, 146432
  s_mul_i32 s64, s62, 1327104
  s_mul_i32 s65, s61, 384
  s_add_u32 s50, s64, s65
  s_mul_i32 s45, s40, 3072
  s_lshl_b32 s51, s40, 11
  s_add_u32 s51, s51, 12288
  v_lshlrev_b32 v1, 4, v0
  v_lshrrev_b32 v18, 3, v0
  v_bfe_u32 v19, v0, 1, 2
  v_bfe_u32 v20, v18, 1, 2
  v_xor_b32 v19, v19, v20
  v_lshlrev_b32 v19, 5, v19
  v_and_b32 v20, 1, v0
  v_lshl_add_u32 v19, v20, 4, v19
  v_add_u32 v19, 0x800, v19
  s_lshl_b32 s64, s40, 3
  v_add_u32 v18, s64, v18
  v_mul_u32_u24 v20, 1152, v18
  v_add_u32 v2, v20, v19
  v_subrev_u32 v3, 896, v2
  v_subrev_u32 v4, 1792, v2
  s_waitcnt lgkmcnt(0)
  s_mov_b32 s6, 33333248
  s_mov_b32 s7, 0x20000
  s_sub_u32 s8, s8, 2048
  s_subb_u32 s9, s9, 0
  s_cmp_lg_u32 s40, 0
  s_cbranch_scc1 fnet_k2_kernel_l3f
  s_lshl_b32 s52, s2, 7
  s_add_u32 s52, s52, 33300488
  v_mov_b32 v242, 1
  v_mov_b32 v243, 0
  s_mov_b64 exec, 1
  buffer_store_dword v242, v243, s[4:7], s52 offen sc1
  s_mov_b64 exec, -1
fnet_k2_kernel_l3f:
  s_and_b32 s64, s60, 7
  s_lshr_b32 s64, s64, 1
  s_lshl_b32 s64, s64, 6
  s_add_u32 s64, s64, s41
  v_and_b32 v239, 7, v0
  v_lshlrev_b32 v239, 3, v239
  v_add_u32 v239, s64, v239
  v_lshlrev_b32 v239, 7, v239
  s_cmp_eq_u32 s37, 1
  s_cbranch_scc1 fnet_k2_kernel_e1_go
  s_cmp_eq_u32 s36, 1
  s_cbranch_scc1 fnet_k2_kernel_e1i_ok
  v_mov_b32 v240, 0
  s_mov_b32 s55, 0
fnet_k2_kernel_e1i_spin:
  global_load_dword v241, v240, s[56:57] sc1
  s_add_u32 s55, s55, 1
  s_waitcnt vmcnt(0)
  v_readfirstlane_b32 s54, v241
  s_nop 3
  s_cmp_ge_u32 s54, 256
  s_cbranch_scc1 fnet_k2_kernel_e1i_ok
  s_sleep 2
  s_cmp_lt_u32 s55, 262144
  s_cbranch_scc1 fnet_k2_kernel_e1i_spin
fnet_k2_kernel_e1i_ok:
  s_mov_b32 s54, 33300480
  s_mov_b32 s55, 0
fnet_k2_kernel_e1f_spin:
  buffer_load_dword v245, v239, s[4:7], s54 offen sc1
  s_waitcnt vmcnt(0)
  v_cmp_eq_u32 vcc, 1, v245
  s_add_u32 s55, s55, 1
  s_nop 3
  s_cmp_eq_u64 vcc, -1
  s_cbranch_scc1 fnet_k2_kernel_e1f_ok
  s_sleep 1
  s_cmp_lt_u32 s55, 262144
  s_cbranch_scc1 fnet_k2_kernel_e1f_spin
fnet_k2_kernel_e1f_ok:
fnet_k2_kernel_e1_go:
  s_mov_b32 s10, 5310464
  s_mov_b32 s11, 0x20000
  s_add_u32 m0, s45, 0
  s_add_u32 s44, s50, 0
  buffer_load_dwordx4 v2, s[8:11], s44 offen lds
  buffer_load_dwordx4 v3, s[8:11], s44 offen offset:1024 lds
  buffer_load_dwordx4 v4, s[8:11], s44 offen offset:2048 lds
  s_add_u32 m0, s51, 0
  s_add_u32 s44, s46, 0
  buffer_load_dwordx4 v1, s[4:7], s44 offen sc1 lds
  s_add_u32 s44, s47, 0
  buffer_load_dwordx4 v1, s[4:7], s44 offen offset:1024 sc1 lds
  s_add_u32 m0, s45, 20480
  s_add_u32 s44, s50, 36864
  buffer_load_dwordx4 v2, s[8:11], s44 offen lds
  buffer_load_dwordx4 v3, s[8:11], s44 offen offset:1024 lds
  buffer_load_dwordx4 v4, s[8:11], s44 offen offset:2048 lds
  s_add_u32 m0, s51, 20480
  s_add_u32 s44, s46, 1024
  buffer_load_dwordx4 v1, s[4:7], s44 offen sc1 lds
  s_add_u32 s44, s47, 1024
  buffer_load_dwordx4 v1, s[4:7], s44 offen offset:1024 sc1 lds
  s_add_u32 m0, s45, 40960
  s_add_u32 s44, s50, 147456
  buffer_load_dwordx4 v2, s[8:11], s44 offen lds
  buffer_load_dwordx4 v3, s[8:11], s44 offen offset:1024 lds
  buffer_load_dwordx4 v4, s[8:11], s44 offen offset:2048 lds
  s_add_u32 m0, s51, 40960
  s_add_u32 s44, s46, 4096
  buffer_load_dwordx4 v1, s[4:7], s44 offen sc1 lds
  s_add_u32 s44, s47, 4096
  buffer_load_dwordx4 v1, s[4:7], s44 offen offset:1024 sc1 lds
  buffer_store_dwordx2 v[56:57], v55, s[16:19], s24 offen sc1
  buffer_store_dwordx2 v[60:61], v55, s[16:19], s25 offen sc1
  buffer_store_dwordx2 v[64:65], v55, s[16:19], s26 offen sc1
  buffer_store_dwordx2 v[68:69], v55, s[16:19], s27 offen sc1
  v_and_b32 v16, 15, v0
  v_lshrrev_b32 v17, 4, v0
  v_and_b32 v21, 12, v18
  v_lshlrev_b32 v21, 1, v21
  v_lshrrev_b32 v20, 4, v18
  v_lshl_add_u32 v21, v20, 2, v21
  v_and_b32 v20, 3, v18
  v_add_u32 v21, v21, v20
  v_mul_u32_u24 v20, 1152, v21
  v_add_u32 v5, v20, v19
  v_subrev_u32 v6, 896, v5
  v_subrev_u32 v7, 1792, v5
  v_lshrrev_b32 v18, 2, v16
  v_and_b32 v19, 1, v17
  v_lshl_add_u32 v18, v19, 2, v18
  v_lshrrev_b32 v19, 1, v17
  v_mul_u32_u24 v19, 3072, v19
  v_lshl_add_u32 v19, v18, 7, v19
  v_and_b32 v20, 3, v0
  v_lshl_add_u32 v19, v20, 3, v19
  v_bfe_u32 v20, v18, 1, 2
  s_and_b32 s64, s40, 1
  s_mul_i32 s64, s64, 6
  s_add_u32 s65, s64, 0
  s_and_b32 s66, s65, 3
  s_lshr_b32 s65, s65, 2
  s_lshl_b32 s65, s65, 10
  v_xor_b32 v21, s66, v20
  v_lshl_add_u32 v21, v21, 5, v19
  v_add_u32 v8, s65, v21
  s_add_u32 s65, s64, 1
  s_and_b32 s66, s65, 3
  s_lshr_b32 s65, s65, 2
  s_lshl_b32 s65, s65, 10
  v_xor_b32 v21, s66, v20
  v_lshl_add_u32 v21, v21, 5, v19
  v_add_u32 v9, s65, v21
  s_add_u32 s65, s64, 2
  s_and_b32 s66, s65, 3
  s_lshr_b32 s65, s65, 2
  s_lshl_b32 s65, s65, 10
  v_xor_b32 v21, s66, v20
  v_lshl_add_u32 v21, v21, 5, v19
  v_add_u32 v10, s65, v21
  s_add_u32 s65, s64, 3
  s_and_b32 s66, s65, 3
  s_lshr_b32 s65, s65, 2
  s_lshl_b32 s65, s65, 10
  v_xor_b32 v21, s66, v20
  v_lshl_add_u32 v21, v21, 5, v19
  v_add_u32 v11, s65, v21
  s_add_u32 s65, s64, 4
  s_and_b32 s66, s65, 3
  s_lshr_b32 s65, s65, 2
  s_lshl_b32 s65, s65, 10
  v_xor_b32 v21, s66, v20
  v_lshl_add_u32 v21, v21, 5, v19
  v_add_u32 v12, s65, v21
  s_add_u32 s65, s64, 5
  s_and_b32 s66, s65, 3
  s_lshr_b32 s65, s65, 2
  s_lshl_b32 s65, s65, 10
  v_xor_b32 v21, s66, v20
  v_lshl_add_u32 v21, v21, 5, v19
  v_add_u32 v13, s65, v21
  s_lshr_b32 s64, s40, 1
  s_lshl_b32 s64, s64, 12
  s_add_u32 s64, s64, 12288
  v_add_u32 v14, s64, v1
  s_lshl_b32 s63, s60, 3
  s_lshr_b32 s64, s40, 1
  s_lshl_b32 s64, s64, 2
  s_add_u32 s63, s63, s64
  s_mul_i32 s64, s63, 18
  s_mul_i32 s65, s61, 6
  s_add_u32 s64, s64, s65
  s_and_b32 s65, s40, 1
  s_mul_i32 s65, s65, 3
  s_add_u32 s64, s64, s65
  s_lshl_b32 s64, s64, 10
  s_mul_i32 s65, s62, 2359296
  s_add_u32 s64, s64, s65
  s_add_u32 s48, s64, 21241856
  s_waitcnt vmcnt(9)
  s_barrier
  ds_read_b128 v[48:51], v14 offset:0
  ds_read_b128 v[52:55], v14 offset:1024
  ds_read_b128 v[56:59], v14 offset:2048
  ds_read_b128 v[60:63], v14 offset:3072
  ds_read_b64_tr_b16 v[24:25], v8 offset:0
  ds_read_b64_tr_b16 v[26:27], v8 offset:6144
  ds_read_b64_tr_b16 v[28:29], v9 offset:0
  ds_read_b64_tr_b16 v[30:31], v9 offset:6144
  ds_read_b64_tr_b16 v[32:33], v10 offset:0
  ds_read_b64_tr_b16 v[34:35], v10 offset:6144
  s_waitcnt lgkmcnt(4)
  v_mfma_f32_16x16x32_bf16 v[80:83], v[24:27], v[48:51], 0
  s_add_u32 m0, s45, 61440
  ds_read_b64_tr_b16 v[36:37], v11 offset:0
  s_add_u32 s44, s50, 184320
  v_mfma_f32_16x16x32_bf16 v[84:87], v[24:27], v[52:55], 0
  buffer_load_dwordx4 v2, s[8:11], s44 offen lds
  v_mfma_f32_16x16x32_bf16 v[88:91], v[24:27], v[56:59], 0
  buffer_load_dwordx4 v3, s[8:11], s44 offen offset:1024 lds
  v_mfma_f32_16x16x32_bf16 v[92:95], v[24:27], v[60:63], 0
  s_waitcnt lgkmcnt(3)
  buffer_load_dwordx4 v4, s[8:11], s44 offen offset:2048 lds
  v_mfma_f32_16x16x32_bf16 v[96:99], v[28:31], v[48:51], 0
  s_add_u32 m0, s51, 61440
  ds_read_b64_tr_b16 v[38:39], v11 offset:6144
  s_add_u32 s44, s46, 5120
  v_mfma_f32_16x16x32_bf16 v[100:103], v[28:31], v[52:55], 0
  buffer_load_dwordx4 v1, s[4:7], s44 offen sc1 lds
  v_mfma_f32_16x16x32_bf16 v[104:107], v[28:31], v[56:59], 0
  s_add_u32 s44, s47, 5120
  buffer_load_dwordx4 v1, s[4:7], s44 offen offset:1024 sc1 lds
  v_mfma_f32_16x16x32_bf16 v[108:111], v[28:31], v[60:63], 0
  s_waitcnt lgkmcnt(2)
  s_add_u32 m0, s45, 81920
  s_add_u32 s44, s50, 294912
  buffer_load_dwordx4 v2, s[8:11], s44 offen lds
  v_mfma_f32_16x16x32_bf16 v[112:115], v[32:35], v[48:51], 0
  buffer_load_dwordx4 v3, s[8:11], s44 offen offset:1024 lds
  v_mfma_f32_16x16x32_bf16 v[116:119], v[32:35], v[52:55], 0
  buffer_load_dwordx4 v4, s[8:11], s44 offen offset:2048 lds
  v_mfma_f32_16x16x32_bf16 v[120:123], v[32:35], v[56:59], 0
  s_add_u32 m0, s51, 81920
  s_add_u32 s44, s46, 8192
  buffer_load_dwordx4 v1, s[4:7], s44 offen sc1 lds
  v_mfma_f32_16x16x32_bf16 v[124:127], v[32:35], v[60:63], 0
  s_waitcnt lgkmcnt(0)
  ds_read_b64_tr_b16 v[40:41], v12 offset:0
  ds_read_b64_tr_b16 v[42:43], v12 offset:6144
  ds_read_b128 v[64:67], v14 offset:20480
  s_add_u32 s44, s47, 8192
  buffer_load_dwordx4 v1, s[4:7], s44 offen offset:1024 sc1 lds
  v_mfma_f32_16x16x32_bf16 v[128:131], v[36:39], v[48:51], 0
  s_add_u32 m0, s45, 102400
  s_add_u32 s44, s50, 331776
  buffer_load_dwordx4 v2, s[8:11], s44 offen lds
  v_mfma_f32_16x16x32_bf16 v[132:135], v[36:39], v[52:55], 0
  buffer_load_dwordx4 v3, s[8:11], s44 offen offset:1024 lds
  v_mfma_f32_16x16x32_bf16 v[136:139], v[36:39], v[56:59], 0
  buffer_load_dwordx4 v4, s[8:11], s44 offen offset:2048 lds
  v_mfma_f32_16x16x32_bf16 v[140:143], v[36:39], v[60:63], 0
  s_waitcnt lgkmcnt(1)
  ds_read_b64_tr_b16 v[44:45], v13 offset:0
  ds_read_b64_tr_b16 v[46:47], v13 offset:6144
  ds_read_b128 v[68:71], v14 offset:21504
  s_add_u32 m0, s51, 102400
  s_add_u32 s44, s46, 9216
  buffer_load_dwordx4 v1, s[4:7], s44 offen sc1 lds
  v_mfma_f32_16x16x32_bf16 v[144:147], v[40:43], v[48:51], 0
  s_add_u32 s44, s47, 9216
  buffer_load_dwordx4 v1, s[4:7], s44 offen offset:1024 sc1 lds
  v_mfma_f32_16x16x32_bf16 v[148:151], v[40:43], v[52:55], 0
  s_add_u32 m0, s45, 122880
  s_add_u32 s44, s50, 442368
  buffer_load_dwordx4 v2, s[8:11], s44 offen lds
  v_mfma_f32_16x16x32_bf16 v[152:155], v[40:43], v[56:59], 0
  buffer_load_dwordx4 v3, s[8:11], s44 offen offset:1024 lds
  v_mfma_f32_16x16x32_bf16 v[156:159], v[40:43], v[60:63], 0
  s_waitcnt lgkmcnt(1)
  ds_read_b64_tr_b16 v[24:25], v8 offset:20480
  ds_read_b64_tr_b16 v[26:27], v8 offset:26624
  ds_read_b128 v[72:75], v14 offset:22528
  buffer_load_dwordx4 v4, s[8:11], s44 offen offset:2048 lds
  v_mfma_f32_16x16x32_bf16 v[160:163], v[44:47], v[48:51], 0
  s_add_u32 m0, s51, 122880
  s_add_u32 s44, s46, 12288
  buffer_load_dwordx4 v1, s[4:7], s44 offen sc1 lds
  v_mfma_f32_16x16x32_bf16 v[164:167], v[44:47], v[52:55], 0
  s_add_u32 s44, s47, 12288
  ds_read_b64_tr_b16 v[28:29], v9 offset:20480
  ds_read_b64_tr_b16 v[30:31], v9 offset:26624
  ds_read_b128 v[76:79], v14 offset:23552
  buffer_load_dwordx4 v1, s[4:7], s44 offen offset:1024 sc1 lds
  v_mfma_f32_16x16x32_bf16 v[168:171], v[44:47], v[56:59], 0
  ds_read_b64_tr_b16 v[32:33], v10 offset:20480
  ds_read_b64_tr_b16 v[34:35], v10 offset:26624
  v_mfma_f32_16x16x32_bf16 v[172:175], v[44:47], v[60:63], 0
  s_waitcnt lgkmcnt(6)
  v_mfma_f32_16x16x32_bf16 v[80:83], v[24:27], v[64:67], v[80:83]
  ds_read_b64_tr_b16 v[36:37], v11 offset:20480
  v_mfma_f32_16x16x32_bf16 v[84:87], v[24:27], v[68:71], v[84:87]
  s_waitcnt lgkmcnt(6)
  ds_read_b64_tr_b16 v[38:39], v11 offset:26624
  v_mfma_f32_16x16x32_bf16 v[88:91], v[24:27], v[72:75], v[88:91]
  s_waitcnt lgkmcnt(4)
  s_waitcnt vmcnt(15)
  s_barrier
  s_cmp_lg_u32 s40, 0
  s_cbranch_scc1 fnet_k2_kernel_l2f
  s_lshl_b32 s52, s2, 7
  s_add_u32 s52, s52, 33300492
  v_mov_b32 v242, 1
  v_mov_b32 v243, 0
  s_mov_b64 exec, 1
  buffer_store_dword v242, v243, s[4:7], s52 offen sc1
  s_mov_b64 exec, -1
fnet_k2_kernel_l2f:
  v_mfma_f32_16x16x32_bf16 v[92:95], v[24:27], v[76:79], v[92:95]
  s_add_u32 m0, s45, 143360
  s_add_u32 s44, s50, 479232
  v_mfma_f32_16x16x32_bf16 v[96:99], v[28:31], v[64:67], v[96:99]
  buffer_load_dwordx4 v2, s[8:11], s44 offen lds
  v_mfma_f32_16x16x32_bf16 v[100:103], v[28:31], v[68:71], v[100:103]
  ds_read_b64_tr_b16 v[40:41], v12 offset:20480
  ds_read_b64_tr_b16 v[42:43], v12 offset:26624
  v_mfma_f32_16x16x32_bf16 v[104:107], v[28:31], v[72:75], v[104:107]
  ds_read_b128 v[48:51], v14 offset:40960
  v_mfma_f32_16x16x32_bf16 v[108:111], v[28:31], v[76:79], v[108:111]
  s_waitcnt lgkmcnt(5)
  buffer_load_dwordx4 v3, s[8:11], s44 offen offset:1024 lds
  v_mfma_f32_16x16x32_bf16 v[112:115], v[32:35], v[64:67], v[112:115]
  ds_read_b64_tr_b16 v[44:45], v13 offset:20480
  v_mfma_f32_16x16x32_bf16 v[116:119], v[32:35], v[68:71], v[116:119]
  ds_read_b64_tr_b16 v[46:47], v13 offset:26624
  v_mfma_f32_16x16x32_bf16 v[120:123], v[32:35], v[72:75], v[120:123]
  ds_read_b128 v[52:55], v14 offset:41984
  v_mfma_f32_16x16x32_bf16 v[124:127], v[32:35], v[76:79], v[124:127]
  s_waitcnt lgkmcnt(6)
  v_mfma_f32_16x16x32_bf16 v[128:131], v[36:39], v[64:67], v[128:131]
  buffer_load_dwordx4 v4, s[8:11], s44 offen offset:2048 lds
  v_mfma_f32_16x16x32_bf16 v[132:135], v[36:39], v[68:71], v[132:135]
  ds_read_b64_tr_b16 v[24:25], v8 offset:40960
  ds_read_b64_tr_b16 v[26:27], v8 offset:47104
  v_mfma_f32_16x16x32_bf16 v[136:139], v[36:39], v[72:75], v[136:139]
  ds_read_b128 v[56:59], v14 offset:43008
  v_mfma_f32_16x16x32_bf16 v[140:143], v[36:39], v[76:79], v[140:143]
  s_waitcnt lgkmcnt(7)
  v_mfma_f32_16x16x32_bf16 v[144:147], v[40:43], v[64:67], v[144:147]
  s_add_u32 m0, s51, 143360
  ds_read_b64_tr_b16 v[28:29], v9 offset:40960
  s_add_u32 s44, s46, 13312
  v_mfma_f32_16x16x32_bf16 v[148:151], v[40:43], v[68:71], v[148:151]
  buffer_load_dwordx4 v1, s[4:7], s44 offen sc1 lds
  v_mfma_f32_16x16x32_bf16 v[152:155], v[40:43], v[72:75], v[152:155]
  ds_read_b64_tr_b16 v[30:31], v9 offset:47104
  ds_read_b128 v[60:63], v14 offset:44032
  v_mfma_f32_16x16x32_bf16 v[156:159], v[40:43], v[76:79], v[156:159]
  s_waitcnt lgkmcnt(7)
  v_mfma_f32_16x16x32_bf16 v[160:163], v[44:47], v[64:67], v[160:163]
  ds_read_b64_tr_b16 v[32:33], v10 offset:40960
  v_mfma_f32_16x16x32_bf16 v[164:167], v[44:47], v[68:71], v[164:167]
  s_add_u32 s44, s47, 13312
  buffer_load_dwordx4 v1, s[4:7], s44 offen offset:1024 sc1 lds
  v_mfma_f32_16x16x32_bf16 v[168:171], v[44:47], v[72:75], v[168:171]
  ds_read_b64_tr_b16 v[34:35], v10 offset:47104
  v_mfma_f32_16x16x32_bf16 v[172:175], v[44:47], v[76:79], v[172:175]
  s_waitcnt lgkmcnt(6)
  v_mfma_f32_16x16x32_bf16 v[80:83], v[24:27], v[48:51], v[80:83]
  ds_read_b64_tr_b16 v[36:37], v11 offset:40960
  v_mfma_f32_16x16x32_bf16 v[84:87], v[24:27], v[52:55], v[84:87]
  s_waitcnt lgkmcnt(6)
  ds_read_b64_tr_b16 v[38:39], v11 offset:47104
  v_mfma_f32_16x16x32_bf16 v[88:91], v[24:27], v[56:59], v[88:91]
  s_waitcnt lgkmcnt(4)
  s_add_u32 m0, s45, 0
  s_add_u32 s44, s50, 663552
  v_mfma_f32_16x16x32_bf16 v[92:95], v[24:27], v[60:63], v[92:95]
  buffer_load_dwordx4 v2, s[8:11], s44 offen lds
  v_mfma_f32_16x16x32_bf16 v[96:99], v[28:31], v[48:51], v[96:99]
  ds_read_b64_tr_b16 v[40:41], v12 offset:40960
  v_mfma_f32_16x16x32_bf16 v[100:103], v[28:31], v[52:55], v[100:103]
  ds_read_b64_tr_b16 v[42:43], v12 offset:47104
  v_mfma_f32_16x16x32_bf16 v[104:107], v[28:31], v[56:59], v[104:107]
  buffer_load_dwordx4 v3, s[8:11], s44 offen offset:1024 lds
  v_mfma_f32_16x16x32_bf16 v[108:111], v[28:31], v[60:63], v[108:111]
  s_waitcnt lgkmcnt(4)
  ds_read_b128 v[64:67], v14 offset:61440
  v_mfma_f32_16x16x32_bf16 v[112:115], v[32:35], v[48:51], v[112:115]
  ds_read_b64_tr_b16 v[44:45], v13 offset:40960
  v_mfma_f32_16x16x32_bf16 v[116:119], v[32:35], v[52:55], v[116:119]
  ds_read_b64_tr_b16 v[46:47], v13 offset:47104
  v_mfma_f32_16x16x32_bf16 v[120:123], v[32:35], v[56:59], v[120:123]
  ds_read_b128 v[68:71], v14 offset:62464
  v_mfma_f32_16x16x32_bf16 v[124:127], v[32:35], v[60:63], v[124:127]
  s_waitcnt lgkmcnt(6)
  buffer_load_dwordx4 v4, s[8:11], s44 offen offset:2048 lds
  v_mfma_f32_16x16x32_bf16 v[128:131], v[36:39], v[48:51], v[128:131]
  v_add_u32 v8, 61440, v8
  ds_read_b64_tr_b16 v[24:25], v8 offset:0
  v_mfma_f32_16x16x32_bf16 v[132:135], v[36:39], v[52:55], v[132:135]
  ds_read_b64_tr_b16 v[26:27], v8 offset:6144
  v_mfma_f32_16x16x32_bf16 v[136:139], v[36:39], v[56:59], v[136:139]
  ds_read_b128 v[72:75], v14 offset:63488
  v_mfma_f32_16x16x32_bf16 v[140:143], v[36:39], v[60:63], v[140:143]
  s_waitcnt lgkmcnt(7)
  s_add_u32 m0, s51, 0
  s_add_u32 s44, s46, 18432
  v_mfma_f32_16x16x32_bf16 v[144:147], v[40:43], v[48:51], v[144:147]
  buffer_load_dwordx4 v1, s[4:7], s44 offen sc1 lds
  v_mfma_f32_16x16x32_bf16 v[148:151], v[40:43], v[52:55], v[148:151]
  v_add_u32 v9, 61440, v9
  ds_read_b64_tr_b16 v[28:29], v9 offset:0
  v_mfma_f32_16x16x32_bf16 v[152:155], v[40:43], v[56:59], v[152:155]
  ds_read_b64_tr_b16 v[30:31], v9 offset:6144
  ds_read_b128 v[76:79], v14 offset:64512
  v_mfma_f32_16x16x32_bf16 v[156:159], v[40:43], v[60:63], v[156:159]
  s_waitcnt lgkmcnt(7)
  v_mfma_f32_16x16x32_bf16 v[160:163], v[44:47], v[48:51], v[160:163]
  s_add_u32 s44, s47, 18432
  buffer_load_dwordx4 v1, s[4:7], s44 offen offset:1024 sc1 lds
  v_mfma_f32_16x16x32_bf16 v[164:167], v[44:47], v[52:55], v[164:167]
  v_add_u32 v10, 61440, v10
  ds_read_b64_tr_b16 v[32:33], v10 offset:0
  v_mfma_f32_16x16x32_bf16 v[168:171], v[44:47], v[56:59], v[168:171]
  ds_read_b64_tr_b16 v[34:35], v10 offset:6144
  v_mfma_f32_16x16x32_bf16 v[172:175], v[44:47], v[60:63], v[172:175]
  s_waitcnt lgkmcnt(6)
  v_mfma_f32_16x16x32_bf16 v[80:83], v[24:27], v[64:67], v[80:83]
  v_add_u32 v11, 61440, v11
  ds_read_b64_tr_b16 v[36:37], v11 offset:0
  v_mfma_f32_16x16x32_bf16 v[84:87], v[24:27], v[68:71], v[84:87]
  s_waitcnt lgkmcnt(6)
  ds_read_b64_tr_b16 v[38:39], v11 offset:6144
  v_mfma_f32_16x16x32_bf16 v[88:91], v[24:27], v[72:75], v[88:91]
  s_waitcnt lgkmcnt(4)
  s_waitcnt vmcnt(15)
  s_barrier
  v_mfma_f32_16x16x32_bf16 v[92:95], v[24:27], v[76:79], v[92:95]
  s_add_u32 m0, s45, 20480
  s_add_u32 s44, s50, 700416
  v_mfma_f32_16x16x32_bf16 v[96:99], v[28:31], v[64:67], v[96:99]
  buffer_load_dwordx4 v2, s[8:11], s44 offen lds
  v_mfma_f32_16x16x32_bf16 v[100:103], v[28:31], v[68:71], v[100:103]
  v_add_u32 v12, 61440, v12
  ds_read_b64_tr_b16 v[40:41], v12 offset:0
  v_mfma_f32_16x16x32_bf16 v[104:107], v[28:31], v[72:75], v[104:107]
  ds_read_b64_tr_b16 v[42:43], v12 offset:6144
  v_add_u32 v14, 81920, v14
  v_mfma_f32_16x16x32_bf16 v[108:111], v[28:31], v[76:79], v[108:111]
  s_waitcnt lgkmcnt(4)
  buffer_load_dwordx4 v3, s[8:11], s44 offen offset:1024 lds
  v_mfma_f32_16x16x32_bf16 v[112:115], v[32:35], v[64:67], v[112:115]
  ds_read_b128 v[48:51], v14 offset:0
  v_add_u32 v13, 61440, v13
  v_mfma_f32_16x16x32_bf16 v[116:119], v[32:35], v[68:71], v[116:119]
  ds_read_b64_tr_b16 v[44:45], v13 offset:0
  ds_read_b64_tr_b16 v[46:47], v13 offset:6144
  v_mfma_f32_16x16x32_bf16 v[120:123], v[32:35], v[72:75], v[120:123]
  ds_read_b128 v[52:55], v14 offset:1024
  v_mfma_f32_16x16x32_bf16 v[124:127], v[32:35], v[76:79], v[124:127]
  s_waitcnt lgkmcnt(6)
  v_mfma_f32_16x16x32_bf16 v[128:131], v[36:39], v[64:67], v[128:131]
  buffer_load_dwordx4 v4, s[8:11], s44 offen offset:2048 lds
  v_mfma_f32_16x16x32_bf16 v[132:135], v[36:39], v[68:71], v[132:135]
  ds_read_b64_tr_b16 v[24:25], v8 offset:20480
  ds_read_b64_tr_b16 v[26:27], v8 offset:26624
  v_mfma_f32_16x16x32_bf16 v[136:139], v[36:39], v[72:75], v[136:139]
  ds_read_b128 v[56:59], v14 offset:2048
  v_mfma_f32_16x16x32_bf16 v[140:143], v[36:39], v[76:79], v[140:143]
  s_waitcnt lgkmcnt(7)
  v_mfma_f32_16x16x32_bf16 v[144:147], v[40:43], v[64:67], v[144:147]
  s_add_u32 m0, s51, 20480
  ds_read_b64_tr_b16 v[28:29], v9 offset:20480
  s_add_u32 s44, s46, 19456
  v_mfma_f32_16x16x32_bf16 v[148:151], v[40:43], v[68:71], v[148:151]
  buffer_load_dwordx4 v1, s[4:7], s44 offen sc1 lds
  v_mfma_f32_16x16x32_bf16 v[152:155], v[40:43], v[72:75], v[152:155]
  ds_read_b64_tr_b16 v[30:31], v9 offset:26624
  ds_read_b128 v[60:63], v14 offset:3072
  v_mfma_f32_16x16x32_bf16 v[156:159], v[40:43], v[76:79], v[156:159]
  s_waitcnt lgkmcnt(7)
  v_mfma_f32_16x16x32_bf16 v[160:163], v[44:47], v[64:67], v[160:163]
  ds_read_b64_tr_b16 v[32:33], v10 offset:20480
  v_mfma_f32_16x16x32_bf16 v[164:167], v[44:47], v[68:71], v[164:167]
  s_add_u32 s44, s47, 19456
  buffer_load_dwordx4 v1, s[4:7], s44 offen offset:1024 sc1 lds
  v_mfma_f32_16x16x32_bf16 v[168:171], v[44:47], v[72:75], v[168:171]
  ds_read_b64_tr_b16 v[34:35], v10 offset:26624
  v_mfma_f32_16x16x32_bf16 v[172:175], v[44:47], v[76:79], v[172:175]
  s_waitcnt lgkmcnt(6)
  v_mfma_f32_16x16x32_bf16 v[80:83], v[24:27], v[48:51], v[80:83]
  ds_read_b64_tr_b16 v[36:37], v11 offset:20480
  v_mfma_f32_16x16x32_bf16 v[84:87], v[24:27], v[52:55], v[84:87]
  s_waitcnt lgkmcnt(6)
  ds_read_b64_tr_b16 v[38:39], v11 offset:26624
  v_mfma_f32_16x16x32_bf16 v[88:91], v[24:27], v[56:59], v[88:91]
  s_waitcnt lgkmcnt(4)
  s_add_u32 m0, s45, 40960
  s_add_u32 s44, s50, 811008
  v_mfma_f32_16x16x32_bf16 v[92:95], v[24:27], v[60:63], v[92:95]
  buffer_load_dwordx4 v2, s[8:11], s44 offen lds
  v_mfma_f32_16x16x32_bf16 v[96:99], v[28:31], v[48:51], v[96:99]
  ds_read_b64_tr_b16 v[40:41], v12 offset:20480
  v_mfma_f32_16x16x32_bf16 v[100:103], v[28:31], v[52:55], v[100:103]
  ds_read_b64_tr_b16 v[42:43], v12 offset:26624
  v_mfma_f32_16x16x32_bf16 v[104:107], v[28:31], v[56:59], v[104:107]
  buffer_load_dwordx4 v3, s[8:11], s44 offen offset:1024 lds
  v_mfma_f32_16x16x32_bf16 v[108:111], v[28:31], v[60:63], v[108:111]
  s_waitcnt lgkmcnt(4)
  ds_read_b128 v[64:67], v14 offset:20480
  v_mfma_f32_16x16x32_bf16 v[112:115], v[32:35], v[48:51], v[112:115]
  ds_read_b64_tr_b16 v[44:45], v13 offset:20480
  v_mfma_f32_16x16x32_bf16 v[116:119], v[32:35], v[52:55], v[116:119]
  ds_read_b64_tr_b16 v[46:47], v13 offset:26624
  v_mfma_f32_16x16x32_bf16 v[120:123], v[32:35], v[56:59], v[120:123]
  ds_read_b128 v[68:71], v14 offset:21504
  v_mfma_f32_16x16x32_bf16 v[124:127], v[32:35], v[60:63], v[124:127]
  s_waitcnt lgkmcnt(6)
  buffer_load_dwordx4 v4, s[8:11], s44 offen offset:2048 lds
  v_mfma_f32_16x16x32_bf16 v[128:131], v[36:39], v[48:51], v[128:131]
  ds_read_b64_tr_b16 v[24:25], v8 offset:40960
  v_mfma_f32_16x16x32_bf16 v[132:135], v[36:39], v[52:55], v[132:135]
  ds_read_b64_tr_b16 v[26:27], v8 offset:47104
  v_mfma_f32_16x16x32_bf16 v[136:139], v[36:39], v[56:59], v[136:139]
  ds_read_b128 v[72:75], v14 offset:22528
  v_mfma_f32_16x16x32_bf16 v[140:143], v[36:39], v[60:63], v[140:143]
  s_waitcnt lgkmcnt(7)
  s_add_u32 m0, s51, 40960
  s_add_u32 s44, s46, 22528
  v_mfma_f32_16x16x32_bf16 v[144:147], v[40:43], v[48:51], v[144:147]
  buffer_load_dwordx4 v1, s[4:7], s44 offen sc1 lds
  v_mfma_f32_16x16x32_bf16 v[148:151], v[40:43], v[52:55], v[148:151]
  ds_read_b64_tr_b16 v[28:29], v9 offset:40960
  ds_read_b64_tr_b16 v[30:31], v9 offset:47104
  v_mfma_f32_16x16x32_bf16 v[152:155], v[40:43], v[56:59], v[152:155]
  ds_read_b128 v[76:79], v14 offset:23552
  v_mfma_f32_16x16x32_bf16 v[156:159], v[40:43], v[60:63], v[156:159]
  s_waitcnt lgkmcnt(7)
  v_mfma_f32_16x16x32_bf16 v[160:163], v[44:47], v[48:51], v[160:163]
  s_add_u32 s44, s47, 22528
  buffer_load_dwordx4 v1, s[4:7], s44 offen offset:1024 sc1 lds
  v_mfma_f32_16x16x32_bf16 v[164:167], v[44:47], v[52:55], v[164:167]
  ds_read_b64_tr_b16 v[32:33], v10 offset:40960
  ds_read_b64_tr_b16 v[34:35], v10 offset:47104
  v_mfma_f32_16x16x32_bf16 v[168:171], v[44:47], v[56:59], v[168:171]
  v_mfma_f32_16x16x32_bf16 v[172:175], v[44:47], v[60:63], v[172:175]
  s_waitcnt lgkmcnt(6)
  v_mfma_f32_16x16x32_bf16 v[80:83], v[24:27], v[64:67], v[80:83]
  ds_read_b64_tr_b16 v[36:37], v11 offset:40960
  v_mfma_f32_16x16x32_bf16 v[84:87], v[24:27], v[68:71], v[84:87]
  s_waitcnt lgkmcnt(6)
  ds_read_b64_tr_b16 v[38:39], v11 offset:47104
  v_mfma_f32_16x16x32_bf16 v[88:91], v[24:27], v[72:75], v[88:91]
  s_waitcnt lgkmcnt(4)
  s_waitcnt vmcnt(15)
  s_barrier
  v_mfma_f32_16x16x32_bf16 v[92:95], v[24:27], v[76:79], v[92:95]
  s_add_u32 m0, s45, 61440
  s_add_u32 s44, s50, 847872
  v_mfma_f32_16x16x32_bf16 v[96:99], v[28:31], v[64:67], v[96:99]
  buffer_load_dwordx4 v2, s[8:11], s44 offen lds
  v_mfma_f32_16x16x32_bf16 v[100:103], v[28:31], v[68:71], v[100:103]
  ds_read_b64_tr_b16 v[40:41], v12 offset:40960
  ds_read_b64_tr_b16 v[42:43], v12 offset:47104
  v_mfma_f32_16x16x32_bf16 v[104:107], v[28:31], v[72:75], v[104:107]
  ds_read_b128 v[48:51], v14 offset:40960
  v_mfma_f32_16x16x32_bf16 v[108:111], v[28:31], v[76:79], v[108:111]
  s_waitcnt lgkmcnt(5)
  buffer_load_dwordx4 v3, s[8:11], s44 offen offset:1024 lds
  v_mfma_f32_16x16x32_bf16 v[112:115], v[32:35], v[64:67], v[112:115]
  ds_read_b64_tr_b16 v[44:45], v13 offset:40960
  v_mfma_f32_16x16x32_bf16 v[116:119], v[32:35], v[68:71], v[116:119]
  ds_read_b64_tr_b16 v[46:47], v13 offset:47104
  v_mfma_f32_16x16x32_bf16 v[120:123], v[32:35], v[72:75], v[120:123]
  ds_read_b128 v[52:55], v14 offset:41984
  v_mfma_f32_16x16x32_bf16 v[124:127], v[32:35], v[76:79], v[124:127]
  s_waitcnt lgkmcnt(6)
  v_mfma_f32_16x16x32_bf16 v[128:131], v[36:39], v[64:67], v[128:131]
  buffer_load_dwordx4 v4, s[8:11], s44 offen offset:2048 lds
  v_mfma_f32_16x16x32_bf16 v[132:135], v[36:39], v[68:71], v[132:135]
  v_add_u32 v8, 61440, v8
  ds_read_b64_tr_b16 v[24:25], v8 offset:0
  v_mfma_f32_16x16x32_bf16 v[136:139], v[36:39], v[72:75], v[136:139]
  ds_read_b64_tr_b16 v[26:27], v8 offset:6144
  ds_read_b128 v[56:59], v14 offset:43008
  v_mfma_f32_16x16x32_bf16 v[140:143], v[36:39], v[76:79], v[140:143]
  s_waitcnt lgkmcnt(7)
  v_mfma_f32_16x16x32_bf16 v[144:147], v[40:43], v[64:67], v[144:147]
  s_add_u32 m0, s51, 61440
  v_add_u32 v9, 61440, v9
  s_add_u32 s44, s46, 23552
  v_mfma_f32_16x16x32_bf16 v[148:151], v[40:43], v[68:71], v[148:151]
  buffer_load_dwordx4 v1, s[4:7], s44 offen sc1 lds
  v_mfma_f32_16x16x32_bf16 v[152:155], v[40:43], v[72:75], v[152:155]
  ds_read_b64_tr_b16 v[28:29], v9 offset:0
  ds_read_b64_tr_b16 v[30:31], v9 offset:6144
  v_mfma_f32_16x16x32_bf16 v[156:159], v[40:43], v[76:79], v[156:159]
  s_waitcnt lgkmcnt(6)
  ds_read_b128 v[60:63], v14 offset:44032
  v_mfma_f32_16x16x32_bf16 v[160:163], v[44:47], v[64:67], v[160:163]
  v_add_u32 v10, 61440, v10
  ds_read_b64_tr_b16 v[32:33], v10 offset:0
  v_mfma_f32_16x16x32_bf16 v[164:167], v[44:47], v[68:71], v[164:167]
  s_add_u32 s44, s47, 23552
  buffer_load_dwordx4 v1, s[4:7], s44 offen offset:1024 sc1 lds
  v_mfma_f32_16x16x32_bf16 v[168:171], v[44:47], v[72:75], v[168:171]
  ds_read_b64_tr_b16 v[34:35], v10 offset:6144
  v_mfma_f32_16x16x32_bf16 v[172:175], v[44:47], v[76:79], v[172:175]
  s_waitcnt lgkmcnt(6)
  v_mfma_f32_16x16x32_bf16 v[80:83], v[24:27], v[48:51], v[80:83]
  v_add_u32 v11, 61440, v11
  ds_read_b64_tr_b16 v[36:37], v11 offset:0
  v_mfma_f32_16x16x32_bf16 v[84:87], v[24:27], v[52:55], v[84:87]
  s_waitcnt lgkmcnt(6)
  ds_read_b64_tr_b16 v[38:39], v11 offset:6144
  v_mfma_f32_16x16x32_bf16 v[88:91], v[24:27], v[56:59], v[88:91]
  s_waitcnt lgkmcnt(4)
  s_add_u32 m0, s45, 81920
  s_add_u32 s44, s50, 958464
  v_mfma_f32_16x16x32_bf16 v[92:95], v[24:27], v[60:63], v[92:95]
  buffer_load_dwordx4 v2, s[8:11], s44 offen lds
  v_mfma_f32_16x16x32_bf16 v[96:99], v[28:31], v[48:51], v[96:99]
  v_add_u32 v12, 61440, v12
  ds_read_b64_tr_b16 v[40:41], v12 offset:0
  v_mfma_f32_16x16x32_bf16 v[100:103], v[28:31], v[52:55], v[100:103]
  ds_read_b64_tr_b16 v[42:43], v12 offset:6144
  v_mfma_f32_16x16x32_bf16 v[104:107], v[28:31], v[56:59], v[104:107]
  buffer_load_dwordx4 v3, s[8:11], s44 offen offset:1024 lds
  v_mfma_f32_16x16x32_bf16 v[108:111], v[28:31], v[60:63], v[108:111]
  s_waitcnt lgkmcnt(4)
  ds_read_b128 v[64:67], v14 offset:61440
  v_mfma_f32_16x16x32_bf16 v[112:115], v[32:35], v[48:51], v[112:115]
  v_add_u32 v13, 61440, v13
  ds_read_b64_tr_b16 v[44:45], v13 offset:0
  v_mfma_f32_16x16x32_bf16 v[116:119], v[32:35], v[52:55], v[116:119]
  ds_read_b64_tr_b16 v[46:47], v13 offset:6144
  v_mfma_f32_16x16x32_bf16 v[120:123], v[32:35], v[56:59], v[120:123]
  ds_read_b128 v[68:71], v14 offset:62464
  v_mfma_f32_16x16x32_bf16 v[124:127], v[32:35], v[60:63], v[124:127]
  s_waitcnt lgkmcnt(6)
  buffer_load_dwordx4 v4, s[8:11], s44 offen offset:2048 lds
  v_mfma_f32_16x16x32_bf16 v[128:131], v[36:39], v[48:51], v[128:131]
  ds_read_b64_tr_b16 v[24:25], v8 offset:20480
  v_mfma_f32_16x16x32_bf16 v[132:135], v[36:39], v[52:55], v[132:135]
  ds_read_b64_tr_b16 v[26:27], v8 offset:26624
  v_mfma_f32_16x16x32_bf16 v[136:139], v[36:39], v[56:59], v[136:139]
  ds_read_b128 v[72:75], v14 offset:63488
  v_mfma_f32_16x16x32_bf16 v[140:143], v[36:39], v[60:63], v[140:143]
  s_waitcnt lgkmcnt(7)
  s_add_u32 m0, s51, 81920
  s_add_u32 s44, s46, 26624
  v_mfma_f32_16x16x32_bf16 v[144:147], v[40:43], v[48:51], v[144:147]
  buffer_load_dwordx4 v1, s[4:7], s44 offen sc1 lds
  v_mfma_f32_16x16x32_bf16 v[148:151], v[40:43], v[52:55], v[148:151]
  ds_read_b64_tr_b16 v[28:29], v9 offset:20480
  ds_read_b64_tr_b16 v[30:31], v9 offset:26624
  v_mfma_f32_16x16x32_bf16 v[152:155], v[40:43], v[56:59], v[152:155]
  ds_read_b128 v[76:79], v14 offset:64512
  v_mfma_f32_16x16x32_bf16 v[156:159], v[40:43], v[60:63], v[156:159]
  s_waitcnt lgkmcnt(7)
  v_mfma_f32_16x16x32_bf16 v[160:163], v[44:47], v[48:51], v[160:163]
  s_add_u32 s44, s47, 26624
  buffer_load_dwordx4 v1, s[4:7], s44 offen offset:1024 sc1 lds
  v_mfma_f32_16x16x32_bf16 v[164:167], v[44:47], v[52:55], v[164:167]
  ds_read_b64_tr_b16 v[32:33], v10 offset:20480
  ds_read_b64_tr_b16 v[34:35], v10 offset:26624
  v_mfma_f32_16x16x32_bf16 v[168:171], v[44:47], v[56:59], v[168:171]
  v_mfma_f32_16x16x32_bf16 v[172:175], v[44:47], v[60:63], v[172:175]
  s_waitcnt lgkmcnt(6)
  v_mfma_f32_16x16x32_bf16 v[80:83], v[24:27], v[64:67], v[80:83]
  ds_read_b64_tr_b16 v[36:37], v11 offset:20480
  v_mfma_f32_16x16x32_bf16 v[84:87], v[24:27], v[68:71], v[84:87]
  s_waitcnt lgkmcnt(6)
  ds_read_b64_tr_b16 v[38:39], v11 offset:26624
  v_mfma_f32_16x16x32_bf16 v[88:91], v[24:27], v[72:75], v[88:91]
  s_waitcnt lgkmcnt(4)
  s_waitcnt vmcnt(15)
  s_barrier
  v_mfma_f32_16x16x32_bf16 v[92:95], v[24:27], v[76:79], v[92:95]
  s_mov_b32 s53, 33300488
  buffer_load_dword v244, v239, s[4:7], s53 offen sc1
  v_mfma_f32_16x16x32_bf16 v[96:99], v[28:31], v[64:67], v[96:99]
  ds_read_b64_tr_b16 v[40:41], v12 offset:20480
  v_mfma_f32_16x16x32_bf16 v[100:103], v[28:31], v[68:71], v[100:103]
  ds_read_b64_tr_b16 v[42:43], v12 offset:26624
  v_mfma_f32_16x16x32_bf16 v[104:107], v[28:31], v[72:75], v[104:107]
  v_subrev_u32 v14, 81920, v14
  ds_read_b128 v[48:51], v14 offset:0
  v_mfma_f32_16x16x32_bf16 v[108:111], v[28:31], v[76:79], v[108:111]
  s_waitcnt lgkmcnt(5)
  s_add_u32 m0, s45, 102400
  s_add_u32 s44, s50, 995328
  v_mfma_f32_16x16x32_bf16 v[112:115], v[32:35], v[64:67], v[112:115]
  buffer_load_dwordx4 v2, s[8:11], s44 offen lds
  v_mfma_f32_16x16x32_bf16 v[116:119], v[32:35], v[68:71], v[116:119]
  ds_read_b64_tr_b16 v[44:45], v13 offset:20480
  ds_read_b64_tr_b16 v[46:47], v13 offset:26624
  v_mfma_f32_16x16x32_bf16 v[120:123], v[32:35], v[72:75], v[120:123]
  ds_read_b128 v[52:55], v14 offset:1024
  v_mfma_f32_16x16x32_bf16 v[124:127], v[32:35], v[76:79], v[124:127]
  s_waitcnt lgkmcnt(6)
  v_mfma_f32_16x16x32_bf16 v[128:131], v[36:39], v[64:67], v[128:131]
  buffer_load_dwordx4 v3, s[8:11], s44 offen offset:1024 lds
  v_mfma_f32_16x16x32_bf16 v[132:135], v[36:39], v[68:71], v[132:135]
  v_subrev_u32 v8, 122880, v8
  ds_read_b64_tr_b16 v[24:25], v8 offset:0
  v_mfma_f32_16x16x32_bf16 v[136:139], v[36:39], v[72:75], v[136:139]
  ds_read_b64_tr_b16 v[26:27], v8 offset:6144
  ds_read_b128 v[56:59], v14 offset:2048
  v_mfma_f32_16x16x32_bf16 v[140:143], v[36:39], v[76:79], v[140:143]
  s_waitcnt lgkmcnt(7)
  v_mfma_f32_16x16x32_bf16 v[144:147], v[40:43], v[64:67], v[144:147]
  buffer_load_dwordx4 v4, s[8:11], s44 offen offset:2048 lds
  v_mfma_f32_16x16x32_bf16 v[148:151], v[40:43], v[68:71], v[148:151]
  v_subrev_u32 v9, 122880, v9
  ds_read_b64_tr_b16 v[28:29], v9 offset:0
  v_mfma_f32_16x16x32_bf16 v[152:155], v[40:43], v[72:75], v[152:155]
  ds_read_b64_tr_b16 v[30:31], v9 offset:6144
  ds_read_b128 v[60:63], v14 offset:3072
  v_mfma_f32_16x16x32_bf16 v[156:159], v[40:43], v[76:79], v[156:159]
  s_waitcnt lgkmcnt(7)
  v_mfma_f32_16x16x32_bf16 v[160:163], v[44:47], v[64:67], v[160:163]
  v_subrev_u32 v10, 122880, v10
  ds_read_b64_tr_b16 v[32:33], v10 offset:0
  v_mfma_f32_16x16x32_bf16 v[164:167], v[44:47], v[68:71], v[164:167]
  s_add_u32 m0, s51, 102400
  ds_read_b64_tr_b16 v[34:35], v10 offset:6144
  s_add_u32 s44, s46, 27648
  v_mfma_f32_16x16x32_bf16 v[168:171], v[44:47], v[72:75], v[168:171]
  buffer_load_dwordx4 v1, s[4:7], s44 offen sc1 lds
  v_mfma_f32_16x16x32_bf16 v[172:175], v[44:47], v[76:79], v[172:175]
  s_waitcnt lgkmcnt(6)
  v_mfma_f32_16x16x32_bf16 v[80:83], v[24:27], v[48:51], v[80:83]
  v_subrev_u32 v11, 122880, v11
  ds_read_b64_tr_b16 v[36:37], v11 offset:0
  v_mfma_f32_16x16x32_bf16 v[84:87], v[24:27], v[52:55], v[84:87]
  s_waitcnt lgkmcnt(6)
  ds_read_b64_tr_b16 v[38:39], v11 offset:6144
  v_mfma_f32_16x16x32_bf16 v[88:91], v[24:27], v[56:59], v[88:91]
  s_waitcnt lgkmcnt(4)
  s_add_u32 s44, s47, 27648
  v_mfma_f32_16x16x32_bf16 v[92:95], v[24:27], v[60:63], v[92:95]
  buffer_load_dwordx4 v1, s[4:7], s44 offen offset:1024 sc1 lds
  v_mfma_f32_16x16x32_bf16 v[96:99], v[28:31], v[48:51], v[96:99]
  v_subrev_u32 v12, 122880, v12
  ds_read_b64_tr_b16 v[40:41], v12 offset:0
  v_mfma_f32_16x16x32_bf16 v[100:103], v[28:31], v[52:55], v[100:103]
  ds_read_b64_tr_b16 v[42:43], v12 offset:6144
  v_mfma_f32_16x16x32_bf16 v[104:107], v[28:31], v[56:59], v[104:107]
  s_add_u32 m0, s45, 122880
  ds_read_b128 v[64:67], v14 offset:20480
  s_add_u32 s44, s50, 1105920
  v_mfma_f32_16x16x32_bf16 v[108:111], v[28:31], v[60:63], v[108:111]
  s_waitcnt lgkmcnt(5)
  buffer_load_dwordx4 v2, s[8:11], s44 offen lds
  v_mfma_f32_16x16x32_bf16 v[112:115], v[32:35], v[48:51], v[112:115]
  v_subrev_u32 v13, 122880, v13
  ds_read_b64_tr_b16 v[44:45], v13 offset:0
  v_mfma_f32_16x16x32_bf16 v[116:119], v[32:35], v[52:55], v[116:119]
  ds_read_b64_tr_b16 v[46:47], v13 offset:6144
  v_mfma_f32_16x16x32_bf16 v[120:123], v[32:35], v[56:59], v[120:123]
  ds_read_b128 v[68:71], v14 offset:21504
  v_mfma_f32_16x16x32_bf16 v[124:127], v[32:35], v[60:63], v[124:127]
  s_waitcnt lgkmcnt(6)
  buffer_load_dwordx4 v3, s[8:11], s44 offen offset:1024 lds
  v_mfma_f32_16x16x32_bf16 v[128:131], v[36:39], v[48:51], v[128:131]
  ds_read_b64_tr_b16 v[24:25], v8 offset:20480
  v_mfma_f32_16x16x32_bf16 v[132:135], v[36:39], v[52:55], v[132:135]
  ds_read_b64_tr_b16 v[26:27], v8 offset:26624
  v_mfma_f32_16x16x32_bf16 v[136:139], v[36:39], v[56:59], v[136:139]
  ds_read_b128 v[72:75], v14 offset:22528
  v_mfma_f32_16x16x32_bf16 v[140:143], v[36:39], v[60:63], v[140:143]
  s_waitcnt lgkmcnt(7)
  buffer_load_dwordx4 v4, s[8:11], s44 offen offset:2048 lds
  v_mfma_f32_16x16x32_bf16 v[144:147], v[40:43], v[48:51], v[144:147]
  ds_read_b64_tr_b16 v[28:29], v9 offset:20480
  v_mfma_f32_16x16x32_bf16 v[148:151], v[40:43], v[52:55], v[148:151]
  ds_read_b64_tr_b16 v[30:31], v9 offset:26624
  v_mfma_f32_16x16x32_bf16 v[152:155], v[40:43], v[56:59], v[152:155]
  ds_read_b128 v[76:79], v14 offset:23552
  v_mfma_f32_16x16x32_bf16 v[156:159], v[40:43], v[60:63], v[156:159]
  s_waitcnt lgkmcnt(7)
  v_mfma_f32_16x16x32_bf16 v[160:163], v[44:47], v[48:51], v[160:163]
  s_add_u32 m0, s51, 122880
  ds_read_b64_tr_b16 v[32:33], v10 offset:20480
  s_add_u32 s44, s46, 30720
  v_mfma_f32_16x16x32_bf16 v[164:167], v[44:47], v[52:55], v[164:167]
  buffer_load_dwordx4 v1, s[4:7], s44 offen sc1 lds
  v_mfma_f32_16x16x32_bf16 v[168:171], v[44:47], v[56:59], v[168:171]
  ds_read_b64_tr_b16 v[34:35], v10 offset:26624
  v_mfma_f32_16x16x32_bf16 v[172:175], v[44:47], v[60:63], v[172:175]
  s_waitcnt lgkmcnt(6)
  v_mfma_f32_16x16x32_bf16 v[80:83], v[24:27], v[64:67], v[80:83]
  ds_read_b64_tr_b16 v[36:37], v11 offset:20480
  v_mfma_f32_16x16x32_bf16 v[84:87], v[24:27], v[68:71], v[84:87]
  s_waitcnt lgkmcnt(6)
  ds_read_b64_tr_b16 v[38:39], v11 offset:26624
  s_add_u32 s44, s47, 30720
  v_mfma_f32_16x16x32_bf16 v[88:91], v[24:27], v[72:75], v[88:91]
  s_waitcnt lgkmcnt(4)
  s_waitcnt vmcnt(15)
  s_barrier
  v_mfma_f32_16x16x32_bf16 v[92:95], v[24:27], v[76:79], v[92:95]
  buffer_load_dwordx4 v1, s[4:7], s44 offen offset:1024 sc1 lds
  v_mfma_f32_16x16x32_bf16 v[96:99], v[28:31], v[64:67], v[96:99]
  s_add_u32 m0, s45, 143360
  ds_read_b64_tr_b16 v[40:41], v12 offset:20480
  s_add_u32 s44, s50, 1142784
  v_mfma_f32_16x16x32_bf16 v[100:103], v[28:31], v[68:71], v[100:103]
  buffer_load_dwordx4 v2, s[8:11], s44 offen lds
  v_mfma_f32_16x16x32_bf16 v[104:107], v[28:31], v[72:75], v[104:107]
  ds_read_b64_tr_b16 v[42:43], v12 offset:26624
  ds_read_b128 v[48:51], v14 offset:40960
  v_mfma_f32_16x16x32_bf16 v[108:111], v[28:31], v[76:79], v[108:111]
  s_waitcnt lgkmcnt(5)
  buffer_load_dwordx4 v3, s[8:11], s44 offen offset:1024 lds
  v_mfma_f32_16x16x32_bf16 v[112:115], v[32:35], v[64:67], v[112:115]
  ds_read_b64_tr_b16 v[44:45], v13 offset:20480
  v_mfma_f32_16x16x32_bf16 v[116:119], v[32:35], v[68:71], v[116:119]
  ds_read_b64_tr_b16 v[46:47], v13 offset:26624
  v_mfma_f32_16x16x32_bf16 v[120:123], v[32:35], v[72:75], v[120:123]
  ds_read_b128 v[52:55], v14 offset:41984
  v_mfma_f32_16x16x32_bf16 v[124:127], v[32:35], v[76:79], v[124:127]
  s_waitcnt lgkmcnt(6)
  v_mfma_f32_16x16x32_bf16 v[128:131], v[36:39], v[64:67], v[128:131]
  buffer_load_dwordx4 v4, s[8:11], s44 offen offset:2048 lds
  v_mfma_f32_16x16x32_bf16 v[132:135], v[36:39], v[68:71], v[132:135]
  ds_read_b64_tr_b16 v[24:25], v8 offset:40960
  ds_read_b64_tr_b16 v[26:27], v8 offset:47104
  v_mfma_f32_16x16x32_bf16 v[136:139], v[36:39], v[72:75], v[136:139]
  ds_read_b128 v[56:59], v14 offset:43008
  v_mfma_f32_16x16x32_bf16 v[140:143], v[36:39], v[76:79], v[140:143]
  s_waitcnt lgkmcnt(7)
  v_mfma_f32_16x16x32_bf16 v[144:147], v[40:43], v[64:67], v[144:147]
  s_add_u32 m0, s51, 143360
  ds_read_b64_tr_b16 v[28:29], v9 offset:40960
  s_add_u32 s44, s46, 31744
  v_mfma_f32_16x16x32_bf16 v[148:151], v[40:43], v[68:71], v[148:151]
  buffer_load_dwordx4 v1, s[4:7], s44 offen sc1 lds
  v_mfma_f32_16x16x32_bf16 v[152:155], v[40:43], v[72:75], v[152:155]
  ds_read_b64_tr_b16 v[30:31], v9 offset:47104
  ds_read_b128 v[60:63], v14 offset:44032
  v_mfma_f32_16x16x32_bf16 v[156:159], v[40:43], v[76:79], v[156:159]
  s_waitcnt lgkmcnt(7)
  v_mfma_f32_16x16x32_bf16 v[160:163], v[44:47], v[64:67], v[160:163]
  ds_read_b64_tr_b16 v[32:33], v10 offset:40960
  v_mfma_f32_16x16x32_bf16 v[164:167], v[44:47], v[68:71], v[164:167]
  s_add_u32 s44, s47, 31744
  buffer_load_dwordx4 v1, s[4:7], s44 offen offset:1024 sc1 lds
  v_mfma_f32_16x16x32_bf16 v[168:171], v[44:47], v[72:75], v[168:171]
  ds_read_b64_tr_b16 v[34:35], v10 offset:47104
  v_mfma_f32_16x16x32_bf16 v[172:175], v[44:47], v[76:79], v[172:175]
  s_waitcnt lgkmcnt(6)
  v_mfma_f32_16x16x32_bf16 v[80:83], v[24:27], v[48:51], v[80:83]
  ds_read_b64_tr_b16 v[36:37], v11 offset:40960
  v_mfma_f32_16x16x32_bf16 v[84:87], v[24:27], v[52:55], v[84:87]
  s_waitcnt lgkmcnt(6)
  ds_read_b64_tr_b16 v[38:39], v11 offset:47104
  v_mfma_f32_16x16x32_bf16 v[88:91], v[24:27], v[56:59], v[88:91]
  s_waitcnt lgkmcnt(4)
  s_waitcnt vmcnt(15)
  v_cmp_eq_u32 vcc, 1, v244
  s_nop 4
  s_cmp_eq_u64 vcc, -1
  s_cbranch_scc1 fnet_k2_kernel_ef3_go
  s_mov_b32 s54, 33300488
  s_mov_b32 s55, 0
fnet_k2_kernel_ef3_spin:
  buffer_load_dword v245, v239, s[4:7], s54 offen sc1
  s_waitcnt vmcnt(0)
  v_cmp_eq_u32 vcc, 1, v245
  s_add_u32 s55, s55, 1
  s_nop 3
  s_cmp_eq_u64 vcc, -1
  s_cbranch_scc1 fnet_k2_kernel_ef3_ok
  s_sleep 1
  s_cmp_lt_u32 s55, 262144
  s_cbranch_scc1 fnet_k2_kernel_ef3_spin
fnet_k2_kernel_ef3_ok:
fnet_k2_kernel_ef3_go:
  v_mfma_f32_16x16x32_bf16 v[92:95], v[24:27], v[60:63], v[92:95]
  v_mfma_f32_16x16x32_bf16 v[96:99], v[28:31], v[48:51], v[96:99]
  ds_read_b64_tr_b16 v[40:41], v12 offset:40960
  v_mfma_f32_16x16x32_bf16 v[100:103], v[28:31], v[52:55], v[100:103]
  ds_read_b64_tr_b16 v[42:43], v12 offset:47104
  v_mfma_f32_16x16x32_bf16 v[104:107], v[28:31], v[56:59], v[104:107]
  s_add_u32 m0, s45, 0
  ds_read_b128 v[64:67], v14 offset:61440
  s_add_u32 s44, s50, 73728
  v_mfma_f32_16x16x32_bf16 v[108:111], v[28:31], v[60:63], v[108:111]
  s_waitcnt lgkmcnt(5)
  buffer_load_dwordx4 v2, s[8:11], s44 offen lds
  v_mfma_f32_16x16x32_bf16 v[112:115], v[32:35], v[48:51], v[112:115]
  ds_read_b64_tr_b16 v[44:45], v13 offset:40960
  v_mfma_f32_16x16x32_bf16 v[116:119], v[32:35], v[52:55], v[116:119]
  ds_read_b64_tr_b16 v[46:47], v13 offset:47104
  v_mfma_f32_16x16x32_bf16 v[120:123], v[32:35], v[56:59], v[120:123]
  ds_read_b128 v[68:71], v14 offset:62464
  v_mfma_f32_16x16x32_bf16 v[124:127], v[32:35], v[60:63], v[124:127]
  s_waitcnt lgkmcnt(6)
  buffer_load_dwordx4 v3, s[8:11], s44 offen offset:1024 lds
  v_mfma_f32_16x16x32_bf16 v[128:131], v[36:39], v[48:51], v[128:131]
  v_add_u32 v8, 61440, v8
  ds_read_b64_tr_b16 v[24:25], v8 offset:0
  v_mfma_f32_16x16x32_bf16 v[132:135], v[36:39], v[52:55], v[132:135]
  ds_read_b64_tr_b16 v[26:27], v8 offset:6144
  v_mfma_f32_16x16x32_bf16 v[136:139], v[36:39], v[56:59], v[136:139]
  ds_read_b128 v[72:75], v14 offset:63488
  v_mfma_f32_16x16x32_bf16 v[140:143], v[36:39], v[60:63], v[140:143]
  s_waitcnt lgkmcnt(7)
  buffer_load_dwordx4 v4, s[8:11], s44 offen offset:2048 lds
  v_mfma_f32_16x16x32_bf16 v[144:147], v[40:43], v[48:51], v[144:147]
  v_add_u32 v9, 61440, v9
  ds_read_b64_tr_b16 v[28:29], v9 offset:0
  v_mfma_f32_16x16x32_bf16 v[148:151], v[40:43], v[52:55], v[148:151]
  ds_read_b64_tr_b16 v[30:31], v9 offset:6144
  v_mfma_f32_16x16x32_bf16 v[152:155], v[40:43], v[56:59], v[152:155]
  ds_read_b128 v[76:79], v14 offset:64512
  v_mfma_f32_16x16x32_bf16 v[156:159], v[40:43], v[60:63], v[156:159]
  s_waitcnt lgkmcnt(7)
  v_mfma_f32_16x16x32_bf16 v[160:163], v[44:47], v[48:51], v[160:163]
  s_add_u32 m0, s51, 0
  v_add_u32 v10, 61440, v10
  s_add_u32 s44, s46, 2048
  v_mfma_f32_16x16x32_bf16 v[164:167], v[44:47], v[52:55], v[164:167]
  buffer_load_dwordx4 v1, s[4:7], s44 offen sc1 lds
  v_mfma_f32_16x16x32_bf16 v[168:171], v[44:47], v[56:59], v[168:171]
  ds_read_b64_tr_b16 v[32:33], v10 offset:0
  ds_read_b64_tr_b16 v[34:35], v10 offset:6144
  v_mfma_f32_16x16x32_bf16 v[172:175], v[44:47], v[60:63], v[172:175]
  s_waitcnt lgkmcnt(6)
  v_mfma_f32_16x16x32_bf16 v[80:83], v[24:27], v[64:67], v[80:83]
  v_add_u32 v11, 61440, v11
  ds_read_b64_tr_b16 v[36:37], v11 offset:0
  v_mfma_f32_16x16x32_bf16 v[84:87], v[24:27], v[68:71], v[84:87]
  s_waitcnt lgkmcnt(6)
  ds_read_b64_tr_b16 v[38:39], v11 offset:6144
  s_add_u32 s44, s47, 2048
  v_mfma_f32_16x16x32_bf16 v[88:91], v[24:27], v[72:75], v[88:91]
  s_waitcnt lgkmcnt(4)
  s_waitcnt vmcnt(14)
  s_barrier
  v_mfma_f32_16x16x32_bf16 v[92:95], v[24:27], v[76:79], v[92:95]
  buffer_load_dwordx4 v1, s[4:7], s44 offen offset:1024 sc1 lds
  v_mfma_f32_16x16x32_bf16 v[96:99], v[28:31], v[64:67], v[96:99]
  s_add_u32 m0, s45, 20480
  v_add_u32 v12, 61440, v12
  s_add_u32 s44, s50, 221184
  v_mfma_f32_16x16x32_bf16 v[100:103], v[28:31], v[68:71], v[100:103]
  buffer_load_dwordx4 v2, s[8:11], s44 offen lds
  v_mfma_f32_16x16x32_bf16 v[104:107], v[28:31], v[72:75], v[104:107]
  ds_read_b64_tr_b16 v[40:41], v12 offset:0
  ds_read_b64_tr_b16 v[42:43], v12 offset:6144
  v_mfma_f32_16x16x32_bf16 v[108:111], v[28:31], v[76:79], v[108:111]
  s_waitcnt lgkmcnt(4)
  buffer_load_dwordx4 v3, s[8:11], s44 offen offset:1024 lds
  v_mfma_f32_16x16x32_bf16 v[112:115], v[32:35], v[64:67], v[112:115]
  v_add_u32 v14, 81920, v14
  ds_read_b128 v[48:51], v14 offset:0
  v_mfma_f32_16x16x32_bf16 v[116:119], v[32:35], v[68:71], v[116:119]
  v_add_u32 v13, 61440, v13
  ds_read_b64_tr_b16 v[44:45], v13 offset:0
  v_mfma_f32_16x16x32_bf16 v[120:123], v[32:35], v[72:75], v[120:123]
  ds_read_b64_tr_b16 v[46:47], v13 offset:6144
  ds_read_b128 v[52:55], v14 offset:1024
  v_mfma_f32_16x16x32_bf16 v[124:127], v[32:35], v[76:79], v[124:127]
  s_waitcnt lgkmcnt(6)
  v_mfma_f32_16x16x32_bf16 v[128:131], v[36:39], v[64:67], v[128:131]
  buffer_load_dwordx4 v4, s[8:11], s44 offen offset:2048 lds
  v_mfma_f32_16x16x32_bf16 v[132:135], v[36:39], v[68:71], v[132:135]
  ds_read_b64_tr_b16 v[24:25], v8 offset:20480
  ds_read_b64_tr_b16 v[26:27], v8 offset:26624
  v_mfma_f32_16x16x32_bf16 v[136:139], v[36:39], v[72:75], v[136:139]
  ds_read_b128 v[56:59], v14 offset:2048
  v_mfma_f32_16x16x32_bf16 v[140:143], v[36:39], v[76:79], v[140:143]
  s_waitcnt lgkmcnt(7)
  v_mfma_f32_16x16x32_bf16 v[144:147], v[40:43], v[64:67], v[144:147]
  s_add_u32 m0, s51, 20480
  ds_read_b64_tr_b16 v[28:29], v9 offset:20480
  s_add_u32 s44, s46, 6144
  v_mfma_f32_16x16x32_bf16 v[148:151], v[40:43], v[68:71], v[148:151]
  buffer_load_dwordx4 v1, s[4:7], s44 offen sc1 lds
  v_mfma_f32_16x16x32_bf16 v[152:155], v[40:43], v[72:75], v[152:155]
  ds_read_b64_tr_b16 v[30:31], v9 offset:26624
  ds_read_b128 v[60:63], v14 offset:3072
  v_mfma_f32_16x16x32_bf16 v[156:159], v[40:43], v[76:79], v[156:159]
  s_waitcnt lgkmcnt(7)
  v_mfma_f32_16x16x32_bf16 v[160:163], v[44:47], v[64:67], v[160:163]
  ds_read_b64_tr_b16 v[32:33], v10 offset:20480
  v_mfma_f32_16x16x32_bf16 v[164:167], v[44:47], v[68:71], v[164:167]
  s_add_u32 s44, s47, 6144
  buffer_load_dwordx4 v1, s[4:7], s44 offen offset:1024 sc1 lds
  v_mfma_f32_16x16x32_bf16 v[168:171], v[44:47], v[72:75], v[168:171]
  ds_read_b64_tr_b16 v[34:35], v10 offset:26624
  v_mfma_f32_16x16x32_bf16 v[172:175], v[44:47], v[76:79], v[172:175]
  s_waitcnt lgkmcnt(6)
  v_mfma_f32_16x16x32_bf16 v[80:83], v[24:27], v[48:51], v[80:83]
  ds_read_b64_tr_b16 v[36:37], v11 offset:20480
  v_mfma_f32_16x16x32_bf16 v[84:87], v[24:27], v[52:55], v[84:87]
  s_waitcnt lgkmcnt(6)
  ds_read_b64_tr_b16 v[38:39], v11 offset:26624
  v_mfma_f32_16x16x32_bf16 v[88:91], v[24:27], v[56:59], v[88:91]
  s_waitcnt lgkmcnt(4)
  s_add_u32 m0, s45, 40960
  s_add_u32 s44, s50, 368640
  v_mfma_f32_16x16x32_bf16 v[92:95], v[24:27], v[60:63], v[92:95]
  buffer_load_dwordx4 v2, s[8:11], s44 offen lds
  v_mfma_f32_16x16x32_bf16 v[96:99], v[28:31], v[48:51], v[96:99]
  ds_read_b64_tr_b16 v[40:41], v12 offset:20480
  v_mfma_f32_16x16x32_bf16 v[100:103], v[28:31], v[52:55], v[100:103]
  ds_read_b64_tr_b16 v[42:43], v12 offset:26624
  v_mfma_f32_16x16x32_bf16 v[104:107], v[28:31], v[56:59], v[104:107]
  buffer_load_dwordx4 v3, s[8:11], s44 offen offset:1024 lds
  v_mfma_f32_16x16x32_bf16 v[108:111], v[28:31], v[60:63], v[108:111]
  s_waitcnt lgkmcnt(4)
  ds_read_b128 v[64:67], v14 offset:20480
  v_mfma_f32_16x16x32_bf16 v[112:115], v[32:35], v[48:51], v[112:115]
  ds_read_b64_tr_b16 v[44:45], v13 offset:20480
  v_mfma_f32_16x16x32_bf16 v[116:119], v[32:35], v[52:55], v[116:119]
  ds_read_b64_tr_b16 v[46:47], v13 offset:26624
  v_mfma_f32_16x16x32_bf16 v[120:123], v[32:35], v[56:59], v[120:123]
  ds_read_b128 v[68:71], v14 offset:21504
  v_mfma_f32_16x16x32_bf16 v[124:127], v[32:35], v[60:63], v[124:127]
  s_waitcnt lgkmcnt(6)
  buffer_load_dwordx4 v4, s[8:11], s44 offen offset:2048 lds
  v_mfma_f32_16x16x32_bf16 v[128:131], v[36:39], v[48:51], v[128:131]
  ds_read_b64_tr_b16 v[24:25], v8 offset:40960
  v_mfma_f32_16x16x32_bf16 v[132:135], v[36:39], v[52:55], v[132:135]
  ds_read_b64_tr_b16 v[26:27], v8 offset:47104
  v_mfma_f32_16x16x32_bf16 v[136:139], v[36:39], v[56:59], v[136:139]
  ds_read_b128 v[72:75], v14 offset:22528
  v_mfma_f32_16x16x32_bf16 v[140:143], v[36:39], v[60:63], v[140:143]
  s_waitcnt lgkmcnt(7)
  s_add_u32 m0, s51, 40960
  s_add_u32 s44, s46, 10240
  v_mfma_f32_16x16x32_bf16 v[144:147], v[40:43], v[48:51], v[144:147]
  buffer_load_dwordx4 v1, s[4:7], s44 offen sc1 lds
  v_mfma_f32_16x16x32_bf16 v[148:151], v[40:43], v[52:55], v[148:151]
  ds_read_b64_tr_b16 v[28:29], v9 offset:40960
  ds_read_b64_tr_b16 v[30:31], v9 offset:47104
  v_mfma_f32_16x16x32_bf16 v[152:155], v[40:43], v[56:59], v[152:155]
  ds_read_b128 v[76:79], v14 offset:23552
  v_mfma_f32_16x16x32_bf16 v[156:159], v[40:43], v[60:63], v[156:159]
  s_waitcnt lgkmcnt(7)
  v_mfma_f32_16x16x32_bf16 v[160:163], v[44:47], v[48:51], v[160:163]
  s_add_u32 s44, s47, 10240
  buffer_load_dwordx4 v1, s[4:7], s44 offen offset:1024 sc1 lds
  v_mfma_f32_16x16x32_bf16 v[164:167], v[44:47], v[52:55], v[164:167]
  ds_read_b64_tr_b16 v[32:33], v10 offset:40960
  ds_read_b64_tr_b16 v[34:35], v10 offset:47104
  v_mfma_f32_16x16x32_bf16 v[168:171], v[44:47], v[56:59], v[168:171]
  v_mfma_f32_16x16x32_bf16 v[172:175], v[44:47], v[60:63], v[172:175]
  s_waitcnt lgkmcnt(6)
  v_mfma_f32_16x16x32_bf16 v[80:83], v[24:27], v[64:67], v[80:83]
  ds_read_b64_tr_b16 v[36:37], v11 offset:40960
  v_mfma_f32_16x16x32_bf16 v[84:87], v[24:27], v[68:71], v[84:87]
  s_waitcnt lgkmcnt(6)
  ds_read_b64_tr_b16 v[38:39], v11 offset:47104
  v_mfma_f32_16x16x32_bf16 v[88:91], v[24:27], v[72:75], v[88:91]
  s_waitcnt lgkmcnt(4)
  s_waitcnt vmcnt(15)
  s_barrier
  v_mfma_f32_16x16x32_bf16 v[92:95], v[24:27], v[76:79], v[92:95]
  s_add_u32 m0, s45, 61440
  s_add_u32 s44, s50, 516096
  v_mfma_f32_16x16x32_bf16 v[96:99], v[28:31], v[64:67], v[96:99]
  buffer_load_dwordx4 v2, s[8:11], s44 offen lds
  v_mfma_f32_16x16x32_bf16 v[100:103], v[28:31], v[68:71], v[100:103]
  ds_read_b64_tr_b16 v[40:41], v12 offset:40960
  ds_read_b64_tr_b16 v[42:43], v12 offset:47104
  v_mfma_f32_16x16x32_bf16 v[104:107], v[28:31], v[72:75], v[104:107]
  ds_read_b128 v[48:51], v14 offset:40960
  v_mfma_f32_16x16x32_bf16 v[108:111], v[28:31], v[76:79], v[108:111]
  s_waitcnt lgkmcnt(5)
  buffer_load_dwordx4 v3, s[8:11], s44 offen offset:1024 lds
  v_mfma_f32_16x16x32_bf16 v[112:115], v[32:35], v[64:67], v[112:115]
  ds_read_b64_tr_b16 v[44:45], v13 offset:40960
  v_mfma_f32_16x16x32_bf16 v[116:119], v[32:35], v[68:71], v[116:119]
  ds_read_b64_tr_b16 v[46:47], v13 offset:47104
  v_mfma_f32_16x16x32_bf16 v[120:123], v[32:35], v[72:75], v[120:123]
  ds_read_b128 v[52:55], v14 offset:41984
  v_mfma_f32_16x16x32_bf16 v[124:127], v[32:35], v[76:79], v[124:127]
  s_waitcnt lgkmcnt(6)
  v_mfma_f32_16x16x32_bf16 v[128:131], v[36:39], v[64:67], v[128:131]
  buffer_load_dwordx4 v4, s[8:11], s44 offen offset:2048 lds
  v_mfma_f32_16x16x32_bf16 v[132:135], v[36:39], v[68:71], v[132:135]
  v_add_u32 v8, 61440, v8
  ds_read_b64_tr_b16 v[24:25], v8 offset:0
  v_mfma_f32_16x16x32_bf16 v[136:139], v[36:39], v[72:75], v[136:139]
  ds_read_b64_tr_b16 v[26:27], v8 offset:6144
  ds_read_b128 v[56:59], v14 offset:43008
  v_mfma_f32_16x16x32_bf16 v[140:143], v[36:39], v[76:79], v[140:143]
  s_waitcnt lgkmcnt(7)
  v_mfma_f32_16x16x32_bf16 v[144:147], v[40:43], v[64:67], v[144:147]
  s_add_u32 m0, s51, 61440
  v_add_u32 v9, 61440, v9
  s_add_u32 s44, s46, 14336
  v_mfma_f32_16x16x32_bf16 v[148:151], v[40:43], v[68:71], v[148:151]
  buffer_load_dwordx4 v1, s[4:7], s44 offen sc1 lds
  v_mfma_f32_16x16x32_bf16 v[152:155], v[40:43], v[72:75], v[152:155]
  ds_read_b64_tr_b16 v[28:29], v9 offset:0
  ds_read_b64_tr_b16 v[30:31], v9 offset:6144
  v_mfma_f32_16x16x32_bf16 v[156:159], v[40:43], v[76:79], v[156:159]
  s_waitcnt lgkmcnt(6)
  ds_read_b128 v[60:63], v14 offset:44032
  v_mfma_f32_16x16x32_bf16 v[160:163], v[44:47], v[64:67], v[160:163]
  v_add_u32 v10, 61440, v10
  ds_read_b64_tr_b16 v[32:33], v10 offset:0
  v_mfma_f32_16x16x32_bf16 v[164:167], v[44:47], v[68:71], v[164:167]
  s_add_u32 s44, s47, 14336
  buffer_load_dwordx4 v1, s[4:7], s44 offen offset:1024 sc1 lds
  v_mfma_f32_16x16x32_bf16 v[168:171], v[44:47], v[72:75], v[168:171]
  ds_read_b64_tr_b16 v[34:35], v10 offset:6144
  v_mfma_f32_16x16x32_bf16 v[172:175], v[44:47], v[76:79], v[172:175]
  s_waitcnt lgkmcnt(6)
  v_mfma_f32_16x16x32_bf16 v[80:83], v[24:27], v[48:51], v[80:83]
  v_add_u32 v11, 61440, v11
  ds_read_b64_tr_b16 v[36:37], v11 offset:0
  v_mfma_f32_16x16x32_bf16 v[84:87], v[24:27], v[52:55], v[84:87]
  s_waitcnt lgkmcnt(6)
  ds_read_b64_tr_b16 v[38:39], v11 offset:6144
  v_mfma_f32_16x16x32_bf16 v[88:91], v[24:27], v[56:59], v[88:91]
  s_waitcnt lgkmcnt(4)
  s_add_u32 m0, s45, 81920
  s_add_u32 s44, s50, 737280
  v_mfma_f32_16x16x32_bf16 v[92:95], v[24:27], v[60:63], v[92:95]
  buffer_load_dwordx4 v2, s[8:11], s44 offen lds
  v_mfma_f32_16x16x32_bf16 v[96:99], v[28:31], v[48:51], v[96:99]
  v_add_u32 v12, 61440, v12
  ds_read_b64_tr_b16 v[40:41], v12 offset:0
  v_mfma_f32_16x16x32_bf16 v[100:103], v[28:31], v[52:55], v[100:103]
  ds_read_b64_tr_b16 v[42:43], v12 offset:6144
  v_mfma_f32_16x16x32_bf16 v[104:107], v[28:31], v[56:59], v[104:107]
  buffer_load_dwordx4 v3, s[8:11], s44 offen offset:1024 lds
  v_mfma_f32_16x16x32_bf16 v[108:111], v[28:31], v[60:63], v[108:111]
  s_waitcnt lgkmcnt(4)
  ds_read_b128 v[64:67], v14 offset:61440
  v_mfma_f32_16x16x32_bf16 v[112:115], v[32:35], v[48:51], v[112:115]
  v_add_u32 v13, 61440, v13
  ds_read_b64_tr_b16 v[44:45], v13 offset:0
  v_mfma_f32_16x16x32_bf16 v[116:119], v[32:35], v[52:55], v[116:119]
  ds_read_b64_tr_b16 v[46:47], v13 offset:6144
  v_mfma_f32_16x16x32_bf16 v[120:123], v[32:35], v[56:59], v[120:123]
  ds_read_b128 v[68:71], v14 offset:62464
  v_mfma_f32_16x16x32_bf16 v[124:127], v[32:35], v[60:63], v[124:127]
  s_waitcnt lgkmcnt(6)
  buffer_load_dwordx4 v4, s[8:11], s44 offen offset:2048 lds
  v_mfma_f32_16x16x32_bf16 v[128:131], v[36:39], v[48:51], v[128:131]
  ds_read_b64_tr_b16 v[24:25], v8 offset:20480
  v_mfma_f32_16x16x32_bf16 v[132:135], v[36:39], v[52:55], v[132:135]
  ds_read_b64_tr_b16 v[26:27], v8 offset:26624
  v_mfma_f32_16x16x32_bf16 v[136:139], v[36:39], v[56:59], v[136:139]
  ds_read_b128 v[72:75], v14 offset:63488
  v_mfma_f32_16x16x32_bf16 v[140:143], v[36:39], v[60:63], v[140:143]
  s_waitcnt lgkmcnt(7)
  s_add_u32 m0, s51, 81920
  s_add_u32 s44, s46, 20480
  v_mfma_f32_16x16x32_bf16 v[144:147], v[40:43], v[48:51], v[144:147]
  buffer_load_dwordx4 v1, s[4:7], s44 offen sc1 lds
  v_mfma_f32_16x16x32_bf16 v[148:151], v[40:43], v[52:55], v[148:151]
  ds_read_b64_tr_b16 v[28:29], v9 offset:20480
  ds_read_b64_tr_b16 v[30:31], v9 offset:26624
  v_mfma_f32_16x16x32_bf16 v[152:155], v[40:43], v[56:59], v[152:155]
  ds_read_b128 v[76:79], v14 offset:64512
  v_mfma_f32_16x16x32_bf16 v[156:159], v[40:43], v[60:63], v[156:159]
  s_waitcnt lgkmcnt(7)
  v_mfma_f32_16x16x32_bf16 v[160:163], v[44:47], v[48:51], v[160:163]
  s_add_u32 s44, s47, 20480
  buffer_load_dwordx4 v1, s[4:7], s44 offen offset:1024 sc1 lds
  v_mfma_f32_16x16x32_bf16 v[164:167], v[44:47], v[52:55], v[164:167]
  ds_read_b64_tr_b16 v[32:33], v10 offset:20480
  ds_read_b64_tr_b16 v[34:35], v10 offset:26624
  v_mfma_f32_16x16x32_bf16 v[168:171], v[44:47], v[56:59], v[168:171]
  v_mfma_f32_16x16x32_bf16 v[172:175], v[44:47], v[60:63], v[172:175]
  s_waitcnt lgkmcnt(6)
  v_mfma_f32_16x16x32_bf16 v[80:83], v[24:27], v[64:67], v[80:83]
  ds_read_b64_tr_b16 v[36:37], v11 offset:20480
  v_mfma_f32_16x16x32_bf16 v[84:87], v[24:27], v[68:71], v[84:87]
  s_waitcnt lgkmcnt(6)
  ds_read_b64_tr_b16 v[38:39], v11 offset:26624
  v_mfma_f32_16x16x32_bf16 v[88:91], v[24:27], v[72:75], v[88:91]
  s_waitcnt lgkmcnt(4)
  s_waitcnt vmcnt(15)
  s_barrier
  v_mfma_f32_16x16x32_bf16 v[92:95], v[24:27], v[76:79], v[92:95]
  s_mov_b32 s53, 33300492
  buffer_load_dword v244, v239, s[4:7], s53 offen sc1
  v_mfma_f32_16x16x32_bf16 v[96:99], v[28:31], v[64:67], v[96:99]
  ds_read_b64_tr_b16 v[40:41], v12 offset:20480
  v_mfma_f32_16x16x32_bf16 v[100:103], v[28:31], v[68:71], v[100:103]
  ds_read_b64_tr_b16 v[42:43], v12 offset:26624
  v_mfma_f32_16x16x32_bf16 v[104:107], v[28:31], v[72:75], v[104:107]
  v_subrev_u32 v14, 81920, v14
  ds_read_b128 v[48:51], v14 offset:0
  v_mfma_f32_16x16x32_bf16 v[108:111], v[28:31], v[76:79], v[108:111]
  s_waitcnt lgkmcnt(5)
  s_add_u32 m0, s45, 102400
  s_add_u32 s44, s50, 884736
  v_mfma_f32_16x16x32_bf16 v[112:115], v[32:35], v[64:67], v[112:115]
  buffer_load_dwordx4 v2, s[8:11], s44 offen lds
  v_mfma_f32_16x16x32_bf16 v[116:119], v[32:35], v[68:71], v[116:119]
  ds_read_b64_tr_b16 v[44:45], v13 offset:20480
  ds_read_b64_tr_b16 v[46:47], v13 offset:26624
  v_mfma_f32_16x16x32_bf16 v[120:123], v[32:35], v[72:75], v[120:123]
  ds_read_b128 v[52:55], v14 offset:1024
  v_mfma_f32_16x16x32_bf16 v[124:127], v[32:35], v[76:79], v[124:127]
  s_waitcnt lgkmcnt(6)
  v_mfma_f32_16x16x32_bf16 v[128:131], v[36:39], v[64:67], v[128:131]
  buffer_load_dwordx4 v3, s[8:11], s44 offen offset:1024 lds
  v_mfma_f32_16x16x32_bf16 v[132:135], v[36:39], v[68:71], v[132:135]
  v_subrev_u32 v8, 122880, v8
  ds_read_b64_tr_b16 v[24:25], v8 offset:0
  v_mfma_f32_16x16x32_bf16 v[136:139], v[36:39], v[72:75], v[136:139]
  ds_read_b64_tr_b16 v[26:27], v8 offset:6144
  ds_read_b128 v[56:59], v14 offset:2048
  v_mfma_f32_16x16x32_bf16 v[140:143], v[36:39], v[76:79], v[140:143]
  s_waitcnt lgkmcnt(7)
  v_mfma_f32_16x16x32_bf16 v[144:147], v[40:43], v[64:67], v[144:147]
  buffer_load_dwordx4 v4, s[8:11], s44 offen offset:2048 lds
  v_mfma_f32_16x16x32_bf16 v[148:151], v[40:43], v[68:71], v[148:151]
  v_subrev_u32 v9, 122880, v9
  ds_read_b64_tr_b16 v[28:29], v9 offset:0
  v_mfma_f32_16x16x32_bf16 v[152:155], v[40:43], v[72:75], v[152:155]
  ds_read_b64_tr_b16 v[30:31], v9 offset:6144
  ds_read_b128 v[60:63], v14 offset:3072
  v_mfma_f32_16x16x32_bf16 v[156:159], v[40:43], v[76:79], v[156:159]
  s_waitcnt lgkmcnt(7)
  v_mfma_f32_16x16x32_bf16 v[160:163], v[44:47], v[64:67], v[160:163]
  v_subrev_u32 v10, 122880, v10
  ds_read_b64_tr_b16 v[32:33], v10 offset:0
  v_mfma_f32_16x16x32_bf16 v[164:167], v[44:47], v[68:71], v[164:167]
  s_add_u32 m0, s51, 102400
  ds_read_b64_tr_b16 v[34:35], v10 offset:6144
  s_add_u32 s44, s46, 24576
  v_mfma_f32_16x16x32_bf16 v[168:171], v[44:47], v[72:75], v[168:171]
  buffer_load_dwordx4 v1, s[4:7], s44 offen sc1 lds
  v_mfma_f32_16x16x32_bf16 v[172:175], v[44:47], v[76:79], v[172:175]
  s_waitcnt lgkmcnt(6)
  v_mfma_f32_16x16x32_bf16 v[80:83], v[24:27], v[48:51], v[80:83]
  v_subrev_u32 v11, 122880, v11
  ds_read_b64_tr_b16 v[36:37], v11 offset:0
  v_mfma_f32_16x16x32_bf16 v[84:87], v[24:27], v[52:55], v[84:87]
  s_waitcnt lgkmcnt(6)
  ds_read_b64_tr_b16 v[38:39], v11 offset:6144
  v_mfma_f32_16x16x32_bf16 v[88:91], v[24:27], v[56:59], v[88:91]
  s_waitcnt lgkmcnt(4)
  s_add_u32 s44, s47, 24576
  v_mfma_f32_16x16x32_bf16 v[92:95], v[24:27], v[60:63], v[92:95]
  buffer_load_dwordx4 v1, s[4:7], s44 offen offset:1024 sc1 lds
  v_mfma_f32_16x16x32_bf16 v[96:99], v[28:31], v[48:51], v[96:99]
  v_subrev_u32 v12, 122880, v12
  ds_read_b64_tr_b16 v[40:41], v12 offset:0
  v_mfma_f32_16x16x32_bf16 v[100:103], v[28:31], v[52:55], v[100:103]
  ds_read_b64_tr_b16 v[42:43], v12 offset:6144
  v_mfma_f32_16x16x32_bf16 v[104:107], v[28:31], v[56:59], v[104:107]
  s_add_u32 m0, s45, 122880
  ds_read_b128 v[64:67], v14 offset:20480
  s_add_u32 s44, s50, 1032192
  v_mfma_f32_16x16x32_bf16 v[108:111], v[28:31], v[60:63], v[108:111]
  s_waitcnt lgkmcnt(5)
  buffer_load_dwordx4 v2, s[8:11], s44 offen lds
  v_mfma_f32_16x16x32_bf16 v[112:115], v[32:35], v[48:51], v[112:115]
  v_subrev_u32 v13, 122880, v13
  ds_read_b64_tr_b16 v[44:45], v13 offset:0
  v_mfma_f32_16x16x32_bf16 v[116:119], v[32:35], v[52:55], v[116:119]
  ds_read_b64_tr_b16 v[46:47], v13 offset:6144
  v_mfma_f32_16x16x32_bf16 v[120:123], v[32:35], v[56:59], v[120:123]
  ds_read_b128 v[68:71], v14 offset:21504
  v_mfma_f32_16x16x32_bf16 v[124:127], v[32:35], v[60:63], v[124:127]
  s_waitcnt lgkmcnt(6)
  buffer_load_dwordx4 v3, s[8:11], s44 offen offset:1024 lds
  v_mfma_f32_16x16x32_bf16 v[128:131], v[36:39], v[48:51], v[128:131]
  ds_read_b64_tr_b16 v[24:25], v8 offset:20480
  v_mfma_f32_16x16x32_bf16 v[132:135], v[36:39], v[52:55], v[132:135]
  ds_read_b64_tr_b16 v[26:27], v8 offset:26624
  v_mfma_f32_16x16x32_bf16 v[136:139], v[36:39], v[56:59], v[136:139]
  ds_read_b128 v[72:75], v14 offset:22528
  v_mfma_f32_16x16x32_bf16 v[140:143], v[36:39], v[60:63], v[140:143]
  s_waitcnt lgkmcnt(7)
  buffer_load_dwordx4 v4, s[8:11], s44 offen offset:2048 lds
  v_mfma_f32_16x16x32_bf16 v[144:147], v[40:43], v[48:51], v[144:147]
  ds_read_b64_tr_b16 v[28:29], v9 offset:20480
  v_mfma_f32_16x16x32_bf16 v[148:151], v[40:43], v[52:55], v[148:151]
  ds_read_b64_tr_b16 v[30:31], v9 offset:26624
  v_mfma_f32_16x16x32_bf16 v[152:155], v[40:43], v[56:59], v[152:155]
  ds_read_b128 v[76:79], v14 offset:23552
  v_mfma_f32_16x16x32_bf16 v[156:159], v[40:43], v[60:63], v[156:159]
  s_waitcnt lgkmcnt(7)
  v_mfma_f32_16x16x32_bf16 v[160:163], v[44:47], v[48:51], v[160:163]
  s_add_u32 m0, s51, 122880
  ds_read_b64_tr_b16 v[32:33], v10 offset:20480
  s_add_u32 s44, s46, 28672
  v_mfma_f32_16x16x32_bf16 v[164:167], v[44:47], v[52:55], v[164:167]
  buffer_load_dwordx4 v1, s[4:7], s44 offen sc1 lds
  v_mfma_f32_16x16x32_bf16 v[168:171], v[44:47], v[56:59], v[168:171]
  ds_read_b64_tr_b16 v[34:35], v10 offset:26624
  v_mfma_f32_16x16x32_bf16 v[172:175], v[44:47], v[60:63], v[172:175]
  s_waitcnt lgkmcnt(6)
  v_mfma_f32_16x16x32_bf16 v[80:83], v[24:27], v[64:67], v[80:83]
  ds_read_b64_tr_b16 v[36:37], v11 offset:20480
  v_mfma_f32_16x16x32_bf16 v[84:87], v[24:27], v[68:71], v[84:87]
  s_waitcnt lgkmcnt(6)
  ds_read_b64_tr_b16 v[38:39], v11 offset:26624
  s_add_u32 s44, s47, 28672
  v_mfma_f32_16x16x32_bf16 v[88:91], v[24:27], v[72:75], v[88:91]
  s_waitcnt lgkmcnt(4)
  s_waitcnt vmcnt(15)
  s_barrier
  v_mfma_f32_16x16x32_bf16 v[92:95], v[24:27], v[76:79], v[92:95]
  buffer_load_dwordx4 v1, s[4:7], s44 offen offset:1024 sc1 lds
  v_mfma_f32_16x16x32_bf16 v[96:99], v[28:31], v[64:67], v[96:99]
  s_add_u32 m0, s45, 143360
  ds_read_b64_tr_b16 v[40:41], v12 offset:20480
  s_add_u32 s44, s50, 1179648
  v_mfma_f32_16x16x32_bf16 v[100:103], v[28:31], v[68:71], v[100:103]
  buffer_load_dwordx4 v2, s[8:11], s44 offen lds
  v_mfma_f32_16x16x32_bf16 v[104:107], v[28:31], v[72:75], v[104:107]
  ds_read_b64_tr_b16 v[42:43], v12 offset:26624
  ds_read_b128 v[48:51], v14 offset:40960
  v_mfma_f32_16x16x32_bf16 v[108:111], v[28:31], v[76:79], v[108:111]
  s_waitcnt lgkmcnt(5)
  buffer_load_dwordx4 v3, s[8:11], s44 offen offset:1024 lds
  v_mfma_f32_16x16x32_bf16 v[112:115], v[32:35], v[64:67], v[112:115]
  ds_read_b64_tr_b16 v[44:45], v13 offset:20480
  v_mfma_f32_16x16x32_bf16 v[116:119], v[32:35], v[68:71], v[116:119]
  ds_read_b64_tr_b16 v[46:47], v13 offset:26624
  v_mfma_f32_16x16x32_bf16 v[120:123], v[32:35], v[72:75], v[120:123]
  ds_read_b128 v[52:55], v14 offset:41984
  v_mfma_f32_16x16x32_bf16 v[124:127], v[32:35], v[76:79], v[124:127]
  s_waitcnt lgkmcnt(6)
  v_mfma_f32_16x16x32_bf16 v[128:131], v[36:39], v[64:67], v[128:131]
  buffer_load_dwordx4 v4, s[8:11], s44 offen offset:2048 lds
  v_mfma_f32_16x16x32_bf16 v[132:135], v[36:39], v[68:71], v[132:135]
  ds_read_b64_tr_b16 v[24:25], v8 offset:40960
  ds_read_b64_tr_b16 v[26:27], v8 offset:47104
  v_mfma_f32_16x16x32_bf16 v[136:139], v[36:39], v[72:75], v[136:139]
  ds_read_b128 v[56:59], v14 offset:43008
  v_mfma_f32_16x16x32_bf16 v[140:143], v[36:39], v[76:79], v[140:143]
  s_waitcnt lgkmcnt(7)
  v_mfma_f32_16x16x32_bf16 v[144:147], v[40:43], v[64:67], v[144:147]
  s_add_u32 m0, s51, 143360
  ds_read_b64_tr_b16 v[28:29], v9 offset:40960
  s_add_u32 s44, s46, 32768
  v_mfma_f32_16x16x32_bf16 v[148:151], v[40:43], v[68:71], v[148:151]
  buffer_load_dwordx4 v1, s[4:7], s44 offen sc1 lds
  v_mfma_f32_16x16x32_bf16 v[152:155], v[40:43], v[72:75], v[152:155]
  ds_read_b64_tr_b16 v[30:31], v9 offset:47104
  ds_read_b128 v[60:63], v14 offset:44032
  v_mfma_f32_16x16x32_bf16 v[156:159], v[40:43], v[76:79], v[156:159]
  s_waitcnt lgkmcnt(7)
  v_mfma_f32_16x16x32_bf16 v[160:163], v[44:47], v[64:67], v[160:163]
  ds_read_b64_tr_b16 v[32:33], v10 offset:40960
  v_mfma_f32_16x16x32_bf16 v[164:167], v[44:47], v[68:71], v[164:167]
  s_add_u32 s44, s47, 32768
  buffer_load_dwordx4 v1, s[4:7], s44 offen offset:1024 sc1 lds
  v_mfma_f32_16x16x32_bf16 v[168:171], v[44:47], v[72:75], v[168:171]
  ds_read_b64_tr_b16 v[34:35], v10 offset:47104
  v_mfma_f32_16x16x32_bf16 v[172:175], v[44:47], v[76:79], v[172:175]
  s_waitcnt lgkmcnt(6)
  v_mfma_f32_16x16x32_bf16 v[80:83], v[24:27], v[48:51], v[80:83]
  ds_read_b64_tr_b16 v[36:37], v11 offset:40960
  v_mfma_f32_16x16x32_bf16 v[84:87], v[24:27], v[52:55], v[84:87]
  s_waitcnt lgkmcnt(6)
  ds_read_b64_tr_b16 v[38:39], v11 offset:47104
  v_mfma_f32_16x16x32_bf16 v[88:91], v[24:27], v[56:59], v[88:91]
  s_waitcnt lgkmcnt(4)
  s_waitcnt vmcnt(15)
  v_cmp_eq_u32 vcc, 1, v244
  s_nop 4
  s_cmp_eq_u64 vcc, -1
  s_cbranch_scc1 fnet_k2_kernel_ef2_go
  s_mov_b32 s54, 33300492
  s_mov_b32 s55, 0
fnet_k2_kernel_ef2_spin:
  buffer_load_dword v245, v239, s[4:7], s54 offen sc1
  s_waitcnt vmcnt(0)
  v_cmp_eq_u32 vcc, 1, v245
  s_add_u32 s55, s55, 1
  s_nop 3
  s_cmp_eq_u64 vcc, -1
  s_cbranch_scc1 fnet_k2_kernel_ef2_ok
  s_sleep 1
  s_cmp_lt_u32 s55, 262144
  s_cbranch_scc1 fnet_k2_kernel_ef2_spin
fnet_k2_kernel_ef2_ok:
fnet_k2_kernel_ef2_go:
  v_mfma_f32_16x16x32_bf16 v[92:95], v[24:27], v[60:63], v[92:95]
  v_mfma_f32_16x16x32_bf16 v[96:99], v[28:31], v[48:51], v[96:99]
  ds_read_b64_tr_b16 v[40:41], v12 offset:40960
  v_mfma_f32_16x16x32_bf16 v[100:103], v[28:31], v[52:55], v[100:103]
  ds_read_b64_tr_b16 v[42:43], v12 offset:47104
  v_mfma_f32_16x16x32_bf16 v[104:107], v[28:31], v[56:59], v[104:107]
  s_add_u32 m0, s45, 0
  ds_read_b128 v[64:67], v14 offset:61440
  s_add_u32 s44, s50, 110592
  v_mfma_f32_16x16x32_bf16 v[108:111], v[28:31], v[60:63], v[108:111]
  s_waitcnt lgkmcnt(5)
  buffer_load_dwordx4 v2, s[8:11], s44 offen lds
  v_mfma_f32_16x16x32_bf16 v[112:115], v[32:35], v[48:51], v[112:115]
  ds_read_b64_tr_b16 v[44:45], v13 offset:40960
  v_mfma_f32_16x16x32_bf16 v[116:119], v[32:35], v[52:55], v[116:119]
  ds_read_b64_tr_b16 v[46:47], v13 offset:47104
  v_mfma_f32_16x16x32_bf16 v[120:123], v[32:35], v[56:59], v[120:123]
  ds_read_b128 v[68:71], v14 offset:62464
  v_mfma_f32_16x16x32_bf16 v[124:127], v[32:35], v[60:63], v[124:127]
  s_waitcnt lgkmcnt(6)
  buffer_load_dwordx4 v3, s[8:11], s44 offen offset:1024 lds
  v_mfma_f32_16x16x32_bf16 v[128:131], v[36:39], v[48:51], v[128:131]
  v_add_u32 v8, 61440, v8
  ds_read_b64_tr_b16 v[24:25], v8 offset:0
  v_mfma_f32_16x16x32_bf16 v[132:135], v[36:39], v[52:55], v[132:135]
  ds_read_b64_tr_b16 v[26:27], v8 offset:6144
  v_mfma_f32_16x16x32_bf16 v[136:139], v[36:39], v[56:59], v[136:139]
  ds_read_b128 v[72:75], v14 offset:63488
  v_mfma_f32_16x16x32_bf16 v[140:143], v[36:39], v[60:63], v[140:143]
  s_waitcnt lgkmcnt(7)
  buffer_load_dwordx4 v4, s[8:11], s44 offen offset:2048 lds
  v_mfma_f32_16x16x32_bf16 v[144:147], v[40:43], v[48:51], v[144:147]
  v_add_u32 v9, 61440, v9
  ds_read_b64_tr_b16 v[28:29], v9 offset:0
  v_mfma_f32_16x16x32_bf16 v[148:151], v[40:43], v[52:55], v[148:151]
  ds_read_b64_tr_b16 v[30:31], v9 offset:6144
  v_mfma_f32_16x16x32_bf16 v[152:155], v[40:43], v[56:59], v[152:155]
  ds_read_b128 v[76:79], v14 offset:64512
  v_mfma_f32_16x16x32_bf16 v[156:159], v[40:43], v[60:63], v[156:159]
  s_waitcnt lgkmcnt(7)
  v_mfma_f32_16x16x32_bf16 v[160:163], v[44:47], v[48:51], v[160:163]
  s_add_u32 m0, s51, 0
  v_add_u32 v10, 61440, v10
  s_add_u32 s44, s46, 3072
  v_mfma_f32_16x16x32_bf16 v[164:167], v[44:47], v[52:55], v[164:167]
  buffer_load_dwordx4 v1, s[4:7], s44 offen sc1 lds
  v_mfma_f32_16x16x32_bf16 v[168:171], v[44:47], v[56:59], v[168:171]
  ds_read_b64_tr_b16 v[32:33], v10 offset:0
  ds_read_b64_tr_b16 v[34:35], v10 offset:6144
  v_mfma_f32_16x16x32_bf16 v[172:175], v[44:47], v[60:63], v[172:175]
  s_waitcnt lgkmcnt(6)
  v_mfma_f32_16x16x32_bf16 v[80:83], v[24:27], v[64:67], v[80:83]
  v_add_u32 v11, 61440, v11
  ds_read_b64_tr_b16 v[36:37], v11 offset:0
  v_mfma_f32_16x16x32_bf16 v[84:87], v[24:27], v[68:71], v[84:87]
  s_waitcnt lgkmcnt(6)
  ds_read_b64_tr_b16 v[38:39], v11 offset:6144
  s_add_u32 s44, s47, 3072
  v_mfma_f32_16x16x32_bf16 v[88:91], v[24:27], v[72:75], v[88:91]
  s_waitcnt lgkmcnt(4)
  s_waitcnt vmcnt(14)
  s_barrier
  v_mfma_f32_16x16x32_bf16 v[92:95], v[24:27], v[76:79], v[92:95]
  buffer_load_dwordx4 v1, s[4:7], s44 offen offset:1024 sc1 lds
  v_mfma_f32_16x16x32_bf16 v[96:99], v[28:31], v[64:67], v[96:99]
  s_add_u32 m0, s45, 20480
  v_add_u32 v12, 61440, v12
  s_add_u32 s44, s50, 258048
  v_mfma_f32_16x16x32_bf16 v[100:103], v[28:31], v[68:71], v[100:103]
  buffer_load_dwordx4 v2, s[8:11], s44 offen lds
  v_mfma_f32_16x16x32_bf16 v[104:107], v[28:31], v[72:75], v[104:107]
  ds_read_b64_tr_b16 v[40:41], v12 offset:0
  ds_read_b64_tr_b16 v[42:43], v12 offset:6144
  v_mfma_f32_16x16x32_bf16 v[108:111], v[28:31], v[76:79], v[108:111]
  s_waitcnt lgkmcnt(4)
  buffer_load_dwordx4 v3, s[8:11], s44 offen offset:1024 lds
  v_mfma_f32_16x16x32_bf16 v[112:115], v[32:35], v[64:67], v[112:115]
  v_add_u32 v14, 81920, v14
  ds_read_b128 v[48:51], v14 offset:0
  v_mfma_f32_16x16x32_bf16 v[116:119], v[32:35], v[68:71], v[116:119]
  v_add_u32 v13, 61440, v13
  ds_read_b64_tr_b16 v[44:45], v13 offset:0
  v_mfma_f32_16x16x32_bf16 v[120:123], v[32:35], v[72:75], v[120:123]
  ds_read_b64_tr_b16 v[46:47], v13 offset:6144
  ds_read_b128 v[52:55], v14 offset:1024
  v_mfma_f32_16x16x32_bf16 v[124:127], v[32:35], v[76:79], v[124:127]
  s_waitcnt lgkmcnt(6)
  v_mfma_f32_16x16x32_bf16 v[128:131], v[36:39], v[64:67], v[128:131]
  buffer_load_dwordx4 v4, s[8:11], s44 offen offset:2048 lds
  v_mfma_f32_16x16x32_bf16 v[132:135], v[36:39], v[68:71], v[132:135]
  ds_read_b64_tr_b16 v[24:25], v8 offset:20480
  ds_read_b64_tr_b16 v[26:27], v8 offset:26624
  v_mfma_f32_16x16x32_bf16 v[136:139], v[36:39], v[72:75], v[136:139]
  ds_read_b128 v[56:59], v14 offset:2048
  v_mfma_f32_16x16x32_bf16 v[140:143], v[36:39], v[76:79], v[140:143]
  s_waitcnt lgkmcnt(7)
  v_mfma_f32_16x16x32_bf16 v[144:147], v[40:43], v[64:67], v[144:147]
  s_add_u32 m0, s51, 20480
  ds_read_b64_tr_b16 v[28:29], v9 offset:20480
  s_add_u32 s44, s46, 7168
  v_mfma_f32_16x16x32_bf16 v[148:151], v[40:43], v[68:71], v[148:151]
  buffer_load_dwordx4 v1, s[4:7], s44 offen sc1 lds
  v_mfma_f32_16x16x32_bf16 v[152:155], v[40:43], v[72:75], v[152:155]
  ds_read_b64_tr_b16 v[30:31], v9 offset:26624
  ds_read_b128 v[60:63], v14 offset:3072
  v_mfma_f32_16x16x32_bf16 v[156:159], v[40:43], v[76:79], v[156:159]
  s_waitcnt lgkmcnt(7)
  v_mfma_f32_16x16x32_bf16 v[160:163], v[44:47], v[64:67], v[160:163]
  ds_read_b64_tr_b16 v[32:33], v10 offset:20480
  v_mfma_f32_16x16x32_bf16 v[164:167], v[44:47], v[68:71], v[164:167]
  s_add_u32 s44, s47, 7168
  buffer_load_dwordx4 v1, s[4:7], s44 offen offset:1024 sc1 lds
  v_mfma_f32_16x16x32_bf16 v[168:171], v[44:47], v[72:75], v[168:171]
  ds_read_b64_tr_b16 v[34:35], v10 offset:26624
  v_mfma_f32_16x16x32_bf16 v[172:175], v[44:47], v[76:79], v[172:175]
  s_waitcnt lgkmcnt(6)
  v_mfma_f32_16x16x32_bf16 v[80:83], v[24:27], v[48:51], v[80:83]
  ds_read_b64_tr_b16 v[36:37], v11 offset:20480
  v_mfma_f32_16x16x32_bf16 v[84:87], v[24:27], v[52:55], v[84:87]
  s_waitcnt lgkmcnt(6)
  ds_read_b64_tr_b16 v[38:39], v11 offset:26624
  v_mfma_f32_16x16x32_bf16 v[88:91], v[24:27], v[56:59], v[88:91]
  s_waitcnt lgkmcnt(4)
  s_add_u32 m0, s45, 40960
  s_add_u32 s44, s50, 405504
  v_mfma_f32_16x16x32_bf16 v[92:95], v[24:27], v[60:63], v[92:95]
  buffer_load_dwordx4 v2, s[8:11], s44 offen lds
  v_mfma_f32_16x16x32_bf16 v[96:99], v[28:31], v[48:51], v[96:99]
  ds_read_b64_tr_b16 v[40:41], v12 offset:20480
  v_mfma_f32_16x16x32_bf16 v[100:103], v[28:31], v[52:55], v[100:103]
  ds_read_b64_tr_b16 v[42:43], v12 offset:26624
  v_mfma_f32_16x16x32_bf16 v[104:107], v[28:31], v[56:59], v[104:107]
  buffer_load_dwordx4 v3, s[8:11], s44 offen offset:1024 lds
  v_mfma_f32_16x16x32_bf16 v[108:111], v[28:31], v[60:63], v[108:111]
  s_waitcnt lgkmcnt(4)
  ds_read_b128 v[64:67], v14 offset:20480
  v_mfma_f32_16x16x32_bf16 v[112:115], v[32:35], v[48:51], v[112:115]
  ds_read_b64_tr_b16 v[44:45], v13 offset:20480
  v_mfma_f32_16x16x32_bf16 v[116:119], v[32:35], v[52:55], v[116:119]
  ds_read_b64_tr_b16 v[46:47], v13 offset:26624
  v_mfma_f32_16x16x32_bf16 v[120:123], v[32:35], v[56:59], v[120:123]
  ds_read_b128 v[68:71], v14 offset:21504
  v_mfma_f32_16x16x32_bf16 v[124:127], v[32:35], v[60:63], v[124:127]
  s_waitcnt lgkmcnt(6)
  buffer_load_dwordx4 v4, s[8:11], s44 offen offset:2048 lds
  v_mfma_f32_16x16x32_bf16 v[128:131], v[36:39], v[48:51], v[128:131]
  ds_read_b64_tr_b16 v[24:25], v8 offset:40960
  v_mfma_f32_16x16x32_bf16 v[132:135], v[36:39], v[52:55], v[132:135]
  ds_read_b64_tr_b16 v[26:27], v8 offset:47104
  v_mfma_f32_16x16x32_bf16 v[136:139], v[36:39], v[56:59], v[136:139]
  ds_read_b128 v[72:75], v14 offset:22528
  v_mfma_f32_16x16x32_bf16 v[140:143], v[36:39], v[60:63], v[140:143]
  s_waitcnt lgkmcnt(7)
  s_add_u32 m0, s51, 40960
  s_add_u32 s44, s46, 11264
  v_mfma_f32_16x16x32_bf16 v[144:147], v[40:43], v[48:51], v[144:147]
  buffer_load_dwordx4 v1, s[4:7], s44 offen sc1 lds
  v_mfma_f32_16x16x32_bf16 v[148:151], v[40:43], v[52:55], v[148:151]
  ds_read_b64_tr_b16 v[28:29], v9 offset:40960
  ds_read_b64_tr_b16 v[30:31], v9 offset:47104
  v_mfma_f32_16x16x32_bf16 v[152:155], v[40:43], v[56:59], v[152:155]
  ds_read_b128 v[76:79], v14 offset:23552
  v_mfma_f32_16x16x32_bf16 v[156:159], v[40:43], v[60:63], v[156:159]
  s_waitcnt lgkmcnt(7)
  v_mfma_f32_16x16x32_bf16 v[160:163], v[44:47], v[48:51], v[160:163]
  s_add_u32 s44, s47, 11264
  buffer_load_dwordx4 v1, s[4:7], s44 offen offset:1024 sc1 lds
  v_mfma_f32_16x16x32_bf16 v[164:167], v[44:47], v[52:55], v[164:167]
  ds_read_b64_tr_b16 v[32:33], v10 offset:40960
  ds_read_b64_tr_b16 v[34:35], v10 offset:47104
  v_mfma_f32_16x16x32_bf16 v[168:171], v[44:47], v[56:59], v[168:171]
  v_mfma_f32_16x16x32_bf16 v[172:175], v[44:47], v[60:63], v[172:175]
  s_waitcnt lgkmcnt(6)
  v_mfma_f32_16x16x32_bf16 v[80:83], v[24:27], v[64:67], v[80:83]
  ds_read_b64_tr_b16 v[36:37], v11 offset:40960
  v_mfma_f32_16x16x32_bf16 v[84:87], v[24:27], v[68:71], v[84:87]
  s_waitcnt lgkmcnt(6)
  ds_read_b64_tr_b16 v[38:39], v11 offset:47104
  v_mfma_f32_16x16x32_bf16 v[88:91], v[24:27], v[72:75], v[88:91]
  s_waitcnt lgkmcnt(4)
  s_waitcnt vmcnt(15)
  s_barrier
  v_mfma_f32_16x16x32_bf16 v[92:95], v[24:27], v[76:79], v[92:95]
  s_add_u32 m0, s45, 61440
  s_add_u32 s44, s50, 552960
  v_mfma_f32_16x16x32_bf16 v[96:99], v[28:31], v[64:67], v[96:99]
  buffer_load_dwordx4 v2, s[8:11], s44 offen lds
  v_mfma_f32_16x16x32_bf16 v[100:103], v[28:31], v[68:71], v[100:103]
  ds_read_b64_tr_b16 v[40:41], v12 offset:40960
  ds_read_b64_tr_b16 v[42:43], v12 offset:47104
  v_mfma_f32_16x16x32_bf16 v[104:107], v[28:31], v[72:75], v[104:107]
  ds_read_b128 v[48:51], v14 offset:40960
  v_mfma_f32_16x16x32_bf16 v[108:111], v[28:31], v[76:79], v[108:111]
  s_waitcnt lgkmcnt(5)
  buffer_load_dwordx4 v3, s[8:11], s44 offen offset:1024 lds
  v_mfma_f32_16x16x32_bf16 v[112:115], v[32:35], v[64:67], v[112:115]
  ds_read_b64_tr_b16 v[44:45], v13 offset:40960
  v_mfma_f32_16x16x32_bf16 v[116:119], v[32:35], v[68:71], v[116:119]
  ds_read_b64_tr_b16 v[46:47], v13 offset:47104
  v_mfma_f32_16x16x32_bf16 v[120:123], v[32:35], v[72:75], v[120:123]
  ds_read_b128 v[52:55], v14 offset:41984
  v_mfma_f32_16x16x32_bf16 v[124:127], v[32:35], v[76:79], v[124:127]
  s_waitcnt lgkmcnt(6)
  v_mfma_f32_16x16x32_bf16 v[128:131], v[36:39], v[64:67], v[128:131]
  buffer_load_dwordx4 v4, s[8:11], s44 offen offset:2048 lds
  v_mfma_f32_16x16x32_bf16 v[132:135], v[36:39], v[68:71], v[132:135]
  v_add_u32 v8, 61440, v8
  ds_read_b64_tr_b16 v[24:25], v8 offset:0
  v_mfma_f32_16x16x32_bf16 v[136:139], v[36:39], v[72:75], v[136:139]
  ds_read_b64_tr_b16 v[26:27], v8 offset:6144
  ds_read_b128 v[56:59], v14 offset:43008
  v_mfma_f32_16x16x32_bf16 v[140:143], v[36:39], v[76:79], v[140:143]
  s_waitcnt lgkmcnt(7)
  v_mfma_f32_16x16x32_bf16 v[144:147], v[40:43], v[64:67], v[144:147]
  s_add_u32 m0, s51, 61440
  v_add_u32 v9, 61440, v9
  s_add_u32 s44, s46, 15360
  v_mfma_f32_16x16x32_bf16 v[148:151], v[40:43], v[68:71], v[148:151]
  buffer_load_dwordx4 v1, s[4:7], s44 offen sc1 lds
  v_mfma_f32_16x16x32_bf16 v[152:155], v[40:43], v[72:75], v[152:155]
  ds_read_b64_tr_b16 v[28:29], v9 offset:0
  ds_read_b64_tr_b16 v[30:31], v9 offset:6144
  v_mfma_f32_16x16x32_bf16 v[156:159], v[40:43], v[76:79], v[156:159]
  s_waitcnt lgkmcnt(6)
  ds_read_b128 v[60:63], v14 offset:44032
  v_mfma_f32_16x16x32_bf16 v[160:163], v[44:47], v[64:67], v[160:163]
  v_add_u32 v10, 61440, v10
  ds_read_b64_tr_b16 v[32:33], v10 offset:0
  v_mfma_f32_16x16x32_bf16 v[164:167], v[44:47], v[68:71], v[164:167]
  s_add_u32 s44, s47, 15360
  buffer_load_dwordx4 v1, s[4:7], s44 offen offset:1024 sc1 lds
  v_mfma_f32_16x16x32_bf16 v[168:171], v[44:47], v[72:75], v[168:171]
  ds_read_b64_tr_b16 v[34:35], v10 offset:6144
  v_mfma_f32_16x16x32_bf16 v[172:175], v[44:47], v[76:79], v[172:175]
  s_waitcnt lgkmcnt(6)
  v_mfma_f32_16x16x32_bf16 v[80:83], v[24:27], v[48:51], v[80:83]
  v_add_u32 v11, 61440, v11
  ds_read_b64_tr_b16 v[36:37], v11 offset:0
  v_mfma_f32_16x16x32_bf16 v[84:87], v[24:27], v[52:55], v[84:87]
  s_waitcnt lgkmcnt(6)
  ds_read_b64_tr_b16 v[38:39], v11 offset:6144
  v_mfma_f32_16x16x32_bf16 v[88:91], v[24:27], v[56:59], v[88:91]
  s_waitcnt lgkmcnt(4)
  s_add_u32 m0, s45, 81920
  s_add_u32 s44, s50, 774144
  v_mfma_f32_16x16x32_bf16 v[92:95], v[24:27], v[60:63], v[92:95]
  buffer_load_dwordx4 v2, s[8:11], s44 offen lds
  v_mfma_f32_16x16x32_bf16 v[96:99], v[28:31], v[48:51], v[96:99]
  v_add_u32 v12, 61440, v12
  ds_read_b64_tr_b16 v[40:41], v12 offset:0
  v_mfma_f32_16x16x32_bf16 v[100:103], v[28:31], v[52:55], v[100:103]
  ds_read_b64_tr_b16 v[42:43], v12 offset:6144
  v_mfma_f32_16x16x32_bf16 v[104:107], v[28:31], v[56:59], v[104:107]
  buffer_load_dwordx4 v3, s[8:11], s44 offen offset:1024 lds
  v_mfma_f32_16x16x32_bf16 v[108:111], v[28:31], v[60:63], v[108:111]
  s_waitcnt lgkmcnt(4)
  ds_read_b128 v[64:67], v14 offset:61440
  v_mfma_f32_16x16x32_bf16 v[112:115], v[32:35], v[48:51], v[112:115]
  v_add_u32 v13, 61440, v13
  ds_read_b64_tr_b16 v[44:45], v13 offset:0
  v_mfma_f32_16x16x32_bf16 v[116:119], v[32:35], v[52:55], v[116:119]
  ds_read_b64_tr_b16 v[46:47], v13 offset:6144
  v_mfma_f32_16x16x32_bf16 v[120:123], v[32:35], v[56:59], v[120:123]
  ds_read_b128 v[68:71], v14 offset:62464
  v_mfma_f32_16x16x32_bf16 v[124:127], v[32:35], v[60:63], v[124:127]
  s_waitcnt lgkmcnt(6)
  buffer_load_dwordx4 v4, s[8:11], s44 offen offset:2048 lds
  v_mfma_f32_16x16x32_bf16 v[128:131], v[36:39], v[48:51], v[128:131]
  ds_read_b64_tr_b16 v[24:25], v8 offset:20480
  v_mfma_f32_16x16x32_bf16 v[132:135], v[36:39], v[52:55], v[132:135]
  ds_read_b64_tr_b16 v[26:27], v8 offset:26624
  v_mfma_f32_16x16x32_bf16 v[136:139], v[36:39], v[56:59], v[136:139]
  ds_read_b128 v[72:75], v14 offset:63488
  v_mfma_f32_16x16x32_bf16 v[140:143], v[36:39], v[60:63], v[140:143]
  s_waitcnt lgkmcnt(7)
  s_add_u32 m0, s51, 81920
  s_add_u32 s44, s46, 21504
  v_mfma_f32_16x16x32_bf16 v[144:147], v[40:43], v[48:51], v[144:147]
  buffer_load_dwordx4 v1, s[4:7], s44 offen sc1 lds
  v_mfma_f32_16x16x32_bf16 v[148:151], v[40:43], v[52:55], v[148:151]
  ds_read_b64_tr_b16 v[28:29], v9 offset:20480
  ds_read_b64_tr_b16 v[30:31], v9 offset:26624
  v_mfma_f32_16x16x32_bf16 v[152:155], v[40:43], v[56:59], v[152:155]
  ds_read_b128 v[76:79], v14 offset:64512
  v_mfma_f32_16x16x32_bf16 v[156:159], v[40:43], v[60:63], v[156:159]
  s_waitcnt lgkmcnt(7)
  v_mfma_f32_16x16x32_bf16 v[160:163], v[44:47], v[48:51], v[160:163]
  s_add_u32 s44, s47, 21504
  buffer_load_dwordx4 v1, s[4:7], s44 offen offset:1024 sc1 lds
  v_mfma_f32_16x16x32_bf16 v[164:167], v[44:47], v[52:55], v[164:167]
  ds_read_b64_tr_b16 v[32:33], v10 offset:20480
  ds_read_b64_tr_b16 v[34:35], v10 offset:26624
  v_mfma_f32_16x16x32_bf16 v[168:171], v[44:47], v[56:59], v[168:171]
  v_mfma_f32_16x16x32_bf16 v[172:175], v[44:47], v[60:63], v[172:175]
  s_waitcnt lgkmcnt(6)
  v_mfma_f32_16x16x32_bf16 v[80:83], v[24:27], v[64:67], v[80:83]
  ds_read_b64_tr_b16 v[36:37], v11 offset:20480
  v_mfma_f32_16x16x32_bf16 v[84:87], v[24:27], v[68:71], v[84:87]
  s_waitcnt lgkmcnt(6)
  ds_read_b64_tr_b16 v[38:39], v11 offset:26624
  v_mfma_f32_16x16x32_bf16 v[88:91], v[24:27], v[72:75], v[88:91]
  s_waitcnt lgkmcnt(4)
  s_waitcnt vmcnt(15)
  s_barrier
  v_mfma_f32_16x16x32_bf16 v[92:95], v[24:27], v[76:79], v[92:95]
  s_add_u32 m0, s45, 102400
  s_add_u32 s44, s50, 921600
  v_mfma_f32_16x16x32_bf16 v[96:99], v[28:31], v[64:67], v[96:99]
  buffer_load_dwordx4 v2, s[8:11], s44 offen lds
  v_mfma_f32_16x16x32_bf16 v[100:103], v[28:31], v[68:71], v[100:103]
  ds_read_b64_tr_b16 v[40:41], v12 offset:20480
  ds_read_b64_tr_b16 v[42:43], v12 offset:26624
  v_mfma_f32_16x16x32_bf16 v[104:107], v[28:31], v[72:75], v[104:107]
  v_subrev_u32 v14, 81920, v14
  ds_read_b128 v[48:51], v14 offset:0
  v_mfma_f32_16x16x32_bf16 v[108:111], v[28:31], v[76:79], v[108:111]
  s_waitcnt lgkmcnt(5)
  buffer_load_dwordx4 v3, s[8:11], s44 offen offset:1024 lds
  v_mfma_f32_16x16x32_bf16 v[112:115], v[32:35], v[64:67], v[112:115]
  ds_read_b64_tr_b16 v[44:45], v13 offset:20480
  v_mfma_f32_16x16x32_bf16 v[116:119], v[32:35], v[68:71], v[116:119]
  ds_read_b64_tr_b16 v[46:47], v13 offset:26624
  v_mfma_f32_16x16x32_bf16 v[120:123], v[32:35], v[72:75], v[120:123]
  ds_read_b128 v[52:55], v14 offset:1024
  v_mfma_f32_16x16x32_bf16 v[124:127], v[32:35], v[76:79], v[124:127]
  s_waitcnt lgkmcnt(6)
  v_mfma_f32_16x16x32_bf16 v[128:131], v[36:39], v[64:67], v[128:131]
  buffer_load_dwordx4 v4, s[8:11], s44 offen offset:2048 lds
  v_mfma_f32_16x16x32_bf16 v[132:135], v[36:39], v[68:71], v[132:135]
  v_subrev_u32 v8, 122880, v8
  ds_read_b64_tr_b16 v[24:25], v8 offset:0
  v_mfma_f32_16x16x32_bf16 v[136:139], v[36:39], v[72:75], v[136:139]
  ds_read_b64_tr_b16 v[26:27], v8 offset:6144
  ds_read_b128 v[56:59], v14 offset:2048
  v_mfma_f32_16x16x32_bf16 v[140:143], v[36:39], v[76:79], v[140:143]
  s_waitcnt lgkmcnt(7)
  v_mfma_f32_16x16x32_bf16 v[144:147], v[40:43], v[64:67], v[144:147]
  s_add_u32 m0, s51, 102400
  v_subrev_u32 v9, 122880, v9
  s_add_u32 s44, s46, 25600
  v_mfma_f32_16x16x32_bf16 v[148:151], v[40:43], v[68:71], v[148:151]
  buffer_load_dwordx4 v1, s[4:7], s44 offen sc1 lds
  v_mfma_f32_16x16x32_bf16 v[152:155], v[40:43], v[72:75], v[152:155]
  ds_read_b64_tr_b16 v[28:29], v9 offset:0
  ds_read_b64_tr_b16 v[30:31], v9 offset:6144
  v_mfma_f32_16x16x32_bf16 v[156:159], v[40:43], v[76:79], v[156:159]
  s_waitcnt lgkmcnt(6)
  ds_read_b128 v[60:63], v14 offset:3072
  v_mfma_f32_16x16x32_bf16 v[160:163], v[44:47], v[64:67], v[160:163]
  v_subrev_u32 v10, 122880, v10
  ds_read_b64_tr_b16 v[32:33], v10 offset:0
  v_mfma_f32_16x16x32_bf16 v[164:167], v[44:47], v[68:71], v[164:167]
  s_add_u32 s44, s47, 25600
  buffer_load_dwordx4 v1, s[4:7], s44 offen offset:1024 sc1 lds
  v_mfma_f32_16x16x32_bf16 v[168:171], v[44:47], v[72:75], v[168:171]
  ds_read_b64_tr_b16 v[34:35], v10 offset:6144
  v_mfma_f32_16x16x32_bf16 v[172:175], v[44:47], v[76:79], v[172:175]
  s_waitcnt lgkmcnt(6)
  v_mfma_f32_16x16x32_bf16 v[80:83], v[24:27], v[48:51], v[80:83]
  v_subrev_u32 v11, 122880, v11
  ds_read_b64_tr_b16 v[36:37], v11 offset:0
  v_mfma_f32_16x16x32_bf16 v[84:87], v[24:27], v[52:55], v[84:87]
  s_waitcnt lgkmcnt(6)
  ds_read_b64_tr_b16 v[38:39], v11 offset:6144
  v_mfma_f32_16x16x32_bf16 v[88:91], v[24:27], v[56:59], v[88:91]
  s_waitcnt lgkmcnt(4)
  s_add_u32 m0, s45, 122880
  s_add_u32 s44, s50, 1069056
  v_mfma_f32_16x16x32_bf16 v[92:95], v[24:27], v[60:63], v[92:95]
  buffer_load_dwordx4 v2, s[8:11], s44 offen lds
  v_mfma_f32_16x16x32_bf16 v[96:99], v[28:31], v[48:51], v[96:99]
  v_subrev_u32 v12, 122880, v12
  ds_read_b64_tr_b16 v[40:41], v12 offset:0
  v_mfma_f32_16x16x32_bf16 v[100:103], v[28:31], v[52:55], v[100:103]
  ds_read_b64_tr_b16 v[42:43], v12 offset:6144
  v_mfma_f32_16x16x32_bf16 v[104:107], v[28:31], v[56:59], v[104:107]
  buffer_load_dwordx4 v3, s[8:11], s44 offen offset:1024 lds
  v_mfma_f32_16x16x32_bf16 v[108:111], v[28:31], v[60:63], v[108:111]
  s_waitcnt lgkmcnt(4)
  ds_read_b128 v[64:67], v14 offset:20480
  v_mfma_f32_16x16x32_bf16 v[112:115], v[32:35], v[48:51], v[112:115]
  v_subrev_u32 v13, 122880, v13
  ds_read_b64_tr_b16 v[44:45], v13 offset:0
  v_mfma_f32_16x16x32_bf16 v[116:119], v[32:35], v[52:55], v[116:119]
  ds_read_b64_tr_b16 v[46:47], v13 offset:6144
  v_mfma_f32_16x16x32_bf16 v[120:123], v[32:35], v[56:59], v[120:123]
  ds_read_b128 v[68:71], v14 offset:21504
  v_mfma_f32_16x16x32_bf16 v[124:127], v[32:35], v[60:63], v[124:127]
  s_waitcnt lgkmcnt(6)
  buffer_load_dwordx4 v4, s[8:11], s44 offen offset:2048 lds
  v_mfma_f32_16x16x32_bf16 v[128:131], v[36:39], v[48:51], v[128:131]
  ds_read_b64_tr_b16 v[24:25], v8 offset:20480
  v_mfma_f32_16x16x32_bf16 v[132:135], v[36:39], v[52:55], v[132:135]
  ds_read_b64_tr_b16 v[26:27], v8 offset:26624
  v_mfma_f32_16x16x32_bf16 v[136:139], v[36:39], v[56:59], v[136:139]
  ds_read_b128 v[72:75], v14 offset:22528
  v_mfma_f32_16x16x32_bf16 v[140:143], v[36:39], v[60:63], v[140:143]
  s_waitcnt lgkmcnt(7)
  s_add_u32 m0, s51, 122880
  s_add_u32 s44, s46, 29696
  v_mfma_f32_16x16x32_bf16 v[144:147], v[40:43], v[48:51], v[144:147]
  buffer_load_dwordx4 v1, s[4:7], s44 offen sc1 lds
  v_mfma_f32_16x16x32_bf16 v[148:151], v[40:43], v[52:55], v[148:151]
  ds_read_b64_tr_b16 v[28:29], v9 offset:20480
  ds_read_b64_tr_b16 v[30:31], v9 offset:26624
  v_mfma_f32_16x16x32_bf16 v[152:155], v[40:43], v[56:59], v[152:155]
  ds_read_b128 v[76:79], v14 offset:23552
  v_mfma_f32_16x16x32_bf16 v[156:159], v[40:43], v[60:63], v[156:159]
  s_waitcnt lgkmcnt(7)
  v_mfma_f32_16x16x32_bf16 v[160:163], v[44:47], v[48:51], v[160:163]
  s_add_u32 s44, s47, 29696
  buffer_load_dwordx4 v1, s[4:7], s44 offen offset:1024 sc1 lds
  v_mfma_f32_16x16x32_bf16 v[164:167], v[44:47], v[52:55], v[164:167]
  ds_read_b64_tr_b16 v[32:33], v10 offset:20480
  ds_read_b64_tr_b16 v[34:35], v10 offset:26624
  v_mfma_f32_16x16x32_bf16 v[168:171], v[44:47], v[56:59], v[168:171]
  v_mfma_f32_16x16x32_bf16 v[172:175], v[44:47], v[60:63], v[172:175]
  s_waitcnt lgkmcnt(6)
  v_mfma_f32_16x16x32_bf16 v[80:83], v[24:27], v[64:67], v[80:83]
  ds_read_b64_tr_b16 v[36:37], v11 offset:20480
  v_mfma_f32_16x16x32_bf16 v[84:87], v[24:27], v[68:71], v[84:87]
  s_waitcnt lgkmcnt(6)
  ds_read_b64_tr_b16 v[38:39], v11 offset:26624
  v_mfma_f32_16x16x32_bf16 v[88:91], v[24:27], v[72:75], v[88:91]
  s_waitcnt lgkmcnt(4)
  s_waitcnt vmcnt(15)
  s_barrier
  v_mfma_f32_16x16x32_bf16 v[92:95], v[24:27], v[76:79], v[92:95]
  s_add_u32 m0, s45, 143360
  s_add_u32 s44, s50, 1216512
  v_mfma_f32_16x16x32_bf16 v[96:99], v[28:31], v[64:67], v[96:99]
  buffer_load_dwordx4 v2, s[8:11], s44 offen lds
  v_mfma_f32_16x16x32_bf16 v[100:103], v[28:31], v[68:71], v[100:103]
  ds_read_b64_tr_b16 v[40:41], v12 offset:20480
  ds_read_b64_tr_b16 v[42:43], v12 offset:26624
  v_mfma_f32_16x16x32_bf16 v[104:107], v[28:31], v[72:75], v[104:107]
  ds_read_b128 v[48:51], v14 offset:40960
  v_mfma_f32_16x16x32_bf16 v[108:111], v[28:31], v[76:79], v[108:111]
  s_waitcnt lgkmcnt(5)
  buffer_load_dwordx4 v3, s[8:11], s44 offen offset:1024 lds
  v_mfma_f32_16x16x32_bf16 v[112:115], v[32:35], v[64:67], v[112:115]
  ds_read_b64_tr_b16 v[44:45], v13 offset:20480
  v_mfma_f32_16x16x32_bf16 v[116:119], v[32:35], v[68:71], v[116:119]
  ds_read_b64_tr_b16 v[46:47], v13 offset:26624
  v_mfma_f32_16x16x32_bf16 v[120:123], v[32:35], v[72:75], v[120:123]
  ds_read_b128 v[52:55], v14 offset:41984
  v_mfma_f32_16x16x32_bf16 v[124:127], v[32:35], v[76:79], v[124:127]
  s_waitcnt lgkmcnt(6)
  v_mfma_f32_16x16x32_bf16 v[128:131], v[36:39], v[64:67], v[128:131]
  buffer_load_dwordx4 v4, s[8:11], s44 offen offset:2048 lds
  v_mfma_f32_16x16x32_bf16 v[132:135], v[36:39], v[68:71], v[132:135]
  ds_read_b64_tr_b16 v[24:25], v8 offset:40960
  ds_read_b64_tr_b16 v[26:27], v8 offset:47104
  v_mfma_f32_16x16x32_bf16 v[136:139], v[36:39], v[72:75], v[136:139]
  ds_read_b128 v[56:59], v14 offset:43008
  v_mfma_f32_16x16x32_bf16 v[140:143], v[36:39], v[76:79], v[140:143]
  s_waitcnt lgkmcnt(7)
  v_mfma_f32_16x16x32_bf16 v[144:147], v[40:43], v[64:67], v[144:147]
  s_add_u32 m0, s51, 143360
  ds_read_b64_tr_b16 v[28:29], v9 offset:40960
  s_add_u32 s44, s46, 33792
  v_mfma_f32_16x16x32_bf16 v[148:151], v[40:43], v[68:71], v[148:151]
  buffer_load_dwordx4 v1, s[4:7], s44 offen sc1 lds
  v_mfma_f32_16x16x32_bf16 v[152:155], v[40:43], v[72:75], v[152:155]
  ds_read_b64_tr_b16 v[30:31], v9 offset:47104
  ds_read_b128 v[60:63], v14 offset:44032
  v_mfma_f32_16x16x32_bf16 v[156:159], v[40:43], v[76:79], v[156:159]
  s_waitcnt lgkmcnt(7)
  v_mfma_f32_16x16x32_bf16 v[160:163], v[44:47], v[64:67], v[160:163]
  ds_read_b64_tr_b16 v[32:33], v10 offset:40960
  v_mfma_f32_16x16x32_bf16 v[164:167], v[44:47], v[68:71], v[164:167]
  s_add_u32 s44, s47, 33792
  buffer_load_dwordx4 v1, s[4:7], s44 offen offset:1024 sc1 lds
  v_mfma_f32_16x16x32_bf16 v[168:171], v[44:47], v[72:75], v[168:171]
  ds_read_b64_tr_b16 v[34:35], v10 offset:47104
  v_mfma_f32_16x16x32_bf16 v[172:175], v[44:47], v[76:79], v[172:175]
  s_waitcnt lgkmcnt(6)
  v_mfma_f32_16x16x32_bf16 v[80:83], v[24:27], v[48:51], v[80:83]
  ds_read_b64_tr_b16 v[36:37], v11 offset:40960
  v_mfma_f32_16x16x32_bf16 v[84:87], v[24:27], v[52:55], v[84:87]
  s_waitcnt lgkmcnt(6)
  ds_read_b64_tr_b16 v[38:39], v11 offset:47104
  v_mfma_f32_16x16x32_bf16 v[88:91], v[24:27], v[56:59], v[88:91]
  s_waitcnt lgkmcnt(4)
  s_add_u32 m0, s45, 0
  s_add_u32 s44, s50, 589824
  v_mfma_f32_16x16x32_bf16 v[92:95], v[24:27], v[60:63], v[92:95]
  buffer_load_dwordx4 v5, s[8:11], s44 offen lds
  v_mfma_f32_16x16x32_bf16 v[96:99], v[28:31], v[48:51], v[96:99]
  ds_read_b64_tr_b16 v[40:41], v12 offset:40960
  v_mfma_f32_16x16x32_bf16 v[100:103], v[28:31], v[52:55], v[100:103]
  ds_read_b64_tr_b16 v[42:43], v12 offset:47104
  v_mfma_f32_16x16x32_bf16 v[104:107], v[28:31], v[56:59], v[104:107]
  buffer_load_dwordx4 v6, s[8:11], s44 offen offset:1024 lds
  v_mfma_f32_16x16x32_bf16 v[108:111], v[28:31], v[60:63], v[108:111]
  s_waitcnt lgkmcnt(4)
  ds_read_b128 v[64:67], v14 offset:61440
  v_mfma_f32_16x16x32_bf16 v[112:115], v[32:35], v[48:51], v[112:115]
  ds_read_b64_tr_b16 v[44:45], v13 offset:40960
  v_mfma_f32_16x16x32_bf16 v[116:119], v[32:35], v[52:55], v[116:119]
  ds_read_b64_tr_b16 v[46:47], v13 offset:47104
  v_mfma_f32_16x16x32_bf16 v[120:123], v[32:35], v[56:59], v[120:123]
  ds_read_b128 v[68:71], v14 offset:62464
  v_mfma_f32_16x16x32_bf16 v[124:127], v[32:35], v[60:63], v[124:127]
  s_waitcnt lgkmcnt(6)
  buffer_load_dwordx4 v7, s[8:11], s44 offen offset:2048 lds
  v_mfma_f32_16x16x32_bf16 v[128:131], v[36:39], v[48:51], v[128:131]
  v_add_u32 v8, 61440, v8
  ds_read_b64_tr_b16 v[24:25], v8 offset:0
  v_mfma_f32_16x16x32_bf16 v[132:135], v[36:39], v[52:55], v[132:135]
  ds_read_b64_tr_b16 v[26:27], v8 offset:6144
  v_mfma_f32_16x16x32_bf16 v[136:139], v[36:39], v[56:59], v[136:139]
  ds_read_b128 v[72:75], v14 offset:63488
  v_mfma_f32_16x16x32_bf16 v[140:143], v[36:39], v[60:63], v[140:143]
  s_waitcnt lgkmcnt(7)
  s_add_u32 m0, s51, 0
  s_add_u32 s44, s46, 16384
  v_mfma_f32_16x16x32_bf16 v[144:147], v[40:43], v[48:51], v[144:147]
  buffer_load_dwordx4 v1, s[4:7], s44 offen sc1 lds
  v_mfma_f32_16x16x32_bf16 v[148:151], v[40:43], v[52:55], v[148:151]
  v_add_u32 v9, 61440, v9
  ds_read_b64_tr_b16 v[28:29], v9 offset:0
  v_mfma_f32_16x16x32_bf16 v[152:155], v[40:43], v[56:59], v[152:155]
  ds_read_b64_tr_b16 v[30:31], v9 offset:6144
  ds_read_b128 v[76:79], v14 offset:64512
  v_mfma_f32_16x16x32_bf16 v[156:159], v[40:43], v[60:63], v[156:159]
  s_waitcnt lgkmcnt(7)
  v_mfma_f32_16x16x32_bf16 v[160:163], v[44:47], v[48:51], v[160:163]
  s_add_u32 s44, s47, 16384
  buffer_load_dwordx4 v1, s[4:7], s44 offen offset:1024 sc1 lds
  v_mfma_f32_16x16x32_bf16 v[164:167], v[44:47], v[52:55], v[164:167]
  v_add_u32 v10, 61440, v10
  ds_read_b64_tr_b16 v[32:33], v10 offset:0
  v_mfma_f32_16x16x32_bf16 v[168:171], v[44:47], v[56:59], v[168:171]
  ds_read_b64_tr_b16 v[34:35], v10 offset:6144
  v_mfma_f32_16x16x32_bf16 v[172:175], v[44:47], v[60:63], v[172:175]
  s_waitcnt lgkmcnt(6)
  v_mfma_f32_16x16x32_bf16 v[80:83], v[24:27], v[64:67], v[80:83]
  v_add_u32 v11, 61440, v11
  ds_read_b64_tr_b16 v[36:37], v11 offset:0
  v_mfma_f32_16x16x32_bf16 v[84:87], v[24:27], v[68:71], v[84:87]
  s_waitcnt lgkmcnt(6)
  ds_read_b64_tr_b16 v[38:39], v11 offset:6144
  v_mfma_f32_16x16x32_bf16 v[88:91], v[24:27], v[72:75], v[88:91]
  s_waitcnt lgkmcnt(4)
  s_waitcnt vmcnt(15)
  s_barrier
  v_mfma_f32_16x16x32_bf16 v[92:95], v[24:27], v[76:79], v[92:95]
  s_add_u32 m0, s45, 20480
  s_add_u32 s44, s50, 626688
  v_mfma_f32_16x16x32_bf16 v[96:99], v[28:31], v[64:67], v[96:99]
  buffer_load_dwordx4 v5, s[8:11], s44 offen lds
  v_mfma_f32_16x16x32_bf16 v[100:103], v[28:31], v[68:71], v[100:103]
  v_add_u32 v12, 61440, v12
  ds_read_b64_tr_b16 v[40:41], v12 offset:0
  v_mfma_f32_16x16x32_bf16 v[104:107], v[28:31], v[72:75], v[104:107]
  ds_read_b64_tr_b16 v[42:43], v12 offset:6144
  v_add_u32 v14, 81920, v14
  v_mfma_f32_16x16x32_bf16 v[108:111], v[28:31], v[76:79], v[108:111]
  s_waitcnt lgkmcnt(4)
  buffer_load_dwordx4 v6, s[8:11], s44 offen offset:1024 lds
  v_mfma_f32_16x16x32_bf16 v[112:115], v[32:35], v[64:67], v[112:115]
  ds_read_b128 v[48:51], v14 offset:0
  v_add_u32 v13, 61440, v13
  v_mfma_f32_16x16x32_bf16 v[116:119], v[32:35], v[68:71], v[116:119]
  ds_read_b64_tr_b16 v[44:45], v13 offset:0
  ds_read_b64_tr_b16 v[46:47], v13 offset:6144
  v_mfma_f32_16x16x32_bf16 v[120:123], v[32:35], v[72:75], v[120:123]
  ds_read_b128 v[52:55], v14 offset:1024
  v_mfma_f32_16x16x32_bf16 v[124:127], v[32:35], v[76:79], v[124:127]
  s_waitcnt lgkmcnt(6)
  v_mfma_f32_16x16x32_bf16 v[128:131], v[36:39], v[64:67], v[128:131]
  buffer_load_dwordx4 v7, s[8:11], s44 offen offset:2048 lds
  v_mfma_f32_16x16x32_bf16 v[132:135], v[36:39], v[68:71], v[132:135]
  ds_read_b64_tr_b16 v[24:25], v8 offset:20480
  ds_read_b64_tr_b16 v[26:27], v8 offset:26624
  v_mfma_f32_16x16x32_bf16 v[136:139], v[36:39], v[72:75], v[136:139]
  ds_read_b128 v[56:59], v14 offset:2048
  v_mfma_f32_16x16x32_bf16 v[140:143], v[36:39], v[76:79], v[140:143]
  s_waitcnt lgkmcnt(7)
  v_mfma_f32_16x16x32_bf16 v[144:147], v[40:43], v[64:67], v[144:147]
  s_add_u32 m0, s51, 20480
  ds_read_b64_tr_b16 v[28:29], v9 offset:20480
  s_add_u32 s44, s46, 17408
  v_mfma_f32_16x16x32_bf16 v[148:151], v[40:43], v[68:71], v[148:151]
  buffer_load_dwordx4 v1, s[4:7], s44 offen sc1 lds
  v_mfma_f32_16x16x32_bf16 v[152:155], v[40:43], v[72:75], v[152:155]
  ds_read_b64_tr_b16 v[30:31], v9 offset:26624
  ds_read_b128 v[60:63], v14 offset:3072
  v_mfma_f32_16x16x32_bf16 v[156:159], v[40:43], v[76:79], v[156:159]
  s_waitcnt lgkmcnt(7)
  v_mfma_f32_16x16x32_bf16 v[160:163], v[44:47], v[64:67], v[160:163]
  ds_read_b64_tr_b16 v[32:33], v10 offset:20480
  v_mfma_f32_16x16x32_bf16 v[164:167], v[44:47], v[68:71], v[164:167]
  s_add_u32 s44, s47, 17408
  buffer_load_dwordx4 v1, s[4:7], s44 offen offset:1024 sc1 lds
  v_mfma_f32_16x16x32_bf16 v[168:171], v[44:47], v[72:75], v[168:171]
  ds_read_b64_tr_b16 v[34:35], v10 offset:26624
  v_mfma_f32_16x16x32_bf16 v[172:175], v[44:47], v[76:79], v[172:175]
  s_waitcnt lgkmcnt(6)
  v_mfma_f32_16x16x32_bf16 v[80:83], v[24:27], v[48:51], v[80:83]
  ds_read_b64_tr_b16 v[36:37], v11 offset:20480
  v_mfma_f32_16x16x32_bf16 v[84:87], v[24:27], v[52:55], v[84:87]
  s_waitcnt lgkmcnt(6)
  ds_read_b64_tr_b16 v[38:39], v11 offset:26624
  v_mfma_f32_16x16x32_bf16 v[88:91], v[24:27], v[56:59], v[88:91]
  s_waitcnt lgkmcnt(4)
  s_add_u32 m0, s45, 40960
  s_add_u32 s44, s50, 1253376
  v_mfma_f32_16x16x32_bf16 v[92:95], v[24:27], v[60:63], v[92:95]
  buffer_load_dwordx4 v5, s[8:11], s44 offen lds
  v_mfma_f32_16x16x32_bf16 v[96:99], v[28:31], v[48:51], v[96:99]
  ds_read_b64_tr_b16 v[40:41], v12 offset:20480
  v_mfma_f32_16x16x32_bf16 v[100:103], v[28:31], v[52:55], v[100:103]
  ds_read_b64_tr_b16 v[42:43], v12 offset:26624
  v_mfma_f32_16x16x32_bf16 v[104:107], v[28:31], v[56:59], v[104:107]
  buffer_load_dwordx4 v6, s[8:11], s44 offen offset:1024 lds
  v_mfma_f32_16x16x32_bf16 v[108:111], v[28:31], v[60:63], v[108:111]
  s_waitcnt lgkmcnt(4)
  ds_read_b128 v[64:67], v14 offset:20480
  v_mfma_f32_16x16x32_bf16 v[112:115], v[32:35], v[48:51], v[112:115]
  ds_read_b64_tr_b16 v[44:45], v13 offset:20480
  v_mfma_f32_16x16x32_bf16 v[116:119], v[32:35], v[52:55], v[116:119]
  ds_read_b64_tr_b16 v[46:47], v13 offset:26624
  v_mfma_f32_16x16x32_bf16 v[120:123], v[32:35], v[56:59], v[120:123]
  ds_read_b128 v[68:71], v14 offset:21504
  v_mfma_f32_16x16x32_bf16 v[124:127], v[32:35], v[60:63], v[124:127]
  s_waitcnt lgkmcnt(6)
  buffer_load_dwordx4 v7, s[8:11], s44 offen offset:2048 lds
  v_mfma_f32_16x16x32_bf16 v[128:131], v[36:39], v[48:51], v[128:131]
  ds_read_b64_tr_b16 v[24:25], v8 offset:40960
  v_mfma_f32_16x16x32_bf16 v[132:135], v[36:39], v[52:55], v[132:135]
  ds_read_b64_tr_b16 v[26:27], v8 offset:47104
  v_mfma_f32_16x16x32_bf16 v[136:139], v[36:39], v[56:59], v[136:139]
  ds_read_b128 v[72:75], v14 offset:22528
  v_mfma_f32_16x16x32_bf16 v[140:143], v[36:39], v[60:63], v[140:143]
  s_waitcnt lgkmcnt(7)
  s_add_u32 m0, s51, 40960
  s_add_u32 s44, s46, 34816
  v_mfma_f32_16x16x32_bf16 v[144:147], v[40:43], v[48:51], v[144:147]
  buffer_load_dwordx4 v1, s[4:7], s44 offen sc1 lds
  v_mfma_f32_16x16x32_bf16 v[148:151], v[40:43], v[52:55], v[148:151]
  ds_read_b64_tr_b16 v[28:29], v9 offset:40960
  ds_read_b64_tr_b16 v[30:31], v9 offset:47104
  v_mfma_f32_16x16x32_bf16 v[152:155], v[40:43], v[56:59], v[152:155]
  ds_read_b128 v[76:79], v14 offset:23552
  v_mfma_f32_16x16x32_bf16 v[156:159], v[40:43], v[60:63], v[156:159]
  s_waitcnt lgkmcnt(7)
  v_mfma_f32_16x16x32_bf16 v[160:163], v[44:47], v[48:51], v[160:163]
  s_add_u32 s44, s47, 34816
  buffer_load_dwordx4 v1, s[4:7], s44 offen offset:1024 sc1 lds
  v_mfma_f32_16x16x32_bf16 v[164:167], v[44:47], v[52:55], v[164:167]
  ds_read_b64_tr_b16 v[32:33], v10 offset:40960
  ds_read_b64_tr_b16 v[34:35], v10 offset:47104
  v_mfma_f32_16x16x32_bf16 v[168:171], v[44:47], v[56:59], v[168:171]
  v_mfma_f32_16x16x32_bf16 v[172:175], v[44:47], v[60:63], v[172:175]
  s_waitcnt lgkmcnt(6)
  v_mfma_f32_16x16x32_bf16 v[80:83], v[24:27], v[64:67], v[80:83]
  ds_read_b64_tr_b16 v[36:37], v11 offset:40960
  v_mfma_f32_16x16x32_bf16 v[84:87], v[24:27], v[68:71], v[84:87]
  s_waitcnt lgkmcnt(6)
  ds_read_b64_tr_b16 v[38:39], v11 offset:47104
  v_mfma_f32_16x16x32_bf16 v[88:91], v[24:27], v[72:75], v[88:91]
  s_waitcnt lgkmcnt(4)
  s_waitcnt vmcnt(15)
  s_barrier
  v_mfma_f32_16x16x32_bf16 v[92:95], v[24:27], v[76:79], v[92:95]
  s_add_u32 m0, s45, 61440
  s_add_u32 s44, s50, 1290240
  v_mfma_f32_16x16x32_bf16 v[96:99], v[28:31], v[64:67], v[96:99]
  buffer_load_dwordx4 v5, s[8:11], s44 offen lds
  v_mfma_f32_16x16x32_bf16 v[100:103], v[28:31], v[68:71], v[100:103]
  ds_read_b64_tr_b16 v[40:41], v12 offset:40960
  ds_read_b64_tr_b16 v[42:43], v12 offset:47104
  v_mfma_f32_16x16x32_bf16 v[104:107], v[28:31], v[72:75], v[104:107]
  ds_read_b128 v[48:51], v14 offset:40960
  v_mfma_f32_16x16x32_bf16 v[108:111], v[28:31], v[76:79], v[108:111]
  s_waitcnt lgkmcnt(5)
  buffer_load_dwordx4 v6, s[8:11], s44 offen offset:1024 lds
  v_mfma_f32_16x16x32_bf16 v[112:115], v[32:35], v[64:67], v[112:115]
  ds_read_b64_tr_b16 v[44:45], v13 offset:40960
  v_mfma_f32_16x16x32_bf16 v[116:119], v[32:35], v[68:71], v[116:119]
  ds_read_b64_tr_b16 v[46:47], v13 offset:47104
  v_mfma_f32_16x16x32_bf16 v[120:123], v[32:35], v[72:75], v[120:123]
  ds_read_b128 v[52:55], v14 offset:41984
  v_mfma_f32_16x16x32_bf16 v[124:127], v[32:35], v[76:79], v[124:127]
  s_waitcnt lgkmcnt(6)
  v_mfma_f32_16x16x32_bf16 v[128:131], v[36:39], v[64:67], v[128:131]
  buffer_load_dwordx4 v7, s[8:11], s44 offen offset:2048 lds
  v_mfma_f32_16x16x32_bf16 v[132:135], v[36:39], v[68:71], v[132:135]
  v_add_u32 v8, 61440, v8
  ds_read_b64_tr_b16 v[24:25], v8 offset:0
  v_mfma_f32_16x16x32_bf16 v[136:139], v[36:39], v[72:75], v[136:139]
  ds_read_b64_tr_b16 v[26:27], v8 offset:6144
  ds_read_b128 v[56:59], v14 offset:43008
  v_mfma_f32_16x16x32_bf16 v[140:143], v[36:39], v[76:79], v[140:143]
  s_waitcnt lgkmcnt(7)
  v_mfma_f32_16x16x32_bf16 v[144:147], v[40:43], v[64:67], v[144:147]
  s_add_u32 m0, s51, 61440
  v_add_u32 v9, 61440, v9
  s_add_u32 s44, s46, 35840
  v_mfma_f32_16x16x32_bf16 v[148:151], v[40:43], v[68:71], v[148:151]
  buffer_load_dwordx4 v1, s[4:7], s44 offen sc1 lds
  v_mfma_f32_16x16x32_bf16 v[152:155], v[40:43], v[72:75], v[152:155]
  ds_read_b64_tr_b16 v[28:29], v9 offset:0
  ds_read_b64_tr_b16 v[30:31], v9 offset:6144
  v_mfma_f32_16x16x32_bf16 v[156:159], v[40:43], v[76:79], v[156:159]
  s_waitcnt lgkmcnt(6)
  ds_read_b128 v[60:63], v14 offset:44032
  v_mfma_f32_16x16x32_bf16 v[160:163], v[44:47], v[64:67], v[160:163]
  v_add_u32 v10, 61440, v10
  ds_read_b64_tr_b16 v[32:33], v10 offset:0
  v_mfma_f32_16x16x32_bf16 v[164:167], v[44:47], v[68:71], v[164:167]
  s_add_u32 s44, s47, 35840
  buffer_load_dwordx4 v1, s[4:7], s44 offen offset:1024 sc1 lds
  v_mfma_f32_16x16x32_bf16 v[168:171], v[44:47], v[72:75], v[168:171]
  ds_read_b64_tr_b16 v[34:35], v10 offset:6144
  v_mfma_f32_16x16x32_bf16 v[172:175], v[44:47], v[76:79], v[172:175]
  s_waitcnt lgkmcnt(6)
  v_mfma_f32_16x16x32_bf16 v[80:83], v[24:27], v[48:51], v[80:83]
  v_add_u32 v11, 61440, v11
  ds_read_b64_tr_b16 v[36:37], v11 offset:0
  v_mfma_f32_16x16x32_bf16 v[84:87], v[24:27], v[52:55], v[84:87]
  s_waitcnt lgkmcnt(6)
  ds_read_b64_tr_b16 v[38:39], v11 offset:6144
  v_mfma_f32_16x16x32_bf16 v[88:91], v[24:27], v[56:59], v[88:91]
  s_waitcnt lgkmcnt(4)
  v_mfma_f32_16x16x32_bf16 v[92:95], v[24:27], v[60:63], v[92:95]
  v_mfma_f32_16x16x32_bf16 v[96:99], v[28:31], v[48:51], v[96:99]
  v_add_u32 v12, 61440, v12
  ds_read_b64_tr_b16 v[40:41], v12 offset:0
  v_mfma_f32_16x16x32_bf16 v[100:103], v[28:31], v[52:55], v[100:103]
  ds_read_b64_tr_b16 v[42:43], v12 offset:6144
  v_mfma_f32_16x16x32_bf16 v[104:107], v[28:31], v[56:59], v[104:107]
  ds_read_b128 v[64:67], v14 offset:61440
  v_mfma_f32_16x16x32_bf16 v[108:111], v[28:31], v[60:63], v[108:111]
  s_waitcnt lgkmcnt(5)
  v_mfma_f32_16x16x32_bf16 v[112:115], v[32:35], v[48:51], v[112:115]
  v_add_u32 v13, 61440, v13
  ds_read_b64_tr_b16 v[44:45], v13 offset:0
  v_mfma_f32_16x16x32_bf16 v[116:119], v[32:35], v[52:55], v[116:119]
  ds_read_b64_tr_b16 v[46:47], v13 offset:6144
  v_mfma_f32_16x16x32_bf16 v[120:123], v[32:35], v[56:59], v[120:123]
  ds_read_b128 v[68:71], v14 offset:62464
  v_mfma_f32_16x16x32_bf16 v[124:127], v[32:35], v[60:63], v[124:127]
  s_waitcnt lgkmcnt(6)
  v_mfma_f32_16x16x32_bf16 v[128:131], v[36:39], v[48:51], v[128:131]
  ds_read_b64_tr_b16 v[24:25], v8 offset:20480
  v_mfma_f32_16x16x32_bf16 v[132:135], v[36:39], v[52:55], v[132:135]
  ds_read_b64_tr_b16 v[26:27], v8 offset:26624
  v_mfma_f32_16x16x32_bf16 v[136:139], v[36:39], v[56:59], v[136:139]
  ds_read_b128 v[72:75], v14 offset:63488
  v_mfma_f32_16x16x32_bf16 v[140:143], v[36:39], v[60:63], v[140:143]
  s_waitcnt lgkmcnt(7)
  v_mfma_f32_16x16x32_bf16 v[144:147], v[40:43], v[48:51], v[144:147]
  ds_read_b64_tr_b16 v[28:29], v9 offset:20480
  v_mfma_f32_16x16x32_bf16 v[148:151], v[40:43], v[52:55], v[148:151]
  ds_read_b64_tr_b16 v[30:31], v9 offset:26624
  v_mfma_f32_16x16x32_bf16 v[152:155], v[40:43], v[56:59], v[152:155]
  ds_read_b128 v[76:79], v14 offset:64512
  v_mfma_f32_16x16x32_bf16 v[156:159], v[40:43], v[60:63], v[156:159]
  s_waitcnt lgkmcnt(7)
  v_mfma_f32_16x16x32_bf16 v[160:163], v[44:47], v[48:51], v[160:163]
  ds_read_b64_tr_b16 v[32:33], v10 offset:20480
  v_mfma_f32_16x16x32_bf16 v[164:167], v[44:47], v[52:55], v[164:167]
  ds_read_b64_tr_b16 v[34:35], v10 offset:26624
  v_mfma_f32_16x16x32_bf16 v[168:171], v[44:47], v[56:59], v[168:171]
  v_mfma_f32_16x16x32_bf16 v[172:175], v[44:47], v[60:63], v[172:175]
  s_waitcnt lgkmcnt(6)
  v_mfma_f32_16x16x32_bf16 v[80:83], v[24:27], v[64:67], v[80:83]
  ds_read_b64_tr_b16 v[36:37], v11 offset:20480
  v_mfma_f32_16x16x32_bf16 v[84:87], v[24:27], v[68:71], v[84:87]
  s_waitcnt lgkmcnt(6)
  ds_read_b64_tr_b16 v[38:39], v11 offset:26624
  v_mfma_f32_16x16x32_bf16 v[88:91], v[24:27], v[72:75], v[88:91]
  s_waitcnt lgkmcnt(4)
  s_waitcnt vmcnt(10)
  s_barrier
  v_mfma_f32_16x16x32_bf16 v[92:95], v[24:27], v[76:79], v[92:95]
  v_mfma_f32_16x16x32_bf16 v[96:99], v[28:31], v[64:67], v[96:99]
  ds_read_b64_tr_b16 v[40:41], v12 offset:20480
  v_mfma_f32_16x16x32_bf16 v[100:103], v[28:31], v[68:71], v[100:103]
  ds_read_b64_tr_b16 v[42:43], v12 offset:26624
  v_mfma_f32_16x16x32_bf16 v[104:107], v[28:31], v[72:75], v[104:107]
  v_subrev_u32 v14, 81920, v14
  ds_read_b128 v[48:51], v14 offset:0
  v_mfma_f32_16x16x32_bf16 v[108:111], v[28:31], v[76:79], v[108:111]
  s_waitcnt lgkmcnt(5)
  v_mfma_f32_16x16x32_bf16 v[112:115], v[32:35], v[64:67], v[112:115]
  ds_read_b64_tr_b16 v[44:45], v13 offset:20480
  v_mfma_f32_16x16x32_bf16 v[116:119], v[32:35], v[68:71], v[116:119]
  ds_read_b64_tr_b16 v[46:47], v13 offset:26624
  v_mfma_f32_16x16x32_bf16 v[120:123], v[32:35], v[72:75], v[120:123]
  ds_read_b128 v[52:55], v14 offset:1024
  v_mfma_f32_16x16x32_bf16 v[124:127], v[32:35], v[76:79], v[124:127]
  s_waitcnt lgkmcnt(6)
  v_mfma_f32_16x16x32_bf16 v[128:131], v[36:39], v[64:67], v[128:131]
  v_subrev_u32 v8, 122880, v8
  ds_read_b64_tr_b16 v[24:25], v8 offset:0
  v_mfma_f32_16x16x32_bf16 v[132:135], v[36:39], v[68:71], v[132:135]
  ds_read_b64_tr_b16 v[26:27], v8 offset:6144
  v_mfma_f32_16x16x32_bf16 v[136:139], v[36:39], v[72:75], v[136:139]
  ds_read_b128 v[56:59], v14 offset:2048
  v_mfma_f32_16x16x32_bf16 v[140:143], v[36:39], v[76:79], v[140:143]
  s_waitcnt lgkmcnt(7)
  v_mfma_f32_16x16x32_bf16 v[144:147], v[40:43], v[64:67], v[144:147]
  v_subrev_u32 v9, 122880, v9
  ds_read_b64_tr_b16 v[28:29], v9 offset:0
  v_mfma_f32_16x16x32_bf16 v[148:151], v[40:43], v[68:71], v[148:151]
  ds_read_b64_tr_b16 v[30:31], v9 offset:6144
  v_mfma_f32_16x16x32_bf16 v[152:155], v[40:43], v[72:75], v[152:155]
  ds_read_b128 v[60:63], v14 offset:3072
  v_mfma_f32_16x16x32_bf16 v[156:159], v[40:43], v[76:79], v[156:159]
  s_waitcnt lgkmcnt(7)
  v_mfma_f32_16x16x32_bf16 v[160:163], v[44:47], v[64:67], v[160:163]
  v_subrev_u32 v10, 122880, v10
  ds_read_b64_tr_b16 v[32:33], v10 offset:0
  v_mfma_f32_16x16x32_bf16 v[164:167], v[44:47], v[68:71], v[164:167]
  ds_read_b64_tr_b16 v[34:35], v10 offset:6144
  v_mfma_f32_16x16x32_bf16 v[168:171], v[44:47], v[72:75], v[168:171]
  v_mfma_f32_16x16x32_bf16 v[172:175], v[44:47], v[76:79], v[172:175]
  s_waitcnt lgkmcnt(6)
  v_mfma_f32_16x16x32_bf16 v[80:83], v[24:27], v[48:51], v[80:83]
  v_subrev_u32 v11, 122880, v11
  ds_read_b64_tr_b16 v[36:37], v11 offset:0
  v_mfma_f32_16x16x32_bf16 v[84:87], v[24:27], v[52:55], v[84:87]
  s_waitcnt lgkmcnt(6)
  ds_read_b64_tr_b16 v[38:39], v11 offset:6144
  v_mfma_f32_16x16x32_bf16 v[88:91], v[24:27], v[56:59], v[88:91]
  s_waitcnt lgkmcnt(4)
  v_mfma_f32_16x16x32_bf16 v[92:95], v[24:27], v[60:63], v[92:95]
  v_mfma_f32_16x16x32_bf16 v[96:99], v[28:31], v[48:51], v[96:99]
  v_subrev_u32 v12, 122880, v12
  ds_read_b64_tr_b16 v[40:41], v12 offset:0
  v_mfma_f32_16x16x32_bf16 v[100:103], v[28:31], v[52:55], v[100:103]
  ds_read_b64_tr_b16 v[42:43], v12 offset:6144
  v_mfma_f32_16x16x32_bf16 v[104:107], v[28:31], v[56:59], v[104:107]
  ds_read_b128 v[64:67], v14 offset:20480
  v_mfma_f32_16x16x32_bf16 v[108:111], v[28:31], v[60:63], v[108:111]
  s_waitcnt lgkmcnt(5)
  v_mfma_f32_16x16x32_bf16 v[112:115], v[32:35], v[48:51], v[112:115]
  v_subrev_u32 v13, 122880, v13
  ds_read_b64_tr_b16 v[44:45], v13 offset:0
  v_mfma_f32_16x16x32_bf16 v[116:119], v[32:35], v[52:55], v[116:119]
  ds_read_b64_tr_b16 v[46:47], v13 offset:6144
  v_mfma_f32_16x16x32_bf16 v[120:123], v[32:35], v[56:59], v[120:123]
  ds_read_b128 v[68:71], v14 offset:21504
  v_mfma_f32_16x16x32_bf16 v[124:127], v[32:35], v[60:63], v[124:127]
  s_waitcnt lgkmcnt(6)
  v_mfma_f32_16x16x32_bf16 v[128:131], v[36:39], v[48:51], v[128:131]
  ds_read_b64_tr_b16 v[24:25], v8 offset:20480
  v_mfma_f32_16x16x32_bf16 v[132:135], v[36:39], v[52:55], v[132:135]
  ds_read_b64_tr_b16 v[26:27], v8 offset:26624
  v_mfma_f32_16x16x32_bf16 v[136:139], v[36:39], v[56:59], v[136:139]
  ds_read_b128 v[72:75], v14 offset:22528
  v_mfma_f32_16x16x32_bf16 v[140:143], v[36:39], v[60:63], v[140:143]
  s_waitcnt lgkmcnt(7)
  v_mfma_f32_16x16x32_bf16 v[144:147], v[40:43], v[48:51], v[144:147]
  ds_read_b64_tr_b16 v[28:29], v9 offset:20480
  v_mfma_f32_16x16x32_bf16 v[148:151], v[40:43], v[52:55], v[148:151]
  ds_read_b64_tr_b16 v[30:31], v9 offset:26624
  v_mfma_f32_16x16x32_bf16 v[152:155], v[40:43], v[56:59], v[152:155]
  ds_read_b128 v[76:79], v14 offset:23552
  v_mfma_f32_16x16x32_bf16 v[156:159], v[40:43], v[60:63], v[156:159]
  s_waitcnt lgkmcnt(7)
  v_mfma_f32_16x16x32_bf16 v[160:163], v[44:47], v[48:51], v[160:163]
  ds_read_b64_tr_b16 v[32:33], v10 offset:20480
  v_mfma_f32_16x16x32_bf16 v[164:167], v[44:47], v[52:55], v[164:167]
  ds_read_b64_tr_b16 v[34:35], v10 offset:26624
  v_mfma_f32_16x16x32_bf16 v[168:171], v[44:47], v[56:59], v[168:171]
  v_mfma_f32_16x16x32_bf16 v[172:175], v[44:47], v[60:63], v[172:175]
  s_waitcnt lgkmcnt(6)
  v_mfma_f32_16x16x32_bf16 v[80:83], v[24:27], v[64:67], v[80:83]
  ds_read_b64_tr_b16 v[36:37], v11 offset:20480
  v_mfma_f32_16x16x32_bf16 v[84:87], v[24:27], v[68:71], v[84:87]
  s_waitcnt lgkmcnt(6)
  ds_read_b64_tr_b16 v[38:39], v11 offset:26624
  v_mfma_f32_16x16x32_bf16 v[88:91], v[24:27], v[72:75], v[88:91]
  s_waitcnt lgkmcnt(4)
  s_waitcnt vmcnt(0)
  s_barrier
  v_mfma_f32_16x16x32_bf16 v[92:95], v[24:27], v[76:79], v[92:95]
  v_mfma_f32_16x16x32_bf16 v[96:99], v[28:31], v[64:67], v[96:99]
  ds_read_b64_tr_b16 v[40:41], v12 offset:20480
  v_mfma_f32_16x16x32_bf16 v[100:103], v[28:31], v[68:71], v[100:103]
  ds_read_b64_tr_b16 v[42:43], v12 offset:26624
  v_mfma_f32_16x16x32_bf16 v[104:107], v[28:31], v[72:75], v[104:107]
  ds_read_b128 v[48:51], v14 offset:40960
  v_mfma_f32_16x16x32_bf16 v[108:111], v[28:31], v[76:79], v[108:111]
  s_waitcnt lgkmcnt(5)
  v_mfma_f32_16x16x32_bf16 v[112:115], v[32:35], v[64:67], v[112:115]
  ds_read_b64_tr_b16 v[44:45], v13 offset:20480
  v_mfma_f32_16x16x32_bf16 v[116:119], v[32:35], v[68:71], v[116:119]
  ds_read_b64_tr_b16 v[46:47], v13 offset:26624
  v_mfma_f32_16x16x32_bf16 v[120:123], v[32:35], v[72:75], v[120:123]
  ds_read_b128 v[52:55], v14 offset:41984
  v_mfma_f32_16x16x32_bf16 v[124:127], v[32:35], v[76:79], v[124:127]
  s_waitcnt lgkmcnt(6)
  v_mfma_f32_16x16x32_bf16 v[128:131], v[36:39], v[64:67], v[128:131]
  ds_read_b64_tr_b16 v[24:25], v8 offset:40960
  v_mfma_f32_16x16x32_bf16 v[132:135], v[36:39], v[68:71], v[132:135]
  ds_read_b64_tr_b16 v[26:27], v8 offset:47104
  v_mfma_f32_16x16x32_bf16 v[136:139], v[36:39], v[72:75], v[136:139]
  ds_read_b128 v[56:59], v14 offset:43008
  v_mfma_f32_16x16x32_bf16 v[140:143], v[36:39], v[76:79], v[140:143]
  s_waitcnt lgkmcnt(7)
  v_mfma_f32_16x16x32_bf16 v[144:147], v[40:43], v[64:67], v[144:147]
  ds_read_b64_tr_b16 v[28:29], v9 offset:40960
  v_mfma_f32_16x16x32_bf16 v[148:151], v[40:43], v[68:71], v[148:151]
  ds_read_b64_tr_b16 v[30:31], v9 offset:47104
  v_mfma_f32_16x16x32_bf16 v[152:155], v[40:43], v[72:75], v[152:155]
  ds_read_b128 v[60:63], v14 offset:44032
  v_mfma_f32_16x16x32_bf16 v[156:159], v[40:43], v[76:79], v[156:159]
  s_waitcnt lgkmcnt(7)
  v_mfma_f32_16x16x32_bf16 v[160:163], v[44:47], v[64:67], v[160:163]
  ds_read_b64_tr_b16 v[32:33], v10 offset:40960
  v_mfma_f32_16x16x32_bf16 v[164:167], v[44:47], v[68:71], v[164:167]
  ds_read_b64_tr_b16 v[34:35], v10 offset:47104
  v_mfma_f32_16x16x32_bf16 v[168:171], v[44:47], v[72:75], v[168:171]
  v_mfma_f32_16x16x32_bf16 v[172:175], v[44:47], v[76:79], v[172:175]
  s_waitcnt lgkmcnt(6)
  v_mfma_f32_16x16x32_bf16 v[80:83], v[24:27], v[48:51], v[80:83]
  ds_read_b64_tr_b16 v[36:37], v11 offset:40960
  v_mfma_f32_16x16x32_bf16 v[84:87], v[24:27], v[52:55], v[84:87]
  s_waitcnt lgkmcnt(6)
  ds_read_b64_tr_b16 v[38:39], v11 offset:47104
  v_mfma_f32_16x16x32_bf16 v[88:91], v[24:27], v[56:59], v[88:91]
  s_waitcnt lgkmcnt(4)
  v_mfma_f32_16x16x32_bf16 v[92:95], v[24:27], v[60:63], v[92:95]
  v_mfma_f32_16x16x32_bf16 v[96:99], v[28:31], v[48:51], v[96:99]
  ds_read_b64_tr_b16 v[40:41], v12 offset:40960
  v_mfma_f32_16x16x32_bf16 v[100:103], v[28:31], v[52:55], v[100:103]
  ds_read_b64_tr_b16 v[42:43], v12 offset:47104
  v_mfma_f32_16x16x32_bf16 v[104:107], v[28:31], v[56:59], v[104:107]
  ds_read_b128 v[64:67], v14 offset:61440
  v_mfma_f32_16x16x32_bf16 v[108:111], v[28:31], v[60:63], v[108:111]
  s_waitcnt lgkmcnt(5)
  v_mfma_f32_16x16x32_bf16 v[112:115], v[32:35], v[48:51], v[112:115]
  ds_read_b64_tr_b16 v[44:45], v13 offset:40960
  v_mfma_f32_16x16x32_bf16 v[116:119], v[32:35], v[52:55], v[116:119]
  ds_read_b64_tr_b16 v[46:47], v13 offset:47104
  v_mfma_f32_16x16x32_bf16 v[120:123], v[32:35], v[56:59], v[120:123]
  ds_read_b128 v[68:71], v14 offset:62464
  v_mfma_f32_16x16x32_bf16 v[124:127], v[32:35], v[60:63], v[124:127]
  s_waitcnt lgkmcnt(6)
  v_mfma_f32_16x16x32_bf16 v[128:131], v[36:39], v[48:51], v[128:131]
  v_add_u32 v8, 61440, v8
  ds_read_b64_tr_b16 v[24:25], v8 offset:0
  v_mfma_f32_16x16x32_bf16 v[132:135], v[36:39], v[52:55], v[132:135]
  ds_read_b64_tr_b16 v[26:27], v8 offset:6144
  v_mfma_f32_16x16x32_bf16 v[136:139], v[36:39], v[56:59], v[136:139]
  ds_read_b128 v[72:75], v14 offset:63488
  v_mfma_f32_16x16x32_bf16 v[140:143], v[36:39], v[60:63], v[140:143]
  s_waitcnt lgkmcnt(7)
  v_mfma_f32_16x16x32_bf16 v[144:147], v[40:43], v[48:51], v[144:147]
  v_add_u32 v9, 61440, v9
  ds_read_b64_tr_b16 v[28:29], v9 offset:0
  v_mfma_f32_16x16x32_bf16 v[148:151], v[40:43], v[52:55], v[148:151]
  ds_read_b64_tr_b16 v[30:31], v9 offset:6144
  v_mfma_f32_16x16x32_bf16 v[152:155], v[40:43], v[56:59], v[152:155]
  ds_read_b128 v[76:79], v14 offset:64512
  v_mfma_f32_16x16x32_bf16 v[156:159], v[40:43], v[60:63], v[156:159]
  s_waitcnt lgkmcnt(7)
  v_mfma_f32_16x16x32_bf16 v[160:163], v[44:47], v[48:51], v[160:163]
  v_add_u32 v10, 61440, v10
  ds_read_b64_tr_b16 v[32:33], v10 offset:0
  v_mfma_f32_16x16x32_bf16 v[164:167], v[44:47], v[52:55], v[164:167]
  ds_read_b64_tr_b16 v[34:35], v10 offset:6144
  v_mfma_f32_16x16x32_bf16 v[168:171], v[44:47], v[56:59], v[168:171]
  v_mfma_f32_16x16x32_bf16 v[172:175], v[44:47], v[60:63], v[172:175]
  s_waitcnt lgkmcnt(6)
  v_mfma_f32_16x16x32_bf16 v[80:83], v[24:27], v[64:67], v[80:83]
  v_add_u32 v11, 61440, v11
  ds_read_b64_tr_b16 v[36:37], v11 offset:0
  v_mfma_f32_16x16x32_bf16 v[84:87], v[24:27], v[68:71], v[84:87]
  s_waitcnt lgkmcnt(6)
  ds_read_b64_tr_b16 v[38:39], v11 offset:6144
  v_mfma_f32_16x16x32_bf16 v[88:91], v[24:27], v[72:75], v[88:91]
  s_waitcnt lgkmcnt(4)
  v_mfma_f32_16x16x32_bf16 v[92:95], v[24:27], v[76:79], v[92:95]
  v_mfma_f32_16x16x32_bf16 v[96:99], v[28:31], v[64:67], v[96:99]
  v_add_u32 v12, 61440, v12
  ds_read_b64_tr_b16 v[40:41], v12 offset:0
  v_mfma_f32_16x16x32_bf16 v[100:103], v[28:31], v[68:71], v[100:103]
  ds_read_b64_tr_b16 v[42:43], v12 offset:6144
  v_mfma_f32_16x16x32_bf16 v[104:107], v[28:31], v[72:75], v[104:107]
  v_mfma_f32_16x16x32_bf16 v[108:111], v[28:31], v[76:79], v[108:111]
  s_waitcnt lgkmcnt(4)
  v_mfma_f32_16x16x32_bf16 v[112:115], v[32:35], v[64:67], v[112:115]
  v_add_u32 v13, 61440, v13
  ds_read_b64_tr_b16 v[44:45], v13 offset:0
  v_mfma_f32_16x16x32_bf16 v[116:119], v[32:35], v[68:71], v[116:119]
  ds_read_b64_tr_b16 v[46:47], v13 offset:6144
  v_mfma_f32_16x16x32_bf16 v[120:123], v[32:35], v[72:75], v[120:123]
  v_mfma_f32_16x16x32_bf16 v[124:127], v[32:35], v[76:79], v[124:127]
  s_waitcnt lgkmcnt(4)
  v_mfma_f32_16x16x32_bf16 v[128:131], v[36:39], v[64:67], v[128:131]
  v_mfma_f32_16x16x32_bf16 v[132:135], v[36:39], v[68:71], v[132:135]
  v_mfma_f32_16x16x32_bf16 v[136:139], v[36:39], v[72:75], v[136:139]
  v_mfma_f32_16x16x32_bf16 v[140:143], v[36:39], v[76:79], v[140:143]
  s_waitcnt lgkmcnt(2)
  v_mfma_f32_16x16x32_bf16 v[144:147], v[40:43], v[64:67], v[144:147]
  v_mfma_f32_16x16x32_bf16 v[148:151], v[40:43], v[68:71], v[148:151]
  v_mfma_f32_16x16x32_bf16 v[152:155], v[40:43], v[72:75], v[152:155]
  v_mfma_f32_16x16x32_bf16 v[156:159], v[40:43], v[76:79], v[156:159]
  s_waitcnt lgkmcnt(0)
  v_mfma_f32_16x16x32_bf16 v[160:163], v[44:47], v[64:67], v[160:163]
  v_mfma_f32_16x16x32_bf16 v[164:167], v[44:47], v[68:71], v[164:167]
  v_mfma_f32_16x16x32_bf16 v[168:171], v[44:47], v[72:75], v[168:171]
  v_mfma_f32_16x16x32_bf16 v[172:175], v[44:47], v[76:79], v[172:175]
  s_barrier
  s_lshr_b32 s52, s62, 1
  s_lshr_b32 s53, s40, 1
  s_and_b32 s54, s62, 1
  s_cmp_eq_u32 s52, s53
  s_cselect_b32 s54, s54, 2
  s_and_b32 s55, s40, 1
  s_mul_i32 s55, s55, 3072
  v_add_u32 v16, s55, v1
  s_cmp_eq_u32 s54, 0
  s_cbranch_scc1 fnet_k2_kernel_own0
  v_cvt_pk_bf16_f32 v176, v80, v81
  v_cvt_pk_bf16_f32 v177, v82, v83
  v_cvt_pk_bf16_f32 v178, v96, v97
  v_cvt_pk_bf16_f32 v179, v98, v99
  s_add_u32 s55, s48, 0
  buffer_store_dwordx4 v[176:179], v1, s[4:7], s55 offen offset:0 sc1
  v_cvt_pk_bf16_f32 v180, v112, v113
  v_cvt_pk_bf16_f32 v181, v114, v115
  v_cvt_pk_bf16_f32 v182, v128, v129
  v_cvt_pk_bf16_f32 v183, v130, v131
  s_add_u32 s55, s48, 0
  buffer_store_dwordx4 v[180:183], v1, s[4:7], s55 offen offset:1024 sc1
  v_cvt_pk_bf16_f32 v184, v144, v145
  v_cvt_pk_bf16_f32 v185, v146, v147
  v_cvt_pk_bf16_f32 v186, v160, v161
  v_cvt_pk_bf16_f32 v187, v162, v163
  s_add_u32 s55, s48, 0
  buffer_store_dwordx4 v[184:187], v1, s[4:7], s55 offen offset:2048 sc1
  v_cvt_pk_bf16_f32 v188, v84, v85
  v_cvt_pk_bf16_f32 v189, v86, v87
  v_cvt_pk_bf16_f32 v190, v100, v101
  v_cvt_pk_bf16_f32 v191, v102, v103
  s_add_u32 s55, s48, 18432
  buffer_store_dwordx4 v[188:191], v1, s[4:7], s55 offen offset:0 sc1
  v_cvt_pk_bf16_f32 v176, v116, v117
  v_cvt_pk_bf16_f32 v177, v118, v119
  v_cvt_pk_bf16_f32 v178, v132, v133
  v_cvt_pk_bf16_f32 v179, v134, v135
  s_add_u32 s55, s48, 18432
  buffer_store_dwordx4 v[176:179], v1, s[4:7], s55 offen offset:1024 sc1
  v_cvt_pk_bf16_f32 v180, v148, v149
  v_cvt_pk_bf16_f32 v181, v150, v151
  v_cvt_pk_bf16_f32 v182, v164, v165
  v_cvt_pk_bf16_f32 v183, v166, v167
  s_add_u32 s55, s48, 18432
  buffer_store_dwordx4 v[180:183], v1, s[4:7], s55 offen offset:2048 sc1
  s_branch fnet_k2_kernel_done0
fnet_k2_kernel_own0:
  v_cvt_pk_bf16_f32 v184, v80, v81
  v_cvt_pk_bf16_f32 v185, v82, v83
  v_cvt_pk_bf16_f32 v186, v96, v97
  v_cvt_pk_bf16_f32 v187, v98, v99
  ds_write_b128 v16, v[184:187] offset:0
  v_cvt_pk_bf16_f32 v188, v112, v113
  v_cvt_pk_bf16_f32 v189, v114, v115
  v_cvt_pk_bf16_f32 v190, v128, v129
  v_cvt_pk_bf16_f32 v191, v130, v131
  ds_write_b128 v16, v[188:191] offset:1024
  v_cvt_pk_bf16_f32 v176, v144, v145
  v_cvt_pk_bf16_f32 v177, v146, v147
  v_cvt_pk_bf16_f32 v178, v160, v161
  v_cvt_pk_bf16_f32 v179, v162, v163
  ds_write_b128 v16, v[176:179] offset:2048
  v_cvt_pk_bf16_f32 v180, v84, v85
  v_cvt_pk_bf16_f32 v181, v86, v87
  v_cvt_pk_bf16_f32 v182, v100, v101
  v_cvt_pk_bf16_f32 v183, v102, v103
  ds_write_b128 v16, v[180:183] offset:6144
  v_cvt_pk_bf16_f32 v184, v116, v117
  v_cvt_pk_bf16_f32 v185, v118, v119
  v_cvt_pk_bf16_f32 v186, v132, v133
  v_cvt_pk_bf16_f32 v187, v134, v135
  ds_write_b128 v16, v[184:187] offset:7168
  v_cvt_pk_bf16_f32 v188, v148, v149
  v_cvt_pk_bf16_f32 v189, v150, v151
  v_cvt_pk_bf16_f32 v190, v164, v165
  v_cvt_pk_bf16_f32 v191, v166, v167
  ds_write_b128 v16, v[188:191] offset:8192
fnet_k2_kernel_done0:
  s_nop 1
  s_cmp_eq_u32 s54, 1
  s_cbranch_scc1 fnet_k2_kernel_own1
  v_cvt_pk_bf16_f32 v176, v88, v89
  v_cvt_pk_bf16_f32 v177, v90, v91
  v_cvt_pk_bf16_f32 v178, v104, v105
  v_cvt_pk_bf16_f32 v179, v106, v107
  s_add_u32 s55, s48, 36864
  buffer_store_dwordx4 v[176:179], v1, s[4:7], s55 offen offset:0 sc1
  v_cvt_pk_bf16_f32 v180, v120, v121
  v_cvt_pk_bf16_f32 v181, v122, v123
  v_cvt_pk_bf16_f32 v182, v136, v137
  v_cvt_pk_bf16_f32 v183, v138, v139
  s_add_u32 s55, s48, 36864
  buffer_store_dwordx4 v[180:183], v1, s[4:7], s55 offen offset:1024 sc1
  v_cvt_pk_bf16_f32 v184, v152, v153
  v_cvt_pk_bf16_f32 v185, v154, v155
  v_cvt_pk_bf16_f32 v186, v168, v169
  v_cvt_pk_bf16_f32 v187, v170, v171
  s_add_u32 s55, s48, 36864
  buffer_store_dwordx4 v[184:187], v1, s[4:7], s55 offen offset:2048 sc1
  v_cvt_pk_bf16_f32 v188, v92, v93
  v_cvt_pk_bf16_f32 v189, v94, v95
  v_cvt_pk_bf16_f32 v190, v108, v109
  v_cvt_pk_bf16_f32 v191, v110, v111
  s_add_u32 s55, s48, 55296
  buffer_store_dwordx4 v[188:191], v1, s[4:7], s55 offen offset:0 sc1
  v_cvt_pk_bf16_f32 v176, v124, v125
  v_cvt_pk_bf16_f32 v177, v126, v127
  v_cvt_pk_bf16_f32 v178, v140, v141
  v_cvt_pk_bf16_f32 v179, v142, v143
  s_add_u32 s55, s48, 55296
  buffer_store_dwordx4 v[176:179], v1, s[4:7], s55 offen offset:1024 sc1
  v_cvt_pk_bf16_f32 v180, v156, v157
  v_cvt_pk_bf16_f32 v181, v158, v159
  v_cvt_pk_bf16_f32 v182, v172, v173
  v_cvt_pk_bf16_f32 v183, v174, v175
  s_add_u32 s55, s48, 55296
  buffer_store_dwordx4 v[180:183], v1, s[4:7], s55 offen offset:2048 sc1
  s_branch fnet_k2_kernel_done1
fnet_k2_kernel_own1:
  v_cvt_pk_bf16_f32 v184, v88, v89
  v_cvt_pk_bf16_f32 v185, v90, v91
  v_cvt_pk_bf16_f32 v186, v104, v105
  v_cvt_pk_bf16_f32 v187, v106, v107
  ds_write_b128 v16, v[184:187] offset:0
  v_cvt_pk_bf16_f32 v188, v120, v121
  v_cvt_pk_bf16_f32 v189, v122, v123
  v_cvt_pk_bf16_f32 v190, v136, v137
  v_cvt_pk_bf16_f32 v191, v138, v139
  ds_write_b128 v16, v[188:191] offset:1024
  v_cvt_pk_bf16_f32 v176, v152, v153
  v_cvt_pk_bf16_f32 v177, v154, v155
  v_cvt_pk_bf16_f32 v178, v168, v169
  v_cvt_pk_bf16_f32 v179, v170, v171
  ds_write_b128 v16, v[176:179] offset:2048
  v_cvt_pk_bf16_f32 v180, v92, v93
  v_cvt_pk_bf16_f32 v181, v94, v95
  v_cvt_pk_bf16_f32 v182, v108, v109
  v_cvt_pk_bf16_f32 v183, v110, v111
  ds_write_b128 v16, v[180:183] offset:6144
  v_cvt_pk_bf16_f32 v184, v124, v125
  v_cvt_pk_bf16_f32 v185, v126, v127
  v_cvt_pk_bf16_f32 v186, v140, v141
  v_cvt_pk_bf16_f32 v187, v142, v143
  ds_write_b128 v16, v[184:187] offset:7168
  v_cvt_pk_bf16_f32 v188, v156, v157
  v_cvt_pk_bf16_f32 v189, v158, v159
  v_cvt_pk_bf16_f32 v190, v172, v173
  v_cvt_pk_bf16_f32 v191, v174, v175
  ds_write_b128 v16, v[188:191] offset:8192
fnet_k2_kernel_done1:
  s_nop 1
  s_load_dwordx2 s[16:17], s[0:1], 80
  s_mov_b32 s39, 0xffff0000
  v_and_b32 v6, 15, v0
  v_lshrrev_b32 v7, 4, v0
  s_mul_i32 s52, s40, 3
  s_add_u32 s52, s52, 0
  s_lshl_b32 s54, s52, 10
  v_add_u32 v44, s54, v1
  s_cmp_ge_u32 s52, 6
  s_cselect_b32 s53, 1, 0
  s_cselect_b32 s54, 6, 0
  s_sub_u32 s52, s52, s54
  s_mul_i32 s54, s61, 6
  s_add_u32 s52, s52, s54
  s_lshl_b32 s54, s60, 3
  s_add_u32 s53, s53, s54
  s_lshl_b32 s54, s62, 1
  s_add_u32 s53, s53, s54
  s_mul_i32 s54, s53, 18
  s_add_u32 s54, s54, s52
  s_lshl_b32 s54, s54, 10
  s_add_u32 s67, s54, 21241856
  s_lshr_b32 s54, s53, 4
  s_lshl_b32 s54, s54, 7
  s_bfe_u32 s55, s53, 0x10002
  s_lshl_b32 s55, s55, 6
  s_add_u32 s54, s54, s55
  s_bfe_u32 s55, s53, 0x10003
  s_add_u32 s54, s54, s55
  s_and_b32 s55, s53, 1
  s_lshl_b32 s55, s55, 5
  s_add_u32 s54, s54, s55
  v_lshlrev_b32 v8, 1, v6
  v_add_u32 v8, s54, v8
  v_sub_u32 v11, 0x800, v8
  v_cmp_eq_u32 vcc, 0, v8
  v_mov_b32 v12, 0x400
  s_nop 0
  v_cndmask_b32 v11, v11, v12, vcc
  s_bitcmp1_b32 s53, 1
  s_cselect_b64 s[56:57], -1, 0
  v_cndmask_b32 v9, v8, v11, s[56:57]
  v_and_b32 v10, 0x3ff, v9
  v_lshrrev_b32 v11, 4, v10
  v_mul_u32_u24 v11, 18432, v11
  v_and_b32 v12, 15, v10
  v_lshl_add_u32 v12, v7, 4, v12
  v_lshl_add_u32 v43, v12, 4, v11
  v_lshrrev_b32 v11, 4, v10
  v_lshlrev_b32 v11, 11, v11
  v_lshl_add_u32 v45, v12, 3, v11
  s_cmp_eq_u32 s52, 4
  s_cselect_b32 s32, 33038336, 0
  s_cmp_eq_u32 s52, 13
  s_cselect_b32 s32, 33039360, s32
  s_lshl_b32 s54, s52, 10
  s_add_u32 s20, s54, 30679040
  s_lshl_b32 s54, s53, 6
  s_add_u32 s28, s54, 21233664
  v_lshlrev_b32 v15, 2, v6
  v_mul_u32_u24 v41, 1152, v9
  v_and_b32 v12, 1, v7
  v_lshl_add_u32 v41, v12, 5, v41
  v_lshrrev_b32 v12, 1, v7
  v_lshl_add_u32 v41, v12, 4, v41
  s_lshl_b32 s64, s52, 6
  v_cmp_gt_u32 vcc, 0x400, v9
  v_mov_b32 v42, -1.0
  v_mov_b32 v12, 1.0
  v_cndmask_b32 v42, v42, v12, vcc
  s_mul_i32 s52, s40, 3
  s_add_u32 s52, s52, 1
  s_lshl_b32 s54, s52, 10
  v_add_u32 v80, s54, v1
  s_cmp_ge_u32 s52, 6
  s_cselect_b32 s53, 1, 0
  s_cselect_b32 s54, 6, 0
  s_sub_u32 s52, s52, s54
  s_mul_i32 s54, s61, 6
  s_add_u32 s52, s52, s54
  s_lshl_b32 s54, s60, 3
  s_add_u32 s53, s53, s54
  s_lshl_b32 s54, s62, 1
  s_add_u32 s53, s53, s54
  s_mul_i32 s54, s53, 18
  s_add_u32 s54, s54, s52
  s_lshl_b32 s54, s54, 10
  s_add_u32 s68, s54, 21241856
  s_lshr_b32 s54, s53, 4
  s_lshl_b32 s54, s54, 7
  s_bfe_u32 s55, s53, 0x10002
  s_lshl_b32 s55, s55, 6
  s_add_u32 s54, s54, s55
  s_bfe_u32 s55, s53, 0x10003
  s_add_u32 s54, s54, s55
  s_and_b32 s55, s53, 1
  s_lshl_b32 s55, s55, 5
  s_add_u32 s54, s54, s55
  v_lshlrev_b32 v8, 1, v6
  v_add_u32 v8, s54, v8
  v_sub_u32 v11, 0x800, v8
  v_cmp_eq_u32 vcc, 0, v8
  v_mov_b32 v12, 0x400
  s_nop 0
  v_cndmask_b32 v11, v11, v12, vcc
  s_bitcmp1_b32 s53, 1
  s_cselect_b64 s[56:57], -1, 0
  v_cndmask_b32 v9, v8, v11, s[56:57]
  v_and_b32 v10, 0x3ff, v9
  v_lshrrev_b32 v11, 4, v10
  v_mul_u32_u24 v11, 18432, v11
  v_and_b32 v12, 15, v10
  v_lshl_add_u32 v12, v7, 4, v12
  v_lshl_add_u32 v79, v12, 4, v11
  v_lshrrev_b32 v11, 4, v10
  v_lshlrev_b32 v11, 11, v11
  v_lshl_add_u32 v81, v12, 3, v11
  s_cmp_eq_u32 s52, 4
  s_cselect_b32 s33, 33038336, 0
  s_cmp_eq_u32 s52, 13
  s_cselect_b32 s33, 33039360, s33
  s_lshl_b32 s54, s52, 10
  s_add_u32 s21, s54, 30679040
  s_lshl_b32 s54, s53, 6
  s_add_u32 s29, s54, 21233664
  v_lshlrev_b32 v15, 2, v6
  v_mul_u32_u24 v77, 1152, v9
  v_and_b32 v12, 1, v7
  v_lshl_add_u32 v77, v12, 5, v77
  v_lshrrev_b32 v12, 1, v7
  v_lshl_add_u32 v77, v12, 4, v77
  s_lshl_b32 s65, s52, 6
  v_cmp_gt_u32 vcc, 0x400, v9
  v_mov_b32 v78, -1.0
  v_mov_b32 v12, 1.0
  v_cndmask_b32 v78, v78, v12, vcc
  s_mul_i32 s52, s40, 3
  s_add_u32 s52, s52, 2
  s_lshl_b32 s54, s52, 10
  v_add_u32 v116, s54, v1
  s_cmp_ge_u32 s52, 6
  s_cselect_b32 s53, 1, 0
  s_cselect_b32 s54, 6, 0
  s_sub_u32 s52, s52, s54
  s_mul_i32 s54, s61, 6
  s_add_u32 s52, s52, s54
  s_lshl_b32 s54, s60, 3
  s_add_u32 s53, s53, s54
  s_lshl_b32 s54, s62, 1
  s_add_u32 s53, s53, s54
  s_mul_i32 s54, s53, 18
  s_add_u32 s54, s54, s52
  s_lshl_b32 s54, s54, 10
  s_add_u32 s69, s54, 21241856
  s_lshr_b32 s54, s53, 4
  s_lshl_b32 s54, s54, 7
  s_bfe_u32 s55, s53, 0x10002
  s_lshl_b32 s55, s55, 6
  s_add_u32 s54, s54, s55
  s_bfe_u32 s55, s53, 0x10003
  s_add_u32 s54, s54, s55
  s_and_b32 s55, s53, 1
  s_lshl_b32 s55, s55, 5
  s_add_u32 s54, s54, s55
  v_lshlrev_b32 v8, 1, v6
  v_add_u32 v8, s54, v8
  v_sub_u32 v11, 0x800, v8
  v_cmp_eq_u32 vcc, 0, v8
  v_mov_b32 v12, 0x400
  s_nop 0
  v_cndmask_b32 v11, v11, v12, vcc
  s_bitcmp1_b32 s53, 1
  s_cselect_b64 s[56:57], -1, 0
  v_cndmask_b32 v9, v8, v11, s[56:57]
  v_and_b32 v10, 0x3ff, v9
  v_lshrrev_b32 v11, 4, v10
  v_mul_u32_u24 v11, 18432, v11
  v_and_b32 v12, 15, v10
  v_lshl_add_u32 v12, v7, 4, v12
  v_lshl_add_u32 v115, v12, 4, v11
  v_lshrrev_b32 v11, 4, v10
  v_lshlrev_b32 v11, 11, v11
  v_lshl_add_u32 v117, v12, 3, v11
  s_cmp_eq_u32 s52, 4
  s_cselect_b32 s34, 33038336, 0
  s_cmp_eq_u32 s52, 13
  s_cselect_b32 s34, 33039360, s34
  s_lshl_b32 s54, s52, 10
  s_add_u32 s22, s54, 30679040
  s_lshl_b32 s54, s53, 6
  s_add_u32 s30, s54, 21233664
  v_lshlrev_b32 v15, 2, v6
  v_mul_u32_u24 v113, 1152, v9
  v_and_b32 v12, 1, v7
  v_lshl_add_u32 v113, v12, 5, v113
  v_lshrrev_b32 v12, 1, v7
  v_lshl_add_u32 v113, v12, 4, v113
  s_lshl_b32 s66, s52, 6
  v_cmp_gt_u32 vcc, 0x400, v9
  v_mov_b32 v114, -1.0
  v_mov_b32 v12, 1.0
  v_cndmask_b32 v114, v114, v12, vcc
  s_lshr_b32 s52, s60, 1
  s_sub_u32 s53, 7, s52
  s_sub_u32 s54, 8, s52
  s_and_b32 s54, s54, 7
  s_bitcmp1_b32 s62, 0
  s_cselect_b32 s53, s53, s52
  s_cselect_b32 s54, s54, s52
  v_mov_b32 v13, s53
  v_mov_b32 v14, s54
  v_and_b32 v11, 4, v0
  v_cmp_eq_u32 vcc, 0, v11
  s_nop 1
  v_cndmask_b32 v13, v14, v13, vcc
  v_and_b32 v11, 1, v13
  v_lshlrev_b32 v11, 2, v11
  v_bfe_u32 v12, v0, 1, 1
  v_add_u32 v11, v11, v12
  s_add_u32 s52, s61, 24
  v_add_u32 v11, s52, v11
  v_lshlrev_b32 v11, 3, v11
  v_and_b32 v13, 6, v13
  v_add_u32 v11, v11, v13
  v_and_b32 v12, 1, v0
  v_add_u32 v13, v11, v12
  v_lshlrev_b32 v13, 7, v13
  v_and_b32 v14, 3, v0
  v_lshlrev_b32 v14, 1, v14
  s_lshl_b32 s52, s42, 3
  s_and_b32 s53, s41, 1
  s_add_u32 s52, s52, s53
  v_add_u32 v14, s52, v14
  v_lshlrev_b32 v14, 7, v14
  s_add_u32 s52, s62, 1
  s_and_b32 s52, s52, 3
  s_mul_i32 s25, s52, 2359296
  s_add_u32 s52, s62, 2
  s_and_b32 s52, s52, 3
  s_mul_i32 s26, s52, 2359296
  s_add_u32 s52, s62, 3
  s_and_b32 s52, s52, 3
  s_mul_i32 s27, s52, 2359296
  s_waitcnt lgkmcnt(0)
  s_waitcnt vmcnt(0)
  s_barrier
  s_lshl_b32 s52, s2, 7
  s_add_u32 s52, s52, 33300484
  v_mov_b32 v2, 1
  v_mov_b32 v3, 0
  s_cmp_lg_u32 s40, 0
  s_cbranch_scc1 fnet_k2_kernel_pub1
  s_mov_b64 exec, 1
  buffer_store_dword v2, v3, s[4:7], s52 offen sc1
  s_mov_b64 exec, -1
fnet_k2_kernel_pub1:
  s_cmp_lg_u32 s40, 1
  s_cbranch_scc1 fnet_k2_kernel_polled
  s_mov_b32 s54, 33300484
  s_mov_b32 s55, 0
fnet_k2_kernel_poll:
  buffer_load_dword v4, v13, s[4:7], s54 offen sc1
  buffer_load_dword v5, v14, s[4:7], s54 offen sc1
  s_waitcnt vmcnt(0)
  v_and_b32 v4, v4, v5
  v_cmp_eq_u32 vcc, 1, v4
  s_add_u32 s55, s55, 1
  s_nop 3
  s_cmp_eq_u64 vcc, -1
  s_cbranch_scc1 fnet_k2_kernel_polled
  s_sleep 1
  s_cmp_lt_u32 s55, 262144
  s_cbranch_scc1 fnet_k2_kernel_poll
fnet_k2_kernel_polled:
  s_barrier
  s_mov_b32 s18, 2359296
  s_mov_b32 s19, 0x20000
  buffer_load_dword v40, v15, s[4:7], s28 offen sc1
  s_add_u32 s53, s67, s25
  s_add_u32 s54, s67, s26
  s_add_u32 s55, s67, s27
  buffer_load_dwordx4 v[20:23], v1, s[4:7], s53 offen sc1
  buffer_load_dwordx4 v[24:27], v1, s[4:7], s54 offen sc1
  buffer_load_dwordx4 v[28:31], v1, s[4:7], s55 offen sc1
  s_cmp_lg_u32 s32, 0
  s_cbranch_scc1 fnet_k2_kernel_sx0
  s_add_u32 s52, s20, 1179648
  buffer_load_dwordx4 v[32:35], v43, s[4:7], s20 offen sc1
  buffer_load_dwordx4 v[36:39], v43, s[4:7], s52 offen sc1
  buffer_load_dword v126, v15, s[4:7], s28 offen sc1
  buffer_load_dword v126, v15, s[4:7], s28 offen sc1
  s_branch fnet_k2_kernel_sy0
fnet_k2_kernel_sx0:
  s_add_u32 s52, s32, 131072
  buffer_load_dwordx2 v[32:33], v45, s[4:7], s32 offen sc1
  buffer_load_dwordx2 v[34:35], v45, s[4:7], s32 offen offset:512 sc1
  buffer_load_dwordx2 v[36:37], v45, s[4:7], s52 offen sc1
  buffer_load_dwordx2 v[38:39], v45, s[4:7], s52 offen offset:512 sc1
fnet_k2_kernel_sy0:
  ds_read_b128 v[16:19], v44
  buffer_load_dword v76, v15, s[4:7], s29 offen sc1
  s_add_u32 s53, s68, s25
  s_add_u32 s54, s68, s26
  s_add_u32 s55, s68, s27
  buffer_load_dwordx4 v[56:59], v1, s[4:7], s53 offen sc1
  buffer_load_dwordx4 v[60:63], v1, s[4:7], s54 offen sc1
  buffer_load_dwordx4 v[64:67], v1, s[4:7], s55 offen sc1
  s_cmp_lg_u32 s33, 0
  s_cbranch_scc1 fnet_k2_kernel_sx1
  s_add_u32 s52, s21, 1179648
  buffer_load_dwordx4 v[68:71], v79, s[4:7], s21 offen sc1
  buffer_load_dwordx4 v[72:75], v79, s[4:7], s52 offen sc1
  buffer_load_dword v126, v15, s[4:7], s29 offen sc1
  buffer_load_dword v126, v15, s[4:7], s29 offen sc1
  s_branch fnet_k2_kernel_sy1
fnet_k2_kernel_sx1:
  s_add_u32 s52, s33, 131072
  buffer_load_dwordx2 v[68:69], v81, s[4:7], s33 offen sc1
  buffer_load_dwordx2 v[70:71], v81, s[4:7], s33 offen offset:512 sc1
  buffer_load_dwordx2 v[72:73], v81, s[4:7], s52 offen sc1
  buffer_load_dwordx2 v[74:75], v81, s[4:7], s52 offen offset:512 sc1
fnet_k2_kernel_sy1:
  ds_read_b128 v[52:55], v80
  buffer_load_dword v112, v15, s[4:7], s30 offen sc1
  s_add_u32 s53, s69, s25
  s_add_u32 s54, s69, s26
  s_add_u32 s55, s69, s27
  buffer_load_dwordx4 v[92:95], v1, s[4:7], s53 offen sc1
  buffer_load_dwordx4 v[96:99], v1, s[4:7], s54 offen sc1
  buffer_load_dwordx4 v[100:103], v1, s[4:7], s55 offen sc1
  s_cmp_lg_u32 s34, 0
  s_cbranch_scc1 fnet_k2_kernel_sx2
  s_add_u32 s52, s22, 1179648
  buffer_load_dwordx4 v[104:107], v115, s[4:7], s22 offen sc1
  buffer_load_dwordx4 v[108:111], v115, s[4:7], s52 offen sc1
  buffer_load_dword v126, v15, s[4:7], s30 offen sc1
  buffer_load_dword v126, v15, s[4:7], s30 offen sc1
  s_branch fnet_k2_kernel_sy2
fnet_k2_kernel_sx2:
  s_add_u32 s52, s34, 131072
  buffer_load_dwordx2 v[104:105], v117, s[4:7], s34 offen sc1
  buffer_load_dwordx2 v[106:107], v117, s[4:7], s34 offen offset:512 sc1
  buffer_load_dwordx2 v[108:109], v117, s[4:7], s52 offen sc1
  buffer_load_dwordx2 v[110:111], v117, s[4:7], s52 offen offset:512 sc1
fnet_k2_kernel_sy2:
  ds_read_b128 v[88:91], v116
  s_waitcnt vmcnt(23)
  v_cvt_pk_bf16_f32 v140, v40, v40
  v_and_b32 v144, s39, v140
  v_sub_f32 v142, 1.0, v144
  v_lshrrev_b32 v143, 16, v140
  v_cvt_pk_bf16_f32 v142, v142, v142
  v_and_b32 v146, 0x80000000, v42
  v_lshrrev_b32 v141, 16, v142
  v_and_b32 v142, s39, v142
  v_xor_b32 v146, v146, v144
  v_lshrrev_b32 v145, 16, v146
  s_waitcnt lgkmcnt(2)
  v_dot2_f32_bf16 v130, v16, v141, 0
  v_dot2_f32_bf16 v131, v16, v142, 0
  v_dot2_f32_bf16 v132, v17, v141, 0
  v_dot2_f32_bf16 v133, v17, v142, 0
  v_dot2_f32_bf16 v134, v18, v141, 0
  v_dot2_f32_bf16 v135, v18, v142, 0
  v_dot2_f32_bf16 v136, v19, v141, 0
  v_dot2_f32_bf16 v137, v19, v142, 0
  s_waitcnt vmcnt(22)
  v_dot2_f32_bf16 v130, v20, v141, v130
  v_dot2_f32_bf16 v131, v20, v142, v131
  v_dot2_f32_bf16 v132, v21, v141, v132
  v_dot2_f32_bf16 v133, v21, v142, v133
  v_dot2_f32_bf16 v134, v22, v141, v134
  v_dot2_f32_bf16 v135, v22, v142, v135
  v_dot2_f32_bf16 v136, v23, v141, v136
  v_dot2_f32_bf16 v137, v23, v142, v137
  s_waitcnt vmcnt(21)
  v_dot2_f32_bf16 v130, v24, v141, v130
  v_dot2_f32_bf16 v131, v24, v142, v131
  v_dot2_f32_bf16 v132, v25, v141, v132
  v_dot2_f32_bf16 v133, v25, v142, v133
  v_dot2_f32_bf16 v134, v26, v141, v134
  v_dot2_f32_bf16 v135, v26, v142, v135
  v_dot2_f32_bf16 v136, v27, v141, v136
  v_dot2_f32_bf16 v137, v27, v142, v137
  s_waitcnt vmcnt(20)
  v_dot2_f32_bf16 v130, v28, v141, v130
  v_dot2_f32_bf16 v131, v28, v142, v131
  v_dot2_f32_bf16 v132, v29, v141, v132
  v_dot2_f32_bf16 v133, v29, v142, v133
  v_dot2_f32_bf16 v134, v30, v141, v134
  v_dot2_f32_bf16 v135, v30, v142, v135
  v_dot2_f32_bf16 v136, v31, v141, v136
  v_dot2_f32_bf16 v137, v31, v142, v137
  s_waitcnt vmcnt(16)
  v_dot2_f32_bf16 v130, v32, v143, v130
  v_dot2_f32_bf16 v131, v32, v144, v131
  v_dot2_f32_bf16 v132, v33, v143, v132
  v_dot2_f32_bf16 v133, v33, v144, v133
  v_dot2_f32_bf16 v134, v34, v143, v134
  v_dot2_f32_bf16 v135, v34, v144, v135
  v_dot2_f32_bf16 v136, v35, v143, v136
  v_dot2_f32_bf16 v137, v35, v144, v137
  v_dot2_f32_bf16 v130, v36, v145, v130
  v_dot2_f32_bf16 v131, v36, v146, v131
  v_dot2_f32_bf16 v132, v37, v145, v132
  v_dot2_f32_bf16 v133, v37, v146, v133
  v_dot2_f32_bf16 v134, v38, v145, v134
  v_dot2_f32_bf16 v135, v38, v146, v135
  v_dot2_f32_bf16 v136, v39, v145, v136
  v_dot2_f32_bf16 v137, v39, v146, v137
  v_cvt_pk_bf16_f32 v152, v130, v131
  v_cvt_pk_bf16_f32 v153, v132, v133
  v_cvt_pk_bf16_f32 v154, v134, v135
  v_cvt_pk_bf16_f32 v155, v136, v137
  s_nop 0
  v_permlane16_swap_b32 v152, v154
  v_permlane16_swap_b32 v153, v155
  buffer_store_dwordx4 v[152:155], v41, s[16:19], s64 offen
  s_waitcnt vmcnt(16)
  v_cvt_pk_bf16_f32 v140, v76, v76
  v_and_b32 v144, s39, v140
  v_sub_f32 v142, 1.0, v144
  v_lshrrev_b32 v143, 16, v140
  v_cvt_pk_bf16_f32 v142, v142, v142
  v_and_b32 v146, 0x80000000, v78
  v_lshrrev_b32 v141, 16, v142
  v_and_b32 v142, s39, v142
  v_xor_b32 v146, v146, v144
  v_lshrrev_b32 v145, 16, v146
  s_waitcnt lgkmcnt(1)
  v_dot2_f32_bf16 v130, v52, v141, 0
  v_dot2_f32_bf16 v131, v52, v142, 0
  v_dot2_f32_bf16 v132, v53, v141, 0
  v_dot2_f32_bf16 v133, v53, v142, 0
  v_dot2_f32_bf16 v134, v54, v141, 0
  v_dot2_f32_bf16 v135, v54, v142, 0
  v_dot2_f32_bf16 v136, v55, v141, 0
  v_dot2_f32_bf16 v137, v55, v142, 0
  s_waitcnt vmcnt(15)
  v_dot2_f32_bf16 v130, v56, v141, v130
  v_dot2_f32_bf16 v131, v56, v142, v131
  v_dot2_f32_bf16 v132, v57, v141, v132
  v_dot2_f32_bf16 v133, v57, v142, v133
  v_dot2_f32_bf16 v134, v58, v141, v134
  v_dot2_f32_bf16 v135, v58, v142, v135
  v_dot2_f32_bf16 v136, v59, v141, v136
  v_dot2_f32_bf16 v137, v59, v142, v137
  s_waitcnt vmcnt(14)
  v_dot2_f32_bf16 v130, v60, v141, v130
  v_dot2_f32_bf16 v131, v60, v142, v131
  v_dot2_f32_bf16 v132, v61, v141, v132
  v_dot2_f32_bf16 v133, v61, v142, v133
  v_dot2_f32_bf16 v134, v62, v141, v134
  v_dot2_f32_bf16 v135, v62, v142, v135
  v_dot2_f32_bf16 v136, v63, v141, v136
  v_dot2_f32_bf16 v137, v63, v142, v137
  s_waitcnt vmcnt(13)
  v_dot2_f32_bf16 v130, v64, v141, v130
  v_dot2_f32_bf16 v131, v64, v142, v131
  v_dot2_f32_bf16 v132, v65, v141, v132
  v_dot2_f32_bf16 v133, v65, v142, v133
  v_dot2_f32_bf16 v134, v66, v141, v134
  v_dot2_f32_bf16 v135, v66, v142, v135
  v_dot2_f32_bf16 v136, v67, v141, v136
  v_dot2_f32_bf16 v137, v67, v142, v137
  s_waitcnt vmcnt(9)
  v_dot2_f32_bf16 v130, v68, v143, v130
  v_dot2_f32_bf16 v131, v68, v144, v131
  v_dot2_f32_bf16 v132, v69, v143, v132
  v_dot2_f32_bf16 v133, v69, v144, v133
  v_dot2_f32_bf16 v134, v70, v143, v134
  v_dot2_f32_bf16 v135, v70, v144, v135
  v_dot2_f32_bf16 v136, v71, v143, v136
  v_dot2_f32_bf16 v137, v71, v144, v137
  v_dot2_f32_bf16 v130, v72, v145, v130
  v_dot2_f32_bf16 v131, v72, v146, v131
  v_dot2_f32_bf16 v132, v73, v145, v132
  v_dot2_f32_bf16 v133, v73, v146, v133
  v_dot2_f32_bf16 v134, v74, v145, v134
  v_dot2_f32_bf16 v135, v74, v146, v135
  v_dot2_f32_bf16 v136, v75, v145, v136
  v_dot2_f32_bf16 v137, v75, v146, v137
  v_cvt_pk_bf16_f32 v156, v130, v131
  v_cvt_pk_bf16_f32 v157, v132, v133
  v_cvt_pk_bf16_f32 v158, v134, v135
  v_cvt_pk_bf16_f32 v159, v136, v137
  s_nop 0
  v_permlane16_swap_b32 v156, v158
  v_permlane16_swap_b32 v157, v159
  buffer_store_dwordx4 v[156:159], v77, s[16:19], s65 offen
  s_waitcnt vmcnt(9)
  v_cvt_pk_bf16_f32 v140, v112, v112
  v_and_b32 v144, s39, v140
  v_sub_f32 v142, 1.0, v144
  v_lshrrev_b32 v143, 16, v140
  v_cvt_pk_bf16_f32 v142, v142, v142
  v_and_b32 v146, 0x80000000, v114
  v_lshrrev_b32 v141, 16, v142
  v_and_b32 v142, s39, v142
  v_xor_b32 v146, v146, v144
  v_lshrrev_b32 v145, 16, v146
  s_waitcnt lgkmcnt(0)
  v_dot2_f32_bf16 v130, v88, v141, 0
  v_dot2_f32_bf16 v131, v88, v142, 0
  v_dot2_f32_bf16 v132, v89, v141, 0
  v_dot2_f32_bf16 v133, v89, v142, 0
  v_dot2_f32_bf16 v134, v90, v141, 0
  v_dot2_f32_bf16 v135, v90, v142, 0
  v_dot2_f32_bf16 v136, v91, v141, 0
  v_dot2_f32_bf16 v137, v91, v142, 0
  s_waitcnt vmcnt(8)
  v_dot2_f32_bf16 v130, v92, v141, v130
  v_dot2_f32_bf16 v131, v92, v142, v131
  v_dot2_f32_bf16 v132, v93, v141, v132
  v_dot2_f32_bf16 v133, v93, v142, v133
  v_dot2_f32_bf16 v134, v94, v141, v134
  v_dot2_f32_bf16 v135, v94, v142, v135
  v_dot2_f32_bf16 v136, v95, v141, v136
  v_dot2_f32_bf16 v137, v95, v142, v137
  s_waitcnt vmcnt(7)
  v_dot2_f32_bf16 v130, v96, v141, v130
  v_dot2_f32_bf16 v131, v96, v142, v131
  v_dot2_f32_bf16 v132, v97, v141, v132
  v_dot2_f32_bf16 v133, v97, v142, v133
  v_dot2_f32_bf16 v134, v98, v141, v134
  v_dot2_f32_bf16 v135, v98, v142, v135
  v_dot2_f32_bf16 v136, v99, v141, v136
  v_dot2_f32_bf16 v137, v99, v142, v137
  s_waitcnt vmcnt(6)
  v_dot2_f32_bf16 v130, v100, v141, v130
  v_dot2_f32_bf16 v131, v100, v142, v131
  v_dot2_f32_bf16 v132, v101, v141, v132
  v_dot2_f32_bf16 v133, v101, v142, v133
  v_dot2_f32_bf16 v134, v102, v141, v134
  v_dot2_f32_bf16 v135, v102, v142, v135
  v_dot2_f32_bf16 v136, v103, v141, v136
  v_dot2_f32_bf16 v137, v103, v142, v137
  s_waitcnt vmcnt(2)
  v_dot2_f32_bf16 v130, v104, v143, v130
  v_dot2_f32_bf16 v131, v104, v144, v131
  v_dot2_f32_bf16 v132, v105, v143, v132
  v_dot2_f32_bf16 v133, v105, v144, v133
  v_dot2_f32_bf16 v134, v106, v143, v134
  v_dot2_f32_bf16 v135, v106, v144, v135
  v_dot2_f32_bf16 v136, v107, v143, v136
  v_dot2_f32_bf16 v137, v107, v144, v137
  v_dot2_f32_bf16 v130, v108, v145, v130
  v_dot2_f32_bf16 v131, v108, v146, v131
  v_dot2_f32_bf16 v132, v109, v145, v132
  v_dot2_f32_bf16 v133, v109, v146, v133
  v_dot2_f32_bf16 v134, v110, v145, v134
  v_dot2_f32_bf16 v135, v110, v146, v135
  v_dot2_f32_bf16 v136, v111, v145, v136
  v_dot2_f32_bf16 v137, v111, v146, v137
  v_cvt_pk_bf16_f32 v160, v130, v131
  v_cvt_pk_bf16_f32 v161, v132, v133
  v_cvt_pk_bf16_f32 v162, v134, v135
  v_cvt_pk_bf16_f32 v163, v136, v137
  s_nop 0
  v_permlane16_swap_b32 v160, v162
  v_permlane16_swap_b32 v161, v163
  buffer_store_dwordx4 v[160:163], v113, s[16:19], s66 offen
  s_endpgm
fnet_k2_kernel_dft:
  s_load_dwordx2 s[8:9], s[0:1], 8
  s_load_dwordx2 s[12:13], s[0:1], 16
  s_sub_u32 s63, s42, 24
  s_and_b32 s60, s41, 1
  s_lshr_b32 s64, s41, 1
  s_lshl_b32 s64, s64, 1
  s_lshr_b32 s65, s63, 2
  s_add_u32 s61, s64, s65
  s_and_b32 s62, s63, 3
  s_mul_i32 s63, s60, 589824
  s_mul_i32 s64, s62, 9216
  s_add_u32 s63, s63, s64
  s_mul_i32 s46, s40, 2304
  s_add_u32 s63, s63, s46
  s_add_u32 s44, s63, 18874368
  s_lshl_b32 s63, s60, 12
  s_lshl_b32 s64, s61, 8
  s_add_u32 s45, s63, s64
  s_lshl_b32 s47, s40, 11
  s_add_u32 s47, s47, 9216
  s_lshl_b32 s63, s61, 3
  s_lshl_b32 s64, s40, 1
  s_add_u32 s63, s63, s64
  s_mul_i32 s63, s63, 18432
  s_mul_i32 s64, s60, 1179648
  s_add_u32 s63, s63, s64
  s_add_u32 s50, s63, 30679040
  s_mul_i32 s51, s62, 9
  s_lshl_b32 s63, s61, 3
  s_lshl_b32 s64, s40, 1
  s_add_u32 s63, s63, s64
  s_lshl_b32 s64, s60, 6
  s_add_u32 s63, s63, s64
  s_lshl_b32 s63, s63, 2
  s_add_u32 s63, s63, s62
  s_lshl_b32 s63, s63, 9
  s_add_u32 s58, s63, 33038336
  v_lshlrev_b32 v1, 4, v0
  v_mov_b32 v6, v1
  v_and_b32 v12, 15, v0
  v_lshrrev_b32 v13, 4, v0
  s_lshl_b32 s64, s40, 3
  v_add_u32 v14, s64, v13
  v_lshrrev_b32 v15, 1, v12
  v_and_b32 v16, 7, v14
  v_xor_b32 v15, v15, v16
  v_lshlrev_b32 v15, 5, v15
  v_and_b32 v16, 1, v0
  v_lshl_add_u32 v15, v16, 4, v15
  v_lshl_add_u32 v15, v14, 13, v15
  v_mov_b32 v2, v15
  v_add_u32 v14, s64, v13
  v_add_u32 v14, 4, v14
  v_lshrrev_b32 v15, 1, v12
  v_and_b32 v16, 7, v14
  v_xor_b32 v15, v15, v16
  v_lshlrev_b32 v15, 5, v15
  v_and_b32 v16, 1, v0
  v_lshl_add_u32 v15, v16, 4, v15
  v_lshl_add_u32 v15, v14, 13, v15
  v_subrev_u32 v3, 1024, v15
  v_lshrrev_b32 v14, 2, v12
  v_lshl_add_u32 v14, v13, 2, v14
  v_and_b32 v16, 7, v14
  v_and_b32 v17, 3, v0
  v_lshlrev_b32 v17, 3, v17
  v_lshl_add_u32 v17, v14, 8, v17
  v_add_u32 v17, 9216, v17
  s_lshl_b32 s64, s40, 1
  s_add_u32 s65, s64, 0
  v_xor_b32 v15, s65, v16
  v_lshl_add_u32 v4, v15, 5, v17
  s_add_u32 s65, s64, 1
  v_xor_b32 v15, s65, v16
  v_lshl_add_u32 v5, v15, 5, v17
  v_and_b32 v14, 1, v0
  v_lshlrev_b32 v14, 15, v14
  v_or_b32 v7, 0x3f80, v14
  v_cmp_gt_u32 vcc, 16, v0
  s_cmp_eq_u32 s60, 0
  s_cselect_b32 s65, 0xffff, 0
  v_mov_b32 v14, s65
  v_cndmask_b32 v8, 0, v14, vcc
  s_waitcnt lgkmcnt(0)
  s_mov_b32 s6, 33333248
  s_mov_b32 s7, 0x20000
  s_cmp_lg_u32 s40, 0
  s_cbranch_scc1 fnet_k2_kernel_l3d
  s_lshl_b32 s52, s2, 7
  s_add_u32 s52, s52, 33300488
  v_mov_b32 v242, 1
  v_mov_b32 v243, 0
  s_mov_b64 exec, 1
  buffer_store_dword v242, v243, s[4:7], s52 offen sc1
  s_mov_b64 exec, -1
fnet_k2_kernel_l3d:
  s_mov_b32 s10, 8388608
  s_mov_b32 s11, 0x20000
  s_mov_b32 s14, 8388608
  s_mov_b32 s15, 0x20000
  s_add_u32 m0, s47, 0
  s_add_u32 s49, s45, 0
  buffer_load_dwordx4 v2, s[8:11], s49 offen lds
  buffer_load_dwordx4 v3, s[8:11], s49 offen offset:1024 lds
  s_add_u32 m0, s47, 17408
  s_add_u32 s49, s45, 262144
  buffer_load_dwordx4 v2, s[8:11], s49 offen lds
  buffer_load_dwordx4 v3, s[8:11], s49 offen offset:1024 lds
  s_add_u32 m0, s47, 34816
  s_add_u32 s49, s45, 0
  buffer_load_dwordx4 v2, s[12:15], s49 offen lds
  buffer_load_dwordx4 v3, s[12:15], s49 offen offset:1024 lds
  s_add_u32 m0, s47, 52224
  s_add_u32 s49, s45, 262144
  buffer_load_dwordx4 v2, s[12:15], s49 offen lds
  buffer_load_dwordx4 v3, s[12:15], s49 offen offset:1024 lds
  s_add_u32 m0, s47, 69632
  s_add_u32 s49, s45, 2097152
  buffer_load_dwordx4 v2, s[8:11], s49 offen lds
  buffer_load_dwordx4 v3, s[8:11], s49 offen offset:1024 lds
  s_add_u32 m0, s47, 87040
  s_add_u32 s49, s45, 2359296
  buffer_load_dwordx4 v2, s[8:11], s49 offen lds
  buffer_load_dwordx4 v3, s[8:11], s49 offen offset:1024 lds
  s_add_u32 m0, s47, 104448
  s_add_u32 s49, s45, 2097152
  buffer_load_dwordx4 v2, s[12:15], s49 offen lds
  buffer_load_dwordx4 v3, s[12:15], s49 offen offset:1024 lds
  s_add_u32 m0, s47, 121856
  s_add_u32 s49, s45, 2359296
  buffer_load_dwordx4 v2, s[12:15], s49 offen lds
  buffer_load_dwordx4 v3, s[12:15], s49 offen offset:1024 lds
  v_add_u32 v235, 0, v0
  v_lshlrev_b32 v235, 7, v235
  v_add_u32 v236, 64, v0
  v_lshlrev_b32 v236, 7, v236
  v_add_u32 v237, 128, v0
  v_lshlrev_b32 v237, 7, v237
  v_add_u32 v238, 192, v0
  v_lshlrev_b32 v238, 7, v238
  buffer_store_dwordx2 v[56:57], v55, s[16:19], s24 offen sc1
  buffer_store_dwordx2 v[60:61], v55, s[16:19], s25 offen sc1
  buffer_store_dwordx2 v[64:65], v55, s[16:19], s26 offen sc1
  buffer_store_dwordx2 v[68:69], v55, s[16:19], s27 offen sc1
  s_waitcnt vmcnt(0)
  s_barrier
  s_cmp_lg_u32 s40, 0
  s_cbranch_scc1 fnet_k2_kernel_l2d
  s_lshl_b32 s52, s2, 7
  s_add_u32 s52, s52, 33300492
  v_mov_b32 v242, 1
  v_mov_b32 v243, 0
  s_mov_b64 exec, 1
  buffer_store_dword v242, v243, s[4:7], s52 offen sc1
  s_mov_b64 exec, -1
fnet_k2_kernel_l2d:
  s_cmp_eq_u32 s36, 1
  s_cbranch_scc1 fnet_k2_kernel_d1i_ok
  v_mov_b32 v240, 0
  s_mov_b32 s55, 0
fnet_k2_kernel_d1i_spin:
  global_load_dword v241, v240, s[56:57] sc1
  s_add_u32 s55, s55, 1
  s_waitcnt vmcnt(0)
  v_readfirstlane_b32 s54, v241
  s_nop 3
  s_cmp_ge_u32 s54, 256
  s_cbranch_scc1 fnet_k2_kernel_d1i_ok
  s_sleep 2
  s_cmp_lt_u32 s55, 262144
  s_cbranch_scc1 fnet_k2_kernel_d1i_spin
fnet_k2_kernel_d1i_ok:
  v_min_u32 v235, 18, v0
  v_and_b32 v236, 7, v235
  v_lshlrev_b32 v236, 3, v236
  v_lshrrev_b32 v235, 3, v235
  v_lshl_add_u32 v235, v235, 1, v236
  v_lshlrev_b32 v235, 7, v235
  v_add_u32 v236, 0, v235
  v_add_u32 v237, 128, v235
  s_mov_b32 s54, 33300488
  s_mov_b32 s55, 0
fnet_k2_kernel_d1f_spin:
  buffer_load_dword v245, v236, s[4:7], s54 offen sc1
  buffer_load_dword v246, v237, s[4:7], s54 offen sc1
  s_waitcnt vmcnt(0)
  v_and_b32 v245, v245, v246
  v_cmp_eq_u32 vcc, 1, v245
  s_add_u32 s55, s55, 1
  s_nop 3
  s_cmp_eq_u64 vcc, -1
  s_cbranch_scc1 fnet_k2_kernel_d1f_ok
  s_sleep 1
  s_cmp_lt_u32 s55, 262144
  s_cbranch_scc1 fnet_k2_kernel_d1f_spin
fnet_k2_kernel_d1f_ok:
  s_add_u32 m0, s46, 0
  s_add_u32 s48, s44, 0
  buffer_load_dwordx4 v1, s[4:7], s48 offen sc1 lds
  buffer_load_dwordx4 v1, s[4:7], s48 offen offset:1024 sc1 lds
  s_mov_b64 exec, 0xffff
  buffer_load_dwordx4 v1, s[4:7], s48 offen offset:2048 sc1 lds
  s_mov_b64 exec, -1
  s_add_u32 m0, s46, 17408
  s_add_u32 s48, s44, 36864
  buffer_load_dwordx4 v1, s[4:7], s48 offen sc1 lds
  buffer_load_dwordx4 v1, s[4:7], s48 offen offset:1024 sc1 lds
  s_mov_b64 exec, 0xffff
  buffer_load_dwordx4 v1, s[4:7], s48 offen offset:2048 sc1 lds
  s_mov_b64 exec, -1
  s_add_u32 m0, s46, 34816
  s_add_u32 s48, s44, 1179648
  buffer_load_dwordx4 v1, s[4:7], s48 offen sc1 lds
  buffer_load_dwordx4 v1, s[4:7], s48 offen offset:1024 sc1 lds
  s_mov_b64 exec, 0xffff
  buffer_load_dwordx4 v1, s[4:7], s48 offen offset:2048 sc1 lds
  s_mov_b64 exec, -1
  s_add_u32 m0, s46, 52224
  s_add_u32 s48, s44, 1216512
  buffer_load_dwordx4 v1, s[4:7], s48 offen sc1 lds
  buffer_load_dwordx4 v1, s[4:7], s48 offen offset:1024 sc1 lds
  s_mov_b64 exec, 0xffff
  buffer_load_dwordx4 v1, s[4:7], s48 offen offset:2048 sc1 lds
  s_mov_b64 exec, -1
  s_add_u32 m0, s46, 69632
  s_add_u32 s48, s44, 294912
  buffer_load_dwordx4 v1, s[4:7], s48 offen sc1 lds
  buffer_load_dwordx4 v1, s[4:7], s48 offen offset:1024 sc1 lds
  s_mov_b64 exec, 0xffff
  buffer_load_dwordx4 v1, s[4:7], s48 offen offset:2048 sc1 lds
  s_mov_b64 exec, -1
  s_add_u32 m0, s46, 87040
  s_add_u32 s48, s44, 331776
  buffer_load_dwordx4 v1, s[4:7], s48 offen sc1 lds
  buffer_load_dwordx4 v1, s[4:7], s48 offen offset:1024 sc1 lds
  s_mov_b64 exec, 0xffff
  buffer_load_dwordx4 v1, s[4:7], s48 offen offset:2048 sc1 lds
  s_mov_b64 exec, -1
  s_add_u32 m0, s46, 104448
  s_add_u32 s48, s44, 1474560
  buffer_load_dwordx4 v1, s[4:7], s48 offen sc1 lds
  buffer_load_dwordx4 v1, s[4:7], s48 offen offset:1024 sc1 lds
  s_mov_b64 exec, 0xffff
  buffer_load_dwordx4 v1, s[4:7], s48 offen offset:2048 sc1 lds
  s_mov_b64 exec, -1
  s_add_u32 m0, s46, 121856
  s_add_u32 s48, s44, 1511424
  buffer_load_dwordx4 v1, s[4:7], s48 offen sc1 lds
  buffer_load_dwordx4 v1, s[4:7], s48 offen offset:1024 sc1 lds
  s_mov_b64 exec, 0xffff
  buffer_load_dwordx4 v1, s[4:7], s48 offen offset:2048 sc1 lds
  s_mov_b64 exec, -1
  s_mov_b32 s53, 33308680
  buffer_load_dword v244, v235, s[4:7], s53 offen sc1
  s_waitcnt vmcnt(19)
  s_barrier
  ds_read_b64_tr_b16 v[48:49], v4 offset:0
  ds_read_b64_tr_b16 v[50:51], v4 offset:4096
  ds_read_b64_tr_b16 v[52:53], v5 offset:0
  ds_read_b64_tr_b16 v[54:55], v5 offset:4096
  ds_read_b128 v[24:27], v6 offset:0
  ds_read_b128 v[28:31], v6 offset:1024
  ds_read_b128 v[32:35], v6 offset:2048
  s_waitcnt lgkmcnt(2)
  v_mfma_f32_16x16x32_bf16 v[64:67], v[24:27], v[48:51], 0
  ds_read_b128 v[36:39], v6 offset:3072
  v_mfma_f32_16x16x32_bf16 v[68:71], v[24:27], v[52:55], 0
  s_waitcnt lgkmcnt(2)
  v_mfma_f32_16x16x32_bf16 v[72:75], v[28:31], v[48:51], 0
  ds_read_b128 v[40:43], v6 offset:4096
  v_mfma_f32_16x16x32_bf16 v[76:79], v[28:31], v[52:55], 0
  s_waitcnt lgkmcnt(2)
  v_mfma_f32_16x16x32_bf16 v[80:83], v[32:35], v[48:51], 0
  ds_read_b128 v[44:47], v6 offset:5120
  v_mfma_f32_16x16x32_bf16 v[84:87], v[32:35], v[52:55], 0
  s_waitcnt lgkmcnt(2)
  v_mfma_f32_16x16x32_bf16 v[88:91], v[36:39], v[48:51], 0
  ds_read_b128 v[24:27], v6 offset:6144
  v_mfma_f32_16x16x32_bf16 v[92:95], v[36:39], v[52:55], 0
  s_waitcnt lgkmcnt(2)
  v_mfma_f32_16x16x32_bf16 v[96:99], v[40:43], v[48:51], 0
  ds_read_b128 v[28:31], v6 offset:7168
  v_mfma_f32_16x16x32_bf16 v[100:103], v[40:43], v[52:55], 0
  s_waitcnt lgkmcnt(2)
  v_mfma_f32_16x16x32_bf16 v[104:107], v[44:47], v[48:51], 0
  ds_read_b128 v[32:35], v6 offset:8192
  v_mfma_f32_16x16x32_bf16 v[108:111], v[44:47], v[52:55], 0
  s_waitcnt lgkmcnt(2)
  v_mfma_f32_16x16x32_bf16 v[112:115], v[24:27], v[48:51], 0
  ds_read_b64_tr_b16 v[56:57], v4 offset:17408
  ds_read_b64_tr_b16 v[58:59], v4 offset:21504
  v_mfma_f32_16x16x32_bf16 v[116:119], v[24:27], v[52:55], 0
  s_waitcnt lgkmcnt(3)
  ds_read_b64_tr_b16 v[60:61], v5 offset:17408
  ds_read_b64_tr_b16 v[62:63], v5 offset:21504
  v_mfma_f32_16x16x32_bf16 v[120:123], v[28:31], v[48:51], 0
  ds_read_b128 v[36:39], v6 offset:17408
  ds_read_b128 v[40:43], v6 offset:18432
  v_mfma_f32_16x16x32_bf16 v[124:127], v[28:31], v[52:55], 0
  s_waitcnt lgkmcnt(6)
  v_mfma_f32_16x16x32_bf16 v[128:131], v[32:35], v[48:51], 0
  ds_read_b128 v[44:47], v6 offset:19456
  v_mfma_f32_16x16x32_bf16 v[132:135], v[32:35], v[52:55], 0
  s_waitcnt lgkmcnt(2)
  v_mfma_f32_16x16x32_bf16 v[64:67], v[36:39], v[56:59], v[64:67]
  ds_read_b128 v[24:27], v6 offset:20480
  v_mfma_f32_16x16x32_bf16 v[68:71], v[36:39], v[60:63], v[68:71]
  s_waitcnt lgkmcnt(2)
  v_mfma_f32_16x16x32_bf16 v[72:75], v[40:43], v[56:59], v[72:75]
  ds_read_b128 v[28:31], v6 offset:21504
  v_mfma_f32_16x16x32_bf16 v[76:79], v[40:43], v[60:63], v[76:79]
  s_waitcnt lgkmcnt(2)
  v_mfma_f32_16x16x32_bf16 v[80:83], v[44:47], v[56:59], v[80:83]
  ds_read_b128 v[32:35], v6 offset:22528
  v_mfma_f32_16x16x32_bf16 v[84:87], v[44:47], v[60:63], v[84:87]
  s_waitcnt lgkmcnt(2)
  v_mfma_f32_16x16x32_bf16 v[88:91], v[24:27], v[56:59], v[88:91]
  ds_read_b128 v[36:39], v6 offset:23552
  v_mfma_f32_16x16x32_bf16 v[92:95], v[24:27], v[60:63], v[92:95]
  s_waitcnt lgkmcnt(2)
  v_mfma_f32_16x16x32_bf16 v[96:99], v[28:31], v[56:59], v[96:99]
  ds_read_b128 v[40:43], v6 offset:24576
  v_mfma_f32_16x16x32_bf16 v[100:103], v[28:31], v[60:63], v[100:103]
  s_waitcnt lgkmcnt(2)
  v_mfma_f32_16x16x32_bf16 v[104:107], v[32:35], v[56:59], v[104:107]
  ds_read_b128 v[44:47], v6 offset:25600
  v_mfma_f32_16x16x32_bf16 v[108:111], v[32:35], v[60:63], v[108:111]
  s_waitcnt lgkmcnt(2)
  v_mfma_f32_16x16x32_bf16 v[112:115], v[36:39], v[56:59], v[112:115]
  s_waitcnt vmcnt(13)
  s_barrier
  ds_read_b64_tr_b16 v[48:49], v4 offset:34816
  v_mfma_f32_16x16x32_bf16 v[116:119], v[36:39], v[60:63], v[116:119]
  s_waitcnt lgkmcnt(2)
  ds_read_b64_tr_b16 v[50:51], v4 offset:38912
  v_mfma_f32_16x16x32_bf16 v[120:123], v[40:43], v[56:59], v[120:123]
  s_waitcnt vmcnt(0)
  v_cmp_eq_u32 vcc, 1, v244
  s_nop 4
  s_cmp_eq_u64 vcc, -1
  s_cbranch_scc1 fnet_k2_kernel_dg2_go
  v_add_u32 v236, 8192, v235
  s_mov_b32 s54, 33300488
  s_mov_b32 s55, 0
fnet_k2_kernel_dg2_spin:
  buffer_load_dword v245, v236, s[4:7], s54 offen sc1
  s_waitcnt vmcnt(0)
  v_cmp_eq_u32 vcc, 1, v245
  s_add_u32 s55, s55, 1
  s_nop 3
  s_cmp_eq_u64 vcc, -1
  s_cbranch_scc1 fnet_k2_kernel_dg2_ok
  s_sleep 1
  s_cmp_lt_u32 s55, 262144
  s_cbranch_scc1 fnet_k2_kernel_dg2_spin
fnet_k2_kernel_dg2_ok:
fnet_k2_kernel_dg2_go:
  v_mfma_f32_16x16x32_bf16 v[124:127], v[40:43], v[60:63], v[124:127]
  s_waitcnt lgkmcnt(2)
  v_mfma_f32_16x16x32_bf16 v[128:131], v[44:47], v[56:59], v[128:131]
  s_waitcnt lgkmcnt(1)
  v_bfi_b32 v48, v8, v7, v48
  ds_read_b64_tr_b16 v[52:53], v5 offset:34816
  ds_read_b64_tr_b16 v[54:55], v5 offset:38912
  s_waitcnt lgkmcnt(1)
  v_bfi_b32 v52, v8, v7, v52
  ds_read_b128 v[24:27], v6 offset:34816
  v_mfma_f32_16x16x32_bf16 v[132:135], v[44:47], v[60:63], v[132:135]
  s_waitcnt lgkmcnt(0)
  ds_read_b128 v[28:31], v6 offset:35840
  ds_read_b128 v[32:35], v6 offset:36864
  v_mfma_f32_16x16x32_bf16 v[64:67], v[24:27], v[48:51], v[64:67]
  s_add_u32 m0, s46, 139264
  ds_read_b128 v[36:39], v6 offset:37888
  s_add_u32 s48, s44, 73728
  v_mfma_f32_16x16x32_bf16 v[68:71], v[24:27], v[52:55], v[68:71]
  s_waitcnt lgkmcnt(2)
  buffer_load_dwordx4 v1, s[4:7], s48 offen sc1 lds
  v_mfma_f32_16x16x32_bf16 v[72:75], v[28:31], v[48:51], v[72:75]
  buffer_load_dwordx4 v1, s[4:7], s48 offen offset:1024 sc1 lds
  v_mfma_f32_16x16x32_bf16 v[76:79], v[28:31], v[52:55], v[76:79]
  s_waitcnt lgkmcnt(1)
  ds_read_b128 v[40:43], v6 offset:38912
  v_mfma_f32_16x16x32_bf16 v[80:83], v[32:35], v[48:51], v[80:83]
  ds_read_b128 v[44:47], v6 offset:39936
  v_mfma_f32_16x16x32_bf16 v[84:87], v[32:35], v[52:55], v[84:87]
  s_waitcnt lgkmcnt(2)
  v_mfma_f32_16x16x32_bf16 v[88:91], v[36:39], v[48:51], v[88:91]
  s_mov_b64 exec, 0xffff
  buffer_load_dwordx4 v1, s[4:7], s48 offen offset:2048 sc1 lds
  s_mov_b64 exec, -1
  v_mfma_f32_16x16x32_bf16 v[92:95], v[36:39], v[52:55], v[92:95]
  s_waitcnt lgkmcnt(1)
  ds_read_b128 v[24:27], v6 offset:40960
  v_mfma_f32_16x16x32_bf16 v[96:99], v[40:43], v[48:51], v[96:99]
  ds_read_b128 v[28:31], v6 offset:41984
  v_mfma_f32_16x16x32_bf16 v[100:103], v[40:43], v[52:55], v[100:103]
  s_waitcnt lgkmcnt(2)
  s_add_u32 m0, s47, 139264
  s_add_u32 s49, s45, 524288
  v_mfma_f32_16x16x32_bf16 v[104:107], v[44:47], v[48:51], v[104:107]
  buffer_load_dwordx4 v2, s[8:11], s49 offen lds
  v_mfma_f32_16x16x32_bf16 v[108:111], v[44:47], v[52:55], v[108:111]
  s_waitcnt lgkmcnt(1)
  ds_read_b128 v[32:35], v6 offset:43008
  v_mfma_f32_16x16x32_bf16 v[112:115], v[24:27], v[48:51], v[112:115]
  v_add_u32 v4, 52224, v4
  ds_read_b64_tr_b16 v[56:57], v4 offset:0
  v_mfma_f32_16x16x32_bf16 v[116:119], v[24:27], v[52:55], v[116:119]
  s_waitcnt lgkmcnt(2)
  ds_read_b64_tr_b16 v[58:59], v4 offset:4096
  v_add_u32 v5, 52224, v5
  v_mfma_f32_16x16x32_bf16 v[120:123], v[28:31], v[48:51], v[120:123]
  ds_read_b64_tr_b16 v[60:61], v5 offset:0
  ds_read_b64_tr_b16 v[62:63], v5 offset:4096
  v_mfma_f32_16x16x32_bf16 v[124:127], v[28:31], v[52:55], v[124:127]
  s_waitcnt lgkmcnt(4)
  ds_read_b128 v[36:39], v6 offset:52224
  ds_read_b128 v[40:43], v6 offset:53248
  v_mfma_f32_16x16x32_bf16 v[128:131], v[32:35], v[48:51], v[128:131]
  buffer_load_dwordx4 v3, s[8:11], s49 offen offset:1024 lds
  v_mfma_f32_16x16x32_bf16 v[132:135], v[32:35], v[52:55], v[132:135]
  s_waitcnt lgkmcnt(1)
  ds_read_b128 v[44:47], v6 offset:54272
  s_add_u32 m0, s46, 0
  v_mfma_f32_16x16x32_bf16 v[64:67], v[36:39], v[56:59], v[64:67]
  s_add_u32 s48, s44, 110592
  buffer_load_dwordx4 v1, s[4:7], s48 offen sc1 lds
  v_mfma_f32_16x16x32_bf16 v[68:71], v[36:39], v[60:63], v[68:71]
  s_waitcnt lgkmcnt(1)
  buffer_load_dwordx4 v1, s[4:7], s48 offen offset:1024 sc1 lds
  v_mfma_f32_16x16x32_bf16 v[72:75], v[40:43], v[56:59], v[72:75]
  ds_read_b128 v[24:27], v6 offset:55296
  ds_read_b128 v[28:31], v6 offset:56320
  v_mfma_f32_16x16x32_bf16 v[76:79], v[40:43], v[60:63], v[76:79]
  s_waitcnt lgkmcnt(2)
  v_mfma_f32_16x16x32_bf16 v[80:83], v[44:47], v[56:59], v[80:83]
  ds_read_b128 v[32:35], v6 offset:57344
  v_mfma_f32_16x16x32_bf16 v[84:87], v[44:47], v[60:63], v[84:87]
  s_waitcnt lgkmcnt(2)
  s_mov_b64 exec, 0xffff
  buffer_load_dwordx4 v1, s[4:7], s48 offen offset:2048 sc1 lds
  s_mov_b64 exec, -1
  v_mfma_f32_16x16x32_bf16 v[88:91], v[24:27], v[56:59], v[88:91]
  ds_read_b128 v[36:39], v6 offset:58368
  v_mfma_f32_16x16x32_bf16 v[92:95], v[24:27], v[60:63], v[92:95]
  s_waitcnt lgkmcnt(2)
  v_mfma_f32_16x16x32_bf16 v[96:99], v[28:31], v[56:59], v[96:99]
  s_add_u32 m0, s47, 0
  ds_read_b128 v[40:43], v6 offset:59392
  s_add_u32 s49, s45, 786432
  v_mfma_f32_16x16x32_bf16 v[100:103], v[28:31], v[60:63], v[100:103]
  s_waitcnt lgkmcnt(2)
  buffer_load_dwordx4 v2, s[8:11], s49 offen lds
  v_mfma_f32_16x16x32_bf16 v[104:107], v[32:35], v[56:59], v[104:107]
  ds_read_b128 v[44:47], v6 offset:60416
  v_mfma_f32_16x16x32_bf16 v[108:111], v[32:35], v[60:63], v[108:111]
  s_waitcnt lgkmcnt(2)
  v_mfma_f32_16x16x32_bf16 v[112:115], v[36:39], v[56:59], v[112:115]
  s_barrier
  ds_read_b64_tr_b16 v[48:49], v4 offset:17408
  ds_read_b64_tr_b16 v[50:51], v4 offset:21504
  v_mfma_f32_16x16x32_bf16 v[116:119], v[36:39], v[60:63], v[116:119]
  s_waitcnt lgkmcnt(3)
  ds_read_b64_tr_b16 v[52:53], v5 offset:17408
  ds_read_b64_tr_b16 v[54:55], v5 offset:21504
  v_mfma_f32_16x16x32_bf16 v[120:123], v[40:43], v[56:59], v[120:123]
  v_add_u32 v6, 69632, v6
  ds_read_b128 v[24:27], v6 offset:0
  v_mfma_f32_16x16x32_bf16 v[124:127], v[40:43], v[60:63], v[124:127]
  s_waitcnt lgkmcnt(5)
  buffer_load_dwordx4 v3, s[8:11], s49 offen offset:1024 lds
  v_mfma_f32_16x16x32_bf16 v[128:131], v[44:47], v[56:59], v[128:131]
  s_mov_b32 s53, 33308808
  ds_read_b128 v[28:31], v6 offset:1024
  ds_read_b128 v[32:35], v6 offset:2048
  v_mfma_f32_16x16x32_bf16 v[132:135], v[44:47], v[60:63], v[132:135]
  s_waitcnt lgkmcnt(2)
  buffer_load_dword v244, v235, s[4:7], s53 offen sc1
  v_mfma_f32_16x16x32_bf16 v[64:67], v[24:27], v[48:51], v[64:67]
  s_add_u32 m0, s46, 17408
  ds_read_b128 v[36:39], v6 offset:3072
  s_add_u32 s48, s44, 1253376
  v_mfma_f32_16x16x32_bf16 v[68:71], v[24:27], v[52:55], v[68:71]
  s_waitcnt lgkmcnt(2)
  buffer_load_dwordx4 v1, s[4:7], s48 offen sc1 lds
  v_mfma_f32_16x16x32_bf16 v[72:75], v[28:31], v[48:51], v[72:75]
  buffer_load_dwordx4 v1, s[4:7], s48 offen offset:1024 sc1 lds
  v_mfma_f32_16x16x32_bf16 v[76:79], v[28:31], v[52:55], v[76:79]
  s_waitcnt lgkmcnt(1)
  ds_read_b128 v[40:43], v6 offset:4096
  v_mfma_f32_16x16x32_bf16 v[80:83], v[32:35], v[48:51], v[80:83]
  ds_read_b128 v[44:47], v6 offset:5120
  v_mfma_f32_16x16x32_bf16 v[84:87], v[32:35], v[52:55], v[84:87]
  s_waitcnt lgkmcnt(2)
  v_mfma_f32_16x16x32_bf16 v[88:91], v[36:39], v[48:51], v[88:91]
  s_mov_b64 exec, 0xffff
  buffer_load_dwordx4 v1, s[4:7], s48 offen offset:2048 sc1 lds
  s_mov_b64 exec, -1
  v_mfma_f32_16x16x32_bf16 v[92:95], v[36:39], v[52:55], v[92:95]
  s_waitcnt lgkmcnt(1)
  ds_read_b128 v[24:27], v6 offset:6144
  v_mfma_f32_16x16x32_bf16 v[96:99], v[40:43], v[48:51], v[96:99]
  ds_read_b128 v[28:31], v6 offset:7168
  v_mfma_f32_16x16x32_bf16 v[100:103], v[40:43], v[52:55], v[100:103]
  s_waitcnt lgkmcnt(2)
  s_add_u32 m0, s47, 17408
  s_add_u32 s49, s45, 524288
  v_mfma_f32_16x16x32_bf16 v[104:107], v[44:47], v[48:51], v[104:107]
  buffer_load_dwordx4 v2, s[12:15], s49 offen lds
  v_mfma_f32_16x16x32_bf16 v[108:111], v[44:47], v[52:55], v[108:111]
  s_waitcnt lgkmcnt(1)
  ds_read_b128 v[32:35], v6 offset:8192
  v_mfma_f32_16x16x32_bf16 v[112:115], v[24:27], v[48:51], v[112:115]
  ds_read_b64_tr_b16 v[56:57], v4 offset:34816
  ds_read_b64_tr_b16 v[58:59], v4 offset:38912
  v_mfma_f32_16x16x32_bf16 v[116:119], v[24:27], v[52:55], v[116:119]
  s_waitcnt lgkmcnt(3)
  ds_read_b64_tr_b16 v[60:61], v5 offset:34816
  ds_read_b64_tr_b16 v[62:63], v5 offset:38912
  v_mfma_f32_16x16x32_bf16 v[120:123], v[28:31], v[48:51], v[120:123]
  ds_read_b128 v[36:39], v6 offset:17408
  ds_read_b128 v[40:43], v6 offset:18432
  v_mfma_f32_16x16x32_bf16 v[124:127], v[28:31], v[52:55], v[124:127]
  s_waitcnt lgkmcnt(6)
  buffer_load_dwordx4 v3, s[12:15], s49 offen offset:1024 lds
  v_mfma_f32_16x16x32_bf16 v[128:131], v[32:35], v[48:51], v[128:131]
  s_add_u32 m0, s46, 34816
  ds_read_b128 v[44:47], v6 offset:19456
  s_add_u32 s48, s44, 1290240
  v_mfma_f32_16x16x32_bf16 v[132:135], v[32:35], v[52:55], v[132:135]
  s_waitcnt lgkmcnt(2)
  buffer_load_dwordx4 v1, s[4:7], s48 offen sc1 lds
  v_mfma_f32_16x16x32_bf16 v[64:67], v[36:39], v[56:59], v[64:67]
  ds_read_b128 v[24:27], v6 offset:20480
  v_mfma_f32_16x16x32_bf16 v[68:71], v[36:39], v[60:63], v[68:71]
  s_waitcnt lgkmcnt(2)
  buffer_load_dwordx4 v1, s[4:7], s48 offen offset:1024 sc1 lds
  v_mfma_f32_16x16x32_bf16 v[72:75], v[40:43], v[56:59], v[72:75]
  ds_read_b128 v[28:31], v6 offset:21504
  v_mfma_f32_16x16x32_bf16 v[76:79], v[40:43], v[60:63], v[76:79]
  s_waitcnt lgkmcnt(2)
  v_mfma_f32_16x16x32_bf16 v[80:83], v[44:47], v[56:59], v[80:83]
  ds_read_b128 v[32:35], v6 offset:22528
  v_mfma_f32_16x16x32_bf16 v[84:87], v[44:47], v[60:63], v[84:87]
  s_waitcnt lgkmcnt(2)
  s_mov_b64 exec, 0xffff
  buffer_load_dwordx4 v1, s[4:7], s48 offen offset:2048 sc1 lds
  s_mov_b64 exec, -1
  v_mfma_f32_16x16x32_bf16 v[88:91], v[24:27], v[56:59], v[88:91]
  ds_read_b128 v[36:39], v6 offset:23552
  v_mfma_f32_16x16x32_bf16 v[92:95], v[24:27], v[60:63], v[92:95]
  s_waitcnt lgkmcnt(2)
  v_mfma_f32_16x16x32_bf16 v[96:99], v[28:31], v[56:59], v[96:99]
  s_add_u32 m0, s47, 34816
  ds_read_b128 v[40:43], v6 offset:24576
  s_add_u32 s49, s45, 786432
  v_mfma_f32_16x16x32_bf16 v[100:103], v[28:31], v[60:63], v[100:103]
  s_waitcnt lgkmcnt(2)
  buffer_load_dwordx4 v2, s[12:15], s49 offen lds
  v_mfma_f32_16x16x32_bf16 v[104:107], v[32:35], v[56:59], v[104:107]
  ds_read_b128 v[44:47], v6 offset:25600
  v_mfma_f32_16x16x32_bf16 v[108:111], v[32:35], v[60:63], v[108:111]
  s_waitcnt lgkmcnt(2)
  v_mfma_f32_16x16x32_bf16 v[112:115], v[36:39], v[56:59], v[112:115]
  s_barrier
  v_add_u32 v4, 52224, v4
  ds_read_b64_tr_b16 v[48:49], v4 offset:0
  v_mfma_f32_16x16x32_bf16 v[116:119], v[36:39], v[60:63], v[116:119]
  s_waitcnt lgkmcnt(2)
  ds_read_b64_tr_b16 v[50:51], v4 offset:4096
  v_add_u32 v5, 52224, v5
  v_mfma_f32_16x16x32_bf16 v[120:123], v[40:43], v[56:59], v[120:123]
  ds_read_b64_tr_b16 v[52:53], v5 offset:0
  ds_read_b64_tr_b16 v[54:55], v5 offset:4096
  v_mfma_f32_16x16x32_bf16 v[124:127], v[40:43], v[60:63], v[124:127]
  s_waitcnt lgkmcnt(4)
  ds_read_b128 v[24:27], v6 offset:34816
  ds_read_b128 v[28:31], v6 offset:35840
  v_mfma_f32_16x16x32_bf16 v[128:131], v[44:47], v[56:59], v[128:131]
  buffer_load_dwordx4 v3, s[12:15], s49 offen offset:1024 lds
  v_mfma_f32_16x16x32_bf16 v[132:135], v[44:47], v[60:63], v[132:135]
  s_waitcnt lgkmcnt(1)
  s_waitcnt vmcnt(10)
  v_cmp_eq_u32 vcc, 1, v244
  s_nop 4
  s_cmp_eq_u64 vcc, -1
  s_cbranch_scc1 fnet_k2_kernel_dg3_go
  v_add_u32 v236, 8320, v235
  s_mov_b32 s54, 33300488
  s_mov_b32 s55, 0
fnet_k2_kernel_dg3_spin:
  buffer_load_dword v245, v236, s[4:7], s54 offen sc1
  s_waitcnt vmcnt(0)
  v_cmp_eq_u32 vcc, 1, v245
  s_add_u32 s55, s55, 1
  s_nop 3
  s_cmp_eq_u64 vcc, -1
  s_cbranch_scc1 fnet_k2_kernel_dg3_ok
  s_sleep 1
  s_cmp_lt_u32 s55, 262144
  s_cbranch_scc1 fnet_k2_kernel_dg3_spin
fnet_k2_kernel_dg3_ok:
fnet_k2_kernel_dg3_go:
  v_mfma_f32_16x16x32_bf16 v[64:67], v[24:27], v[48:51], v[64:67]
  s_add_u32 m0, s46, 52224
  ds_read_b128 v[32:35], v6 offset:36864
  s_add_u32 s48, s44, 368640
  v_mfma_f32_16x16x32_bf16 v[68:71], v[24:27], v[52:55], v[68:71]
  s_waitcnt lgkmcnt(1)
  buffer_load_dwordx4 v1, s[4:7], s48 offen sc1 lds
  v_mfma_f32_16x16x32_bf16 v[72:75], v[28:31], v[48:51], v[72:75]
  ds_read_b128 v[36:39], v6 offset:37888
  ds_read_b128 v[40:43], v6 offset:38912
  v_mfma_f32_16x16x32_bf16 v[76:79], v[28:31], v[52:55], v[76:79]
  s_waitcnt lgkmcnt(2)
  buffer_load_dwordx4 v1, s[4:7], s48 offen offset:1024 sc1 lds
  v_mfma_f32_16x16x32_bf16 v[80:83], v[32:35], v[48:51], v[80:83]
  ds_read_b128 v[44:47], v6 offset:39936
  v_mfma_f32_16x16x32_bf16 v[84:87], v[32:35], v[52:55], v[84:87]
  s_waitcnt lgkmcnt(2)
  v_mfma_f32_16x16x32_bf16 v[88:91], v[36:39], v[48:51], v[88:91]
  s_mov_b64 exec, 0xffff
  buffer_load_dwordx4 v1, s[4:7], s48 offen offset:2048 sc1 lds
  s_mov_b64 exec, -1
  v_mfma_f32_16x16x32_bf16 v[92:95], v[36:39], v[52:55], v[92:95]
  s_waitcnt lgkmcnt(1)
  ds_read_b128 v[24:27], v6 offset:40960
  v_mfma_f32_16x16x32_bf16 v[96:99], v[40:43], v[48:51], v[96:99]
  ds_read_b128 v[28:31], v6 offset:41984
  v_mfma_f32_16x16x32_bf16 v[100:103], v[40:43], v[52:55], v[100:103]
  s_waitcnt lgkmcnt(2)
  s_add_u32 m0, s47, 52224
  s_add_u32 s49, s45, 2621440
  v_mfma_f32_16x16x32_bf16 v[104:107], v[44:47], v[48:51], v[104:107]
  buffer_load_dwordx4 v2, s[8:11], s49 offen lds
  v_mfma_f32_16x16x32_bf16 v[108:111], v[44:47], v[52:55], v[108:111]
  s_waitcnt lgkmcnt(1)
  ds_read_b128 v[32:35], v6 offset:43008
  v_mfma_f32_16x16x32_bf16 v[112:115], v[24:27], v[48:51], v[112:115]
  ds_read_b64_tr_b16 v[56:57], v4 offset:17408
  ds_read_b64_tr_b16 v[58:59], v4 offset:21504
  v_mfma_f32_16x16x32_bf16 v[116:119], v[24:27], v[52:55], v[116:119]
  s_waitcnt lgkmcnt(3)
  ds_read_b64_tr_b16 v[60:61], v5 offset:17408
  ds_read_b64_tr_b16 v[62:63], v5 offset:21504
  v_mfma_f32_16x16x32_bf16 v[120:123], v[28:31], v[48:51], v[120:123]
  ds_read_b128 v[36:39], v6 offset:52224
  ds_read_b128 v[40:43], v6 offset:53248
  v_mfma_f32_16x16x32_bf16 v[124:127], v[28:31], v[52:55], v[124:127]
  s_waitcnt lgkmcnt(6)
  buffer_load_dwordx4 v3, s[8:11], s49 offen offset:1024 lds
  v_mfma_f32_16x16x32_bf16 v[128:131], v[32:35], v[48:51], v[128:131]
  s_add_u32 m0, s46, 69632
  ds_read_b128 v[44:47], v6 offset:54272
  s_add_u32 s48, s44, 405504
  v_mfma_f32_16x16x32_bf16 v[132:135], v[32:35], v[52:55], v[132:135]
  s_waitcnt lgkmcnt(2)
  buffer_load_dwordx4 v1, s[4:7], s48 offen sc1 lds
  v_mfma_f32_16x16x32_bf16 v[64:67], v[36:39], v[56:59], v[64:67]
  ds_read_b128 v[24:27], v6 offset:55296
  v_mfma_f32_16x16x32_bf16 v[68:71], v[36:39], v[60:63], v[68:71]
  s_waitcnt lgkmcnt(2)
  buffer_load_dwordx4 v1, s[4:7], s48 offen offset:1024 sc1 lds
  v_mfma_f32_16x16x32_bf16 v[72:75], v[40:43], v[56:59], v[72:75]
  ds_read_b128 v[28:31], v6 offset:56320
  v_mfma_f32_16x16x32_bf16 v[76:79], v[40:43], v[60:63], v[76:79]
  s_waitcnt lgkmcnt(2)
  v_mfma_f32_16x16x32_bf16 v[80:83], v[44:47], v[56:59], v[80:83]
  ds_read_b128 v[32:35], v6 offset:57344
  v_mfma_f32_16x16x32_bf16 v[84:87], v[44:47], v[60:63], v[84:87]
  s_waitcnt lgkmcnt(2)
  s_mov_b64 exec, 0xffff
  buffer_load_dwordx4 v1, s[4:7], s48 offen offset:2048 sc1 lds
  s_mov_b64 exec, -1
  v_mfma_f32_16x16x32_bf16 v[88:91], v[24:27], v[56:59], v[88:91]
  ds_read_b128 v[36:39], v6 offset:58368
  v_mfma_f32_16x16x32_bf16 v[92:95], v[24:27], v[60:63], v[92:95]
  s_waitcnt lgkmcnt(2)
  v_mfma_f32_16x16x32_bf16 v[96:99], v[28:31], v[56:59], v[96:99]
  s_add_u32 m0, s47, 69632
  ds_read_b128 v[40:43], v6 offset:59392
  s_add_u32 s49, s45, 2883584
  v_mfma_f32_16x16x32_bf16 v[100:103], v[28:31], v[60:63], v[100:103]
  s_waitcnt lgkmcnt(2)
  buffer_load_dwordx4 v2, s[8:11], s49 offen lds
  v_mfma_f32_16x16x32_bf16 v[104:107], v[32:35], v[56:59], v[104:107]
  ds_read_b128 v[44:47], v6 offset:60416
  v_mfma_f32_16x16x32_bf16 v[108:111], v[32:35], v[60:63], v[108:111]
  s_waitcnt lgkmcnt(2)
  v_mfma_f32_16x16x32_bf16 v[112:115], v[36:39], v[56:59], v[112:115]
  s_barrier
  ds_read_b64_tr_b16 v[48:49], v4 offset:34816
  ds_read_b64_tr_b16 v[50:51], v4 offset:38912
  v_mfma_f32_16x16x32_bf16 v[116:119], v[36:39], v[60:63], v[116:119]
  s_waitcnt lgkmcnt(3)
  ds_read_b64_tr_b16 v[52:53], v5 offset:34816
  ds_read_b64_tr_b16 v[54:55], v5 offset:38912
  v_mfma_f32_16x16x32_bf16 v[120:123], v[40:43], v[56:59], v[120:123]
  v_add_u32 v6, 69632, v6
  ds_read_b128 v[24:27], v6 offset:0
  v_mfma_f32_16x16x32_bf16 v[124:127], v[40:43], v[60:63], v[124:127]
  s_waitcnt lgkmcnt(5)
  buffer_load_dwordx4 v3, s[8:11], s49 offen offset:1024 lds
  v_mfma_f32_16x16x32_bf16 v[128:131], v[44:47], v[56:59], v[128:131]
  s_mov_b32 s53, 33316872
  ds_read_b128 v[28:31], v6 offset:1024
  ds_read_b128 v[32:35], v6 offset:2048
  v_mfma_f32_16x16x32_bf16 v[132:135], v[44:47], v[60:63], v[132:135]
  s_waitcnt lgkmcnt(2)
  buffer_load_dword v244, v235, s[4:7], s53 offen sc1
  v_mfma_f32_16x16x32_bf16 v[64:67], v[24:27], v[48:51], v[64:67]
  s_add_u32 m0, s46, 87040
  ds_read_b128 v[36:39], v6 offset:3072
  s_add_u32 s48, s44, 1548288
  v_mfma_f32_16x16x32_bf16 v[68:71], v[24:27], v[52:55], v[68:71]
  s_waitcnt lgkmcnt(2)
  buffer_load_dwordx4 v1, s[4:7], s48 offen sc1 lds
  v_mfma_f32_16x16x32_bf16 v[72:75], v[28:31], v[48:51], v[72:75]
  buffer_load_dwordx4 v1, s[4:7], s48 offen offset:1024 sc1 lds
  v_mfma_f32_16x16x32_bf16 v[76:79], v[28:31], v[52:55], v[76:79]
  s_waitcnt lgkmcnt(1)
  ds_read_b128 v[40:43], v6 offset:4096
  v_mfma_f32_16x16x32_bf16 v[80:83], v[32:35], v[48:51], v[80:83]
  ds_read_b128 v[44:47], v6 offset:5120
  v_mfma_f32_16x16x32_bf16 v[84:87], v[32:35], v[52:55], v[84:87]
  s_waitcnt lgkmcnt(2)
  v_mfma_f32_16x16x32_bf16 v[88:91], v[36:39], v[48:51], v[88:91]
  s_mov_b64 exec, 0xffff
  buffer_load_dwordx4 v1, s[4:7], s48 offen offset:2048 sc1 lds
  s_mov_b64 exec, -1
  v_mfma_f32_16x16x32_bf16 v[92:95], v[36:39], v[52:55], v[92:95]
  s_waitcnt lgkmcnt(1)
  ds_read_b128 v[24:27], v6 offset:6144
  v_mfma_f32_16x16x32_bf16 v[96:99], v[40:43], v[48:51], v[96:99]
  ds_read_b128 v[28:31], v6 offset:7168
  v_mfma_f32_16x16x32_bf16 v[100:103], v[40:43], v[52:55], v[100:103]
  s_waitcnt lgkmcnt(2)
  s_add_u32 m0, s47, 87040
  s_add_u32 s49, s45, 2621440
  v_mfma_f32_16x16x32_bf16 v[104:107], v[44:47], v[48:51], v[104:107]
  buffer_load_dwordx4 v2, s[12:15], s49 offen lds
  v_mfma_f32_16x16x32_bf16 v[108:111], v[44:47], v[52:55], v[108:111]
  s_waitcnt lgkmcnt(1)
  ds_read_b128 v[32:35], v6 offset:8192
  v_mfma_f32_16x16x32_bf16 v[112:115], v[24:27], v[48:51], v[112:115]
  v_subrev_u32 v4, 104448, v4
  ds_read_b64_tr_b16 v[56:57], v4 offset:0
  v_mfma_f32_16x16x32_bf16 v[116:119], v[24:27], v[52:55], v[116:119]
  s_waitcnt lgkmcnt(2)
  ds_read_b64_tr_b16 v[58:59], v4 offset:4096
  v_subrev_u32 v5, 104448, v5
  v_mfma_f32_16x16x32_bf16 v[120:123], v[28:31], v[48:51], v[120:123]
  ds_read_b64_tr_b16 v[60:61], v5 offset:0
  ds_read_b64_tr_b16 v[62:63], v5 offset:4096
  v_mfma_f32_16x16x32_bf16 v[124:127], v[28:31], v[52:55], v[124:127]
  s_waitcnt lgkmcnt(4)
  v_subrev_u32 v6, 139264, v6
  ds_read_b128 v[36:39], v6 offset:0
  v_mfma_f32_16x16x32_bf16 v[128:131], v[32:35], v[48:51], v[128:131]
  ds_read_b128 v[40:43], v6 offset:1024
  ds_read_b128 v[44:47], v6 offset:2048
  v_mfma_f32_16x16x32_bf16 v[132:135], v[32:35], v[52:55], v[132:135]
  s_waitcnt lgkmcnt(2)
  buffer_load_dwordx4 v3, s[12:15], s49 offen offset:1024 lds
  v_mfma_f32_16x16x32_bf16 v[64:67], v[36:39], v[56:59], v[64:67]
  s_add_u32 m0, s46, 104448
  ds_read_b128 v[24:27], v6 offset:3072
  s_add_u32 s48, s44, 1585152
  v_mfma_f32_16x16x32_bf16 v[68:71], v[36:39], v[60:63], v[68:71]
  s_waitcnt lgkmcnt(2)
  buffer_load_dwordx4 v1, s[4:7], s48 offen sc1 lds
  v_mfma_f32_16x16x32_bf16 v[72:75], v[40:43], v[56:59], v[72:75]
  buffer_load_dwordx4 v1, s[4:7], s48 offen offset:1024 sc1 lds
  v_mfma_f32_16x16x32_bf16 v[76:79], v[40:43], v[60:63], v[76:79]
  s_waitcnt lgkmcnt(1)
  ds_read_b128 v[28:31], v6 offset:4096
  v_mfma_f32_16x16x32_bf16 v[80:83], v[44:47], v[56:59], v[80:83]
  ds_read_b128 v[32:35], v6 offset:5120
  v_mfma_f32_16x16x32_bf16 v[84:87], v[44:47], v[60:63], v[84:87]
  s_waitcnt lgkmcnt(2)
  s_mov_b64 exec, 0xffff
  buffer_load_dwordx4 v1, s[4:7], s48 offen offset:2048 sc1 lds
  s_mov_b64 exec, -1
  v_mfma_f32_16x16x32_bf16 v[88:91], v[24:27], v[56:59], v[88:91]
  ds_read_b128 v[36:39], v6 offset:6144
  v_mfma_f32_16x16x32_bf16 v[92:95], v[24:27], v[60:63], v[92:95]
  s_waitcnt lgkmcnt(2)
  v_mfma_f32_16x16x32_bf16 v[96:99], v[28:31], v[56:59], v[96:99]
  s_add_u32 m0, s47, 104448
  ds_read_b128 v[40:43], v6 offset:7168
  s_add_u32 s49, s45, 2883584
  v_mfma_f32_16x16x32_bf16 v[100:103], v[28:31], v[60:63], v[100:103]
  s_waitcnt lgkmcnt(2)
  buffer_load_dwordx4 v2, s[12:15], s49 offen lds
  v_mfma_f32_16x16x32_bf16 v[104:107], v[32:35], v[56:59], v[104:107]
  ds_read_b128 v[44:47], v6 offset:8192
  v_mfma_f32_16x16x32_bf16 v[108:111], v[32:35], v[60:63], v[108:111]
  s_waitcnt lgkmcnt(2)
  v_mfma_f32_16x16x32_bf16 v[112:115], v[36:39], v[56:59], v[112:115]
  s_waitcnt vmcnt(20)
  s_barrier
  ds_read_b64_tr_b16 v[48:49], v4 offset:17408
  v_mfma_f32_16x16x32_bf16 v[116:119], v[36:39], v[60:63], v[116:119]
  s_waitcnt lgkmcnt(2)
  ds_read_b64_tr_b16 v[50:51], v4 offset:21504
  ds_read_b64_tr_b16 v[52:53], v5 offset:17408
  v_mfma_f32_16x16x32_bf16 v[120:123], v[40:43], v[56:59], v[120:123]
  ds_read_b64_tr_b16 v[54:55], v5 offset:21504
  ds_read_b128 v[24:27], v6 offset:17408
  v_mfma_f32_16x16x32_bf16 v[124:127], v[40:43], v[60:63], v[124:127]
  s_waitcnt lgkmcnt(5)
  buffer_load_dwordx4 v3, s[12:15], s49 offen offset:1024 lds
  v_mfma_f32_16x16x32_bf16 v[128:131], v[44:47], v[56:59], v[128:131]
  ds_read_b128 v[28:31], v6 offset:18432
  ds_read_b128 v[32:35], v6 offset:19456
  v_mfma_f32_16x16x32_bf16 v[132:135], v[44:47], v[60:63], v[132:135]
  s_waitcnt lgkmcnt(2)
  s_waitcnt vmcnt(10)
  v_cmp_eq_u32 vcc, 1, v244
  s_nop 4
  s_cmp_eq_u64 vcc, -1
  s_cbranch_scc1 fnet_k2_kernel_dg4_go
  v_add_u32 v236, 16384, v235
  s_mov_b32 s54, 33300488
  s_mov_b32 s55, 0
fnet_k2_kernel_dg4_spin:
  buffer_load_dword v245, v236, s[4:7], s54 offen sc1
  s_waitcnt vmcnt(0)
  v_cmp_eq_u32 vcc, 1, v245
  s_add_u32 s55, s55, 1
  s_nop 3
  s_cmp_eq_u64 vcc, -1
  s_cbranch_scc1 fnet_k2_kernel_dg4_ok
  s_sleep 1
  s_cmp_lt_u32 s55, 262144
  s_cbranch_scc1 fnet_k2_kernel_dg4_spin
fnet_k2_kernel_dg4_ok:
fnet_k2_kernel_dg4_go:
  v_mfma_f32_16x16x32_bf16 v[64:67], v[24:27], v[48:51], v[64:67]
  s_add_u32 m0, s46, 121856
  ds_read_b128 v[36:39], v6 offset:20480
  s_add_u32 s48, s44, 147456
  v_mfma_f32_16x16x32_bf16 v[68:71], v[24:27], v[52:55], v[68:71]
  s_waitcnt lgkmcnt(2)
  buffer_load_dwordx4 v1, s[4:7], s48 offen sc1 lds
  v_mfma_f32_16x16x32_bf16 v[72:75], v[28:31], v[48:51], v[72:75]
  buffer_load_dwordx4 v1, s[4:7], s48 offen offset:1024 sc1 lds
  v_mfma_f32_16x16x32_bf16 v[76:79], v[28:31], v[52:55], v[76:79]
  s_waitcnt lgkmcnt(1)
  ds_read_b128 v[40:43], v6 offset:21504
  v_mfma_f32_16x16x32_bf16 v[80:83], v[32:35], v[48:51], v[80:83]
  ds_read_b128 v[44:47], v6 offset:22528
  v_mfma_f32_16x16x32_bf16 v[84:87], v[32:35], v[52:55], v[84:87]
  s_waitcnt lgkmcnt(2)
  v_mfma_f32_16x16x32_bf16 v[88:91], v[36:39], v[48:51], v[88:91]
  s_mov_b64 exec, 0xffff
  buffer_load_dwordx4 v1, s[4:7], s48 offen offset:2048 sc1 lds
  s_mov_b64 exec, -1
  v_mfma_f32_16x16x32_bf16 v[92:95], v[36:39], v[52:55], v[92:95]
  s_waitcnt lgkmcnt(1)
  ds_read_b128 v[24:27], v6 offset:23552
  v_mfma_f32_16x16x32_bf16 v[96:99], v[40:43], v[48:51], v[96:99]
  ds_read_b128 v[28:31], v6 offset:24576
  v_mfma_f32_16x16x32_bf16 v[100:103], v[40:43], v[52:55], v[100:103]
  s_waitcnt lgkmcnt(2)
  s_add_u32 m0, s47, 121856
  s_add_u32 s49, s45, 1048576
  v_mfma_f32_16x16x32_bf16 v[104:107], v[44:47], v[48:51], v[104:107]
  buffer_load_dwordx4 v2, s[8:11], s49 offen lds
  v_mfma_f32_16x16x32_bf16 v[108:111], v[44:47], v[52:55], v[108:111]
  s_waitcnt lgkmcnt(1)
  ds_read_b128 v[32:35], v6 offset:25600
  v_mfma_f32_16x16x32_bf16 v[112:115], v[24:27], v[48:51], v[112:115]
  ds_read_b64_tr_b16 v[56:57], v4 offset:34816
  ds_read_b64_tr_b16 v[58:59], v4 offset:38912
  v_mfma_f32_16x16x32_bf16 v[116:119], v[24:27], v[52:55], v[116:119]
  s_waitcnt lgkmcnt(3)
  ds_read_b64_tr_b16 v[60:61], v5 offset:34816
  ds_read_b64_tr_b16 v[62:63], v5 offset:38912
  v_mfma_f32_16x16x32_bf16 v[120:123], v[28:31], v[48:51], v[120:123]
  ds_read_b128 v[36:39], v6 offset:34816
  ds_read_b128 v[40:43], v6 offset:35840
  v_mfma_f32_16x16x32_bf16 v[124:127], v[28:31], v[52:55], v[124:127]
  s_waitcnt lgkmcnt(6)
  buffer_load_dwordx4 v3, s[8:11], s49 offen offset:1024 lds
  v_mfma_f32_16x16x32_bf16 v[128:131], v[32:35], v[48:51], v[128:131]
  s_add_u32 m0, s46, 139264
  ds_read_b128 v[44:47], v6 offset:36864
  s_add_u32 s48, s44, 184320
  v_mfma_f32_16x16x32_bf16 v[132:135], v[32:35], v[52:55], v[132:135]
  s_waitcnt lgkmcnt(2)
  buffer_load_dwordx4 v1, s[4:7], s48 offen sc1 lds
  v_mfma_f32_16x16x32_bf16 v[64:67], v[36:39], v[56:59], v[64:67]
  ds_read_b128 v[24:27], v6 offset:37888
  v_mfma_f32_16x16x32_bf16 v[68:71], v[36:39], v[60:63], v[68:71]
  s_waitcnt lgkmcnt(2)
  buffer_load_dwordx4 v1, s[4:7], s48 offen offset:1024 sc1 lds
  v_mfma_f32_16x16x32_bf16 v[72:75], v[40:43], v[56:59], v[72:75]
  ds_read_b128 v[28:31], v6 offset:38912
  v_mfma_f32_16x16x32_bf16 v[76:79], v[40:43], v[60:63], v[76:79]
  s_waitcnt lgkmcnt(2)
  v_mfma_f32_16x16x32_bf16 v[80:83], v[44:47], v[56:59], v[80:83]
  ds_read_b128 v[32:35], v6 offset:39936
  v_mfma_f32_16x16x32_bf16 v[84:87], v[44:47], v[60:63], v[84:87]
  s_waitcnt lgkmcnt(2)
  s_mov_b64 exec, 0xffff
  buffer_load_dwordx4 v1, s[4:7], s48 offen offset:2048 sc1 lds
  s_mov_b64 exec, -1
  v_mfma_f32_16x16x32_bf16 v[88:91], v[24:27], v[56:59], v[88:91]
  ds_read_b128 v[36:39], v6 offset:40960
  v_mfma_f32_16x16x32_bf16 v[92:95], v[24:27], v[60:63], v[92:95]
  s_waitcnt lgkmcnt(2)
  v_mfma_f32_16x16x32_bf16 v[96:99], v[28:31], v[56:59], v[96:99]
  s_add_u32 m0, s47, 139264
  ds_read_b128 v[40:43], v6 offset:41984
  s_add_u32 s49, s45, 1310720
  v_mfma_f32_16x16x32_bf16 v[100:103], v[28:31], v[60:63], v[100:103]
  s_waitcnt lgkmcnt(2)
  buffer_load_dwordx4 v2, s[8:11], s49 offen lds
  v_mfma_f32_16x16x32_bf16 v[104:107], v[32:35], v[56:59], v[104:107]
  ds_read_b128 v[44:47], v6 offset:43008
  v_mfma_f32_16x16x32_bf16 v[108:111], v[32:35], v[60:63], v[108:111]
  s_waitcnt lgkmcnt(2)
  v_mfma_f32_16x16x32_bf16 v[112:115], v[36:39], v[56:59], v[112:115]
  s_barrier
  v_add_u32 v4, 52224, v4
  ds_read_b64_tr_b16 v[48:49], v4 offset:0
  v_mfma_f32_16x16x32_bf16 v[116:119], v[36:39], v[60:63], v[116:119]
  s_waitcnt lgkmcnt(2)
  ds_read_b64_tr_b16 v[50:51], v4 offset:4096
  v_add_u32 v5, 52224, v5
  v_mfma_f32_16x16x32_bf16 v[120:123], v[40:43], v[56:59], v[120:123]
  ds_read_b64_tr_b16 v[52:53], v5 offset:0
  ds_read_b64_tr_b16 v[54:55], v5 offset:4096
  v_mfma_f32_16x16x32_bf16 v[124:127], v[40:43], v[60:63], v[124:127]
  s_waitcnt lgkmcnt(4)
  ds_read_b128 v[24:27], v6 offset:52224
  ds_read_b128 v[28:31], v6 offset:53248
  v_mfma_f32_16x16x32_bf16 v[128:131], v[44:47], v[56:59], v[128:131]
  buffer_load_dwordx4 v3, s[8:11], s49 offen offset:1024 lds
  v_mfma_f32_16x16x32_bf16 v[132:135], v[44:47], v[60:63], v[132:135]
  s_waitcnt lgkmcnt(1)
  ds_read_b128 v[32:35], v6 offset:54272
  s_mov_b32 s53, 33317000
  v_mfma_f32_16x16x32_bf16 v[64:67], v[24:27], v[48:51], v[64:67]
  buffer_load_dword v244, v235, s[4:7], s53 offen sc1
  v_mfma_f32_16x16x32_bf16 v[68:71], v[24:27], v[52:55], v[68:71]
  s_waitcnt lgkmcnt(1)
  ds_read_b128 v[36:39], v6 offset:55296
  s_add_u32 m0, s46, 0
  v_mfma_f32_16x16x32_bf16 v[72:75], v[28:31], v[48:51], v[72:75]
  s_add_u32 s48, s44, 1327104
  buffer_load_dwordx4 v1, s[4:7], s48 offen sc1 lds
  v_mfma_f32_16x16x32_bf16 v[76:79], v[28:31], v[52:55], v[76:79]
  s_waitcnt lgkmcnt(1)
  buffer_load_dwordx4 v1, s[4:7], s48 offen offset:1024 sc1 lds
  v_mfma_f32_16x16x32_bf16 v[80:83], v[32:35], v[48:51], v[80:83]
  ds_read_b128 v[40:43], v6 offset:56320
  ds_read_b128 v[44:47], v6 offset:57344
  v_mfma_f32_16x16x32_bf16 v[84:87], v[32:35], v[52:55], v[84:87]
  s_waitcnt lgkmcnt(2)
  v_mfma_f32_16x16x32_bf16 v[88:91], v[36:39], v[48:51], v[88:91]
  s_mov_b64 exec, 0xffff
  buffer_load_dwordx4 v1, s[4:7], s48 offen offset:2048 sc1 lds
  s_mov_b64 exec, -1
  v_mfma_f32_16x16x32_bf16 v[92:95], v[36:39], v[52:55], v[92:95]
  s_waitcnt lgkmcnt(1)
  ds_read_b128 v[24:27], v6 offset:58368
  v_mfma_f32_16x16x32_bf16 v[96:99], v[40:43], v[48:51], v[96:99]
  ds_read_b128 v[28:31], v6 offset:59392
  v_mfma_f32_16x16x32_bf16 v[100:103], v[40:43], v[52:55], v[100:103]
  s_waitcnt lgkmcnt(2)
  s_add_u32 m0, s47, 0
  s_add_u32 s49, s45, 1048576
  v_mfma_f32_16x16x32_bf16 v[104:107], v[44:47], v[48:51], v[104:107]
  buffer_load_dwordx4 v2, s[12:15], s49 offen lds
  v_mfma_f32_16x16x32_bf16 v[108:111], v[44:47], v[52:55], v[108:111]
  s_waitcnt lgkmcnt(1)
  ds_read_b128 v[32:35], v6 offset:60416
  v_mfma_f32_16x16x32_bf16 v[112:115], v[24:27], v[48:51], v[112:115]
  ds_read_b64_tr_b16 v[56:57], v4 offset:17408
  ds_read_b64_tr_b16 v[58:59], v4 offset:21504
  v_mfma_f32_16x16x32_bf16 v[116:119], v[24:27], v[52:55], v[116:119]
  s_waitcnt lgkmcnt(3)
  ds_read_b64_tr_b16 v[60:61], v5 offset:17408
  ds_read_b64_tr_b16 v[62:63], v5 offset:21504
  v_mfma_f32_16x16x32_bf16 v[120:123], v[28:31], v[48:51], v[120:123]
  v_add_u32 v6, 69632, v6
  ds_read_b128 v[36:39], v6 offset:0
  v_mfma_f32_16x16x32_bf16 v[124:127], v[28:31], v[52:55], v[124:127]
  s_waitcnt lgkmcnt(5)
  buffer_load_dwordx4 v3, s[12:15], s49 offen offset:1024 lds
  v_mfma_f32_16x16x32_bf16 v[128:131], v[32:35], v[48:51], v[128:131]
  s_add_u32 m0, s46, 17408
  ds_read_b128 v[40:43], v6 offset:1024
  s_add_u32 s48, s44, 1363968
  v_mfma_f32_16x16x32_bf16 v[132:135], v[32:35], v[52:55], v[132:135]
  s_waitcnt lgkmcnt(1)
  buffer_load_dwordx4 v1, s[4:7], s48 offen sc1 lds
  v_mfma_f32_16x16x32_bf16 v[64:67], v[36:39], v[56:59], v[64:67]
  ds_read_b128 v[44:47], v6 offset:2048
  ds_read_b128 v[24:27], v6 offset:3072
  v_mfma_f32_16x16x32_bf16 v[68:71], v[36:39], v[60:63], v[68:71]
  s_waitcnt lgkmcnt(2)
  buffer_load_dwordx4 v1, s[4:7], s48 offen offset:1024 sc1 lds
  v_mfma_f32_16x16x32_bf16 v[72:75], v[40:43], v[56:59], v[72:75]
  ds_read_b128 v[28:31], v6 offset:4096
  v_mfma_f32_16x16x32_bf16 v[76:79], v[40:43], v[60:63], v[76:79]
  s_waitcnt lgkmcnt(2)
  v_mfma_f32_16x16x32_bf16 v[80:83], v[44:47], v[56:59], v[80:83]
  ds_read_b128 v[32:35], v6 offset:5120
  v_mfma_f32_16x16x32_bf16 v[84:87], v[44:47], v[60:63], v[84:87]
  s_waitcnt lgkmcnt(2)
  s_mov_b64 exec, 0xffff
  buffer_load_dwordx4 v1, s[4:7], s48 offen offset:2048 sc1 lds
  s_mov_b64 exec, -1
  v_mfma_f32_16x16x32_bf16 v[88:91], v[24:27], v[56:59], v[88:91]
  ds_read_b128 v[36:39], v6 offset:6144
  v_mfma_f32_16x16x32_bf16 v[92:95], v[24:27], v[60:63], v[92:95]
  s_waitcnt lgkmcnt(2)
  v_mfma_f32_16x16x32_bf16 v[96:99], v[28:31], v[56:59], v[96:99]
  s_add_u32 m0, s47, 17408
  ds_read_b128 v[40:43], v6 offset:7168
  s_add_u32 s49, s45, 1310720
  v_mfma_f32_16x16x32_bf16 v[100:103], v[28:31], v[60:63], v[100:103]
  s_waitcnt lgkmcnt(2)
  buffer_load_dwordx4 v2, s[12:15], s49 offen lds
  v_mfma_f32_16x16x32_bf16 v[104:107], v[32:35], v[56:59], v[104:107]
  ds_read_b128 v[44:47], v6 offset:8192
  v_mfma_f32_16x16x32_bf16 v[108:111], v[32:35], v[60:63], v[108:111]
  s_waitcnt lgkmcnt(2)
  v_mfma_f32_16x16x32_bf16 v[112:115], v[36:39], v[56:59], v[112:115]
  s_waitcnt vmcnt(20)
  s_barrier
  ds_read_b64_tr_b16 v[48:49], v4 offset:34816
  v_mfma_f32_16x16x32_bf16 v[116:119], v[36:39], v[60:63], v[116:119]
  s_waitcnt lgkmcnt(2)
  ds_read_b64_tr_b16 v[50:51], v4 offset:38912
  ds_read_b64_tr_b16 v[52:53], v5 offset:34816
  v_mfma_f32_16x16x32_bf16 v[120:123], v[40:43], v[56:59], v[120:123]
  ds_read_b64_tr_b16 v[54:55], v5 offset:38912
  ds_read_b128 v[24:27], v6 offset:17408
  v_mfma_f32_16x16x32_bf16 v[124:127], v[40:43], v[60:63], v[124:127]
  s_waitcnt lgkmcnt(5)
  buffer_load_dwordx4 v3, s[12:15], s49 offen offset:1024 lds
  v_mfma_f32_16x16x32_bf16 v[128:131], v[44:47], v[56:59], v[128:131]
  ds_read_b128 v[28:31], v6 offset:18432
  ds_read_b128 v[32:35], v6 offset:19456
  v_mfma_f32_16x16x32_bf16 v[132:135], v[44:47], v[60:63], v[132:135]
  s_waitcnt lgkmcnt(2)
  s_waitcnt vmcnt(10)
  v_cmp_eq_u32 vcc, 1, v244
  s_nop 4
  s_cmp_eq_u64 vcc, -1
  s_cbranch_scc1 fnet_k2_kernel_dg5_go
  v_add_u32 v236, 16512, v235
  s_mov_b32 s54, 33300488
  s_mov_b32 s55, 0
fnet_k2_kernel_dg5_spin:
  buffer_load_dword v245, v236, s[4:7], s54 offen sc1
  s_waitcnt vmcnt(0)
  v_cmp_eq_u32 vcc, 1, v245
  s_add_u32 s55, s55, 1
  s_nop 3
  s_cmp_eq_u64 vcc, -1
  s_cbranch_scc1 fnet_k2_kernel_dg5_ok
  s_sleep 1
  s_cmp_lt_u32 s55, 262144
  s_cbranch_scc1 fnet_k2_kernel_dg5_spin
fnet_k2_kernel_dg5_ok:
fnet_k2_kernel_dg5_go:
  v_mfma_f32_16x16x32_bf16 v[64:67], v[24:27], v[48:51], v[64:67]
  s_add_u32 m0, s46, 34816
  ds_read_b128 v[36:39], v6 offset:20480
  s_add_u32 s48, s44, 442368
  v_mfma_f32_16x16x32_bf16 v[68:71], v[24:27], v[52:55], v[68:71]
  s_waitcnt lgkmcnt(2)
  buffer_load_dwordx4 v1, s[4:7], s48 offen sc1 lds
  v_mfma_f32_16x16x32_bf16 v[72:75], v[28:31], v[48:51], v[72:75]
  buffer_load_dwordx4 v1, s[4:7], s48 offen offset:1024 sc1 lds
  v_mfma_f32_16x16x32_bf16 v[76:79], v[28:31], v[52:55], v[76:79]
  s_waitcnt lgkmcnt(1)
  ds_read_b128 v[40:43], v6 offset:21504
  v_mfma_f32_16x16x32_bf16 v[80:83], v[32:35], v[48:51], v[80:83]
  ds_read_b128 v[44:47], v6 offset:22528
  v_mfma_f32_16x16x32_bf16 v[84:87], v[32:35], v[52:55], v[84:87]
  s_waitcnt lgkmcnt(2)
  v_mfma_f32_16x16x32_bf16 v[88:91], v[36:39], v[48:51], v[88:91]
  s_mov_b64 exec, 0xffff
  buffer_load_dwordx4 v1, s[4:7], s48 offen offset:2048 sc1 lds
  s_mov_b64 exec, -1
  v_mfma_f32_16x16x32_bf16 v[92:95], v[36:39], v[52:55], v[92:95]
  s_waitcnt lgkmcnt(1)
  ds_read_b128 v[24:27], v6 offset:23552
  v_mfma_f32_16x16x32_bf16 v[96:99], v[40:43], v[48:51], v[96:99]
  ds_read_b128 v[28:31], v6 offset:24576
  v_mfma_f32_16x16x32_bf16 v[100:103], v[40:43], v[52:55], v[100:103]
  s_waitcnt lgkmcnt(2)
  s_add_u32 m0, s47, 34816
  s_add_u32 s49, s45, 3145728
  v_mfma_f32_16x16x32_bf16 v[104:107], v[44:47], v[48:51], v[104:107]
  buffer_load_dwordx4 v2, s[8:11], s49 offen lds
  v_mfma_f32_16x16x32_bf16 v[108:111], v[44:47], v[52:55], v[108:111]
  s_waitcnt lgkmcnt(1)
  ds_read_b128 v[32:35], v6 offset:25600
  v_mfma_f32_16x16x32_bf16 v[112:115], v[24:27], v[48:51], v[112:115]
  v_add_u32 v4, 52224, v4
  ds_read_b64_tr_b16 v[56:57], v4 offset:0
  v_mfma_f32_16x16x32_bf16 v[116:119], v[24:27], v[52:55], v[116:119]
  s_waitcnt lgkmcnt(2)
  ds_read_b64_tr_b16 v[58:59], v4 offset:4096
  v_add_u32 v5, 52224, v5
  v_mfma_f32_16x16x32_bf16 v[120:123], v[28:31], v[48:51], v[120:123]
  ds_read_b64_tr_b16 v[60:61], v5 offset:0
  ds_read_b64_tr_b16 v[62:63], v5 offset:4096
  v_mfma_f32_16x16x32_bf16 v[124:127], v[28:31], v[52:55], v[124:127]
  s_waitcnt lgkmcnt(4)
  ds_read_b128 v[36:39], v6 offset:34816
  ds_read_b128 v[40:43], v6 offset:35840
  v_mfma_f32_16x16x32_bf16 v[128:131], v[32:35], v[48:51], v[128:131]
  buffer_load_dwordx4 v3, s[8:11], s49 offen offset:1024 lds
  v_mfma_f32_16x16x32_bf16 v[132:135], v[32:35], v[52:55], v[132:135]
  s_waitcnt lgkmcnt(1)
  ds_read_b128 v[44:47], v6 offset:36864
  s_add_u32 m0, s46, 52224
  v_mfma_f32_16x16x32_bf16 v[64:67], v[36:39], v[56:59], v[64:67]
  s_add_u32 s48, s44, 479232
  buffer_load_dwordx4 v1, s[4:7], s48 offen sc1 lds
  v_mfma_f32_16x16x32_bf16 v[68:71], v[36:39], v[60:63], v[68:71]
  s_waitcnt lgkmcnt(1)
  buffer_load_dwordx4 v1, s[4:7], s48 offen offset:1024 sc1 lds
  v_mfma_f32_16x16x32_bf16 v[72:75], v[40:43], v[56:59], v[72:75]
  ds_read_b128 v[24:27], v6 offset:37888
  ds_read_b128 v[28:31], v6 offset:38912
  v_mfma_f32_16x16x32_bf16 v[76:79], v[40:43], v[60:63], v[76:79]
  s_waitcnt lgkmcnt(2)
  v_mfma_f32_16x16x32_bf16 v[80:83], v[44:47], v[56:59], v[80:83]
  ds_read_b128 v[32:35], v6 offset:39936
  v_mfma_f32_16x16x32_bf16 v[84:87], v[44:47], v[60:63], v[84:87]
  s_waitcnt lgkmcnt(2)
  s_mov_b64 exec, 0xffff
  buffer_load_dwordx4 v1, s[4:7], s48 offen offset:2048 sc1 lds
  s_mov_b64 exec, -1
  v_mfma_f32_16x16x32_bf16 v[88:91], v[24:27], v[56:59], v[88:91]
  ds_read_b128 v[36:39], v6 offset:40960
  v_mfma_f32_16x16x32_bf16 v[92:95], v[24:27], v[60:63], v[92:95]
  s_waitcnt lgkmcnt(2)
  v_mfma_f32_16x16x32_bf16 v[96:99], v[28:31], v[56:59], v[96:99]
  s_add_u32 m0, s47, 52224
  ds_read_b128 v[40:43], v6 offset:41984
  s_add_u32 s49, s45, 3407872
  v_mfma_f32_16x16x32_bf16 v[100:103], v[28:31], v[60:63], v[100:103]
  s_waitcnt lgkmcnt(2)
  buffer_load_dwordx4 v2, s[8:11], s49 offen lds
  v_mfma_f32_16x16x32_bf16 v[104:107], v[32:35], v[56:59], v[104:107]
  ds_read_b128 v[44:47], v6 offset:43008
  v_mfma_f32_16x16x32_bf16 v[108:111], v[32:35], v[60:63], v[108:111]
  s_waitcnt lgkmcnt(2)
  v_mfma_f32_16x16x32_bf16 v[112:115], v[36:39], v[56:59], v[112:115]
  s_barrier
  ds_read_b64_tr_b16 v[48:49], v4 offset:17408
  ds_read_b64_tr_b16 v[50:51], v4 offset:21504
  v_mfma_f32_16x16x32_bf16 v[116:119], v[36:39], v[60:63], v[116:119]
  s_waitcnt lgkmcnt(3)
  ds_read_b64_tr_b16 v[52:53], v5 offset:17408
  ds_read_b64_tr_b16 v[54:55], v5 offset:21504
  v_mfma_f32_16x16x32_bf16 v[120:123], v[40:43], v[56:59], v[120:123]
  ds_read_b128 v[24:27], v6 offset:52224
  ds_read_b128 v[28:31], v6 offset:53248
  v_mfma_f32_16x16x32_bf16 v[124:127], v[40:43], v[60:63], v[124:127]
  s_waitcnt lgkmcnt(6)
  buffer_load_dwordx4 v3, s[8:11], s49 offen offset:1024 lds
  v_mfma_f32_16x16x32_bf16 v[128:131], v[44:47], v[56:59], v[128:131]
  s_mov_b32 s53, 33325064
  buffer_load_dword v244, v235, s[4:7], s53 offen sc1
  v_mfma_f32_16x16x32_bf16 v[132:135], v[44:47], v[60:63], v[132:135]
  s_waitcnt lgkmcnt(1)
  ds_read_b128 v[32:35], v6 offset:54272
  s_add_u32 m0, s46, 69632
  v_mfma_f32_16x16x32_bf16 v[64:67], v[24:27], v[48:51], v[64:67]
  s_add_u32 s48, s44, 1622016
  buffer_load_dwordx4 v1, s[4:7], s48 offen sc1 lds
  v_mfma_f32_16x16x32_bf16 v[68:71], v[24:27], v[52:55], v[68:71]
  s_waitcnt lgkmcnt(1)
  ds_read_b128 v[36:39], v6 offset:55296
  v_mfma_f32_16x16x32_bf16 v[72:75], v[28:31], v[48:51], v[72:75]
  buffer_load_dwordx4 v1, s[4:7], s48 offen offset:1024 sc1 lds
  v_mfma_f32_16x16x32_bf16 v[76:79], v[28:31], v[52:55], v[76:79]
  s_waitcnt lgkmcnt(1)
  ds_read_b128 v[40:43], v6 offset:56320
  v_mfma_f32_16x16x32_bf16 v[80:83], v[32:35], v[48:51], v[80:83]
  ds_read_b128 v[44:47], v6 offset:57344
  v_mfma_f32_16x16x32_bf16 v[84:87], v[32:35], v[52:55], v[84:87]
  s_waitcnt lgkmcnt(2)
  v_mfma_f32_16x16x32_bf16 v[88:91], v[36:39], v[48:51], v[88:91]
  s_mov_b64 exec, 0xffff
  buffer_load_dwordx4 v1, s[4:7], s48 offen offset:2048 sc1 lds
  s_mov_b64 exec, -1
  v_mfma_f32_16x16x32_bf16 v[92:95], v[36:39], v[52:55], v[92:95]
  s_waitcnt lgkmcnt(1)
  ds_read_b128 v[24:27], v6 offset:58368
  v_mfma_f32_16x16x32_bf16 v[96:99], v[40:43], v[48:51], v[96:99]
  ds_read_b128 v[28:31], v6 offset:59392
  v_mfma_f32_16x16x32_bf16 v[100:103], v[40:43], v[52:55], v[100:103]
  s_waitcnt lgkmcnt(2)
  s_add_u32 m0, s47, 69632
  s_add_u32 s49, s45, 3145728
  v_mfma_f32_16x16x32_bf16 v[104:107], v[44:47], v[48:51], v[104:107]
  buffer_load_dwordx4 v2, s[12:15], s49 offen lds
  v_mfma_f32_16x16x32_bf16 v[108:111], v[44:47], v[52:55], v[108:111]
  s_waitcnt lgkmcnt(1)
  ds_read_b128 v[32:35], v6 offset:60416
  v_mfma_f32_16x16x32_bf16 v[112:115], v[24:27], v[48:51], v[112:115]
  ds_read_b64_tr_b16 v[56:57], v4 offset:34816
  ds_read_b64_tr_b16 v[58:59], v4 offset:38912
  v_mfma_f32_16x16x32_bf16 v[116:119], v[24:27], v[52:55], v[116:119]
  s_waitcnt lgkmcnt(3)
  ds_read_b64_tr_b16 v[60:61], v5 offset:34816
  ds_read_b64_tr_b16 v[62:63], v5 offset:38912
  v_mfma_f32_16x16x32_bf16 v[120:123], v[28:31], v[48:51], v[120:123]
  v_add_u32 v6, 69632, v6
  ds_read_b128 v[36:39], v6 offset:0
  v_mfma_f32_16x16x32_bf16 v[124:127], v[28:31], v[52:55], v[124:127]
  s_waitcnt lgkmcnt(5)
  buffer_load_dwordx4 v3, s[12:15], s49 offen offset:1024 lds
  v_mfma_f32_16x16x32_bf16 v[128:131], v[32:35], v[48:51], v[128:131]
  s_add_u32 m0, s46, 87040
  ds_read_b128 v[40:43], v6 offset:1024
  s_add_u32 s48, s44, 1658880
  v_mfma_f32_16x16x32_bf16 v[132:135], v[32:35], v[52:55], v[132:135]
  s_waitcnt lgkmcnt(1)
  buffer_load_dwordx4 v1, s[4:7], s48 offen sc1 lds
  v_mfma_f32_16x16x32_bf16 v[64:67], v[36:39], v[56:59], v[64:67]
  ds_read_b128 v[44:47], v6 offset:2048
  ds_read_b128 v[24:27], v6 offset:3072
  v_mfma_f32_16x16x32_bf16 v[68:71], v[36:39], v[60:63], v[68:71]
  s_waitcnt lgkmcnt(2)
  buffer_load_dwordx4 v1, s[4:7], s48 offen offset:1024 sc1 lds
  v_mfma_f32_16x16x32_bf16 v[72:75], v[40:43], v[56:59], v[72:75]
  ds_read_b128 v[28:31], v6 offset:4096
  v_mfma_f32_16x16x32_bf16 v[76:79], v[40:43], v[60:63], v[76:79]
  s_waitcnt lgkmcnt(2)
  v_mfma_f32_16x16x32_bf16 v[80:83], v[44:47], v[56:59], v[80:83]
  ds_read_b128 v[32:35], v6 offset:5120
  v_mfma_f32_16x16x32_bf16 v[84:87], v[44:47], v[60:63], v[84:87]
  s_waitcnt lgkmcnt(2)
  s_mov_b64 exec, 0xffff
  buffer_load_dwordx4 v1, s[4:7], s48 offen offset:2048 sc1 lds
  s_mov_b64 exec, -1
  v_mfma_f32_16x16x32_bf16 v[88:91], v[24:27], v[56:59], v[88:91]
  ds_read_b128 v[36:39], v6 offset:6144
  v_mfma_f32_16x16x32_bf16 v[92:95], v[24:27], v[60:63], v[92:95]
  s_waitcnt lgkmcnt(2)
  v_mfma_f32_16x16x32_bf16 v[96:99], v[28:31], v[56:59], v[96:99]
  s_add_u32 m0, s47, 87040
  ds_read_b128 v[40:43], v6 offset:7168
  s_add_u32 s49, s45, 3407872
  v_mfma_f32_16x16x32_bf16 v[100:103], v[28:31], v[60:63], v[100:103]
  s_waitcnt lgkmcnt(2)
  buffer_load_dwordx4 v2, s[12:15], s49 offen lds
  v_mfma_f32_16x16x32_bf16 v[104:107], v[32:35], v[56:59], v[104:107]
  ds_read_b128 v[44:47], v6 offset:8192
  v_mfma_f32_16x16x32_bf16 v[108:111], v[32:35], v[60:63], v[108:111]
  s_waitcnt lgkmcnt(2)
  v_mfma_f32_16x16x32_bf16 v[112:115], v[36:39], v[56:59], v[112:115]
  s_waitcnt vmcnt(20)
  s_barrier
  v_subrev_u32 v4, 104448, v4
  v_mfma_f32_16x16x32_bf16 v[116:119], v[36:39], v[60:63], v[116:119]
  s_waitcnt lgkmcnt(1)
  ds_read_b64_tr_b16 v[48:49], v4 offset:0
  ds_read_b64_tr_b16 v[50:51], v4 offset:4096
  v_mfma_f32_16x16x32_bf16 v[120:123], v[40:43], v[56:59], v[120:123]
  v_subrev_u32 v5, 104448, v5
  ds_read_b64_tr_b16 v[52:53], v5 offset:0
  v_mfma_f32_16x16x32_bf16 v[124:127], v[40:43], v[60:63], v[124:127]
  s_waitcnt lgkmcnt(3)
  ds_read_b64_tr_b16 v[54:55], v5 offset:4096
  v_subrev_u32 v6, 139264, v6
  v_mfma_f32_16x16x32_bf16 v[128:131], v[44:47], v[56:59], v[128:131]
  ds_read_b128 v[24:27], v6 offset:0
  buffer_load_dwordx4 v3, s[12:15], s49 offen offset:1024 lds
  v_mfma_f32_16x16x32_bf16 v[132:135], v[44:47], v[60:63], v[132:135]
  s_waitcnt lgkmcnt(0)
  ds_read_b128 v[28:31], v6 offset:1024
  ds_read_b128 v[32:35], v6 offset:2048
  v_mfma_f32_16x16x32_bf16 v[64:67], v[24:27], v[48:51], v[64:67]
  s_waitcnt vmcnt(10)
  v_cmp_eq_u32 vcc, 1, v244
  s_nop 4
  s_cmp_eq_u64 vcc, -1
  s_cbranch_scc1 fnet_k2_kernel_dg6_go
  v_add_u32 v236, 24576, v235
  s_mov_b32 s54, 33300488
  s_mov_b32 s55, 0
fnet_k2_kernel_dg6_spin:
  buffer_load_dword v245, v236, s[4:7], s54 offen sc1
  s_waitcnt vmcnt(0)
  v_cmp_eq_u32 vcc, 1, v245
  s_add_u32 s55, s55, 1
  s_nop 3
  s_cmp_eq_u64 vcc, -1
  s_cbranch_scc1 fnet_k2_kernel_dg6_ok
  s_sleep 1
  s_cmp_lt_u32 s55, 262144
  s_cbranch_scc1 fnet_k2_kernel_dg6_spin
fnet_k2_kernel_dg6_ok:
fnet_k2_kernel_dg6_go:
  v_mfma_f32_16x16x32_bf16 v[68:71], v[24:27], v[52:55], v[68:71]
  s_waitcnt lgkmcnt(1)
  ds_read_b128 v[36:39], v6 offset:3072
  s_add_u32 m0, s46, 104448
  v_mfma_f32_16x16x32_bf16 v[72:75], v[28:31], v[48:51], v[72:75]
  s_add_u32 s48, s44, 221184
  buffer_load_dwordx4 v1, s[4:7], s48 offen sc1 lds
  v_mfma_f32_16x16x32_bf16 v[76:79], v[28:31], v[52:55], v[76:79]
  s_waitcnt lgkmcnt(1)
  buffer_load_dwordx4 v1, s[4:7], s48 offen offset:1024 sc1 lds
  v_mfma_f32_16x16x32_bf16 v[80:83], v[32:35], v[48:51], v[80:83]
  ds_read_b128 v[40:43], v6 offset:4096
  ds_read_b128 v[44:47], v6 offset:5120
  v_mfma_f32_16x16x32_bf16 v[84:87], v[32:35], v[52:55], v[84:87]
  s_waitcnt lgkmcnt(2)
  v_mfma_f32_16x16x32_bf16 v[88:91], v[36:39], v[48:51], v[88:91]
  s_mov_b64 exec, 0xffff
  buffer_load_dwordx4 v1, s[4:7], s48 offen offset:2048 sc1 lds
  s_mov_b64 exec, -1
  v_mfma_f32_16x16x32_bf16 v[92:95], v[36:39], v[52:55], v[92:95]
  s_waitcnt lgkmcnt(1)
  ds_read_b128 v[24:27], v6 offset:6144
  v_mfma_f32_16x16x32_bf16 v[96:99], v[40:43], v[48:51], v[96:99]
  ds_read_b128 v[28:31], v6 offset:7168
  v_mfma_f32_16x16x32_bf16 v[100:103], v[40:43], v[52:55], v[100:103]
  s_waitcnt lgkmcnt(2)
  s_add_u32 m0, s47, 104448
  s_add_u32 s49, s45, 1572864
  v_mfma_f32_16x16x32_bf16 v[104:107], v[44:47], v[48:51], v[104:107]
  buffer_load_dwordx4 v2, s[8:11], s49 offen lds
  v_mfma_f32_16x16x32_bf16 v[108:111], v[44:47], v[52:55], v[108:111]
  s_waitcnt lgkmcnt(1)
  ds_read_b128 v[32:35], v6 offset:8192
  v_mfma_f32_16x16x32_bf16 v[112:115], v[24:27], v[48:51], v[112:115]
  ds_read_b64_tr_b16 v[56:57], v4 offset:17408
  ds_read_b64_tr_b16 v[58:59], v4 offset:21504
  v_mfma_f32_16x16x32_bf16 v[116:119], v[24:27], v[52:55], v[116:119]
  s_waitcnt lgkmcnt(3)
  ds_read_b64_tr_b16 v[60:61], v5 offset:17408
  ds_read_b64_tr_b16 v[62:63], v5 offset:21504
  v_mfma_f32_16x16x32_bf16 v[120:123], v[28:31], v[48:51], v[120:123]
  ds_read_b128 v[36:39], v6 offset:17408
  ds_read_b128 v[40:43], v6 offset:18432
  v_mfma_f32_16x16x32_bf16 v[124:127], v[28:31], v[52:55], v[124:127]
  s_waitcnt lgkmcnt(6)
  buffer_load_dwordx4 v3, s[8:11], s49 offen offset:1024 lds
  v_mfma_f32_16x16x32_bf16 v[128:131], v[32:35], v[48:51], v[128:131]
  s_add_u32 m0, s46, 121856
  ds_read_b128 v[44:47], v6 offset:19456
  s_add_u32 s48, s44, 258048
  v_mfma_f32_16x16x32_bf16 v[132:135], v[32:35], v[52:55], v[132:135]
  s_waitcnt lgkmcnt(2)
  buffer_load_dwordx4 v1, s[4:7], s48 offen sc1 lds
  v_mfma_f32_16x16x32_bf16 v[64:67], v[36:39], v[56:59], v[64:67]
  ds_read_b128 v[24:27], v6 offset:20480
  v_mfma_f32_16x16x32_bf16 v[68:71], v[36:39], v[60:63], v[68:71]
  s_waitcnt lgkmcnt(2)
  buffer_load_dwordx4 v1, s[4:7], s48 offen offset:1024 sc1 lds
  v_mfma_f32_16x16x32_bf16 v[72:75], v[40:43], v[56:59], v[72:75]
  ds_read_b128 v[28:31], v6 offset:21504
  v_mfma_f32_16x16x32_bf16 v[76:79], v[40:43], v[60:63], v[76:79]
  s_waitcnt lgkmcnt(2)
  v_mfma_f32_16x16x32_bf16 v[80:83], v[44:47], v[56:59], v[80:83]
  ds_read_b128 v[32:35], v6 offset:22528
  v_mfma_f32_16x16x32_bf16 v[84:87], v[44:47], v[60:63], v[84:87]
  s_waitcnt lgkmcnt(2)
  s_mov_b64 exec, 0xffff
  buffer_load_dwordx4 v1, s[4:7], s48 offen offset:2048 sc1 lds
  s_mov_b64 exec, -1
  v_mfma_f32_16x16x32_bf16 v[88:91], v[24:27], v[56:59], v[88:91]
  ds_read_b128 v[36:39], v6 offset:23552
  v_mfma_f32_16x16x32_bf16 v[92:95], v[24:27], v[60:63], v[92:95]
  s_waitcnt lgkmcnt(2)
  v_mfma_f32_16x16x32_bf16 v[96:99], v[28:31], v[56:59], v[96:99]
  s_add_u32 m0, s47, 121856
  ds_read_b128 v[40:43], v6 offset:24576
  s_add_u32 s49, s45, 1835008
  v_mfma_f32_16x16x32_bf16 v[100:103], v[28:31], v[60:63], v[100:103]
  s_waitcnt lgkmcnt(2)
  buffer_load_dwordx4 v2, s[8:11], s49 offen lds
  v_mfma_f32_16x16x32_bf16 v[104:107], v[32:35], v[56:59], v[104:107]
  ds_read_b128 v[44:47], v6 offset:25600
  v_mfma_f32_16x16x32_bf16 v[108:111], v[32:35], v[60:63], v[108:111]
  s_waitcnt lgkmcnt(2)
  v_mfma_f32_16x16x32_bf16 v[112:115], v[36:39], v[56:59], v[112:115]
  s_barrier
  ds_read_b64_tr_b16 v[48:49], v4 offset:34816
  ds_read_b64_tr_b16 v[50:51], v4 offset:38912
  v_mfma_f32_16x16x32_bf16 v[116:119], v[36:39], v[60:63], v[116:119]
  s_waitcnt lgkmcnt(3)
  ds_read_b64_tr_b16 v[52:53], v5 offset:34816
  ds_read_b64_tr_b16 v[54:55], v5 offset:38912
  v_mfma_f32_16x16x32_bf16 v[120:123], v[40:43], v[56:59], v[120:123]
  ds_read_b128 v[24:27], v6 offset:34816
  ds_read_b128 v[28:31], v6 offset:35840
  v_mfma_f32_16x16x32_bf16 v[124:127], v[40:43], v[60:63], v[124:127]
  s_waitcnt lgkmcnt(6)
  buffer_load_dwordx4 v3, s[8:11], s49 offen offset:1024 lds
  v_mfma_f32_16x16x32_bf16 v[128:131], v[44:47], v[56:59], v[128:131]
  s_mov_b32 s53, 33325192
  buffer_load_dword v244, v235, s[4:7], s53 offen sc1
  v_mfma_f32_16x16x32_bf16 v[132:135], v[44:47], v[60:63], v[132:135]
  s_waitcnt lgkmcnt(1)
  ds_read_b128 v[32:35], v6 offset:36864
  s_add_u32 m0, s46, 139264
  v_mfma_f32_16x16x32_bf16 v[64:67], v[24:27], v[48:51], v[64:67]
  s_add_u32 s48, s44, 1400832
  buffer_load_dwordx4 v1, s[4:7], s48 offen sc1 lds
  v_mfma_f32_16x16x32_bf16 v[68:71], v[24:27], v[52:55], v[68:71]
  s_waitcnt lgkmcnt(1)
  ds_read_b128 v[36:39], v6 offset:37888
  v_mfma_f32_16x16x32_bf16 v[72:75], v[28:31], v[48:51], v[72:75]
  buffer_load_dwordx4 v1, s[4:7], s48 offen offset:1024 sc1 lds
  v_mfma_f32_16x16x32_bf16 v[76:79], v[28:31], v[52:55], v[76:79]
  s_waitcnt lgkmcnt(1)
  ds_read_b128 v[40:43], v6 offset:38912
  v_mfma_f32_16x16x32_bf16 v[80:83], v[32:35], v[48:51], v[80:83]
  ds_read_b128 v[44:47], v6 offset:39936
  v_mfma_f32_16x16x32_bf16 v[84:87], v[32:35], v[52:55], v[84:87]
  s_waitcnt lgkmcnt(2)
  v_mfma_f32_16x16x32_bf16 v[88:91], v[36:39], v[48:51], v[88:91]
  s_mov_b64 exec, 0xffff
  buffer_load_dwordx4 v1, s[4:7], s48 offen offset:2048 sc1 lds
  s_mov_b64 exec, -1
  v_mfma_f32_16x16x32_bf16 v[92:95], v[36:39], v[52:55], v[92:95]
  s_waitcnt lgkmcnt(1)
  ds_read_b128 v[24:27], v6 offset:40960
  v_mfma_f32_16x16x32_bf16 v[96:99], v[40:43], v[48:51], v[96:99]
  ds_read_b128 v[28:31], v6 offset:41984
  v_mfma_f32_16x16x32_bf16 v[100:103], v[40:43], v[52:55], v[100:103]
  s_waitcnt lgkmcnt(2)
  s_add_u32 m0, s47, 139264
  s_add_u32 s49, s45, 1572864
  v_mfma_f32_16x16x32_bf16 v[104:107], v[44:47], v[48:51], v[104:107]
  buffer_load_dwordx4 v2, s[12:15], s49 offen lds
  v_mfma_f32_16x16x32_bf16 v[108:111], v[44:47], v[52:55], v[108:111]
  s_waitcnt lgkmcnt(1)
  ds_read_b128 v[32:35], v6 offset:43008
  v_mfma_f32_16x16x32_bf16 v[112:115], v[24:27], v[48:51], v[112:115]
  v_add_u32 v4, 52224, v4
  ds_read_b64_tr_b16 v[56:57], v4 offset:0
  v_mfma_f32_16x16x32_bf16 v[116:119], v[24:27], v[52:55], v[116:119]
  s_waitcnt lgkmcnt(2)
  ds_read_b64_tr_b16 v[58:59], v4 offset:4096
  v_add_u32 v5, 52224, v5
  v_mfma_f32_16x16x32_bf16 v[120:123], v[28:31], v[48:51], v[120:123]
  ds_read_b64_tr_b16 v[60:61], v5 offset:0
  ds_read_b64_tr_b16 v[62:63], v5 offset:4096
  v_mfma_f32_16x16x32_bf16 v[124:127], v[28:31], v[52:55], v[124:127]
  s_waitcnt lgkmcnt(4)
  ds_read_b128 v[36:39], v6 offset:52224
  ds_read_b128 v[40:43], v6 offset:53248
  v_mfma_f32_16x16x32_bf16 v[128:131], v[32:35], v[48:51], v[128:131]
  buffer_load_dwordx4 v3, s[12:15], s49 offen offset:1024 lds
  v_mfma_f32_16x16x32_bf16 v[132:135], v[32:35], v[52:55], v[132:135]
  s_waitcnt lgkmcnt(1)
  ds_read_b128 v[44:47], v6 offset:54272
  s_add_u32 m0, s46, 0
  v_mfma_f32_16x16x32_bf16 v[64:67], v[36:39], v[56:59], v[64:67]
  s_add_u32 s48, s44, 1437696
  buffer_load_dwordx4 v1, s[4:7], s48 offen sc1 lds
  v_mfma_f32_16x16x32_bf16 v[68:71], v[36:39], v[60:63], v[68:71]
  s_waitcnt lgkmcnt(1)
  buffer_load_dwordx4 v1, s[4:7], s48 offen offset:1024 sc1 lds
  v_mfma_f32_16x16x32_bf16 v[72:75], v[40:43], v[56:59], v[72:75]
  ds_read_b128 v[24:27], v6 offset:55296
  ds_read_b128 v[28:31], v6 offset:56320
  v_mfma_f32_16x16x32_bf16 v[76:79], v[40:43], v[60:63], v[76:79]
  s_waitcnt lgkmcnt(2)
  v_mfma_f32_16x16x32_bf16 v[80:83], v[44:47], v[56:59], v[80:83]
  ds_read_b128 v[32:35], v6 offset:57344
  v_mfma_f32_16x16x32_bf16 v[84:87], v[44:47], v[60:63], v[84:87]
  s_waitcnt lgkmcnt(2)
  s_mov_b64 exec, 0xffff
  buffer_load_dwordx4 v1, s[4:7], s48 offen offset:2048 sc1 lds
  s_mov_b64 exec, -1
  v_mfma_f32_16x16x32_bf16 v[88:91], v[24:27], v[56:59], v[88:91]
  ds_read_b128 v[36:39], v6 offset:58368
  v_mfma_f32_16x16x32_bf16 v[92:95], v[24:27], v[60:63], v[92:95]
  s_waitcnt lgkmcnt(2)
  v_mfma_f32_16x16x32_bf16 v[96:99], v[28:31], v[56:59], v[96:99]
  s_add_u32 m0, s47, 0
  ds_read_b128 v[40:43], v6 offset:59392
  s_add_u32 s49, s45, 1835008
  v_mfma_f32_16x16x32_bf16 v[100:103], v[28:31], v[60:63], v[100:103]
  s_waitcnt lgkmcnt(2)
  buffer_load_dwordx4 v2, s[12:15], s49 offen lds
  v_mfma_f32_16x16x32_bf16 v[104:107], v[32:35], v[56:59], v[104:107]
  ds_read_b128 v[44:47], v6 offset:60416
  v_mfma_f32_16x16x32_bf16 v[108:111], v[32:35], v[60:63], v[108:111]
  s_waitcnt lgkmcnt(2)
  v_mfma_f32_16x16x32_bf16 v[112:115], v[36:39], v[56:59], v[112:115]
  s_waitcnt vmcnt(20)
  s_barrier
  ds_read_b64_tr_b16 v[48:49], v4 offset:17408
  v_mfma_f32_16x16x32_bf16 v[116:119], v[36:39], v[60:63], v[116:119]
  s_waitcnt lgkmcnt(2)
  ds_read_b64_tr_b16 v[50:51], v4 offset:21504
  ds_read_b64_tr_b16 v[52:53], v5 offset:17408
  v_mfma_f32_16x16x32_bf16 v[120:123], v[40:43], v[56:59], v[120:123]
  ds_read_b64_tr_b16 v[54:55], v5 offset:21504
  v_add_u32 v6, 69632, v6
  v_mfma_f32_16x16x32_bf16 v[124:127], v[40:43], v[60:63], v[124:127]
  s_waitcnt lgkmcnt(4)
  ds_read_b128 v[24:27], v6 offset:0
  ds_read_b128 v[28:31], v6 offset:1024
  v_mfma_f32_16x16x32_bf16 v[128:131], v[44:47], v[56:59], v[128:131]
  buffer_load_dwordx4 v3, s[12:15], s49 offen offset:1024 lds
  v_mfma_f32_16x16x32_bf16 v[132:135], v[44:47], v[60:63], v[132:135]
  s_waitcnt lgkmcnt(1)
  s_waitcnt vmcnt(10)
  v_cmp_eq_u32 vcc, 1, v244
  s_nop 4
  s_cmp_eq_u64 vcc, -1
  s_cbranch_scc1 fnet_k2_kernel_dg7_go
  v_add_u32 v236, 24704, v235
  s_mov_b32 s54, 33300488
  s_mov_b32 s55, 0
fnet_k2_kernel_dg7_spin:
  buffer_load_dword v245, v236, s[4:7], s54 offen sc1
  s_waitcnt vmcnt(0)
  v_cmp_eq_u32 vcc, 1, v245
  s_add_u32 s55, s55, 1
  s_nop 3
  s_cmp_eq_u64 vcc, -1
  s_cbranch_scc1 fnet_k2_kernel_dg7_ok
  s_sleep 1
  s_cmp_lt_u32 s55, 262144
  s_cbranch_scc1 fnet_k2_kernel_dg7_spin
fnet_k2_kernel_dg7_ok:
fnet_k2_kernel_dg7_go:
  v_mfma_f32_16x16x32_bf16 v[64:67], v[24:27], v[48:51], v[64:67]
  s_add_u32 m0, s46, 17408
  ds_read_b128 v[32:35], v6 offset:2048
  s_add_u32 s48, s44, 516096
  v_mfma_f32_16x16x32_bf16 v[68:71], v[24:27], v[52:55], v[68:71]
  s_waitcnt lgkmcnt(1)
  buffer_load_dwordx4 v1, s[4:7], s48 offen sc1 lds
  v_mfma_f32_16x16x32_bf16 v[72:75], v[28:31], v[48:51], v[72:75]
  ds_read_b128 v[36:39], v6 offset:3072
  ds_read_b128 v[40:43], v6 offset:4096
  v_mfma_f32_16x16x32_bf16 v[76:79], v[28:31], v[52:55], v[76:79]
  s_waitcnt lgkmcnt(2)
  buffer_load_dwordx4 v1, s[4:7], s48 offen offset:1024 sc1 lds
  v_mfma_f32_16x16x32_bf16 v[80:83], v[32:35], v[48:51], v[80:83]
  ds_read_b128 v[44:47], v6 offset:5120
  v_mfma_f32_16x16x32_bf16 v[84:87], v[32:35], v[52:55], v[84:87]
  s_waitcnt lgkmcnt(2)
  v_mfma_f32_16x16x32_bf16 v[88:91], v[36:39], v[48:51], v[88:91]
  s_mov_b64 exec, 0xffff
  buffer_load_dwordx4 v1, s[4:7], s48 offen offset:2048 sc1 lds
  s_mov_b64 exec, -1
  v_mfma_f32_16x16x32_bf16 v[92:95], v[36:39], v[52:55], v[92:95]
  s_waitcnt lgkmcnt(1)
  ds_read_b128 v[24:27], v6 offset:6144
  v_mfma_f32_16x16x32_bf16 v[96:99], v[40:43], v[48:51], v[96:99]
  ds_read_b128 v[28:31], v6 offset:7168
  v_mfma_f32_16x16x32_bf16 v[100:103], v[40:43], v[52:55], v[100:103]
  s_waitcnt lgkmcnt(2)
  s_add_u32 m0, s47, 17408
  s_add_u32 s49, s45, 3670016
  v_mfma_f32_16x16x32_bf16 v[104:107], v[44:47], v[48:51], v[104:107]
  buffer_load_dwordx4 v2, s[8:11], s49 offen lds
  v_mfma_f32_16x16x32_bf16 v[108:111], v[44:47], v[52:55], v[108:111]
  s_waitcnt lgkmcnt(1)
  ds_read_b128 v[32:35], v6 offset:8192
  v_mfma_f32_16x16x32_bf16 v[112:115], v[24:27], v[48:51], v[112:115]
  ds_read_b64_tr_b16 v[56:57], v4 offset:34816
  ds_read_b64_tr_b16 v[58:59], v4 offset:38912
  v_mfma_f32_16x16x32_bf16 v[116:119], v[24:27], v[52:55], v[116:119]
  s_waitcnt lgkmcnt(3)
  ds_read_b64_tr_b16 v[60:61], v5 offset:34816
  ds_read_b64_tr_b16 v[62:63], v5 offset:38912
  v_mfma_f32_16x16x32_bf16 v[120:123], v[28:31], v[48:51], v[120:123]
  ds_read_b128 v[36:39], v6 offset:17408
  ds_read_b128 v[40:43], v6 offset:18432
  v_mfma_f32_16x16x32_bf16 v[124:127], v[28:31], v[52:55], v[124:127]
  s_waitcnt lgkmcnt(6)
  buffer_load_dwordx4 v3, s[8:11], s49 offen offset:1024 lds
  v_mfma_f32_16x16x32_bf16 v[128:131], v[32:35], v[48:51], v[128:131]
  s_add_u32 m0, s46, 34816
  ds_read_b128 v[44:47], v6 offset:19456
  s_add_u32 s48, s44, 552960
  v_mfma_f32_16x16x32_bf16 v[132:135], v[32:35], v[52:55], v[132:135]
  s_waitcnt lgkmcnt(2)
  buffer_load_dwordx4 v1, s[4:7], s48 offen sc1 lds
  v_mfma_f32_16x16x32_bf16 v[64:67], v[36:39], v[56:59], v[64:67]
  ds_read_b128 v[24:27], v6 offset:20480
  v_mfma_f32_16x16x32_bf16 v[68:71], v[36:39], v[60:63], v[68:71]
  s_waitcnt lgkmcnt(2)
  buffer_load_dwordx4 v1, s[4:7], s48 offen offset:1024 sc1 lds
  v_mfma_f32_16x16x32_bf16 v[72:75], v[40:43], v[56:59], v[72:75]
  ds_read_b128 v[28:31], v6 offset:21504
  v_mfma_f32_16x16x32_bf16 v[76:79], v[40:43], v[60:63], v[76:79]
  s_waitcnt lgkmcnt(2)
  v_mfma_f32_16x16x32_bf16 v[80:83], v[44:47], v[56:59], v[80:83]
  ds_read_b128 v[32:35], v6 offset:22528
  v_mfma_f32_16x16x32_bf16 v[84:87], v[44:47], v[60:63], v[84:87]
  s_waitcnt lgkmcnt(2)
  s_mov_b64 exec, 0xffff
  buffer_load_dwordx4 v1, s[4:7], s48 offen offset:2048 sc1 lds
  s_mov_b64 exec, -1
  v_mfma_f32_16x16x32_bf16 v[88:91], v[24:27], v[56:59], v[88:91]
  ds_read_b128 v[36:39], v6 offset:23552
  v_mfma_f32_16x16x32_bf16 v[92:95], v[24:27], v[60:63], v[92:95]
  s_waitcnt lgkmcnt(2)
  v_mfma_f32_16x16x32_bf16 v[96:99], v[28:31], v[56:59], v[96:99]
  s_add_u32 m0, s47, 34816
  ds_read_b128 v[40:43], v6 offset:24576
  s_add_u32 s49, s45, 3932160
  v_mfma_f32_16x16x32_bf16 v[100:103], v[28:31], v[60:63], v[100:103]
  s_waitcnt lgkmcnt(2)
  buffer_load_dwordx4 v2, s[8:11], s49 offen lds
  v_mfma_f32_16x16x32_bf16 v[104:107], v[32:35], v[56:59], v[104:107]
  ds_read_b128 v[44:47], v6 offset:25600
  v_mfma_f32_16x16x32_bf16 v[108:111], v[32:35], v[60:63], v[108:111]
  s_waitcnt lgkmcnt(2)
  v_mfma_f32_16x16x32_bf16 v[112:115], v[36:39], v[56:59], v[112:115]
  s_barrier
  v_add_u32 v4, 52224, v4
  ds_read_b64_tr_b16 v[48:49], v4 offset:0
  v_mfma_f32_16x16x32_bf16 v[116:119], v[36:39], v[60:63], v[116:119]
  s_waitcnt lgkmcnt(2)
  ds_read_b64_tr_b16 v[50:51], v4 offset:4096
  v_add_u32 v5, 52224, v5
  v_mfma_f32_16x16x32_bf16 v[120:123], v[40:43], v[56:59], v[120:123]
  ds_read_b64_tr_b16 v[52:53], v5 offset:0
  ds_read_b64_tr_b16 v[54:55], v5 offset:4096
  v_mfma_f32_16x16x32_bf16 v[124:127], v[40:43], v[60:63], v[124:127]
  s_waitcnt lgkmcnt(4)
  ds_read_b128 v[24:27], v6 offset:34816
  ds_read_b128 v[28:31], v6 offset:35840
  v_mfma_f32_16x16x32_bf16 v[128:131], v[44:47], v[56:59], v[128:131]
  buffer_load_dwordx4 v3, s[8:11], s49 offen offset:1024 lds
  v_mfma_f32_16x16x32_bf16 v[132:135], v[44:47], v[60:63], v[132:135]
  s_waitcnt lgkmcnt(1)
  ds_read_b128 v[32:35], v6 offset:36864
  s_add_u32 m0, s46, 52224
  v_mfma_f32_16x16x32_bf16 v[64:67], v[24:27], v[48:51], v[64:67]
  s_add_u32 s48, s44, 1695744
  buffer_load_dwordx4 v1, s[4:7], s48 offen sc1 lds
  v_mfma_f32_16x16x32_bf16 v[68:71], v[24:27], v[52:55], v[68:71]
  s_waitcnt lgkmcnt(1)
  buffer_load_dwordx4 v1, s[4:7], s48 offen offset:1024 sc1 lds
  v_mfma_f32_16x16x32_bf16 v[72:75], v[28:31], v[48:51], v[72:75]
  ds_read_b128 v[36:39], v6 offset:37888
  ds_read_b128 v[40:43], v6 offset:38912
  v_mfma_f32_16x16x32_bf16 v[76:79], v[28:31], v[52:55], v[76:79]
  s_waitcnt lgkmcnt(2)
  s_mov_b64 exec, 0xffff
  buffer_load_dwordx4 v1, s[4:7], s48 offen offset:2048 sc1 lds
  s_mov_b64 exec, -1
  v_mfma_f32_16x16x32_bf16 v[80:83], v[32:35], v[48:51], v[80:83]
  ds_read_b128 v[44:47], v6 offset:39936
  v_mfma_f32_16x16x32_bf16 v[84:87], v[32:35], v[52:55], v[84:87]
  s_waitcnt lgkmcnt(2)
  v_mfma_f32_16x16x32_bf16 v[88:91], v[36:39], v[48:51], v[88:91]
  s_add_u32 m0, s47, 52224
  ds_read_b128 v[24:27], v6 offset:40960
  s_add_u32 s49, s45, 3670016
  v_mfma_f32_16x16x32_bf16 v[92:95], v[36:39], v[52:55], v[92:95]
  s_waitcnt lgkmcnt(2)
  buffer_load_dwordx4 v2, s[12:15], s49 offen lds
  v_mfma_f32_16x16x32_bf16 v[96:99], v[40:43], v[48:51], v[96:99]
  ds_read_b128 v[28:31], v6 offset:41984
  v_mfma_f32_16x16x32_bf16 v[100:103], v[40:43], v[52:55], v[100:103]
  s_waitcnt lgkmcnt(2)
  buffer_load_dwordx4 v3, s[12:15], s49 offen offset:1024 lds
  v_mfma_f32_16x16x32_bf16 v[104:107], v[44:47], v[48:51], v[104:107]
  ds_read_b128 v[32:35], v6 offset:43008
  v_mfma_f32_16x16x32_bf16 v[108:111], v[44:47], v[52:55], v[108:111]
  s_waitcnt lgkmcnt(2)
  v_mfma_f32_16x16x32_bf16 v[112:115], v[24:27], v[48:51], v[112:115]
  ds_read_b64_tr_b16 v[56:57], v4 offset:17408
  ds_read_b64_tr_b16 v[58:59], v4 offset:21504
  v_mfma_f32_16x16x32_bf16 v[116:119], v[24:27], v[52:55], v[116:119]
  s_waitcnt lgkmcnt(3)
  ds_read_b64_tr_b16 v[60:61], v5 offset:17408
  ds_read_b64_tr_b16 v[62:63], v5 offset:21504
  v_mfma_f32_16x16x32_bf16 v[120:123], v[28:31], v[48:51], v[120:123]
  s_add_u32 m0, s46, 69632
  ds_read_b128 v[36:39], v6 offset:52224
  s_add_u32 s48, s44, 1732608
  v_mfma_f32_16x16x32_bf16 v[124:127], v[28:31], v[52:55], v[124:127]
  s_waitcnt lgkmcnt(5)
  buffer_load_dwordx4 v1, s[4:7], s48 offen sc1 lds
  v_mfma_f32_16x16x32_bf16 v[128:131], v[32:35], v[48:51], v[128:131]
  ds_read_b128 v[40:43], v6 offset:53248
  ds_read_b128 v[44:47], v6 offset:54272
  v_mfma_f32_16x16x32_bf16 v[132:135], v[32:35], v[52:55], v[132:135]
  s_waitcnt lgkmcnt(2)
  buffer_load_dwordx4 v1, s[4:7], s48 offen offset:1024 sc1 lds
  v_mfma_f32_16x16x32_bf16 v[64:67], v[36:39], v[56:59], v[64:67]
  ds_read_b128 v[24:27], v6 offset:55296
  v_mfma_f32_16x16x32_bf16 v[68:71], v[36:39], v[60:63], v[68:71]
  s_waitcnt lgkmcnt(2)
  s_mov_b64 exec, 0xffff
  buffer_load_dwordx4 v1, s[4:7], s48 offen offset:2048 sc1 lds
  s_mov_b64 exec, -1
  v_mfma_f32_16x16x32_bf16 v[72:75], v[40:43], v[56:59], v[72:75]
  ds_read_b128 v[28:31], v6 offset:56320
  v_mfma_f32_16x16x32_bf16 v[76:79], v[40:43], v[60:63], v[76:79]
  s_waitcnt lgkmcnt(2)
  v_mfma_f32_16x16x32_bf16 v[80:83], v[44:47], v[56:59], v[80:83]
  ds_read_b128 v[32:35], v6 offset:57344
  v_mfma_f32_16x16x32_bf16 v[84:87], v[44:47], v[60:63], v[84:87]
  s_waitcnt lgkmcnt(2)
  s_add_u32 m0, s47, 69632
  s_add_u32 s49, s45, 3932160
  v_mfma_f32_16x16x32_bf16 v[88:91], v[24:27], v[56:59], v[88:91]
  buffer_load_dwordx4 v2, s[12:15], s49 offen lds
  v_mfma_f32_16x16x32_bf16 v[92:95], v[24:27], v[60:63], v[92:95]
  s_waitcnt lgkmcnt(1)
  ds_read_b128 v[36:39], v6 offset:58368
  v_mfma_f32_16x16x32_bf16 v[96:99], v[28:31], v[56:59], v[96:99]
  buffer_load_dwordx4 v3, s[12:15], s49 offen offset:1024 lds
  v_mfma_f32_16x16x32_bf16 v[100:103], v[28:31], v[60:63], v[100:103]
  s_waitcnt lgkmcnt(1)
  ds_read_b128 v[40:43], v6 offset:59392
  v_mfma_f32_16x16x32_bf16 v[104:107], v[32:35], v[56:59], v[104:107]
  ds_read_b128 v[44:47], v6 offset:60416
  v_mfma_f32_16x16x32_bf16 v[108:111], v[32:35], v[60:63], v[108:111]
  s_waitcnt lgkmcnt(2)
  v_mfma_f32_16x16x32_bf16 v[112:115], v[36:39], v[56:59], v[112:115]
  s_waitcnt vmcnt(20)
  s_barrier
  ds_read_b64_tr_b16 v[48:49], v4 offset:34816
  v_mfma_f32_16x16x32_bf16 v[116:119], v[36:39], v[60:63], v[116:119]
  s_waitcnt lgkmcnt(2)
  ds_read_b64_tr_b16 v[50:51], v4 offset:38912
  ds_read_b64_tr_b16 v[52:53], v5 offset:34816
  v_mfma_f32_16x16x32_bf16 v[120:123], v[40:43], v[56:59], v[120:123]
  ds_read_b64_tr_b16 v[54:55], v5 offset:38912
  v_add_u32 v6, 69632, v6
  v_mfma_f32_16x16x32_bf16 v[124:127], v[40:43], v[60:63], v[124:127]
  s_waitcnt lgkmcnt(4)
  ds_read_b128 v[24:27], v6 offset:0
  ds_read_b128 v[28:31], v6 offset:1024
  v_mfma_f32_16x16x32_bf16 v[128:131], v[44:47], v[56:59], v[128:131]
  ds_read_b128 v[32:35], v6 offset:2048
  v_mfma_f32_16x16x32_bf16 v[132:135], v[44:47], v[60:63], v[132:135]
  s_waitcnt lgkmcnt(2)
  v_mfma_f32_16x16x32_bf16 v[64:67], v[24:27], v[48:51], v[64:67]
  ds_read_b128 v[36:39], v6 offset:3072
  v_mfma_f32_16x16x32_bf16 v[68:71], v[24:27], v[52:55], v[68:71]
  s_waitcnt lgkmcnt(2)
  v_mfma_f32_16x16x32_bf16 v[72:75], v[28:31], v[48:51], v[72:75]
  ds_read_b128 v[40:43], v6 offset:4096
  v_mfma_f32_16x16x32_bf16 v[76:79], v[28:31], v[52:55], v[76:79]
  s_waitcnt lgkmcnt(2)
  v_mfma_f32_16x16x32_bf16 v[80:83], v[32:35], v[48:51], v[80:83]
  ds_read_b128 v[44:47], v6 offset:5120
  v_mfma_f32_16x16x32_bf16 v[84:87], v[32:35], v[52:55], v[84:87]
  s_waitcnt lgkmcnt(2)
  v_mfma_f32_16x16x32_bf16 v[88:91], v[36:39], v[48:51], v[88:91]
  ds_read_b128 v[24:27], v6 offset:6144
  v_mfma_f32_16x16x32_bf16 v[92:95], v[36:39], v[52:55], v[92:95]
  s_waitcnt lgkmcnt(2)
  v_mfma_f32_16x16x32_bf16 v[96:99], v[40:43], v[48:51], v[96:99]
  ds_read_b128 v[28:31], v6 offset:7168
  v_mfma_f32_16x16x32_bf16 v[100:103], v[40:43], v[52:55], v[100:103]
  s_waitcnt lgkmcnt(2)
  v_mfma_f32_16x16x32_bf16 v[104:107], v[44:47], v[48:51], v[104:107]
  ds_read_b128 v[32:35], v6 offset:8192
  v_mfma_f32_16x16x32_bf16 v[108:111], v[44:47], v[52:55], v[108:111]
  s_waitcnt lgkmcnt(2)
  v_mfma_f32_16x16x32_bf16 v[112:115], v[24:27], v[48:51], v[112:115]
  v_subrev_u32 v4, 104448, v4
  ds_read_b64_tr_b16 v[56:57], v4 offset:0
  v_mfma_f32_16x16x32_bf16 v[116:119], v[24:27], v[52:55], v[116:119]
  s_waitcnt lgkmcnt(2)
  ds_read_b64_tr_b16 v[58:59], v4 offset:4096
  v_subrev_u32 v5, 104448, v5
  v_mfma_f32_16x16x32_bf16 v[120:123], v[28:31], v[48:51], v[120:123]
  ds_read_b64_tr_b16 v[60:61], v5 offset:0
  ds_read_b64_tr_b16 v[62:63], v5 offset:4096
  v_mfma_f32_16x16x32_bf16 v[124:127], v[28:31], v[52:55], v[124:127]
  s_waitcnt lgkmcnt(4)
  v_subrev_u32 v6, 139264, v6
  ds_read_b128 v[36:39], v6 offset:0
  v_mfma_f32_16x16x32_bf16 v[128:131], v[32:35], v[48:51], v[128:131]
  ds_read_b128 v[40:43], v6 offset:1024
  ds_read_b128 v[44:47], v6 offset:2048
  v_mfma_f32_16x16x32_bf16 v[132:135], v[32:35], v[52:55], v[132:135]
  s_waitcnt lgkmcnt(2)
  v_mfma_f32_16x16x32_bf16 v[64:67], v[36:39], v[56:59], v[64:67]
  ds_read_b128 v[24:27], v6 offset:3072
  v_mfma_f32_16x16x32_bf16 v[68:71], v[36:39], v[60:63], v[68:71]
  s_waitcnt lgkmcnt(2)
  v_mfma_f32_16x16x32_bf16 v[72:75], v[40:43], v[56:59], v[72:75]
  ds_read_b128 v[28:31], v6 offset:4096
  v_mfma_f32_16x16x32_bf16 v[76:79], v[40:43], v[60:63], v[76:79]
  s_waitcnt lgkmcnt(2)
  v_mfma_f32_16x16x32_bf16 v[80:83], v[44:47], v[56:59], v[80:83]
  ds_read_b128 v[32:35], v6 offset:5120
  v_mfma_f32_16x16x32_bf16 v[84:87], v[44:47], v[60:63], v[84:87]
  s_waitcnt lgkmcnt(2)
  v_mfma_f32_16x16x32_bf16 v[88:91], v[24:27], v[56:59], v[88:91]
  ds_read_b128 v[36:39], v6 offset:6144
  v_mfma_f32_16x16x32_bf16 v[92:95], v[24:27], v[60:63], v[92:95]
  s_waitcnt lgkmcnt(2)
  v_mfma_f32_16x16x32_bf16 v[96:99], v[28:31], v[56:59], v[96:99]
  ds_read_b128 v[40:43], v6 offset:7168
  v_mfma_f32_16x16x32_bf16 v[100:103], v[28:31], v[60:63], v[100:103]
  s_waitcnt lgkmcnt(2)
  v_mfma_f32_16x16x32_bf16 v[104:107], v[32:35], v[56:59], v[104:107]
  ds_read_b128 v[44:47], v6 offset:8192
  v_mfma_f32_16x16x32_bf16 v[108:111], v[32:35], v[60:63], v[108:111]
  s_waitcnt lgkmcnt(2)
  v_mfma_f32_16x16x32_bf16 v[112:115], v[36:39], v[56:59], v[112:115]
  s_waitcnt vmcnt(10)
  s_barrier
  ds_read_b64_tr_b16 v[48:49], v4 offset:17408
  v_mfma_f32_16x16x32_bf16 v[116:119], v[36:39], v[60:63], v[116:119]
  s_waitcnt lgkmcnt(2)
  ds_read_b64_tr_b16 v[50:51], v4 offset:21504
  ds_read_b64_tr_b16 v[52:53], v5 offset:17408
  v_mfma_f32_16x16x32_bf16 v[120:123], v[40:43], v[56:59], v[120:123]
  ds_read_b64_tr_b16 v[54:55], v5 offset:21504
  ds_read_b128 v[24:27], v6 offset:17408
  v_mfma_f32_16x16x32_bf16 v[124:127], v[40:43], v[60:63], v[124:127]
  s_waitcnt lgkmcnt(5)
  ds_read_b128 v[28:31], v6 offset:18432
  v_mfma_f32_16x16x32_bf16 v[128:131], v[44:47], v[56:59], v[128:131]
  ds_read_b128 v[32:35], v6 offset:19456
  v_mfma_f32_16x16x32_bf16 v[132:135], v[44:47], v[60:63], v[132:135]
  s_waitcnt lgkmcnt(2)
  v_mfma_f32_16x16x32_bf16 v[64:67], v[24:27], v[48:51], v[64:67]
  ds_read_b128 v[36:39], v6 offset:20480
  v_mfma_f32_16x16x32_bf16 v[68:71], v[24:27], v[52:55], v[68:71]
  s_waitcnt lgkmcnt(2)
  v_mfma_f32_16x16x32_bf16 v[72:75], v[28:31], v[48:51], v[72:75]
  ds_read_b128 v[40:43], v6 offset:21504
  v_mfma_f32_16x16x32_bf16 v[76:79], v[28:31], v[52:55], v[76:79]
  s_waitcnt lgkmcnt(2)
  v_mfma_f32_16x16x32_bf16 v[80:83], v[32:35], v[48:51], v[80:83]
  ds_read_b128 v[44:47], v6 offset:22528
  v_mfma_f32_16x16x32_bf16 v[84:87], v[32:35], v[52:55], v[84:87]
  s_waitcnt lgkmcnt(2)
  v_mfma_f32_16x16x32_bf16 v[88:91], v[36:39], v[48:51], v[88:91]
  ds_read_b128 v[24:27], v6 offset:23552
  v_mfma_f32_16x16x32_bf16 v[92:95], v[36:39], v[52:55], v[92:95]
  s_waitcnt lgkmcnt(2)
  v_mfma_f32_16x16x32_bf16 v[96:99], v[40:43], v[48:51], v[96:99]
  ds_read_b128 v[28:31], v6 offset:24576
  v_mfma_f32_16x16x32_bf16 v[100:103], v[40:43], v[52:55], v[100:103]
  s_waitcnt lgkmcnt(2)
  v_mfma_f32_16x16x32_bf16 v[104:107], v[44:47], v[48:51], v[104:107]
  ds_read_b128 v[32:35], v6 offset:25600
  v_mfma_f32_16x16x32_bf16 v[108:111], v[44:47], v[52:55], v[108:111]
  s_waitcnt lgkmcnt(2)
  v_mfma_f32_16x16x32_bf16 v[112:115], v[24:27], v[48:51], v[112:115]
  ds_read_b64_tr_b16 v[56:57], v4 offset:34816
  ds_read_b64_tr_b16 v[58:59], v4 offset:38912
  v_mfma_f32_16x16x32_bf16 v[116:119], v[24:27], v[52:55], v[116:119]
  s_waitcnt lgkmcnt(3)
  ds_read_b64_tr_b16 v[60:61], v5 offset:34816
  ds_read_b64_tr_b16 v[62:63], v5 offset:38912
  v_mfma_f32_16x16x32_bf16 v[120:123], v[28:31], v[48:51], v[120:123]
  ds_read_b128 v[36:39], v6 offset:34816
  ds_read_b128 v[40:43], v6 offset:35840
  v_mfma_f32_16x16x32_bf16 v[124:127], v[28:31], v[52:55], v[124:127]
  s_waitcnt lgkmcnt(6)
  v_mfma_f32_16x16x32_bf16 v[128:131], v[32:35], v[48:51], v[128:131]
  ds_read_b128 v[44:47], v6 offset:36864
  v_mfma_f32_16x16x32_bf16 v[132:135], v[32:35], v[52:55], v[132:135]
  s_waitcnt lgkmcnt(2)
  v_mfma_f32_16x16x32_bf16 v[64:67], v[36:39], v[56:59], v[64:67]
  ds_read_b128 v[24:27], v6 offset:37888
  v_mfma_f32_16x16x32_bf16 v[68:71], v[36:39], v[60:63], v[68:71]
  s_waitcnt lgkmcnt(2)
  v_mfma_f32_16x16x32_bf16 v[72:75], v[40:43], v[56:59], v[72:75]
  ds_read_b128 v[28:31], v6 offset:38912
  v_mfma_f32_16x16x32_bf16 v[76:79], v[40:43], v[60:63], v[76:79]
  s_waitcnt lgkmcnt(2)
  v_mfma_f32_16x16x32_bf16 v[80:83], v[44:47], v[56:59], v[80:83]
  ds_read_b128 v[32:35], v6 offset:39936
  v_mfma_f32_16x16x32_bf16 v[84:87], v[44:47], v[60:63], v[84:87]
  s_waitcnt lgkmcnt(2)
  v_mfma_f32_16x16x32_bf16 v[88:91], v[24:27], v[56:59], v[88:91]
  ds_read_b128 v[36:39], v6 offset:40960
  v_mfma_f32_16x16x32_bf16 v[92:95], v[24:27], v[60:63], v[92:95]
  s_waitcnt lgkmcnt(2)
  v_mfma_f32_16x16x32_bf16 v[96:99], v[28:31], v[56:59], v[96:99]
  ds_read_b128 v[40:43], v6 offset:41984
  v_mfma_f32_16x16x32_bf16 v[100:103], v[28:31], v[60:63], v[100:103]
  s_waitcnt lgkmcnt(2)
  v_mfma_f32_16x16x32_bf16 v[104:107], v[32:35], v[56:59], v[104:107]
  ds_read_b128 v[44:47], v6 offset:43008
  v_mfma_f32_16x16x32_bf16 v[108:111], v[32:35], v[60:63], v[108:111]
  s_waitcnt lgkmcnt(2)
  v_mfma_f32_16x16x32_bf16 v[112:115], v[36:39], v[56:59], v[112:115]
  s_waitcnt vmcnt(0)
  s_barrier
  v_add_u32 v4, 52224, v4
  v_mfma_f32_16x16x32_bf16 v[116:119], v[36:39], v[60:63], v[116:119]
  s_waitcnt lgkmcnt(1)
  ds_read_b64_tr_b16 v[48:49], v4 offset:0
  ds_read_b64_tr_b16 v[50:51], v4 offset:4096
  v_mfma_f32_16x16x32_bf16 v[120:123], v[40:43], v[56:59], v[120:123]
  v_add_u32 v5, 52224, v5
  ds_read_b64_tr_b16 v[52:53], v5 offset:0
  v_mfma_f32_16x16x32_bf16 v[124:127], v[40:43], v[60:63], v[124:127]
  s_waitcnt lgkmcnt(3)
  ds_read_b64_tr_b16 v[54:55], v5 offset:4096
  ds_read_b128 v[24:27], v6 offset:52224
  v_mfma_f32_16x16x32_bf16 v[128:131], v[44:47], v[56:59], v[128:131]
  ds_read_b128 v[28:31], v6 offset:53248
  ds_read_b128 v[32:35], v6 offset:54272
  v_mfma_f32_16x16x32_bf16 v[132:135], v[44:47], v[60:63], v[132:135]
  s_waitcnt lgkmcnt(2)
  v_mfma_f32_16x16x32_bf16 v[64:67], v[24:27], v[48:51], v[64:67]
  ds_read_b128 v[36:39], v6 offset:55296
  v_mfma_f32_16x16x32_bf16 v[68:71], v[24:27], v[52:55], v[68:71]
  s_waitcnt lgkmcnt(2)
  v_mfma_f32_16x16x32_bf16 v[72:75], v[28:31], v[48:51], v[72:75]
  ds_read_b128 v[40:43], v6 offset:56320
  v_mfma_f32_16x16x32_bf16 v[76:79], v[28:31], v[52:55], v[76:79]
  s_waitcnt lgkmcnt(2)
  v_mfma_f32_16x16x32_bf16 v[80:83], v[32:35], v[48:51], v[80:83]
  ds_read_b128 v[44:47], v6 offset:57344
  v_mfma_f32_16x16x32_bf16 v[84:87], v[32:35], v[52:55], v[84:87]
  s_waitcnt lgkmcnt(2)
  v_mfma_f32_16x16x32_bf16 v[88:91], v[36:39], v[48:51], v[88:91]
  ds_read_b128 v[24:27], v6 offset:58368
  v_mfma_f32_16x16x32_bf16 v[92:95], v[36:39], v[52:55], v[92:95]
  s_waitcnt lgkmcnt(2)
  v_mfma_f32_16x16x32_bf16 v[96:99], v[40:43], v[48:51], v[96:99]
  ds_read_b128 v[28:31], v6 offset:59392
  v_mfma_f32_16x16x32_bf16 v[100:103], v[40:43], v[52:55], v[100:103]
  s_waitcnt lgkmcnt(2)
  v_mfma_f32_16x16x32_bf16 v[104:107], v[44:47], v[48:51], v[104:107]
  ds_read_b128 v[32:35], v6 offset:60416
  v_mfma_f32_16x16x32_bf16 v[108:111], v[44:47], v[52:55], v[108:111]
  s_waitcnt lgkmcnt(2)
  v_mfma_f32_16x16x32_bf16 v[112:115], v[24:27], v[48:51], v[112:115]
  ds_read_b64_tr_b16 v[56:57], v4 offset:17408
  ds_read_b64_tr_b16 v[58:59], v4 offset:21504
  v_mfma_f32_16x16x32_bf16 v[116:119], v[24:27], v[52:55], v[116:119]
  s_waitcnt lgkmcnt(3)
  ds_read_b64_tr_b16 v[60:61], v5 offset:17408
  ds_read_b64_tr_b16 v[62:63], v5 offset:21504
  v_mfma_f32_16x16x32_bf16 v[120:123], v[28:31], v[48:51], v[120:123]
  v_add_u32 v6, 69632, v6
  ds_read_b128 v[36:39], v6 offset:0
  v_mfma_f32_16x16x32_bf16 v[124:127], v[28:31], v[52:55], v[124:127]
  s_waitcnt lgkmcnt(5)
  ds_read_b128 v[40:43], v6 offset:1024
  v_mfma_f32_16x16x32_bf16 v[128:131], v[32:35], v[48:51], v[128:131]
  ds_read_b128 v[44:47], v6 offset:2048
  v_mfma_f32_16x16x32_bf16 v[132:135], v[32:35], v[52:55], v[132:135]
  s_waitcnt lgkmcnt(2)
  v_mfma_f32_16x16x32_bf16 v[64:67], v[36:39], v[56:59], v[64:67]
  ds_read_b128 v[24:27], v6 offset:3072
  v_mfma_f32_16x16x32_bf16 v[68:71], v[36:39], v[60:63], v[68:71]
  s_waitcnt lgkmcnt(2)
  v_mfma_f32_16x16x32_bf16 v[72:75], v[40:43], v[56:59], v[72:75]
  ds_read_b128 v[28:31], v6 offset:4096
  v_mfma_f32_16x16x32_bf16 v[76:79], v[40:43], v[60:63], v[76:79]
  s_waitcnt lgkmcnt(2)
  v_mfma_f32_16x16x32_bf16 v[80:83], v[44:47], v[56:59], v[80:83]
  ds_read_b128 v[32:35], v6 offset:5120
  v_mfma_f32_16x16x32_bf16 v[84:87], v[44:47], v[60:63], v[84:87]
  s_waitcnt lgkmcnt(2)
  v_mfma_f32_16x16x32_bf16 v[88:91], v[24:27], v[56:59], v[88:91]
  ds_read_b128 v[36:39], v6 offset:6144
  v_mfma_f32_16x16x32_bf16 v[92:95], v[24:27], v[60:63], v[92:95]
  s_waitcnt lgkmcnt(2)
  v_mfma_f32_16x16x32_bf16 v[96:99], v[28:31], v[56:59], v[96:99]
  ds_read_b128 v[40:43], v6 offset:7168
  v_mfma_f32_16x16x32_bf16 v[100:103], v[28:31], v[60:63], v[100:103]
  s_waitcnt lgkmcnt(2)
  v_mfma_f32_16x16x32_bf16 v[104:107], v[32:35], v[56:59], v[104:107]
  ds_read_b128 v[44:47], v6 offset:8192
  v_mfma_f32_16x16x32_bf16 v[108:111], v[32:35], v[60:63], v[108:111]
  s_waitcnt lgkmcnt(2)
  v_mfma_f32_16x16x32_bf16 v[112:115], v[36:39], v[56:59], v[112:115]
  v_mfma_f32_16x16x32_bf16 v[116:119], v[36:39], v[60:63], v[116:119]
  s_waitcnt lgkmcnt(1)
  v_mfma_f32_16x16x32_bf16 v[120:123], v[40:43], v[56:59], v[120:123]
  v_mfma_f32_16x16x32_bf16 v[124:127], v[40:43], v[60:63], v[124:127]
  s_waitcnt lgkmcnt(0)
  v_mfma_f32_16x16x32_bf16 v[128:131], v[44:47], v[56:59], v[128:131]
  v_mfma_f32_16x16x32_bf16 v[132:135], v[44:47], v[60:63], v[132:135]
  v_lshlrev_b32 v12, 3, v0
  s_bitcmp1_b32 s51, 0
  s_cbranch_scc1 fnet_k2_kernel_odd
  s_add_u32 s63, s51, 0
  s_lshr_b32 s64, s63, 1
  s_lshl_b32 s64, s64, 10
  s_add_u32 s64, s64, s50
  s_add_u32 s65, s64, 18432
  v_cvt_pk_bf16_f32 v140, v64, v65
  v_cvt_pk_bf16_f32 v141, v66, v67
  v_cvt_pk_bf16_f32 v142, v72, v73
  v_cvt_pk_bf16_f32 v143, v74, v75
  buffer_store_dwordx4 v[140:143], v1, s[4:7], s64 offen sc1
  v_cvt_pk_bf16_f32 v144, v68, v69
  v_cvt_pk_bf16_f32 v145, v70, v71
  v_cvt_pk_bf16_f32 v146, v76, v77
  v_cvt_pk_bf16_f32 v147, v78, v79
  buffer_store_dwordx4 v[144:147], v1, s[4:7], s65 offen sc1
  s_add_u32 s63, s51, 2
  s_lshr_b32 s64, s63, 1
  s_lshl_b32 s64, s64, 10
  s_add_u32 s64, s64, s50
  s_add_u32 s65, s64, 18432
  v_cvt_pk_bf16_f32 v148, v80, v81
  v_cvt_pk_bf16_f32 v149, v82, v83
  v_cvt_pk_bf16_f32 v150, v88, v89
  v_cvt_pk_bf16_f32 v151, v90, v91
  buffer_store_dwordx4 v[148:151], v1, s[4:7], s64 offen sc1
  v_cvt_pk_bf16_f32 v152, v84, v85
  v_cvt_pk_bf16_f32 v153, v86, v87
  v_cvt_pk_bf16_f32 v154, v92, v93
  v_cvt_pk_bf16_f32 v155, v94, v95
  buffer_store_dwordx4 v[152:155], v1, s[4:7], s65 offen sc1
  s_add_u32 s63, s51, 4
  s_lshr_b32 s64, s63, 1
  s_lshl_b32 s64, s64, 10
  s_add_u32 s64, s64, s50
  s_add_u32 s65, s64, 18432
  v_cvt_pk_bf16_f32 v140, v96, v97
  v_cvt_pk_bf16_f32 v141, v98, v99
  v_cvt_pk_bf16_f32 v142, v104, v105
  v_cvt_pk_bf16_f32 v143, v106, v107
  buffer_store_dwordx4 v[140:143], v1, s[4:7], s64 offen sc1
  v_cvt_pk_bf16_f32 v144, v100, v101
  v_cvt_pk_bf16_f32 v145, v102, v103
  v_cvt_pk_bf16_f32 v146, v108, v109
  v_cvt_pk_bf16_f32 v147, v110, v111
  buffer_store_dwordx4 v[144:147], v1, s[4:7], s65 offen sc1
  s_add_u32 s63, s51, 6
  s_lshr_b32 s64, s63, 1
  s_lshl_b32 s64, s64, 10
  s_add_u32 s64, s64, s50
  s_add_u32 s65, s64, 18432
  v_cvt_pk_bf16_f32 v148, v112, v113
  v_cvt_pk_bf16_f32 v149, v114, v115
  v_cvt_pk_bf16_f32 v150, v120, v121
  v_cvt_pk_bf16_f32 v151, v122, v123
  buffer_store_dwordx4 v[148:151], v1, s[4:7], s64 offen sc1
  v_cvt_pk_bf16_f32 v152, v116, v117
  v_cvt_pk_bf16_f32 v153, v118, v119
  v_cvt_pk_bf16_f32 v154, v124, v125
  v_cvt_pk_bf16_f32 v155, v126, v127
  buffer_store_dwordx4 v[152:155], v1, s[4:7], s65 offen sc1
  s_add_u32 s63, s51, 8
  s_lshr_b32 s64, s63, 1
  s_lshl_b32 s64, s64, 10
  s_add_u32 s64, s64, s50
  s_add_u32 s65, s64, 18432
  s_mov_b32 s64, s58
  s_add_u32 s65, s58, 2048
  v_cvt_pk_bf16_f32 v140, v128, v129
  v_cvt_pk_bf16_f32 v141, v130, v131
  buffer_store_dwordx2 v[140:141], v12, s[4:7], s64 offen sc1
  v_cvt_pk_bf16_f32 v144, v132, v133
  v_cvt_pk_bf16_f32 v145, v134, v135
  buffer_store_dwordx2 v[144:145], v12, s[4:7], s65 offen sc1
  s_branch fnet_k2_kernel_stored
fnet_k2_kernel_odd:
  s_add_u32 s63, s51, 0
  s_lshr_b32 s64, s63, 1
  s_lshl_b32 s64, s64, 10
  s_add_u32 s64, s64, 8
  s_add_u32 s64, s64, s50
  s_add_u32 s65, s64, 18432
  s_mov_b32 s64, s58
  s_add_u32 s65, s58, 2048
  v_cvt_pk_bf16_f32 v140, v64, v65
  v_cvt_pk_bf16_f32 v141, v66, v67
  buffer_store_dwordx2 v[140:141], v12, s[4:7], s64 offen sc1
  v_cvt_pk_bf16_f32 v144, v68, v69
  v_cvt_pk_bf16_f32 v145, v70, v71
  buffer_store_dwordx2 v[144:145], v12, s[4:7], s65 offen sc1
  s_add_u32 s63, s51, 1
  s_lshr_b32 s64, s63, 1
  s_lshl_b32 s64, s64, 10
  s_add_u32 s64, s64, s50
  s_add_u32 s65, s64, 18432
  v_cvt_pk_bf16_f32 v148, v72, v73
  v_cvt_pk_bf16_f32 v149, v74, v75
  v_cvt_pk_bf16_f32 v150, v80, v81
  v_cvt_pk_bf16_f32 v151, v82, v83
  buffer_store_dwordx4 v[148:151], v1, s[4:7], s64 offen sc1
  v_cvt_pk_bf16_f32 v152, v76, v77
  v_cvt_pk_bf16_f32 v153, v78, v79
  v_cvt_pk_bf16_f32 v154, v84, v85
  v_cvt_pk_bf16_f32 v155, v86, v87
  buffer_store_dwordx4 v[152:155], v1, s[4:7], s65 offen sc1
  s_add_u32 s63, s51, 3
  s_lshr_b32 s64, s63, 1
  s_lshl_b32 s64, s64, 10
  s_add_u32 s64, s64, s50
  s_add_u32 s65, s64, 18432
  v_cvt_pk_bf16_f32 v140, v88, v89
  v_cvt_pk_bf16_f32 v141, v90, v91
  v_cvt_pk_bf16_f32 v142, v96, v97
  v_cvt_pk_bf16_f32 v143, v98, v99
  buffer_store_dwordx4 v[140:143], v1, s[4:7], s64 offen sc1
  v_cvt_pk_bf16_f32 v144, v92, v93
  v_cvt_pk_bf16_f32 v145, v94, v95
  v_cvt_pk_bf16_f32 v146, v100, v101
  v_cvt_pk_bf16_f32 v147, v102, v103
  buffer_store_dwordx4 v[144:147], v1, s[4:7], s65 offen sc1
  s_add_u32 s63, s51, 5
  s_lshr_b32 s64, s63, 1
  s_lshl_b32 s64, s64, 10
  s_add_u32 s64, s64, s50
  s_add_u32 s65, s64, 18432
  v_cvt_pk_bf16_f32 v148, v104, v105
  v_cvt_pk_bf16_f32 v149, v106, v107
  v_cvt_pk_bf16_f32 v150, v112, v113
  v_cvt_pk_bf16_f32 v151, v114, v115
  buffer_store_dwordx4 v[148:151], v1, s[4:7], s64 offen sc1
  v_cvt_pk_bf16_f32 v152, v108, v109
  v_cvt_pk_bf16_f32 v153, v110, v111
  v_cvt_pk_bf16_f32 v154, v116, v117
  v_cvt_pk_bf16_f32 v155, v118, v119
  buffer_store_dwordx4 v[152:155], v1, s[4:7], s65 offen sc1
  s_add_u32 s63, s51, 7
  s_lshr_b32 s64, s63, 1
  s_lshl_b32 s64, s64, 10
  s_add_u32 s64, s64, s50
  s_add_u32 s65, s64, 18432
  v_cvt_pk_bf16_f32 v140, v120, v121
  v_cvt_pk_bf16_f32 v141, v122, v123
  v_cvt_pk_bf16_f32 v142, v128, v129
  v_cvt_pk_bf16_f32 v143, v130, v131
  buffer_store_dwordx4 v[140:143], v1, s[4:7], s64 offen sc1
  v_cvt_pk_bf16_f32 v144, v124, v125
  v_cvt_pk_bf16_f32 v145, v126, v127
  v_cvt_pk_bf16_f32 v146, v132, v133
  v_cvt_pk_bf16_f32 v147, v134, v135
  buffer_store_dwordx4 v[144:147], v1, s[4:7], s65 offen sc1
fnet_k2_kernel_stored:
  s_waitcnt vmcnt(0)
  s_waitcnt vmcnt(0)
  s_barrier
  s_lshl_b32 s63, s2, 7
  s_add_u32 s63, s63, 33300484
  v_mov_b32 v2, 1
  v_mov_b32 v3, 0
  s_cmp_lg_u32 s40, 0
  s_cbranch_scc1 fnet_k2_kernel_pub2
  s_mov_b64 exec, 1
  buffer_store_dword v2, v3, s[4:7], s63 offen sc1
  s_mov_b64 exec, -1
fnet_k2_kernel_pub2:
gated_mix__spectral_fnet__swiglu_ffn__prompt_kernel_end:
  s_endpgm
.section .rodata,"a"
.p2align 6
.amdhsa_kernel gated_mix__spectral_fnet__swiglu_ffn__prompt_kernel
  .amdhsa_next_free_vgpr 512
  .amdhsa_next_free_sgpr 102
  .amdhsa_accum_offset 256
  .amdhsa_group_segment_fixed_size 0
  .amdhsa_kernarg_size 104
  .amdhsa_user_sgpr_count 2
  .amdhsa_user_sgpr_kernarg_segment_ptr 1
  .amdhsa_system_sgpr_workgroup_id_x 1
.end_amdhsa_kernel
```
